```python
import torch

def _softmax(x, axis=-1):
    return torch.softmax(x, dim=axis)

def _gelu(x):
    return torch.nn.functional.gelu(x, approximate='tanh')

def _silu(x):
    return torch.nn.functional.silu(x)

def _sigmoid(x):
    return torch.sigmoid(x)

def _layernorm(x, axis=-1, eps=1e-05):
    m = x.mean(dim=axis, keepdim=True)
    v = x.var(dim=axis, keepdim=True, unbiased=False)
    return (x - m) / torch.sqrt(v + eps)

def _scatter_add(tgt, idx, src, axis=0):
    return tgt.clone().index_add_(axis, idx, src)

def _segment_sum(src, seg, n):
    out = torch.zeros((n,) + src.shape[1:], dtype=src.dtype)
    return out.index_add_(0, seg, src)

def _pad(x, pw):
    flat = tuple((v for pair in reversed(pw) for v in pair))
    return torch.nn.functional.pad(x, flat)
kernel_name = 'adaLN_cond__ssm_conv_h3__mixer_s_mlp__prompt'

def setup_inputs():

    _w = lambda a: (lambda t: t.to(torch.bfloat16) if t.is_floating_point() else t)(torch.as_tensor(a))

    def _A_setup():
        B, S, D = (1, 2048, 576)
        ks = 4
        return {'q': _w((lambda *s: torch.randn(*s, dtype=torch.bfloat16) * 0.05)(B, S, D)), 'k': _w((lambda *s: torch.randn(*s, dtype=torch.bfloat16) * 0.8)(B, S, D)), 'v': _w((lambda *s: torch.randn(*s, dtype=torch.bfloat16) * 0.8)(B, S, D)), 'shift_k': _w((lambda *s: torch.randn(*s, dtype=torch.bfloat16) * 0.8)(D, ks) * 0.5), 'ssm_k': _w((lambda *s: torch.randn(*s, dtype=torch.bfloat16) * 0.8)(D, S) * (1.0 / S ** 0.5)), 'ssm_D': _w((lambda *s: torch.randn(*s, dtype=torch.bfloat16) * 0.8)(D))}
    _A_in = _A_setup()

    def _B_setup():
        B, S, D, F = (1, 2048, 576, 4608)
        return {'x': _w((lambda *s: torch.randn(*s, dtype=torch.bfloat16) * 0.05)(B, S, D)), 'w1': _w((lambda *s: torch.randn(*s, dtype=torch.bfloat16) * 3.2)(D, D) * D ** (-0.5)), 'w2': _w((lambda *s: torch.randn(*s, dtype=torch.bfloat16) * 3.2)(D, D) * D ** (-0.5)), 'w3': _w((lambda *s: torch.randn(*s, dtype=torch.bfloat16) * 3.2)(D, F) * D ** (-0.5)), 'w4': _w((lambda *s: torch.randn(*s, dtype=torch.bfloat16) * 1.6)(F, D) * F ** (-0.5))}
    _B_in = _B_setup()
    return {'A_q': _A_in['q'], 'A_k': _A_in['k'], 'A_v': _A_in['v'], 'A_shift_k': _A_in['shift_k'], 'A_ssm_k': _A_in['ssm_k'], 'A_ssm_D': _A_in['ssm_D'], 'B_x': _B_in['x'], 'B_w1': _B_in['w1'], 'B_w2': _B_in['w2'], 'B_w3': _B_in['w3'], 'B_w4': _B_in['w4'], 'c': _w((lambda *s: torch.randn(*s, dtype=torch.bfloat16) * 0.1)(1, 576) * 8.0), 'w_mod': _w((lambda *s: torch.randn(*s, dtype=torch.bfloat16) * 0.1)(576, 6 * 576) * 576 ** (-0.5) * 8.0)}

def reference(A_q, A_k, A_v, A_shift_k, A_ssm_k, A_ssm_D, B_x, B_w1, B_w2, B_w3, B_w4, c, w_mod):

    def _A_ref(q, k, v, shift_k, ssm_k, ssm_D):
        B, S, D = q.shape
        ks = shift_k.shape[-1]
        k_pad = _pad(k, ((0, 0), (ks - 1, 0), (0, 0)))
        k_shift = torch.zeros_like(k)
        for t in range(ks):
            k_shift = k_shift + k_pad[:, t:t + S, :] * shift_k[:, ks - 1 - t][None, None, :]
        kv = k_shift * v
        L = 2 * S
        kv_pad = _pad(kv, ((0, 0), (0, S), (0, 0)))
        kf_pad = _pad(ssm_k, ((0, 0), (0, S)))
        kv_f = (lambda x, axes=(-2, -1): torch.fft.rfft2(x.float(), dim=axes))(kv_pad[:, None, :, :], axes=(1, 2))
        kf_f = (lambda x, axes=(-2, -1): torch.fft.rfft2(x.float(), dim=axes))(kf_pad[:, None, :], axes=(1, 2))
        kf_f = (lambda x, *d: x.permute(*d))(kf_f, 1, 2, 0)
        y_f = kv_f * kf_f[None, :, :, :]
        y = (lambda x, s, axes=(-2, -1): torch.fft.irfft2(x, s=s, dim=axes).to(torch.bfloat16))(y_f, (1, L), axes=(1, 2))[:, 0, :S, :]
        y = y + kv * ssm_D[None, None, :]
        return q * y

    def _B_ref(x, w1, w2, w3, w4):
        B, S, D = x.shape
        h = _gelu(_layernorm(x, axis=-1) @ w1)
        c = D // 4
        g0 = _pad(h[:, :, 0 * c:1 * c], ((0, 0), (1, 0), (0, 0)))[:, :S, :]
        g1 = _pad(h[:, :, 1 * c:2 * c], ((0, 0), (0, 1), (0, 0)))[:, 1:, :]
        g2 = _pad(h[:, :, 2 * c:3 * c], ((0, 0), (2, 0), (0, 0)))[:, :S, :]
        g3 = _pad(h[:, :, 3 * c:], ((0, 0), (0, 2), (0, 0)))[:, 2:, :]
        hs = torch.concatenate([g0, g1, g2, g3], axis=-1) @ w2
        x1 = x + hs
        h2 = _gelu(_layernorm(x1, axis=-1) @ w3) @ w4
        return x1 + h2
    x = A_q
    mod = (_silu(c) @ w_mod).reshape(c.shape[0], 6, 1, -1)
    sa, ca, ga, sb, cb, gb = (mod[:, 0].clone(), mod[:, 1].clone(), mod[:, 2].clone(), mod[:, 3].clone(), mod[:, 4].clone(), mod[:, 5].clone())
    h = _layernorm(x, axis=-1) * (1 + ca) + sa
    x = x + ga * _A_ref(h, A_k, A_v, A_shift_k, A_ssm_k, A_ssm_D)
    h = _layernorm(x, axis=-1) * (1 + cb) + sb
    x = x + gb * _B_ref(h, B_w1, B_w2, B_w3, B_w4)
    return x
```

```asm
; @launch kernel=k2_kernel grid=(256,1,1) block=(256,1,1) lds=89344
; @launch kernel=k3_kernel grid=(256,1,1) block=(576,1,1) lds=119808
; @launch kernel=k5_kernel grid=(256,1,1) block=(256,1,1) lds=148480
.amdgcn_target "amdgcn-amd-amdhsa--gfx950"
.text
.globl k2_kernel
.p2align 8
.type k2_kernel,@function
k2_kernel:
    s_cmp_ge_u32 s2, 256
    s_cbranch_scc1 K2_END
    s_load_dwordx16 s[16:31], s[0:1], 0
    s_load_dwordx16 s[32:47], s[0:1], 64
    s_getpc_b64 s[4:5]
K2_PC0:
    s_sub_u32 s4, s4, K2_PC0 - k2_kernel
    s_subb_u32 s5, s5, 0
    s_mov_b32 s6, k3_kernel - k2_kernel
    s_mov_b32 s7, 0x20000
    v_lshlrev_b32 v2, 4, v0
    buffer_load_dwordx4 v[200:203], v2, s[4:7], 0 offen
    v_add_u32 v2, 4096, v2
    buffer_load_dwordx4 v[200:203], v2, s[4:7], 0 offen
    v_add_u32 v2, 4096, v2
    buffer_load_dwordx4 v[200:203], v2, s[4:7], 0 offen
    v_add_u32 v2, 4096, v2
    buffer_load_dwordx4 v[200:203], v2, s[4:7], 0 offen
    v_add_u32 v2, 4096, v2
    buffer_load_dwordx4 v[200:203], v2, s[4:7], 0 offen
    v_add_u32 v2, 4096, v2
    buffer_load_dwordx4 v[200:203], v2, s[4:7], 0 offen
    v_add_u32 v2, 4096, v2
    buffer_load_dwordx4 v[200:203], v2, s[4:7], 0 offen
    v_lshrrev_b32 v1, 6, v0
    s_nop 0
    v_readfirstlane_b32 s3, v1
    v_and_b32 v1, 63, v0
    s_cmp_ge_u32 s2, 144
    s_cbranch_scc1 K2_EXTRA
    s_mul_i32 s4, s2, 57
    s_lshr_b32 s4, s4, 9
    s_mul_i32 s5, s4, 9
    s_sub_u32 s5, s2, s5
    v_lshrrev_b32 v2, 3, v1
    v_and_b32 v3, 7, v1
    s_lshl_b32 s6, s4, 7
    s_lshl_b32 s7, s3, 5
    s_add_u32 s6, s6, s7
    v_lshlrev_b32 v2, 2, v2
    v_add_u32 v2, s6, v2
    s_lshl_b32 s7, s5, 6
    v_lshlrev_b32 v3, 3, v3
    v_add_u32 v3, s7, v3
    v_mul_u32_u24 v4, 1152, v2
    v_lshlrev_b32 v5, 1, v3
    v_add_u32 v4, v4, v5
    v_add_u32 v8, -3456, v4
    v_add_u32 v9, -2304, v4
    v_add_u32 v10, -1152, v4
    v_mov_b32 v11, v4
    v_add_u32 v12, 1152, v4
    v_add_u32 v13, 2304, v4
    v_add_u32 v14, 3456, v4
    v_lshlrev_b32 v6, 3, v3
    s_lshl_b32 s8, s2, 2
    s_add_u32 s8, s8, s3
    s_lshl_b32 s9, s8, 12
    v_lshlrev_b32 v160, 4, v1
    v_add_u32 v160, s9, v160
    v_add_u32 v161, 4, v160
    s_lshl_b32 s8, s8, 1
    v_mov_b32 v162, s8
    s_waitcnt lgkmcnt(0)
    s_mov_b32 s48, s18
    s_mov_b32 s49, s19
    s_mov_b32 s50, 2359296
    s_mov_b32 s51, 0x20000
    s_mov_b32 s52, s20
    s_mov_b32 s53, s21
    s_mov_b32 s54, 2359296
    s_mov_b32 s55, 0x20000
    s_mov_b32 s56, s22
    s_mov_b32 s57, s23
    s_mov_b32 s58, 4608
    s_mov_b32 s59, 0x20000
    s_add_u32 s60, s46, 16384
    s_addc_u32 s61, s47, 0
    s_mov_b32 s62, 2359296
    s_mov_b32 s63, 0x20000
    s_mov_b32 s12, s44
    s_mov_b32 s13, s45
    s_mov_b32 s14, 256
    s_mov_b32 s15, 0x20000
    s_cmp_lg_u32 s2, 0
    s_cbranch_scc1 K2_NONONCE
    s_cmp_lg_u32 s3, 0
    s_cbranch_scc1 K2_NONONCE
    s_memrealtime s[98:99]
    s_waitcnt lgkmcnt(0)
    s_or_b32 s98, s98, 1
    v_mov_b32 v164, 0
    v_mov_b32 v165, s98
    s_mov_b64 exec, 1
    buffer_store_dword v165, v164, s[12:15], 0 offen sc1
    s_mov_b64 exec, -1
K2_NONONCE:
    buffer_load_dwordx4 v[16:19], v8, s[48:51], 0 offen
    buffer_load_dwordx4 v[20:23], v9, s[48:51], 0 offen
    buffer_load_dwordx4 v[24:27], v10, s[48:51], 0 offen
    buffer_load_dwordx4 v[28:31], v11, s[48:51], 0 offen nt
    buffer_load_dwordx4 v[32:35], v12, s[48:51], 0 offen nt
    buffer_load_dwordx4 v[36:39], v13, s[48:51], 0 offen nt
    buffer_load_dwordx4 v[40:43], v14, s[48:51], 0 offen nt
    buffer_load_dwordx4 v[44:47], v11, s[52:55], 0 offen nt
    buffer_load_dwordx4 v[48:51], v12, s[52:55], 0 offen nt
    buffer_load_dwordx4 v[52:55], v13, s[52:55], 0 offen nt
    buffer_load_dwordx4 v[56:59], v14, s[52:55], 0 offen nt
    buffer_load_dwordx4 v[60:63], v6, s[56:59], 0 offen offset:0
    buffer_load_dwordx4 v[64:67], v6, s[56:59], 0 offen offset:16
    buffer_load_dwordx4 v[68:71], v6, s[56:59], 0 offen offset:32
    buffer_load_dwordx4 v[72:75], v6, s[56:59], 0 offen offset:48
    s_mov_b32 s72, s24
    s_mov_b32 s73, s25
    s_mov_b32 s74, 2359296
    s_mov_b32 s75, 0x20000
    s_mov_b32 s76, s26
    s_mov_b32 s77, s27
    s_mov_b32 s78, 1152
    s_mov_b32 s79, 0x20000
    buffer_load_dwordx4 v[128:131], v160, s[72:75], 0 offen offset:0 nt
    buffer_load_dwordx4 v[132:135], v160, s[72:75], 0 offen offset:1024 nt
    buffer_load_dwordx4 v[136:139], v160, s[72:75], 0 offen offset:2048 nt
    buffer_load_dwordx4 v[140:143], v160, s[72:75], 0 offen offset:3072 nt
    buffer_load_dwordx4 v[144:147], v161, s[72:75], 0 offen offset:0
    buffer_load_dwordx4 v[148:151], v161, s[72:75], 0 offen offset:1024
    buffer_load_dwordx4 v[152:155], v161, s[72:75], 0 offen offset:2048
    buffer_load_dwordx4 v[156:159], v161, s[72:75], 0 offen offset:3072
    buffer_load_ushort v163, v162, s[76:79], 0 offen
    s_mov_b32 s64, s36
    s_mov_b32 s65, s37
    s_mov_b32 s66, 5308416
    s_mov_b32 s67, 0x20000
    s_add_u32 s68, s46, 11370496
    s_addc_u32 s69, s47, 0
    s_mov_b32 s70, 5308416
    s_mov_b32 s71, 0x20000
    v_and_b32 v7, 7, v1
    v_mul_u32_u24 v7, 2176, v7
    v_lshrrev_b32 v5, 3, v1
    v_lshlrev_b32 v5, 3, v5
    s_lshl_b32 s8, s3, 6
    v_add_u32 v5, s8, v5
    v_sub_u32 v7, v7, v5
    v_add_u32 v7, 52728, v7
    s_waitcnt vmcnt(9)
    v_lshlrev_b32 v76, 16, v16
    v_and_b32 v77, 0xffff0000, v16
    v_lshlrev_b32 v78, 16, v20
    v_and_b32 v79, 0xffff0000, v20
    v_lshlrev_b32 v80, 16, v24
    v_and_b32 v81, 0xffff0000, v24
    v_lshlrev_b32 v82, 16, v28
    v_and_b32 v83, 0xffff0000, v28
    v_lshlrev_b32 v84, 16, v32
    v_and_b32 v85, 0xffff0000, v32
    v_lshlrev_b32 v86, 16, v36
    v_and_b32 v87, 0xffff0000, v36
    v_lshlrev_b32 v88, 16, v40
    v_and_b32 v89, 0xffff0000, v40
    v_lshlrev_b32 v90, 16, v44
    v_and_b32 v91, 0xffff0000, v44
    v_lshlrev_b32 v92, 16, v48
    v_and_b32 v93, 0xffff0000, v48
    v_lshlrev_b32 v94, 16, v52
    v_and_b32 v95, 0xffff0000, v52
    v_lshlrev_b32 v96, 16, v56
    v_and_b32 v97, 0xffff0000, v56
    v_lshlrev_b32 v98, 16, v60
    v_lshlrev_b32 v99, 16, v62
    v_and_b32 v100, 0xffff0000, v60
    v_and_b32 v101, 0xffff0000, v62
    v_lshlrev_b32 v102, 16, v61
    v_lshlrev_b32 v103, 16, v63
    v_and_b32 v104, 0xffff0000, v61
    v_and_b32 v105, 0xffff0000, v63
    v_pk_mul_f32 v[106:107], v[82:83], v[98:99]
    v_pk_mul_f32 v[108:109], v[84:85], v[98:99]
    v_pk_mul_f32 v[110:111], v[86:87], v[98:99]
    v_pk_mul_f32 v[112:113], v[88:89], v[98:99]
    v_pk_fma_f32 v[106:107], v[80:81], v[100:101], v[106:107]
    v_pk_fma_f32 v[108:109], v[82:83], v[100:101], v[108:109]
    v_pk_fma_f32 v[110:111], v[84:85], v[100:101], v[110:111]
    v_pk_fma_f32 v[112:113], v[86:87], v[100:101], v[112:113]
    v_pk_fma_f32 v[106:107], v[78:79], v[102:103], v[106:107]
    v_pk_fma_f32 v[108:109], v[80:81], v[102:103], v[108:109]
    v_pk_fma_f32 v[110:111], v[82:83], v[102:103], v[110:111]
    v_pk_fma_f32 v[112:113], v[84:85], v[102:103], v[112:113]
    v_pk_fma_f32 v[106:107], v[76:77], v[104:105], v[106:107]
    v_pk_fma_f32 v[108:109], v[78:79], v[104:105], v[108:109]
    v_pk_fma_f32 v[110:111], v[80:81], v[104:105], v[110:111]
    v_pk_fma_f32 v[112:113], v[82:83], v[104:105], v[112:113]
    v_pk_mul_f32 v[106:107], v[106:107], v[90:91]
    v_pk_mul_f32 v[108:109], v[108:109], v[92:93]
    v_pk_mul_f32 v[110:111], v[110:111], v[94:95]
    v_pk_mul_f32 v[112:113], v[112:113], v[96:97]
    v_cvt_pk_bf16_f32 v114, v112, v110
    v_cvt_pk_bf16_f32 v115, v108, v106
    ds_write_b64 v7, v[114:115] offset:0
    v_cvt_pk_bf16_f32 v116, v113, v111
    v_cvt_pk_bf16_f32 v117, v109, v107
    ds_write_b64 v7, v[116:117] offset:272
    v_lshlrev_b32 v76, 16, v17
    v_and_b32 v77, 0xffff0000, v17
    v_lshlrev_b32 v78, 16, v21
    v_and_b32 v79, 0xffff0000, v21
    v_lshlrev_b32 v80, 16, v25
    v_and_b32 v81, 0xffff0000, v25
    v_lshlrev_b32 v82, 16, v29
    v_and_b32 v83, 0xffff0000, v29
    v_lshlrev_b32 v84, 16, v33
    v_and_b32 v85, 0xffff0000, v33
    v_lshlrev_b32 v86, 16, v37
    v_and_b32 v87, 0xffff0000, v37
    v_lshlrev_b32 v88, 16, v41
    v_and_b32 v89, 0xffff0000, v41
    v_lshlrev_b32 v90, 16, v45
    v_and_b32 v91, 0xffff0000, v45
    v_lshlrev_b32 v92, 16, v49
    v_and_b32 v93, 0xffff0000, v49
    v_lshlrev_b32 v94, 16, v53
    v_and_b32 v95, 0xffff0000, v53
    v_lshlrev_b32 v96, 16, v57
    v_and_b32 v97, 0xffff0000, v57
    v_lshlrev_b32 v98, 16, v64
    v_lshlrev_b32 v99, 16, v66
    v_and_b32 v100, 0xffff0000, v64
    v_and_b32 v101, 0xffff0000, v66
    v_lshlrev_b32 v102, 16, v65
    v_lshlrev_b32 v103, 16, v67
    v_and_b32 v104, 0xffff0000, v65
    v_and_b32 v105, 0xffff0000, v67
    v_pk_mul_f32 v[106:107], v[82:83], v[98:99]
    v_pk_mul_f32 v[108:109], v[84:85], v[98:99]
    v_pk_mul_f32 v[110:111], v[86:87], v[98:99]
    v_pk_mul_f32 v[112:113], v[88:89], v[98:99]
    v_pk_fma_f32 v[106:107], v[80:81], v[100:101], v[106:107]
    v_pk_fma_f32 v[108:109], v[82:83], v[100:101], v[108:109]
    v_pk_fma_f32 v[110:111], v[84:85], v[100:101], v[110:111]
    v_pk_fma_f32 v[112:113], v[86:87], v[100:101], v[112:113]
    v_pk_fma_f32 v[106:107], v[78:79], v[102:103], v[106:107]
    v_pk_fma_f32 v[108:109], v[80:81], v[102:103], v[108:109]
    v_pk_fma_f32 v[110:111], v[82:83], v[102:103], v[110:111]
    v_pk_fma_f32 v[112:113], v[84:85], v[102:103], v[112:113]
    v_pk_fma_f32 v[106:107], v[76:77], v[104:105], v[106:107]
    v_pk_fma_f32 v[108:109], v[78:79], v[104:105], v[108:109]
    v_pk_fma_f32 v[110:111], v[80:81], v[104:105], v[110:111]
    v_pk_fma_f32 v[112:113], v[82:83], v[104:105], v[112:113]
    v_pk_mul_f32 v[106:107], v[106:107], v[90:91]
    v_pk_mul_f32 v[108:109], v[108:109], v[92:93]
    v_pk_mul_f32 v[110:111], v[110:111], v[94:95]
    v_pk_mul_f32 v[112:113], v[112:113], v[96:97]
    v_cvt_pk_bf16_f32 v114, v112, v110
    v_cvt_pk_bf16_f32 v115, v108, v106
    ds_write_b64 v7, v[114:115] offset:544
    v_cvt_pk_bf16_f32 v116, v113, v111
    v_cvt_pk_bf16_f32 v117, v109, v107
    ds_write_b64 v7, v[116:117] offset:816
    v_lshlrev_b32 v76, 16, v18
    v_and_b32 v77, 0xffff0000, v18
    v_lshlrev_b32 v78, 16, v22
    v_and_b32 v79, 0xffff0000, v22
    v_lshlrev_b32 v80, 16, v26
    v_and_b32 v81, 0xffff0000, v26
    v_lshlrev_b32 v82, 16, v30
    v_and_b32 v83, 0xffff0000, v30
    v_lshlrev_b32 v84, 16, v34
    v_and_b32 v85, 0xffff0000, v34
    v_lshlrev_b32 v86, 16, v38
    v_and_b32 v87, 0xffff0000, v38
    v_lshlrev_b32 v88, 16, v42
    v_and_b32 v89, 0xffff0000, v42
    v_lshlrev_b32 v90, 16, v46
    v_and_b32 v91, 0xffff0000, v46
    v_lshlrev_b32 v92, 16, v50
    v_and_b32 v93, 0xffff0000, v50
    v_lshlrev_b32 v94, 16, v54
    v_and_b32 v95, 0xffff0000, v54
    v_lshlrev_b32 v96, 16, v58
    v_and_b32 v97, 0xffff0000, v58
    v_lshlrev_b32 v98, 16, v68
    v_lshlrev_b32 v99, 16, v70
    v_and_b32 v100, 0xffff0000, v68
    v_and_b32 v101, 0xffff0000, v70
    v_lshlrev_b32 v102, 16, v69
    v_lshlrev_b32 v103, 16, v71
    v_and_b32 v104, 0xffff0000, v69
    v_and_b32 v105, 0xffff0000, v71
    v_pk_mul_f32 v[106:107], v[82:83], v[98:99]
    v_pk_mul_f32 v[108:109], v[84:85], v[98:99]
    v_pk_mul_f32 v[110:111], v[86:87], v[98:99]
    v_pk_mul_f32 v[112:113], v[88:89], v[98:99]
    v_pk_fma_f32 v[106:107], v[80:81], v[100:101], v[106:107]
    v_pk_fma_f32 v[108:109], v[82:83], v[100:101], v[108:109]
    v_pk_fma_f32 v[110:111], v[84:85], v[100:101], v[110:111]
    v_pk_fma_f32 v[112:113], v[86:87], v[100:101], v[112:113]
    v_pk_fma_f32 v[106:107], v[78:79], v[102:103], v[106:107]
    v_pk_fma_f32 v[108:109], v[80:81], v[102:103], v[108:109]
    v_pk_fma_f32 v[110:111], v[82:83], v[102:103], v[110:111]
    v_pk_fma_f32 v[112:113], v[84:85], v[102:103], v[112:113]
    v_pk_fma_f32 v[106:107], v[76:77], v[104:105], v[106:107]
    v_pk_fma_f32 v[108:109], v[78:79], v[104:105], v[108:109]
    v_pk_fma_f32 v[110:111], v[80:81], v[104:105], v[110:111]
    v_pk_fma_f32 v[112:113], v[82:83], v[104:105], v[112:113]
    v_pk_mul_f32 v[106:107], v[106:107], v[90:91]
    v_pk_mul_f32 v[108:109], v[108:109], v[92:93]
    v_pk_mul_f32 v[110:111], v[110:111], v[94:95]
    v_pk_mul_f32 v[112:113], v[112:113], v[96:97]
    v_cvt_pk_bf16_f32 v114, v112, v110
    v_cvt_pk_bf16_f32 v115, v108, v106
    ds_write_b64 v7, v[114:115] offset:1088
    v_cvt_pk_bf16_f32 v116, v113, v111
    v_cvt_pk_bf16_f32 v117, v109, v107
    ds_write_b64 v7, v[116:117] offset:1360
    v_lshlrev_b32 v76, 16, v19
    v_and_b32 v77, 0xffff0000, v19
    v_lshlrev_b32 v78, 16, v23
    v_and_b32 v79, 0xffff0000, v23
    v_lshlrev_b32 v80, 16, v27
    v_and_b32 v81, 0xffff0000, v27
    v_lshlrev_b32 v82, 16, v31
    v_and_b32 v83, 0xffff0000, v31
    v_lshlrev_b32 v84, 16, v35
    v_and_b32 v85, 0xffff0000, v35
    v_lshlrev_b32 v86, 16, v39
    v_and_b32 v87, 0xffff0000, v39
    v_lshlrev_b32 v88, 16, v43
    v_and_b32 v89, 0xffff0000, v43
    v_lshlrev_b32 v90, 16, v47
    v_and_b32 v91, 0xffff0000, v47
    v_lshlrev_b32 v92, 16, v51
    v_and_b32 v93, 0xffff0000, v51
    v_lshlrev_b32 v94, 16, v55
    v_and_b32 v95, 0xffff0000, v55
    v_lshlrev_b32 v96, 16, v59
    v_and_b32 v97, 0xffff0000, v59
    v_lshlrev_b32 v98, 16, v72
    v_lshlrev_b32 v99, 16, v74
    v_and_b32 v100, 0xffff0000, v72
    v_and_b32 v101, 0xffff0000, v74
    v_lshlrev_b32 v102, 16, v73
    v_lshlrev_b32 v103, 16, v75
    v_and_b32 v104, 0xffff0000, v73
    v_and_b32 v105, 0xffff0000, v75
    v_pk_mul_f32 v[106:107], v[82:83], v[98:99]
    v_pk_mul_f32 v[108:109], v[84:85], v[98:99]
    v_pk_mul_f32 v[110:111], v[86:87], v[98:99]
    v_pk_mul_f32 v[112:113], v[88:89], v[98:99]
    v_pk_fma_f32 v[106:107], v[80:81], v[100:101], v[106:107]
    v_pk_fma_f32 v[108:109], v[82:83], v[100:101], v[108:109]
    v_pk_fma_f32 v[110:111], v[84:85], v[100:101], v[110:111]
    v_pk_fma_f32 v[112:113], v[86:87], v[100:101], v[112:113]
    v_pk_fma_f32 v[106:107], v[78:79], v[102:103], v[106:107]
    v_pk_fma_f32 v[108:109], v[80:81], v[102:103], v[108:109]
    v_pk_fma_f32 v[110:111], v[82:83], v[102:103], v[110:111]
    v_pk_fma_f32 v[112:113], v[84:85], v[102:103], v[112:113]
    v_pk_fma_f32 v[106:107], v[76:77], v[104:105], v[106:107]
    v_pk_fma_f32 v[108:109], v[78:79], v[104:105], v[108:109]
    v_pk_fma_f32 v[110:111], v[80:81], v[104:105], v[110:111]
    v_pk_fma_f32 v[112:113], v[82:83], v[104:105], v[112:113]
    v_pk_mul_f32 v[106:107], v[106:107], v[90:91]
    v_pk_mul_f32 v[108:109], v[108:109], v[92:93]
    v_pk_mul_f32 v[110:111], v[110:111], v[94:95]
    v_pk_mul_f32 v[112:113], v[112:113], v[96:97]
    v_cvt_pk_bf16_f32 v114, v112, v110
    v_cvt_pk_bf16_f32 v115, v108, v106
    ds_write_b64 v7, v[114:115] offset:1632
    v_cvt_pk_bf16_f32 v116, v113, v111
    v_cvt_pk_bf16_f32 v117, v109, v107
    ds_write_b64 v7, v[116:117] offset:1904
    s_waitcnt lgkmcnt(0)
    s_barrier
    v_lshrrev_b32 v16, 4, v1
    s_lshl_b32 s8, s3, 4
    v_add_u32 v16, s8, v16
    v_and_b32 v17, 15, v1
    v_lshlrev_b32 v17, 4, v17
    v_mul_u32_u24 v18, 272, v16
    v_add3_u32 v18, v18, v17, 0
    v_add_u32 v18, 52480, v18
    ds_read_b128 v[20:23], v18 offset:0
    ds_read_b128 v[24:27], v18 offset:1088
    ds_read_b128 v[28:31], v18 offset:2176
    ds_read_b128 v[32:35], v18 offset:3264
    s_lshl_b32 s8, s5, 6
    v_add_u32 v16, s8, v16
    v_lshlrev_b32 v16, 12, v16
    s_lshl_b32 s8, s4, 8
    s_sub_u32 s8, 3840, s8
    v_add3_u32 v16, v16, v17, s8
    s_waitcnt lgkmcnt(3)
    buffer_store_dwordx4 v[20:23], v16, s[60:63], 0 offen sc1
    v_add_u32 v16, 16384, v16
    s_waitcnt lgkmcnt(2)
    buffer_store_dwordx4 v[24:27], v16, s[60:63], 0 offen sc1
    v_add_u32 v16, 16384, v16
    s_waitcnt lgkmcnt(1)
    buffer_store_dwordx4 v[28:31], v16, s[60:63], 0 offen sc1
    v_add_u32 v16, 16384, v16
    s_waitcnt lgkmcnt(0)
    buffer_store_dwordx4 v[32:35], v16, s[60:63], 0 offen sc1
    s_mul_i32 s7, s3, 13120
    v_lshlrev_b32 v2, 4, v1
    v_and_b32 v8, 15, v1
    v_lshrrev_b32 v9, 4, v1
    v_lshlrev_b32 v10, 5, v8
    v_sub_u32 v10, 8800, v10
    v_lshlrev_b32 v11, 4, v9
    v_add3_u32 v10, v10, v11, s7
    v_and_b32 v13, 1, v8
    v_cmp_eq_u32 vcc, 1, v13
    v_lshlrev_b32 v12, 1, v8
    v_mov_b32 v14, 4160
    v_mov_b32 v15, 2
    v_cndmask_b32 v14, v14, v15, vcc
    v_add3_u32 v12, v12, v14, v11
    v_add_u32 v12, s7, v12
    v_add_u32 v13, 1024, v12
    v_add_u32 v14, 2048, v12
    v_add_u32 v15, 3072, v12
    v_add_u32 v2, s7, v2
    v_mov_b32 v80, 0
    v_mov_b32 v81, 0
    v_mov_b32 v82, 0
    v_mov_b32 v83, 0
    v_cmp_gt_u32 vcc, 32, v1
    s_and_saveexec_b64 s[10:11], vcc
    ds_write_b128 v2, v[80:83] offset:12416
    s_mov_b64 exec, s[10:11]
    s_waitcnt vmcnt(4)
    ds_write_b128 v2, v[128:131] offset:32
    ds_write_b128 v2, v[132:135] offset:1056
    ds_write_b128 v2, v[136:139] offset:2080
    ds_write_b128 v2, v[140:143] offset:3104
    v_alignbit_b32 v144, v144, v128, 16
    v_alignbit_b32 v145, v145, v129, 16
    v_alignbit_b32 v146, v146, v130, 16
    v_alignbit_b32 v147, v147, v131, 16
    ds_write_b128 v2, v[144:147] offset:4192
    v_alignbit_b32 v148, v148, v132, 16
    v_alignbit_b32 v149, v149, v133, 16
    v_alignbit_b32 v150, v150, v134, 16
    v_alignbit_b32 v151, v151, v135, 16
    ds_write_b128 v2, v[148:151] offset:5216
    v_alignbit_b32 v152, v152, v136, 16
    v_alignbit_b32 v153, v153, v137, 16
    v_alignbit_b32 v154, v154, v138, 16
    v_alignbit_b32 v155, v155, v139, 16
    ds_write_b128 v2, v[152:155] offset:6240
    v_alignbit_b32 v156, v156, v140, 16
    v_alignbit_b32 v157, v157, v141, 16
    v_alignbit_b32 v158, v158, v142, 16
    v_alignbit_b32 v159, v159, v143, 16
    ds_write_b128 v2, v[156:159] offset:7264
    v_readlane_b32 s9, v128, 0
    s_lshl_b32 s9, s9, 16
    v_mov_b32 v84, 0
    v_mov_b32 v85, 0
    v_mov_b32 v86, 0
    v_mov_b32 v87, s9
    v_cmp_eq_u32 vcc, 1, v1
    s_nop 1
    v_cndmask_b32 v87, 0, v87, vcc
    v_cmp_gt_u32 vcc, 2, v1
    s_and_saveexec_b64 s[10:11], vcc
    ds_write_b128 v2, v[80:83] offset:0
    ds_write_b128 v2, v[84:87] offset:4160
    s_mov_b64 exec, s[10:11]
    v_sub_u32 v68, 15, v8
    v_lshrrev_b32 v69, 3, v68
    v_and_b32 v70, 7, v68
    v_and_b32 v71, 1, v70
    v_lshlrev_b32 v71, 4, v71
    v_lshlrev_b32 v7, v71, v163
    v_lshrrev_b32 v70, 1, v70
    v_lshl_add_u32 v70, v69, 2, v70
    v_lshlrev_b32 v71, 2, v9
    v_add_u32 v72, 0, v71
    v_cmp_eq_u32 vcc, v72, v70
    s_nop 1
    v_cndmask_b32 v76, 0, v7, vcc
    v_add_u32 v72, 1, v71
    v_cmp_eq_u32 vcc, v72, v70
    s_nop 1
    v_cndmask_b32 v77, 0, v7, vcc
    v_add_u32 v72, 2, v71
    v_cmp_eq_u32 vcc, v72, v70
    s_nop 1
    v_cndmask_b32 v78, 0, v7, vcc
    v_add_u32 v72, 3, v71
    v_cmp_eq_u32 vcc, v72, v70
    s_nop 1
    v_cndmask_b32 v79, 0, v7, vcc
    v_lshlrev_b32 v58, 4, v1
    s_mul_i32 s8, s3, 9216
    v_add_u32 v58, s8, v58
    v_lshrrev_b32 v60, 4, v1
    v_bfe_u32 v61, v1, 2, 2
    v_and_b32 v62, 3, v1
    v_lshlrev_b32 v62, 3, v62
    v_lshl_add_u32 v56, v60, 2, v61
    v_mul_u32_u24 v56, 1152, v56
    v_add_u32 v56, v56, v62
    s_mul_i32 s8, s3, 288
    s_add_u32 s8, s8, 52480
    v_add_u32 v56, s8, v56
    v_lshlrev_b32 v57, 4, v1
    s_mul_i32 s10, s2, 57
    s_lshr_b32 s10, s10, 10
    s_mul_i32 s11, s10, 18
    s_sub_u32 s11, s2, s11
    s_mul_i32 s20, s10, 648
    s_mul_i32 s14, s11, 3
    s_add_u32 s20, s20, s14
    s_mul_i32 s14, s3, 162
    s_add_u32 s20, s20, s14
    s_lshl_b32 s20, s20, 10
    s_add_u32 s52, s46, 45453312
    s_addc_u32 s53, s47, 0
    s_mov_b32 s54, 32768
    s_mov_b32 s55, 0x20000
    s_add_u32 s48, s46, 2375680
    s_addc_u32 s49, s47, 0
    s_mov_b32 s50, 2359296
    s_mov_b32 s51, 0x20000
    s_mov_b32 s76, s44
    s_mov_b32 s77, s45
    s_mov_b32 s78, 256
    s_mov_b32 s79, 0x20000
    s_cmp_lg_u32 s3, 0
    s_cbranch_scc1 K2_NON2
    v_mov_b32 v16, 0
    s_mov_b32 s9, 400000
K2_NPOLL:
    buffer_load_dword v17, v16, s[76:79], 0 offen sc1
    s_waitcnt vmcnt(0)
    s_nop 0
    v_readfirstlane_b32 s21, v17
    s_cmp_lg_u32 s21, 0
    s_cbranch_scc1 K2_NON2
    s_sleep 1
    s_sub_u32 s9, s9, 1
    s_cmp_lg_u32 s9, 0
    s_cbranch_scc1 K2_NPOLL
K2_NON2:
    s_waitcnt vmcnt(0)
    s_barrier
    s_cmp_lg_u32 s3, 0
    s_cbranch_scc1 K2_NOPOLL
    s_lshl_b32 s9, s2, 7
    v_mov_b32 v16, s9
    v_mov_b32 v17, s21
    s_mov_b64 exec, 1
    buffer_store_dword v17, v16, s[52:55], 0 offen sc1
    s_mov_b64 exec, 0xffff
    v_mul_u32_u24 v16, 9, v1
    s_lshr_b32 s9, s2, 4
    v_add_u32 v16, s9, v16
    v_lshlrev_b32 v16, 7, v16
    s_mov_b32 s9, 400000
K2_POLL:
    buffer_load_dword v17, v16, s[52:55], 0 offen sc1
    s_waitcnt vmcnt(0)
    v_cmp_ne_u32 vcc, s21, v17
    s_cbranch_vccz K2_POLLOK
    s_sleep 1
    s_sub_u32 s9, s9, 1
    s_cmp_lg_u32 s9, 0
    s_cbranch_scc1 K2_POLL
K2_POLLOK:
    s_mov_b64 exec, -1
K2_NOPOLL:
    s_barrier
    buffer_load_dwordx4 v[20:23], v160, s[60:63], 0 offen offset:0 sc1
    buffer_load_dwordx4 v[24:27], v160, s[60:63], 0 offen offset:1024 sc1
    buffer_load_dwordx4 v[28:31], v160, s[60:63], 0 offen offset:2048 sc1
    buffer_load_dwordx4 v[32:35], v160, s[60:63], 0 offen offset:3072 sc1
    v_lshlrev_b32 v144, 4, v1
    s_mul_i32 s8, s3, 9216
    v_add_u32 v144, s8, v144
    s_mul_i32 s12, s2, 36864
    s_mul_i32 s8, s3, 9216
    s_add_u32 s8, s8, 52480
    s_add_u32 m0, s8, 0
    s_add_u32 s9, s12, 0
    buffer_load_dwordx4 v144, s[64:67], s9 offen nt lds
    s_add_u32 m0, s8, 1024
    s_add_u32 s9, s12, 1024
    buffer_load_dwordx4 v144, s[64:67], s9 offen nt lds
    s_add_u32 m0, s8, 2048
    s_add_u32 s9, s12, 2048
    buffer_load_dwordx4 v144, s[64:67], s9 offen nt lds
    s_add_u32 m0, s8, 3072
    s_add_u32 s9, s12, 3072
    buffer_load_dwordx4 v144, s[64:67], s9 offen nt lds
    s_add_u32 m0, s8, 4096
    s_add_u32 s9, s12, 4096
    buffer_load_dwordx4 v144, s[64:67], s9 offen nt lds
    s_add_u32 m0, s8, 5120
    s_add_u32 s9, s12, 5120
    buffer_load_dwordx4 v144, s[64:67], s9 offen nt lds
    s_add_u32 m0, s8, 6144
    s_add_u32 s9, s12, 6144
    buffer_load_dwordx4 v144, s[64:67], s9 offen nt lds
    s_add_u32 m0, s8, 7168
    s_add_u32 s9, s12, 7168
    buffer_load_dwordx4 v144, s[64:67], s9 offen nt lds
    s_add_u32 m0, s8, 8192
    s_add_u32 s9, s12, 8192
    buffer_load_dwordx4 v144, s[64:67], s9 offen nt lds
    s_waitcnt vmcnt(12)
    ds_write_b128 v2, v[20:23] offset:8320
    s_waitcnt vmcnt(11)
    ds_write_b128 v2, v[24:27] offset:9344
    s_waitcnt vmcnt(10)
    ds_write_b128 v2, v[28:31] offset:10368
    s_waitcnt vmcnt(9)
    ds_write_b128 v2, v[32:35] offset:11392
    s_waitcnt lgkmcnt(0)
    ds_read_b128 a[28:31], v10 offset:3584
    ds_read_b128 a[60:63], v10 offset:3072
    ds_read_b128 a[92:95], v10 offset:2560
    ds_read_b128 a[124:127], v10 offset:2048
    ds_read_b128 a[156:159], v10 offset:1536
    ds_read_b128 a[188:191], v10 offset:1024
    ds_read_b128 a[220:223], v10 offset:512
    ds_read_b128 a[252:255], v10 offset:0
    ds_read2_b32 v[112:113], v12 offset0:0 offset1:1
    ds_read2_b32 v[114:115], v12 offset0:2 offset1:3
    ds_read_b128 a[24:27], v10 offset:3648
    ds_read_b128 a[56:59], v10 offset:3136
    ds_read_b128 a[88:91], v10 offset:2624
    ds_read_b128 a[120:123], v10 offset:2112
    ds_read_b128 a[152:155], v10 offset:1600
    ds_read_b128 a[184:187], v10 offset:1088
    ds_read_b128 a[216:219], v10 offset:576
    ds_read_b128 a[248:251], v10 offset:64
    ds_read2_b32 v[116:117], v12 offset0:16 offset1:17
    ds_read2_b32 v[118:119], v12 offset0:18 offset1:19
    s_waitcnt lgkmcnt(12)
    v_mfma_f32_16x16x32_bf16 v[80:83], v[76:79], a[28:31], 0
    v_mfma_f32_16x16x32_bf16 v[84:87], v[76:79], a[60:63], 0
    v_mfma_f32_16x16x32_bf16 v[88:91], v[76:79], a[92:95], 0
    v_mfma_f32_16x16x32_bf16 v[92:95], v[76:79], a[124:127], 0
    v_mfma_f32_16x16x32_bf16 v[96:99], v[76:79], a[156:159], 0
    v_mfma_f32_16x16x32_bf16 v[100:103], v[76:79], a[188:191], 0
    v_mfma_f32_16x16x32_bf16 v[104:107], v[76:79], a[220:223], 0
    v_mfma_f32_16x16x32_bf16 v[108:111], v[76:79], a[252:255], 0
    s_waitcnt lgkmcnt(10)
    v_mfma_f32_16x16x32_bf16 v[80:83], v[112:115], a[28:31], v[80:83]
    ds_read_b128 a[20:23], v10 offset:3712
    v_mfma_f32_16x16x32_bf16 v[84:87], v[112:115], a[60:63], v[84:87]
    ds_read_b128 a[52:55], v10 offset:3200
    v_mfma_f32_16x16x32_bf16 v[88:91], v[112:115], a[92:95], v[88:91]
    ds_read_b128 a[84:87], v10 offset:2688
    v_mfma_f32_16x16x32_bf16 v[92:95], v[112:115], a[124:127], v[92:95]
    ds_read_b128 a[116:119], v10 offset:2176
    v_mfma_f32_16x16x32_bf16 v[96:99], v[112:115], a[156:159], v[96:99]
    ds_read_b128 a[148:151], v10 offset:1664
    v_mfma_f32_16x16x32_bf16 v[100:103], v[112:115], a[188:191], v[100:103]
    ds_read_b128 a[180:183], v10 offset:1152
    v_mfma_f32_16x16x32_bf16 v[104:107], v[112:115], a[220:223], v[104:107]
    ds_read_b128 a[212:215], v10 offset:640
    v_mfma_f32_16x16x32_bf16 v[108:111], v[112:115], a[252:255], v[108:111]
    ds_read_b128 a[244:247], v10 offset:128
    ds_read2_b32 v[120:121], v12 offset0:32 offset1:33
    ds_read2_b32 v[122:123], v12 offset0:34 offset1:35
    s_waitcnt lgkmcnt(10)
    v_mfma_f32_16x16x32_bf16 v[80:83], v[116:119], a[24:27], v[80:83]
    ds_read_b128 a[16:19], v10 offset:3776
    v_mfma_f32_16x16x32_bf16 v[84:87], v[116:119], a[56:59], v[84:87]
    ds_read_b128 a[48:51], v10 offset:3264
    v_mfma_f32_16x16x32_bf16 v[88:91], v[116:119], a[88:91], v[88:91]
    ds_read_b128 a[80:83], v10 offset:2752
    v_mfma_f32_16x16x32_bf16 v[92:95], v[116:119], a[120:123], v[92:95]
    ds_read_b128 a[112:115], v10 offset:2240
    v_mfma_f32_16x16x32_bf16 v[96:99], v[116:119], a[152:155], v[96:99]
    ds_read_b128 a[144:147], v10 offset:1728
    v_mfma_f32_16x16x32_bf16 v[100:103], v[116:119], a[184:187], v[100:103]
    ds_read_b128 a[176:179], v10 offset:1216
    v_mfma_f32_16x16x32_bf16 v[104:107], v[116:119], a[216:219], v[104:107]
    ds_read_b128 a[208:211], v10 offset:704
    v_mfma_f32_16x16x32_bf16 v[108:111], v[116:119], a[248:251], v[108:111]
    ds_read_b128 a[240:243], v10 offset:192
    ds_read2_b32 v[124:125], v12 offset0:48 offset1:49
    ds_read2_b32 v[126:127], v12 offset0:50 offset1:51
    s_waitcnt lgkmcnt(10)
    v_mfma_f32_16x16x32_bf16 v[80:83], v[120:123], a[20:23], v[80:83]
    ds_read_b128 a[12:15], v10 offset:3840
    v_mfma_f32_16x16x32_bf16 v[84:87], v[120:123], a[52:55], v[84:87]
    ds_read_b128 a[44:47], v10 offset:3328
    v_mfma_f32_16x16x32_bf16 v[88:91], v[120:123], a[84:87], v[88:91]
    ds_read_b128 a[76:79], v10 offset:2816
    v_mfma_f32_16x16x32_bf16 v[92:95], v[120:123], a[116:119], v[92:95]
    ds_read_b128 a[108:111], v10 offset:2304
    v_mfma_f32_16x16x32_bf16 v[96:99], v[120:123], a[148:151], v[96:99]
    ds_read_b128 a[140:143], v10 offset:1792
    v_mfma_f32_16x16x32_bf16 v[100:103], v[120:123], a[180:183], v[100:103]
    ds_read_b128 a[172:175], v10 offset:1280
    v_mfma_f32_16x16x32_bf16 v[104:107], v[120:123], a[212:215], v[104:107]
    ds_read_b128 a[204:207], v10 offset:768
    v_mfma_f32_16x16x32_bf16 v[108:111], v[120:123], a[244:247], v[108:111]
    ds_read_b128 a[236:239], v10 offset:256
    ds_read2_b32 v[128:129], v12 offset0:64 offset1:65
    ds_read2_b32 v[130:131], v12 offset0:66 offset1:67
    s_waitcnt lgkmcnt(10)
    v_mfma_f32_16x16x32_bf16 v[80:83], v[124:127], a[16:19], v[80:83]
    ds_read_b128 a[8:11], v10 offset:3904
    v_mfma_f32_16x16x32_bf16 v[84:87], v[124:127], a[48:51], v[84:87]
    ds_read_b128 a[40:43], v10 offset:3392
    v_mfma_f32_16x16x32_bf16 v[88:91], v[124:127], a[80:83], v[88:91]
    ds_read_b128 a[72:75], v10 offset:2880
    v_mfma_f32_16x16x32_bf16 v[92:95], v[124:127], a[112:115], v[92:95]
    ds_read_b128 a[104:107], v10 offset:2368
    v_mfma_f32_16x16x32_bf16 v[96:99], v[124:127], a[144:147], v[96:99]
    ds_read_b128 a[136:139], v10 offset:1856
    v_mfma_f32_16x16x32_bf16 v[100:103], v[124:127], a[176:179], v[100:103]
    ds_read_b128 a[168:171], v10 offset:1344
    v_mfma_f32_16x16x32_bf16 v[104:107], v[124:127], a[208:211], v[104:107]
    ds_read_b128 a[200:203], v10 offset:832
    v_mfma_f32_16x16x32_bf16 v[108:111], v[124:127], a[240:243], v[108:111]
    ds_read_b128 a[232:235], v10 offset:320
    ds_read2_b32 v[132:133], v12 offset0:80 offset1:81
    ds_read2_b32 v[134:135], v12 offset0:82 offset1:83
    s_waitcnt lgkmcnt(10)
    v_mfma_f32_16x16x32_bf16 v[80:83], v[128:131], a[12:15], v[80:83]
    ds_read_b128 a[4:7], v10 offset:3968
    v_mfma_f32_16x16x32_bf16 v[84:87], v[128:131], a[44:47], v[84:87]
    ds_read_b128 a[36:39], v10 offset:3456
    v_mfma_f32_16x16x32_bf16 v[88:91], v[128:131], a[76:79], v[88:91]
    ds_read_b128 a[68:71], v10 offset:2944
    v_mfma_f32_16x16x32_bf16 v[92:95], v[128:131], a[108:111], v[92:95]
    ds_read_b128 a[100:103], v10 offset:2432
    v_mfma_f32_16x16x32_bf16 v[96:99], v[128:131], a[140:143], v[96:99]
    ds_read_b128 a[132:135], v10 offset:1920
    v_mfma_f32_16x16x32_bf16 v[100:103], v[128:131], a[172:175], v[100:103]
    ds_read_b128 a[164:167], v10 offset:1408
    v_mfma_f32_16x16x32_bf16 v[104:107], v[128:131], a[204:207], v[104:107]
    ds_read_b128 a[196:199], v10 offset:896
    v_mfma_f32_16x16x32_bf16 v[108:111], v[128:131], a[236:239], v[108:111]
    ds_read_b128 a[228:231], v10 offset:384
    ds_read2_b32 v[136:137], v12 offset0:96 offset1:97
    ds_read2_b32 v[138:139], v12 offset0:98 offset1:99
    s_waitcnt lgkmcnt(10)
    v_mfma_f32_16x16x32_bf16 v[80:83], v[132:135], a[8:11], v[80:83]
    ds_read_b128 a[0:3], v10 offset:4032
    v_mfma_f32_16x16x32_bf16 v[84:87], v[132:135], a[40:43], v[84:87]
    ds_read_b128 a[32:35], v10 offset:3520
    v_mfma_f32_16x16x32_bf16 v[88:91], v[132:135], a[72:75], v[88:91]
    ds_read_b128 a[64:67], v10 offset:3008
    v_mfma_f32_16x16x32_bf16 v[92:95], v[132:135], a[104:107], v[92:95]
    ds_read_b128 a[96:99], v10 offset:2496
    v_mfma_f32_16x16x32_bf16 v[96:99], v[132:135], a[136:139], v[96:99]
    ds_read_b128 a[128:131], v10 offset:1984
    v_mfma_f32_16x16x32_bf16 v[100:103], v[132:135], a[168:171], v[100:103]
    ds_read_b128 a[160:163], v10 offset:1472
    v_mfma_f32_16x16x32_bf16 v[104:107], v[132:135], a[200:203], v[104:107]
    ds_read_b128 a[192:195], v10 offset:960
    v_mfma_f32_16x16x32_bf16 v[108:111], v[132:135], a[232:235], v[108:111]
    ds_read_b128 a[224:227], v10 offset:448
    ds_read2_b32 v[140:141], v12 offset0:112 offset1:113
    ds_read2_b32 v[142:143], v12 offset0:114 offset1:115
    s_waitcnt lgkmcnt(10)
    v_mfma_f32_16x16x32_bf16 v[80:83], v[136:139], a[4:7], v[80:83]
    v_mfma_f32_16x16x32_bf16 v[84:87], v[136:139], a[36:39], v[84:87]
    ds_read2_b32 v[112:113], v12 offset0:128 offset1:129
    ds_read2_b32 v[114:115], v12 offset0:130 offset1:131
    v_mfma_f32_16x16x32_bf16 v[88:91], v[136:139], a[68:71], v[88:91]
    v_mfma_f32_16x16x32_bf16 v[92:95], v[136:139], a[100:103], v[92:95]
    ds_read2_b32 v[116:117], v12 offset0:144 offset1:145
    ds_read2_b32 v[118:119], v12 offset0:146 offset1:147
    v_mfma_f32_16x16x32_bf16 v[96:99], v[136:139], a[132:135], v[96:99]
    v_mfma_f32_16x16x32_bf16 v[100:103], v[136:139], a[164:167], v[100:103]
    ds_read2_b32 v[120:121], v12 offset0:160 offset1:161
    ds_read2_b32 v[122:123], v12 offset0:162 offset1:163
    v_mfma_f32_16x16x32_bf16 v[104:107], v[136:139], a[196:199], v[104:107]
    v_mfma_f32_16x16x32_bf16 v[108:111], v[136:139], a[228:231], v[108:111]
    ds_read2_b32 v[124:125], v12 offset0:176 offset1:177
    ds_read2_b32 v[126:127], v12 offset0:178 offset1:179
    s_waitcnt lgkmcnt(8)
    v_mfma_f32_16x16x32_bf16 v[80:83], v[140:143], a[0:3], v[80:83]
    v_mfma_f32_16x16x32_bf16 v[84:87], v[140:143], a[32:35], v[84:87]
    v_mfma_f32_16x16x32_bf16 v[88:91], v[140:143], a[64:67], v[88:91]
    v_mfma_f32_16x16x32_bf16 v[92:95], v[140:143], a[96:99], v[92:95]
    v_mfma_f32_16x16x32_bf16 v[96:99], v[140:143], a[128:131], v[96:99]
    v_mfma_f32_16x16x32_bf16 v[100:103], v[140:143], a[160:163], v[100:103]
    v_mfma_f32_16x16x32_bf16 v[104:107], v[140:143], a[192:195], v[104:107]
    v_mfma_f32_16x16x32_bf16 v[108:111], v[140:143], a[224:227], v[108:111]
    ds_read2_b32 v[128:129], v12 offset0:192 offset1:193
    ds_read2_b32 v[130:131], v12 offset0:194 offset1:195
    s_waitcnt lgkmcnt(8)
    v_mfma_f32_16x16x32_bf16 v[84:87], v[112:115], a[28:31], v[84:87]
    v_mfma_f32_16x16x32_bf16 v[88:91], v[112:115], a[60:63], v[88:91]
    v_mfma_f32_16x16x32_bf16 v[92:95], v[112:115], a[92:95], v[92:95]
    v_mfma_f32_16x16x32_bf16 v[96:99], v[112:115], a[124:127], v[96:99]
    v_mfma_f32_16x16x32_bf16 v[100:103], v[112:115], a[156:159], v[100:103]
    v_mfma_f32_16x16x32_bf16 v[104:107], v[112:115], a[188:191], v[104:107]
    v_mfma_f32_16x16x32_bf16 v[108:111], v[112:115], a[220:223], v[108:111]
    ds_read2_b32 v[132:133], v12 offset0:208 offset1:209
    ds_read2_b32 v[134:135], v12 offset0:210 offset1:211
    s_waitcnt lgkmcnt(8)
    v_mfma_f32_16x16x32_bf16 v[84:87], v[116:119], a[24:27], v[84:87]
    v_mfma_f32_16x16x32_bf16 v[88:91], v[116:119], a[56:59], v[88:91]
    v_mfma_f32_16x16x32_bf16 v[92:95], v[116:119], a[88:91], v[92:95]
    v_mfma_f32_16x16x32_bf16 v[96:99], v[116:119], a[120:123], v[96:99]
    v_mfma_f32_16x16x32_bf16 v[100:103], v[116:119], a[152:155], v[100:103]
    v_mfma_f32_16x16x32_bf16 v[104:107], v[116:119], a[184:187], v[104:107]
    v_mfma_f32_16x16x32_bf16 v[108:111], v[116:119], a[216:219], v[108:111]
    ds_read2_b32 v[136:137], v12 offset0:224 offset1:225
    ds_read2_b32 v[138:139], v12 offset0:226 offset1:227
    s_waitcnt lgkmcnt(8)
    v_mfma_f32_16x16x32_bf16 v[84:87], v[120:123], a[20:23], v[84:87]
    v_mfma_f32_16x16x32_bf16 v[88:91], v[120:123], a[52:55], v[88:91]
    v_mfma_f32_16x16x32_bf16 v[92:95], v[120:123], a[84:87], v[92:95]
    v_mfma_f32_16x16x32_bf16 v[96:99], v[120:123], a[116:119], v[96:99]
    v_mfma_f32_16x16x32_bf16 v[100:103], v[120:123], a[148:151], v[100:103]
    v_mfma_f32_16x16x32_bf16 v[104:107], v[120:123], a[180:183], v[104:107]
    v_mfma_f32_16x16x32_bf16 v[108:111], v[120:123], a[212:215], v[108:111]
    ds_read2_b32 v[140:141], v12 offset0:240 offset1:241
    ds_read2_b32 v[142:143], v12 offset0:242 offset1:243
    s_waitcnt lgkmcnt(8)
    v_mfma_f32_16x16x32_bf16 v[84:87], v[124:127], a[16:19], v[84:87]
    v_mfma_f32_16x16x32_bf16 v[88:91], v[124:127], a[48:51], v[88:91]
    v_mfma_f32_16x16x32_bf16 v[92:95], v[124:127], a[80:83], v[92:95]
    v_mfma_f32_16x16x32_bf16 v[96:99], v[124:127], a[112:115], v[96:99]
    v_mfma_f32_16x16x32_bf16 v[100:103], v[124:127], a[144:147], v[100:103]
    v_mfma_f32_16x16x32_bf16 v[104:107], v[124:127], a[176:179], v[104:107]
    v_mfma_f32_16x16x32_bf16 v[108:111], v[124:127], a[208:211], v[108:111]
    ds_read2_b32 v[112:113], v13 offset0:0 offset1:1
    ds_read2_b32 v[114:115], v13 offset0:2 offset1:3
    s_waitcnt lgkmcnt(8)
    v_mfma_f32_16x16x32_bf16 v[84:87], v[128:131], a[12:15], v[84:87]
    v_mfma_f32_16x16x32_bf16 v[88:91], v[128:131], a[44:47], v[88:91]
    v_mfma_f32_16x16x32_bf16 v[92:95], v[128:131], a[76:79], v[92:95]
    v_mfma_f32_16x16x32_bf16 v[96:99], v[128:131], a[108:111], v[96:99]
    v_mfma_f32_16x16x32_bf16 v[100:103], v[128:131], a[140:143], v[100:103]
    v_mfma_f32_16x16x32_bf16 v[104:107], v[128:131], a[172:175], v[104:107]
    v_mfma_f32_16x16x32_bf16 v[108:111], v[128:131], a[204:207], v[108:111]
    ds_read2_b32 v[116:117], v13 offset0:16 offset1:17
    ds_read2_b32 v[118:119], v13 offset0:18 offset1:19
    s_waitcnt lgkmcnt(8)
    v_mfma_f32_16x16x32_bf16 v[84:87], v[132:135], a[8:11], v[84:87]
    v_mfma_f32_16x16x32_bf16 v[88:91], v[132:135], a[40:43], v[88:91]
    v_mfma_f32_16x16x32_bf16 v[92:95], v[132:135], a[72:75], v[92:95]
    v_mfma_f32_16x16x32_bf16 v[96:99], v[132:135], a[104:107], v[96:99]
    v_mfma_f32_16x16x32_bf16 v[100:103], v[132:135], a[136:139], v[100:103]
    v_mfma_f32_16x16x32_bf16 v[104:107], v[132:135], a[168:171], v[104:107]
    v_mfma_f32_16x16x32_bf16 v[108:111], v[132:135], a[200:203], v[108:111]
    ds_read2_b32 v[120:121], v13 offset0:32 offset1:33
    ds_read2_b32 v[122:123], v13 offset0:34 offset1:35
    s_waitcnt lgkmcnt(8)
    v_mfma_f32_16x16x32_bf16 v[84:87], v[136:139], a[4:7], v[84:87]
    v_mfma_f32_16x16x32_bf16 v[88:91], v[136:139], a[36:39], v[88:91]
    v_mfma_f32_16x16x32_bf16 v[92:95], v[136:139], a[68:71], v[92:95]
    v_mfma_f32_16x16x32_bf16 v[96:99], v[136:139], a[100:103], v[96:99]
    v_mfma_f32_16x16x32_bf16 v[100:103], v[136:139], a[132:135], v[100:103]
    v_mfma_f32_16x16x32_bf16 v[104:107], v[136:139], a[164:167], v[104:107]
    v_mfma_f32_16x16x32_bf16 v[108:111], v[136:139], a[196:199], v[108:111]
    ds_read2_b32 v[124:125], v13 offset0:48 offset1:49
    ds_read2_b32 v[126:127], v13 offset0:50 offset1:51
    s_waitcnt lgkmcnt(8)
    v_mfma_f32_16x16x32_bf16 v[84:87], v[140:143], a[0:3], v[84:87]
    v_mfma_f32_16x16x32_bf16 v[88:91], v[140:143], a[32:35], v[88:91]
    v_mfma_f32_16x16x32_bf16 v[92:95], v[140:143], a[64:67], v[92:95]
    v_mfma_f32_16x16x32_bf16 v[96:99], v[140:143], a[96:99], v[96:99]
    v_mfma_f32_16x16x32_bf16 v[100:103], v[140:143], a[128:131], v[100:103]
    v_mfma_f32_16x16x32_bf16 v[104:107], v[140:143], a[160:163], v[104:107]
    v_mfma_f32_16x16x32_bf16 v[108:111], v[140:143], a[192:195], v[108:111]
    ds_read2_b32 v[128:129], v13 offset0:64 offset1:65
    ds_read2_b32 v[130:131], v13 offset0:66 offset1:67
    s_waitcnt lgkmcnt(8)
    v_mfma_f32_16x16x32_bf16 v[88:91], v[112:115], a[28:31], v[88:91]
    v_mfma_f32_16x16x32_bf16 v[92:95], v[112:115], a[60:63], v[92:95]
    v_mfma_f32_16x16x32_bf16 v[96:99], v[112:115], a[92:95], v[96:99]
    v_mfma_f32_16x16x32_bf16 v[100:103], v[112:115], a[124:127], v[100:103]
    v_mfma_f32_16x16x32_bf16 v[104:107], v[112:115], a[156:159], v[104:107]
    v_mfma_f32_16x16x32_bf16 v[108:111], v[112:115], a[188:191], v[108:111]
    ds_read2_b32 v[132:133], v13 offset0:80 offset1:81
    ds_read2_b32 v[134:135], v13 offset0:82 offset1:83
    s_waitcnt lgkmcnt(8)
    v_mfma_f32_16x16x32_bf16 v[88:91], v[116:119], a[24:27], v[88:91]
    v_mfma_f32_16x16x32_bf16 v[92:95], v[116:119], a[56:59], v[92:95]
    v_mfma_f32_16x16x32_bf16 v[96:99], v[116:119], a[88:91], v[96:99]
    v_mfma_f32_16x16x32_bf16 v[100:103], v[116:119], a[120:123], v[100:103]
    v_mfma_f32_16x16x32_bf16 v[104:107], v[116:119], a[152:155], v[104:107]
    v_mfma_f32_16x16x32_bf16 v[108:111], v[116:119], a[184:187], v[108:111]
    ds_read2_b32 v[136:137], v13 offset0:96 offset1:97
    ds_read2_b32 v[138:139], v13 offset0:98 offset1:99
    s_waitcnt lgkmcnt(8)
    v_mfma_f32_16x16x32_bf16 v[88:91], v[120:123], a[20:23], v[88:91]
    v_mfma_f32_16x16x32_bf16 v[92:95], v[120:123], a[52:55], v[92:95]
    v_mfma_f32_16x16x32_bf16 v[96:99], v[120:123], a[84:87], v[96:99]
    v_mfma_f32_16x16x32_bf16 v[100:103], v[120:123], a[116:119], v[100:103]
    v_mfma_f32_16x16x32_bf16 v[104:107], v[120:123], a[148:151], v[104:107]
    v_mfma_f32_16x16x32_bf16 v[108:111], v[120:123], a[180:183], v[108:111]
    ds_read2_b32 v[140:141], v13 offset0:112 offset1:113
    ds_read2_b32 v[142:143], v13 offset0:114 offset1:115
    s_waitcnt lgkmcnt(8)
    v_mfma_f32_16x16x32_bf16 v[88:91], v[124:127], a[16:19], v[88:91]
    v_mfma_f32_16x16x32_bf16 v[92:95], v[124:127], a[48:51], v[92:95]
    v_mfma_f32_16x16x32_bf16 v[96:99], v[124:127], a[80:83], v[96:99]
    v_mfma_f32_16x16x32_bf16 v[100:103], v[124:127], a[112:115], v[100:103]
    v_mfma_f32_16x16x32_bf16 v[104:107], v[124:127], a[144:147], v[104:107]
    v_mfma_f32_16x16x32_bf16 v[108:111], v[124:127], a[176:179], v[108:111]
    ds_read2_b32 v[112:113], v13 offset0:128 offset1:129
    ds_read2_b32 v[114:115], v13 offset0:130 offset1:131
    s_waitcnt lgkmcnt(8)
    v_mfma_f32_16x16x32_bf16 v[88:91], v[128:131], a[12:15], v[88:91]
    v_mfma_f32_16x16x32_bf16 v[92:95], v[128:131], a[44:47], v[92:95]
    v_mfma_f32_16x16x32_bf16 v[96:99], v[128:131], a[76:79], v[96:99]
    v_mfma_f32_16x16x32_bf16 v[100:103], v[128:131], a[108:111], v[100:103]
    v_mfma_f32_16x16x32_bf16 v[104:107], v[128:131], a[140:143], v[104:107]
    v_mfma_f32_16x16x32_bf16 v[108:111], v[128:131], a[172:175], v[108:111]
    ds_read2_b32 v[116:117], v13 offset0:144 offset1:145
    ds_read2_b32 v[118:119], v13 offset0:146 offset1:147
    s_waitcnt lgkmcnt(8)
    v_mfma_f32_16x16x32_bf16 v[88:91], v[132:135], a[8:11], v[88:91]
    v_mfma_f32_16x16x32_bf16 v[92:95], v[132:135], a[40:43], v[92:95]
    v_mfma_f32_16x16x32_bf16 v[96:99], v[132:135], a[72:75], v[96:99]
    v_mfma_f32_16x16x32_bf16 v[100:103], v[132:135], a[104:107], v[100:103]
    v_mfma_f32_16x16x32_bf16 v[104:107], v[132:135], a[136:139], v[104:107]
    v_mfma_f32_16x16x32_bf16 v[108:111], v[132:135], a[168:171], v[108:111]
    ds_read2_b32 v[120:121], v13 offset0:160 offset1:161
    ds_read2_b32 v[122:123], v13 offset0:162 offset1:163
    s_waitcnt lgkmcnt(8)
    v_mfma_f32_16x16x32_bf16 v[88:91], v[136:139], a[4:7], v[88:91]
    v_mfma_f32_16x16x32_bf16 v[92:95], v[136:139], a[36:39], v[92:95]
    v_mfma_f32_16x16x32_bf16 v[96:99], v[136:139], a[68:71], v[96:99]
    v_mfma_f32_16x16x32_bf16 v[100:103], v[136:139], a[100:103], v[100:103]
    v_mfma_f32_16x16x32_bf16 v[104:107], v[136:139], a[132:135], v[104:107]
    v_mfma_f32_16x16x32_bf16 v[108:111], v[136:139], a[164:167], v[108:111]
    ds_read2_b32 v[124:125], v13 offset0:176 offset1:177
    ds_read2_b32 v[126:127], v13 offset0:178 offset1:179
    s_waitcnt lgkmcnt(8)
    v_mfma_f32_16x16x32_bf16 v[88:91], v[140:143], a[0:3], v[88:91]
    v_mfma_f32_16x16x32_bf16 v[92:95], v[140:143], a[32:35], v[92:95]
    v_mfma_f32_16x16x32_bf16 v[96:99], v[140:143], a[64:67], v[96:99]
    v_mfma_f32_16x16x32_bf16 v[100:103], v[140:143], a[96:99], v[100:103]
    v_mfma_f32_16x16x32_bf16 v[104:107], v[140:143], a[128:131], v[104:107]
    v_mfma_f32_16x16x32_bf16 v[108:111], v[140:143], a[160:163], v[108:111]
    ds_read2_b32 v[128:129], v13 offset0:192 offset1:193
    ds_read2_b32 v[130:131], v13 offset0:194 offset1:195
    s_waitcnt lgkmcnt(8)
    v_mfma_f32_16x16x32_bf16 v[92:95], v[112:115], a[28:31], v[92:95]
    v_mfma_f32_16x16x32_bf16 v[96:99], v[112:115], a[60:63], v[96:99]
    v_mfma_f32_16x16x32_bf16 v[100:103], v[112:115], a[92:95], v[100:103]
    v_mfma_f32_16x16x32_bf16 v[104:107], v[112:115], a[124:127], v[104:107]
    v_mfma_f32_16x16x32_bf16 v[108:111], v[112:115], a[156:159], v[108:111]
    ds_read2_b32 v[132:133], v13 offset0:208 offset1:209
    ds_read2_b32 v[134:135], v13 offset0:210 offset1:211
    s_waitcnt lgkmcnt(8)
    v_mfma_f32_16x16x32_bf16 v[92:95], v[116:119], a[24:27], v[92:95]
    v_mfma_f32_16x16x32_bf16 v[96:99], v[116:119], a[56:59], v[96:99]
    v_mfma_f32_16x16x32_bf16 v[100:103], v[116:119], a[88:91], v[100:103]
    v_mfma_f32_16x16x32_bf16 v[104:107], v[116:119], a[120:123], v[104:107]
    v_mfma_f32_16x16x32_bf16 v[108:111], v[116:119], a[152:155], v[108:111]
    ds_read2_b32 v[136:137], v13 offset0:224 offset1:225
    ds_read2_b32 v[138:139], v13 offset0:226 offset1:227
    s_waitcnt lgkmcnt(8)
    v_mfma_f32_16x16x32_bf16 v[92:95], v[120:123], a[20:23], v[92:95]
    v_mfma_f32_16x16x32_bf16 v[96:99], v[120:123], a[52:55], v[96:99]
    v_mfma_f32_16x16x32_bf16 v[100:103], v[120:123], a[84:87], v[100:103]
    v_mfma_f32_16x16x32_bf16 v[104:107], v[120:123], a[116:119], v[104:107]
    v_mfma_f32_16x16x32_bf16 v[108:111], v[120:123], a[148:151], v[108:111]
    ds_read2_b32 v[140:141], v13 offset0:240 offset1:241
    ds_read2_b32 v[142:143], v13 offset0:242 offset1:243
    s_waitcnt lgkmcnt(8)
    v_mfma_f32_16x16x32_bf16 v[92:95], v[124:127], a[16:19], v[92:95]
    v_mfma_f32_16x16x32_bf16 v[96:99], v[124:127], a[48:51], v[96:99]
    v_mfma_f32_16x16x32_bf16 v[100:103], v[124:127], a[80:83], v[100:103]
    v_mfma_f32_16x16x32_bf16 v[104:107], v[124:127], a[112:115], v[104:107]
    v_mfma_f32_16x16x32_bf16 v[108:111], v[124:127], a[144:147], v[108:111]
    ds_read2_b32 v[112:113], v14 offset0:0 offset1:1
    ds_read2_b32 v[114:115], v14 offset0:2 offset1:3
    s_waitcnt lgkmcnt(8)
    v_mfma_f32_16x16x32_bf16 v[92:95], v[128:131], a[12:15], v[92:95]
    v_mfma_f32_16x16x32_bf16 v[96:99], v[128:131], a[44:47], v[96:99]
    v_mfma_f32_16x16x32_bf16 v[100:103], v[128:131], a[76:79], v[100:103]
    v_mfma_f32_16x16x32_bf16 v[104:107], v[128:131], a[108:111], v[104:107]
    v_mfma_f32_16x16x32_bf16 v[108:111], v[128:131], a[140:143], v[108:111]
    ds_read2_b32 v[116:117], v14 offset0:16 offset1:17
    ds_read2_b32 v[118:119], v14 offset0:18 offset1:19
    s_waitcnt lgkmcnt(8)
    v_mfma_f32_16x16x32_bf16 v[92:95], v[132:135], a[8:11], v[92:95]
    v_mfma_f32_16x16x32_bf16 v[96:99], v[132:135], a[40:43], v[96:99]
    v_mfma_f32_16x16x32_bf16 v[100:103], v[132:135], a[72:75], v[100:103]
    v_mfma_f32_16x16x32_bf16 v[104:107], v[132:135], a[104:107], v[104:107]
    v_mfma_f32_16x16x32_bf16 v[108:111], v[132:135], a[136:139], v[108:111]
    ds_read2_b32 v[120:121], v14 offset0:32 offset1:33
    ds_read2_b32 v[122:123], v14 offset0:34 offset1:35
    s_waitcnt lgkmcnt(8)
    v_mfma_f32_16x16x32_bf16 v[92:95], v[136:139], a[4:7], v[92:95]
    v_mfma_f32_16x16x32_bf16 v[96:99], v[136:139], a[36:39], v[96:99]
    v_mfma_f32_16x16x32_bf16 v[100:103], v[136:139], a[68:71], v[100:103]
    v_mfma_f32_16x16x32_bf16 v[104:107], v[136:139], a[100:103], v[104:107]
    v_mfma_f32_16x16x32_bf16 v[108:111], v[136:139], a[132:135], v[108:111]
    ds_read2_b32 v[124:125], v14 offset0:48 offset1:49
    ds_read2_b32 v[126:127], v14 offset0:50 offset1:51
    s_waitcnt lgkmcnt(8)
    v_mfma_f32_16x16x32_bf16 v[92:95], v[140:143], a[0:3], v[92:95]
    v_mfma_f32_16x16x32_bf16 v[96:99], v[140:143], a[32:35], v[96:99]
    v_mfma_f32_16x16x32_bf16 v[100:103], v[140:143], a[64:67], v[100:103]
    v_mfma_f32_16x16x32_bf16 v[104:107], v[140:143], a[96:99], v[104:107]
    v_mfma_f32_16x16x32_bf16 v[108:111], v[140:143], a[128:131], v[108:111]
    ds_read2_b32 v[128:129], v14 offset0:64 offset1:65
    ds_read2_b32 v[130:131], v14 offset0:66 offset1:67
    s_waitcnt lgkmcnt(8)
    v_mfma_f32_16x16x32_bf16 v[96:99], v[112:115], a[28:31], v[96:99]
    v_mfma_f32_16x16x32_bf16 v[100:103], v[112:115], a[60:63], v[100:103]
    v_mfma_f32_16x16x32_bf16 v[104:107], v[112:115], a[92:95], v[104:107]
    v_mfma_f32_16x16x32_bf16 v[108:111], v[112:115], a[124:127], v[108:111]
    ds_read2_b32 v[132:133], v14 offset0:80 offset1:81
    ds_read2_b32 v[134:135], v14 offset0:82 offset1:83
    s_waitcnt lgkmcnt(8)
    v_mfma_f32_16x16x32_bf16 v[96:99], v[116:119], a[24:27], v[96:99]
    v_mfma_f32_16x16x32_bf16 v[100:103], v[116:119], a[56:59], v[100:103]
    v_mfma_f32_16x16x32_bf16 v[104:107], v[116:119], a[88:91], v[104:107]
    v_mfma_f32_16x16x32_bf16 v[108:111], v[116:119], a[120:123], v[108:111]
    ds_read2_b32 v[136:137], v14 offset0:96 offset1:97
    ds_read2_b32 v[138:139], v14 offset0:98 offset1:99
    s_waitcnt vmcnt(0)
    s_barrier
    s_waitcnt lgkmcnt(8)
    v_mfma_f32_16x16x32_bf16 v[96:99], v[120:123], a[20:23], v[96:99]
    v_mfma_f32_16x16x32_bf16 v[100:103], v[120:123], a[52:55], v[100:103]
    ds_read2_b32 v[140:141], v14 offset0:112 offset1:113
    ds_read2_b32 v[142:143], v14 offset0:114 offset1:115
    v_mfma_f32_16x16x32_bf16 v[104:107], v[120:123], a[84:87], v[104:107]
    v_mfma_f32_16x16x32_bf16 v[108:111], v[120:123], a[116:119], v[108:111]
    ds_read_b64_tr_b16 v[20:21], v56 offset:0
    ds_read_b64_tr_b16 v[22:23], v56 offset:18432
    s_waitcnt lgkmcnt(10)
    v_mfma_f32_16x16x32_bf16 v[96:99], v[124:127], a[16:19], v[96:99]
    v_mfma_f32_16x16x32_bf16 v[100:103], v[124:127], a[48:51], v[100:103]
    ds_read2_b32 v[112:113], v14 offset0:128 offset1:129
    ds_read2_b32 v[114:115], v14 offset0:130 offset1:131
    v_mfma_f32_16x16x32_bf16 v[104:107], v[124:127], a[80:83], v[104:107]
    v_mfma_f32_16x16x32_bf16 v[108:111], v[124:127], a[112:115], v[108:111]
    ds_read_b64_tr_b16 v[24:25], v56 offset:32
    ds_read_b64_tr_b16 v[26:27], v56 offset:18464
    s_waitcnt lgkmcnt(12)
    v_mfma_f32_16x16x32_bf16 v[96:99], v[128:131], a[12:15], v[96:99]
    v_mfma_f32_16x16x32_bf16 v[100:103], v[128:131], a[44:47], v[100:103]
    ds_read2_b32 v[116:117], v14 offset0:144 offset1:145
    ds_read2_b32 v[118:119], v14 offset0:146 offset1:147
    v_mfma_f32_16x16x32_bf16 v[104:107], v[128:131], a[76:79], v[104:107]
    ds_read_b64_tr_b16 v[28:29], v56 offset:64
    ds_read_b64_tr_b16 v[30:31], v56 offset:18496
    v_mfma_f32_16x16x32_bf16 v[108:111], v[128:131], a[108:111], v[108:111]
    s_waitcnt lgkmcnt(8)
    s_add_u32 s9, s20, 0
    buffer_store_dwordx4 v[20:23], v57, s[68:71], s9 offen sc1
    v_mfma_f32_16x16x32_bf16 v[96:99], v[132:135], a[8:11], v[96:99]
    v_mfma_f32_16x16x32_bf16 v[100:103], v[132:135], a[40:43], v[100:103]
    ds_read2_b32 v[120:121], v14 offset0:160 offset1:161
    ds_read2_b32 v[122:123], v14 offset0:162 offset1:163
    v_mfma_f32_16x16x32_bf16 v[104:107], v[132:135], a[72:75], v[104:107]
    ds_read_b64_tr_b16 v[32:33], v56 offset:96
    ds_read_b64_tr_b16 v[34:35], v56 offset:18528
    v_mfma_f32_16x16x32_bf16 v[108:111], v[132:135], a[104:107], v[108:111]
    s_waitcnt lgkmcnt(8)
    s_add_u32 s9, s20, 1024
    buffer_store_dwordx4 v[24:27], v57, s[68:71], s9 offen sc1
    v_mfma_f32_16x16x32_bf16 v[96:99], v[136:139], a[4:7], v[96:99]
    v_mfma_f32_16x16x32_bf16 v[100:103], v[136:139], a[36:39], v[100:103]
    ds_read2_b32 v[124:125], v14 offset0:176 offset1:177
    ds_read2_b32 v[126:127], v14 offset0:178 offset1:179
    v_mfma_f32_16x16x32_bf16 v[104:107], v[136:139], a[68:71], v[104:107]
    ds_read_b64_tr_b16 v[36:37], v56 offset:128
    ds_read_b64_tr_b16 v[38:39], v56 offset:18560
    v_mfma_f32_16x16x32_bf16 v[108:111], v[136:139], a[100:103], v[108:111]
    s_waitcnt lgkmcnt(8)
    s_add_u32 s9, s20, 2048
    buffer_store_dwordx4 v[28:31], v57, s[68:71], s9 offen sc1
    v_mfma_f32_16x16x32_bf16 v[96:99], v[140:143], a[0:3], v[96:99]
    v_mfma_f32_16x16x32_bf16 v[100:103], v[140:143], a[32:35], v[100:103]
    ds_read2_b32 v[128:129], v14 offset0:192 offset1:193
    ds_read2_b32 v[130:131], v14 offset0:194 offset1:195
    v_mfma_f32_16x16x32_bf16 v[104:107], v[140:143], a[64:67], v[104:107]
    ds_read_b64_tr_b16 v[40:41], v56 offset:160
    ds_read_b64_tr_b16 v[42:43], v56 offset:18592
    v_mfma_f32_16x16x32_bf16 v[108:111], v[140:143], a[96:99], v[108:111]
    s_waitcnt lgkmcnt(8)
    s_add_u32 s9, s20, 55296
    buffer_store_dwordx4 v[32:35], v57, s[68:71], s9 offen sc1
    v_mfma_f32_16x16x32_bf16 v[100:103], v[112:115], a[28:31], v[100:103]
    ds_read2_b32 v[132:133], v14 offset0:208 offset1:209
    ds_read2_b32 v[134:135], v14 offset0:210 offset1:211
    v_mfma_f32_16x16x32_bf16 v[104:107], v[112:115], a[60:63], v[104:107]
    ds_read_b64_tr_b16 v[44:45], v56 offset:192
    ds_read_b64_tr_b16 v[46:47], v56 offset:18624
    v_mfma_f32_16x16x32_bf16 v[108:111], v[112:115], a[92:95], v[108:111]
    s_waitcnt lgkmcnt(8)
    s_add_u32 s9, s20, 56320
    buffer_store_dwordx4 v[36:39], v57, s[68:71], s9 offen sc1
    v_mfma_f32_16x16x32_bf16 v[100:103], v[116:119], a[24:27], v[100:103]
    ds_read2_b32 v[136:137], v14 offset0:224 offset1:225
    ds_read2_b32 v[138:139], v14 offset0:226 offset1:227
    v_mfma_f32_16x16x32_bf16 v[104:107], v[116:119], a[56:59], v[104:107]
    ds_read_b64_tr_b16 v[48:49], v56 offset:224
    ds_read_b64_tr_b16 v[50:51], v56 offset:18656
    v_mfma_f32_16x16x32_bf16 v[108:111], v[116:119], a[88:91], v[108:111]
    s_waitcnt lgkmcnt(8)
    s_add_u32 s9, s20, 57344
    buffer_store_dwordx4 v[40:43], v57, s[68:71], s9 offen sc1
    v_mfma_f32_16x16x32_bf16 v[100:103], v[120:123], a[20:23], v[100:103]
    ds_read2_b32 v[140:141], v14 offset0:240 offset1:241
    ds_read2_b32 v[142:143], v14 offset0:242 offset1:243
    v_mfma_f32_16x16x32_bf16 v[104:107], v[120:123], a[52:55], v[104:107]
    ds_read_b64_tr_b16 v[52:53], v56 offset:256
    ds_read_b64_tr_b16 v[54:55], v56 offset:18688
    v_mfma_f32_16x16x32_bf16 v[108:111], v[120:123], a[84:87], v[108:111]
    s_waitcnt lgkmcnt(8)
    s_add_u32 s9, s20, 110592
    buffer_store_dwordx4 v[44:47], v57, s[68:71], s9 offen sc1
    v_mfma_f32_16x16x32_bf16 v[100:103], v[124:127], a[16:19], v[100:103]
    v_mfma_f32_16x16x32_bf16 v[104:107], v[124:127], a[48:51], v[104:107]
    ds_read2_b32 v[112:113], v15 offset0:0 offset1:1
    ds_read2_b32 v[114:115], v15 offset0:2 offset1:3
    v_mfma_f32_16x16x32_bf16 v[108:111], v[124:127], a[80:83], v[108:111]
    s_waitcnt lgkmcnt(6)
    s_add_u32 s9, s20, 111616
    buffer_store_dwordx4 v[48:51], v57, s[68:71], s9 offen sc1
    v_mfma_f32_16x16x32_bf16 v[100:103], v[128:131], a[12:15], v[100:103]
    v_mfma_f32_16x16x32_bf16 v[104:107], v[128:131], a[44:47], v[104:107]
    ds_read2_b32 v[116:117], v15 offset0:16 offset1:17
    ds_read2_b32 v[118:119], v15 offset0:18 offset1:19
    v_mfma_f32_16x16x32_bf16 v[108:111], v[128:131], a[76:79], v[108:111]
    s_waitcnt lgkmcnt(4)
    s_add_u32 s9, s20, 112640
    buffer_store_dwordx4 v[52:55], v57, s[68:71], s9 offen sc1
    v_mfma_f32_16x16x32_bf16 v[100:103], v[132:135], a[8:11], v[100:103]
    v_mfma_f32_16x16x32_bf16 v[104:107], v[132:135], a[40:43], v[104:107]
    v_mfma_f32_16x16x32_bf16 v[108:111], v[132:135], a[72:75], v[108:111]
    ds_read2_b32 v[120:121], v15 offset0:32 offset1:33
    ds_read2_b32 v[122:123], v15 offset0:34 offset1:35
    v_mfma_f32_16x16x32_bf16 v[100:103], v[136:139], a[4:7], v[100:103]
    v_mfma_f32_16x16x32_bf16 v[104:107], v[136:139], a[36:39], v[104:107]
    v_mfma_f32_16x16x32_bf16 v[108:111], v[136:139], a[68:71], v[108:111]
    ds_read2_b32 v[124:125], v15 offset0:48 offset1:49
    ds_read2_b32 v[126:127], v15 offset0:50 offset1:51
    v_mfma_f32_16x16x32_bf16 v[100:103], v[140:143], a[0:3], v[100:103]
    v_mfma_f32_16x16x32_bf16 v[104:107], v[140:143], a[32:35], v[104:107]
    v_mfma_f32_16x16x32_bf16 v[108:111], v[140:143], a[64:67], v[108:111]
    ds_read2_b32 v[128:129], v15 offset0:64 offset1:65
    ds_read2_b32 v[130:131], v15 offset0:66 offset1:67
    s_waitcnt lgkmcnt(8)
    v_mfma_f32_16x16x32_bf16 v[104:107], v[112:115], a[28:31], v[104:107]
    v_mfma_f32_16x16x32_bf16 v[108:111], v[112:115], a[60:63], v[108:111]
    ds_read2_b32 v[132:133], v15 offset0:80 offset1:81
    ds_read2_b32 v[134:135], v15 offset0:82 offset1:83
    s_waitcnt lgkmcnt(8)
    v_mfma_f32_16x16x32_bf16 v[104:107], v[116:119], a[24:27], v[104:107]
    v_mfma_f32_16x16x32_bf16 v[108:111], v[116:119], a[56:59], v[108:111]
    ds_read2_b32 v[136:137], v15 offset0:96 offset1:97
    ds_read2_b32 v[138:139], v15 offset0:98 offset1:99
    s_waitcnt lgkmcnt(8)
    v_mfma_f32_16x16x32_bf16 v[104:107], v[120:123], a[20:23], v[104:107]
    v_mfma_f32_16x16x32_bf16 v[108:111], v[120:123], a[52:55], v[108:111]
    ds_read2_b32 v[140:141], v15 offset0:112 offset1:113
    ds_read2_b32 v[142:143], v15 offset0:114 offset1:115
    s_waitcnt lgkmcnt(8)
    v_mfma_f32_16x16x32_bf16 v[104:107], v[124:127], a[16:19], v[104:107]
    v_mfma_f32_16x16x32_bf16 v[108:111], v[124:127], a[48:51], v[108:111]
    ds_read2_b32 v[112:113], v15 offset0:128 offset1:129
    ds_read2_b32 v[114:115], v15 offset0:130 offset1:131
    s_waitcnt lgkmcnt(8)
    v_mfma_f32_16x16x32_bf16 v[104:107], v[128:131], a[12:15], v[104:107]
    v_mfma_f32_16x16x32_bf16 v[108:111], v[128:131], a[44:47], v[108:111]
    ds_read2_b32 v[116:117], v15 offset0:144 offset1:145
    ds_read2_b32 v[118:119], v15 offset0:146 offset1:147
    s_waitcnt lgkmcnt(8)
    v_mfma_f32_16x16x32_bf16 v[104:107], v[132:135], a[8:11], v[104:107]
    v_mfma_f32_16x16x32_bf16 v[108:111], v[132:135], a[40:43], v[108:111]
    ds_read2_b32 v[120:121], v15 offset0:160 offset1:161
    ds_read2_b32 v[122:123], v15 offset0:162 offset1:163
    s_waitcnt lgkmcnt(8)
    v_mfma_f32_16x16x32_bf16 v[104:107], v[136:139], a[4:7], v[104:107]
    v_mfma_f32_16x16x32_bf16 v[108:111], v[136:139], a[36:39], v[108:111]
    ds_read2_b32 v[124:125], v15 offset0:176 offset1:177
    ds_read2_b32 v[126:127], v15 offset0:178 offset1:179
    s_waitcnt lgkmcnt(8)
    v_mfma_f32_16x16x32_bf16 v[104:107], v[140:143], a[0:3], v[104:107]
    v_mfma_f32_16x16x32_bf16 v[108:111], v[140:143], a[32:35], v[108:111]
    ds_read2_b32 v[128:129], v15 offset0:192 offset1:193
    ds_read2_b32 v[130:131], v15 offset0:194 offset1:195
    s_waitcnt lgkmcnt(8)
    v_mfma_f32_16x16x32_bf16 v[108:111], v[112:115], a[28:31], v[108:111]
    ds_read2_b32 v[132:133], v15 offset0:208 offset1:209
    ds_read2_b32 v[134:135], v15 offset0:210 offset1:211
    s_waitcnt lgkmcnt(8)
    v_mfma_f32_16x16x32_bf16 v[108:111], v[116:119], a[24:27], v[108:111]
    ds_read2_b32 v[136:137], v15 offset0:224 offset1:225
    ds_read2_b32 v[138:139], v15 offset0:226 offset1:227
    s_waitcnt lgkmcnt(8)
    v_mfma_f32_16x16x32_bf16 v[108:111], v[120:123], a[20:23], v[108:111]
    ds_read2_b32 v[140:141], v15 offset0:240 offset1:241
    ds_read2_b32 v[142:143], v15 offset0:242 offset1:243
    s_waitcnt lgkmcnt(8)
    v_mfma_f32_16x16x32_bf16 v[108:111], v[124:127], a[16:19], v[108:111]
    s_waitcnt lgkmcnt(6)
    v_mfma_f32_16x16x32_bf16 v[108:111], v[128:131], a[12:15], v[108:111]
    s_waitcnt lgkmcnt(4)
    v_mfma_f32_16x16x32_bf16 v[108:111], v[132:135], a[8:11], v[108:111]
    s_waitcnt lgkmcnt(2)
    v_mfma_f32_16x16x32_bf16 v[108:111], v[136:139], a[4:7], v[108:111]
    s_waitcnt lgkmcnt(0)
    v_mfma_f32_16x16x32_bf16 v[108:111], v[140:143], a[0:3], v[108:111]
    s_nop 7
    s_nop 1
    v_lshlrev_b32 v16, 5, v8
    v_lshlrev_b32 v17, 3, v9
    v_add3_u32 v16, v16, v17, s7
    v_cvt_pk_bf16_f32 v20, v80, v81
    v_cvt_pk_bf16_f32 v21, v82, v83
    ds_write_b64 v16, v[20:21] offset:0
    v_cvt_pk_bf16_f32 v22, v84, v85
    v_cvt_pk_bf16_f32 v23, v86, v87
    ds_write_b64 v16, v[22:23] offset:512
    v_cvt_pk_bf16_f32 v24, v88, v89
    v_cvt_pk_bf16_f32 v25, v90, v91
    ds_write_b64 v16, v[24:25] offset:1024
    v_cvt_pk_bf16_f32 v26, v92, v93
    v_cvt_pk_bf16_f32 v27, v94, v95
    ds_write_b64 v16, v[26:27] offset:1536
    v_cvt_pk_bf16_f32 v28, v96, v97
    v_cvt_pk_bf16_f32 v29, v98, v99
    ds_write_b64 v16, v[28:29] offset:2048
    v_cvt_pk_bf16_f32 v30, v100, v101
    v_cvt_pk_bf16_f32 v31, v102, v103
    ds_write_b64 v16, v[30:31] offset:2560
    v_cvt_pk_bf16_f32 v32, v104, v105
    v_cvt_pk_bf16_f32 v33, v106, v107
    ds_write_b64 v16, v[32:33] offset:3072
    v_cvt_pk_bf16_f32 v34, v108, v109
    v_cvt_pk_bf16_f32 v35, v110, v111
    ds_write_b64 v16, v[34:35] offset:3584
    s_waitcnt lgkmcnt(0)
    s_barrier
    v_bfe_u32 v16, v1, 2, 2
    v_mul_u32_u24 v16, 13120, v16
    v_and_b32 v17, 3, v1
    v_lshlrev_b32 v17, 3, v17
    v_lshlrev_b32 v18, 5, v9
    v_add3_u32 v16, v16, v17, v18
    s_lshl_b32 s8, s3, 10
    v_add_u32 v16, s8, v16
    ds_read_b64_tr_b16 v[20:21], v16 offset:0
    ds_read_b64_tr_b16 v[22:23], v16 offset:128
    ds_read_b64_tr_b16 v[24:25], v16 offset:256
    ds_read_b64_tr_b16 v[26:27], v16 offset:384
    ds_read_b64_tr_b16 v[28:29], v16 offset:512
    ds_read_b64_tr_b16 v[30:31], v16 offset:640
    ds_read_b64_tr_b16 v[32:33], v16 offset:768
    ds_read_b64_tr_b16 v[34:35], v16 offset:896
    s_lshl_b32 s8, s2, 14
    s_lshl_b32 s9, s3, 12
    s_add_u32 s8, s8, s9
    v_lshlrev_b32 v17, 3, v1
    v_add_u32 v17, s8, v17
    s_waitcnt lgkmcnt(7)
    buffer_store_dwordx2 v[20:21], v17, s[48:51], 0 offen offset:0 sc1
    s_waitcnt lgkmcnt(6)
    buffer_store_dwordx2 v[22:23], v17, s[48:51], 0 offen offset:512 sc1
    s_waitcnt lgkmcnt(5)
    buffer_store_dwordx2 v[24:25], v17, s[48:51], 0 offen offset:1024 sc1
    s_waitcnt lgkmcnt(4)
    buffer_store_dwordx2 v[26:27], v17, s[48:51], 0 offen offset:1536 sc1
    s_waitcnt lgkmcnt(3)
    buffer_store_dwordx2 v[28:29], v17, s[48:51], 0 offen offset:2048 sc1
    s_waitcnt lgkmcnt(2)
    buffer_store_dwordx2 v[30:31], v17, s[48:51], 0 offen offset:2560 sc1
    s_waitcnt lgkmcnt(1)
    buffer_store_dwordx2 v[32:33], v17, s[48:51], 0 offen offset:3072 sc1
    s_waitcnt lgkmcnt(0)
    buffer_store_dwordx2 v[34:35], v17, s[48:51], 0 offen offset:3584 sc1
    s_endpgm
K2_EXTRA:
    s_sub_u32 s4, s2, 144
    v_lshlrev_b32 v4, 4, v1
    s_mul_i32 s8, s3, 9216
    v_add_u32 v4, s8, v4
    v_lshrrev_b32 v20, 4, v1
    v_bfe_u32 v21, v1, 2, 2
    v_and_b32 v22, 3, v1
    v_lshlrev_b32 v22, 3, v22
    v_lshl_add_u32 v5, v20, 3, v21
    v_mul_u32_u24 v5, 1152, v5
    v_add_u32 v5, v5, v22
    v_lshlrev_b32 v2, 4, v1
    s_waitcnt lgkmcnt(0)
    s_getpc_b64 s[66:67]
PC_1:
    s_sub_u32 s64, s66, PC_1 - k2_kernel
    s_subb_u32 s65, s67, 0
    s_mov_b32 s66, CODE_END - k2_kernel
    s_mov_b32 s67, 0x20000
    s_lshr_b32 s68, s4, 3
    s_lshl_b32 s68, s68, 2
    s_add_u32 s68, s68, s3
    s_mul_i32 s68, s68, 2048
    v_lshlrev_b32 v18, 4, v1
    v_add_u32 v18, s68, v18
    buffer_load_dwordx4 v[148:151], v18, s[64:67], 0 offen offset:0
    buffer_load_dwordx4 v[148:151], v18, s[64:67], 0 offen offset:1024
    s_getpc_b64 s[68:69]
    s_add_u32 s68, s68, KD_START@rel32@lo+4
    s_addc_u32 s69, s69, KD_START@rel32@hi+12
    s_mov_b32 s70, 192
    s_mov_b32 s71, 0x20000
    v_lshlrev_b32 v18, 3, v1
    buffer_load_dwordx2 v[148:149], v18, s[68:71], 0 offen
    s_mov_b32 s48, s34
    s_mov_b32 s49, s35
    s_mov_b32 s50, 5308416
    s_mov_b32 s51, 0x20000
    s_add_u32 s64, s46, 6062080
    s_addc_u32 s65, s47, 0
    s_mov_b32 s66, 5308416
    s_mov_b32 s67, 0x20000
    s_cmp_ge_u32 s4, 58
    s_cbranch_scc1 K2_CAT1
    v_lshrrev_b32 v8, 3, v1
    v_mul_u32_u24 v8, 9216, v8
    v_and_b32 v9, 7, v1
    v_lshl_add_u32 v8, v9, 4, v8
    s_mul_i32 s12, s3, 1327104
    s_lshl_b32 s13, s4, 7
    s_add_u32 s12, s12, s13
    s_mul_i32 s13, s3, 18432
    s_add_u32 m0, s13, 0
    s_add_u32 s14, s12, 0
    buffer_load_dwordx4 v8, s[48:51], s14 offen nt lds
    s_add_u32 m0, s13, 1024
    s_add_u32 s14, s12, 73728
    buffer_load_dwordx4 v8, s[48:51], s14 offen nt lds
    s_add_u32 m0, s13, 2048
    s_add_u32 s14, s12, 147456
    buffer_load_dwordx4 v8, s[48:51], s14 offen nt lds
    s_add_u32 m0, s13, 3072
    s_add_u32 s14, s12, 221184
    buffer_load_dwordx4 v8, s[48:51], s14 offen nt lds
    s_add_u32 m0, s13, 4096
    s_add_u32 s14, s12, 294912
    buffer_load_dwordx4 v8, s[48:51], s14 offen nt lds
    s_add_u32 m0, s13, 5120
    s_add_u32 s14, s12, 368640
    buffer_load_dwordx4 v8, s[48:51], s14 offen nt lds
    s_add_u32 m0, s13, 6144
    s_add_u32 s14, s12, 442368
    buffer_load_dwordx4 v8, s[48:51], s14 offen nt lds
    s_add_u32 m0, s13, 7168
    s_add_u32 s14, s12, 516096
    buffer_load_dwordx4 v8, s[48:51], s14 offen nt lds
    s_add_u32 m0, s13, 8192
    s_add_u32 s14, s12, 589824
    buffer_load_dwordx4 v8, s[48:51], s14 offen nt lds
    s_add_u32 m0, s13, 9216
    s_add_u32 s14, s12, 663552
    buffer_load_dwordx4 v8, s[48:51], s14 offen nt lds
    s_add_u32 m0, s13, 10240
    s_add_u32 s14, s12, 737280
    buffer_load_dwordx4 v8, s[48:51], s14 offen nt lds
    s_add_u32 m0, s13, 11264
    s_add_u32 s14, s12, 811008
    buffer_load_dwordx4 v8, s[48:51], s14 offen nt lds
    s_add_u32 m0, s13, 12288
    s_add_u32 s14, s12, 884736
    buffer_load_dwordx4 v8, s[48:51], s14 offen nt lds
    s_add_u32 m0, s13, 13312
    s_add_u32 s14, s12, 958464
    buffer_load_dwordx4 v8, s[48:51], s14 offen nt lds
    s_add_u32 m0, s13, 14336
    s_add_u32 s14, s12, 1032192
    buffer_load_dwordx4 v8, s[48:51], s14 offen nt lds
    s_add_u32 m0, s13, 15360
    s_add_u32 s14, s12, 1105920
    buffer_load_dwordx4 v8, s[48:51], s14 offen nt lds
    s_add_u32 m0, s13, 16384
    s_add_u32 s14, s12, 1179648
    buffer_load_dwordx4 v8, s[48:51], s14 offen nt lds
    s_add_u32 m0, s13, 17408
    s_add_u32 s14, s12, 1253376
    buffer_load_dwordx4 v8, s[48:51], s14 offen nt lds
    s_mov_b32 s76, s16
    s_mov_b32 s77, s17
    s_mov_b32 s78, 2359296
    s_mov_b32 s79, 0x20000
    s_lshr_b32 s15, s4, 3
    s_lshl_b32 s15, s15, 2
    s_add_u32 s15, s15, s3
    s_mul_i32 s15, s15, 6
    s_add_u32 s9, s15, 0
    s_mul_i32 s10, s9, 57
    s_lshr_b32 s10, s10, 11
    s_mul_i32 s11, s10, 36
    s_sub_u32 s11, s9, s11
    s_lshl_b32 s10, s10, 3
    s_and_b32 s12, s4, 7
    s_add_u32 s10, s10, s12
    s_mul_i32 s10, s10, 36
    s_add_u32 s10, s10, s11
    s_lshl_b32 s10, s10, 10
    v_add_u32 v18, s10, v2
    buffer_load_dwordx4 v[136:139], v18, s[76:79], 0 offen
    s_add_u32 s9, s15, 1
    s_mul_i32 s10, s9, 57
    s_lshr_b32 s10, s10, 11
    s_mul_i32 s11, s10, 36
    s_sub_u32 s11, s9, s11
    s_lshl_b32 s10, s10, 3
    s_and_b32 s12, s4, 7
    s_add_u32 s10, s10, s12
    s_mul_i32 s10, s10, 36
    s_add_u32 s10, s10, s11
    s_lshl_b32 s10, s10, 10
    v_add_u32 v18, s10, v2
    buffer_load_dwordx4 v[136:139], v18, s[76:79], 0 offen
    s_add_u32 s9, s15, 2
    s_mul_i32 s10, s9, 57
    s_lshr_b32 s10, s10, 11
    s_mul_i32 s11, s10, 36
    s_sub_u32 s11, s9, s11
    s_lshl_b32 s10, s10, 3
    s_and_b32 s12, s4, 7
    s_add_u32 s10, s10, s12
    s_mul_i32 s10, s10, 36
    s_add_u32 s10, s10, s11
    s_lshl_b32 s10, s10, 10
    v_add_u32 v18, s10, v2
    buffer_load_dwordx4 v[136:139], v18, s[76:79], 0 offen
    s_add_u32 s9, s15, 3
    s_mul_i32 s10, s9, 57
    s_lshr_b32 s10, s10, 11
    s_mul_i32 s11, s10, 36
    s_sub_u32 s11, s9, s11
    s_lshl_b32 s10, s10, 3
    s_and_b32 s12, s4, 7
    s_add_u32 s10, s10, s12
    s_mul_i32 s10, s10, 36
    s_add_u32 s10, s10, s11
    s_lshl_b32 s10, s10, 10
    v_add_u32 v18, s10, v2
    buffer_load_dwordx4 v[136:139], v18, s[76:79], 0 offen
    s_add_u32 s9, s15, 4
    s_mul_i32 s10, s9, 57
    s_lshr_b32 s10, s10, 11
    s_mul_i32 s11, s10, 36
    s_sub_u32 s11, s9, s11
    s_lshl_b32 s10, s10, 3
    s_and_b32 s12, s4, 7
    s_add_u32 s10, s10, s12
    s_mul_i32 s10, s10, 36
    s_add_u32 s10, s10, s11
    s_lshl_b32 s10, s10, 10
    v_add_u32 v18, s10, v2
    buffer_load_dwordx4 v[136:139], v18, s[76:79], 0 offen
    s_add_u32 s9, s15, 5
    s_mul_i32 s10, s9, 57
    s_lshr_b32 s10, s10, 11
    s_mul_i32 s11, s10, 36
    s_sub_u32 s11, s9, s11
    s_lshl_b32 s10, s10, 3
    s_and_b32 s12, s4, 7
    s_add_u32 s10, s10, s12
    s_mul_i32 s10, s10, 36
    s_add_u32 s10, s10, s11
    s_lshl_b32 s10, s10, 10
    v_add_u32 v18, s10, v2
    buffer_load_dwordx4 v[136:139], v18, s[76:79], 0 offen
    s_waitcnt vmcnt(6)
    s_barrier
    v_and_b32 v8, 31, v0
    v_lshlrev_b32 v8, 2, v8
    v_lshrrev_b32 v9, 5, v0
    v_lshl_add_u32 v8, v9, 7, v8
    v_add_u32 v10, 0x10000, v8
    s_mov_b32 s14, 0x00003f80
    s_mov_b32 s15, 0x3f800000
    v_mov_b32 v12, 0
    v_mov_b32 v13, 0
    v_mov_b32 v14, 0
    v_mov_b32 v15, 0
    ds_read_b32 v64, v8 offset:0
    ds_read_b32 v65, v8 offset:1024
    ds_read_b32 v66, v8 offset:2048
    ds_read_b32 v67, v8 offset:3072
    ds_read_b32 v68, v8 offset:4096
    ds_read_b32 v69, v8 offset:5120
    ds_read_b32 v70, v8 offset:6144
    ds_read_b32 v71, v8 offset:7168
    ds_read_b32 v72, v8 offset:8192
    ds_read_b32 v73, v8 offset:9216
    ds_read_b32 v74, v8 offset:10240
    s_waitcnt lgkmcnt(10)
    v_dot2_f32_bf16 v12, v64, s14, v12
    v_dot2_f32_bf16 v14, v64, s15, v14
    ds_read_b32 v75, v8 offset:11264
    s_waitcnt lgkmcnt(10)
    v_dot2_f32_bf16 v13, v65, s14, v13
    v_dot2_f32_bf16 v15, v65, s15, v15
    ds_read_b32 v64, v8 offset:12288
    s_waitcnt lgkmcnt(10)
    v_dot2_f32_bf16 v12, v66, s14, v12
    v_dot2_f32_bf16 v14, v66, s15, v14
    ds_read_b32 v65, v8 offset:13312
    s_waitcnt lgkmcnt(10)
    v_dot2_f32_bf16 v13, v67, s14, v13
    v_dot2_f32_bf16 v15, v67, s15, v15
    ds_read_b32 v66, v8 offset:14336
    s_waitcnt lgkmcnt(10)
    v_dot2_f32_bf16 v12, v68, s14, v12
    v_dot2_f32_bf16 v14, v68, s15, v14
    ds_read_b32 v67, v8 offset:15360
    s_waitcnt lgkmcnt(10)
    v_dot2_f32_bf16 v13, v69, s14, v13
    v_dot2_f32_bf16 v15, v69, s15, v15
    ds_read_b32 v68, v8 offset:16384
    s_waitcnt lgkmcnt(10)
    v_dot2_f32_bf16 v12, v70, s14, v12
    v_dot2_f32_bf16 v14, v70, s15, v14
    ds_read_b32 v69, v8 offset:17408
    s_waitcnt lgkmcnt(10)
    v_dot2_f32_bf16 v13, v71, s14, v13
    v_dot2_f32_bf16 v15, v71, s15, v15
    ds_read_b32 v70, v8 offset:18432
    s_waitcnt lgkmcnt(10)
    v_dot2_f32_bf16 v12, v72, s14, v12
    v_dot2_f32_bf16 v14, v72, s15, v14
    ds_read_b32 v71, v8 offset:19456
    s_waitcnt lgkmcnt(10)
    v_dot2_f32_bf16 v13, v73, s14, v13
    v_dot2_f32_bf16 v15, v73, s15, v15
    ds_read_b32 v72, v8 offset:20480
    s_waitcnt lgkmcnt(10)
    v_dot2_f32_bf16 v12, v74, s14, v12
    v_dot2_f32_bf16 v14, v74, s15, v14
    ds_read_b32 v73, v8 offset:21504
    s_waitcnt lgkmcnt(10)
    v_dot2_f32_bf16 v13, v75, s14, v13
    v_dot2_f32_bf16 v15, v75, s15, v15
    ds_read_b32 v74, v8 offset:22528
    s_waitcnt lgkmcnt(10)
    v_dot2_f32_bf16 v12, v64, s14, v12
    v_dot2_f32_bf16 v14, v64, s15, v14
    ds_read_b32 v75, v8 offset:23552
    s_waitcnt lgkmcnt(10)
    v_dot2_f32_bf16 v13, v65, s14, v13
    v_dot2_f32_bf16 v15, v65, s15, v15
    ds_read_b32 v64, v8 offset:24576
    s_waitcnt lgkmcnt(10)
    v_dot2_f32_bf16 v12, v66, s14, v12
    v_dot2_f32_bf16 v14, v66, s15, v14
    ds_read_b32 v65, v8 offset:25600
    s_waitcnt lgkmcnt(10)
    v_dot2_f32_bf16 v13, v67, s14, v13
    v_dot2_f32_bf16 v15, v67, s15, v15
    ds_read_b32 v66, v8 offset:26624
    s_waitcnt lgkmcnt(10)
    v_dot2_f32_bf16 v12, v68, s14, v12
    v_dot2_f32_bf16 v14, v68, s15, v14
    ds_read_b32 v67, v8 offset:27648
    s_waitcnt lgkmcnt(10)
    v_dot2_f32_bf16 v13, v69, s14, v13
    v_dot2_f32_bf16 v15, v69, s15, v15
    ds_read_b32 v68, v8 offset:28672
    s_waitcnt lgkmcnt(10)
    v_dot2_f32_bf16 v12, v70, s14, v12
    v_dot2_f32_bf16 v14, v70, s15, v14
    ds_read_b32 v69, v8 offset:29696
    s_waitcnt lgkmcnt(10)
    v_dot2_f32_bf16 v13, v71, s14, v13
    v_dot2_f32_bf16 v15, v71, s15, v15
    ds_read_b32 v70, v8 offset:30720
    s_waitcnt lgkmcnt(10)
    v_dot2_f32_bf16 v12, v72, s14, v12
    v_dot2_f32_bf16 v14, v72, s15, v14
    ds_read_b32 v71, v8 offset:31744
    s_waitcnt lgkmcnt(10)
    v_dot2_f32_bf16 v13, v73, s14, v13
    v_dot2_f32_bf16 v15, v73, s15, v15
    ds_read_b32 v72, v8 offset:32768
    s_waitcnt lgkmcnt(10)
    v_dot2_f32_bf16 v12, v74, s14, v12
    v_dot2_f32_bf16 v14, v74, s15, v14
    ds_read_b32 v73, v8 offset:33792
    s_waitcnt lgkmcnt(10)
    v_dot2_f32_bf16 v13, v75, s14, v13
    v_dot2_f32_bf16 v15, v75, s15, v15
    ds_read_b32 v74, v8 offset:34816
    s_waitcnt lgkmcnt(10)
    v_dot2_f32_bf16 v12, v64, s14, v12
    v_dot2_f32_bf16 v14, v64, s15, v14
    ds_read_b32 v75, v8 offset:35840
    s_waitcnt lgkmcnt(10)
    v_dot2_f32_bf16 v13, v65, s14, v13
    v_dot2_f32_bf16 v15, v65, s15, v15
    ds_read_b32 v64, v8 offset:36864
    s_waitcnt lgkmcnt(10)
    v_dot2_f32_bf16 v12, v66, s14, v12
    v_dot2_f32_bf16 v14, v66, s15, v14
    ds_read_b32 v65, v8 offset:37888
    s_waitcnt lgkmcnt(10)
    v_dot2_f32_bf16 v13, v67, s14, v13
    v_dot2_f32_bf16 v15, v67, s15, v15
    ds_read_b32 v66, v8 offset:38912
    s_waitcnt lgkmcnt(10)
    v_dot2_f32_bf16 v12, v68, s14, v12
    v_dot2_f32_bf16 v14, v68, s15, v14
    ds_read_b32 v67, v8 offset:39936
    s_waitcnt lgkmcnt(10)
    v_dot2_f32_bf16 v13, v69, s14, v13
    v_dot2_f32_bf16 v15, v69, s15, v15
    ds_read_b32 v68, v8 offset:40960
    s_waitcnt lgkmcnt(10)
    v_dot2_f32_bf16 v12, v70, s14, v12
    v_dot2_f32_bf16 v14, v70, s15, v14
    ds_read_b32 v69, v8 offset:41984
    s_waitcnt lgkmcnt(10)
    v_dot2_f32_bf16 v13, v71, s14, v13
    v_dot2_f32_bf16 v15, v71, s15, v15
    ds_read_b32 v70, v8 offset:43008
    s_waitcnt lgkmcnt(10)
    v_dot2_f32_bf16 v12, v72, s14, v12
    v_dot2_f32_bf16 v14, v72, s15, v14
    ds_read_b32 v71, v8 offset:44032
    s_waitcnt lgkmcnt(10)
    v_dot2_f32_bf16 v13, v73, s14, v13
    v_dot2_f32_bf16 v15, v73, s15, v15
    ds_read_b32 v72, v8 offset:45056
    s_waitcnt lgkmcnt(10)
    v_dot2_f32_bf16 v12, v74, s14, v12
    v_dot2_f32_bf16 v14, v74, s15, v14
    ds_read_b32 v73, v8 offset:46080
    s_waitcnt lgkmcnt(10)
    v_dot2_f32_bf16 v13, v75, s14, v13
    v_dot2_f32_bf16 v15, v75, s15, v15
    ds_read_b32 v74, v8 offset:47104
    s_waitcnt lgkmcnt(10)
    v_dot2_f32_bf16 v12, v64, s14, v12
    v_dot2_f32_bf16 v14, v64, s15, v14
    ds_read_b32 v75, v8 offset:48128
    s_waitcnt lgkmcnt(10)
    v_dot2_f32_bf16 v13, v65, s14, v13
    v_dot2_f32_bf16 v15, v65, s15, v15
    ds_read_b32 v64, v8 offset:49152
    s_waitcnt lgkmcnt(10)
    v_dot2_f32_bf16 v12, v66, s14, v12
    v_dot2_f32_bf16 v14, v66, s15, v14
    ds_read_b32 v65, v8 offset:50176
    s_waitcnt lgkmcnt(10)
    v_dot2_f32_bf16 v13, v67, s14, v13
    v_dot2_f32_bf16 v15, v67, s15, v15
    ds_read_b32 v66, v8 offset:51200
    s_waitcnt lgkmcnt(10)
    v_dot2_f32_bf16 v12, v68, s14, v12
    v_dot2_f32_bf16 v14, v68, s15, v14
    ds_read_b32 v67, v8 offset:52224
    s_waitcnt lgkmcnt(10)
    v_dot2_f32_bf16 v13, v69, s14, v13
    v_dot2_f32_bf16 v15, v69, s15, v15
    ds_read_b32 v68, v8 offset:53248
    s_waitcnt lgkmcnt(10)
    v_dot2_f32_bf16 v12, v70, s14, v12
    v_dot2_f32_bf16 v14, v70, s15, v14
    ds_read_b32 v69, v8 offset:54272
    s_waitcnt lgkmcnt(10)
    v_dot2_f32_bf16 v13, v71, s14, v13
    v_dot2_f32_bf16 v15, v71, s15, v15
    ds_read_b32 v70, v8 offset:55296
    s_waitcnt lgkmcnt(10)
    v_dot2_f32_bf16 v12, v72, s14, v12
    v_dot2_f32_bf16 v14, v72, s15, v14
    ds_read_b32 v71, v8 offset:56320
    s_waitcnt lgkmcnt(10)
    v_dot2_f32_bf16 v13, v73, s14, v13
    v_dot2_f32_bf16 v15, v73, s15, v15
    ds_read_b32 v72, v8 offset:57344
    s_waitcnt lgkmcnt(10)
    v_dot2_f32_bf16 v12, v74, s14, v12
    v_dot2_f32_bf16 v14, v74, s15, v14
    ds_read_b32 v73, v8 offset:58368
    s_waitcnt lgkmcnt(10)
    v_dot2_f32_bf16 v13, v75, s14, v13
    v_dot2_f32_bf16 v15, v75, s15, v15
    ds_read_b32 v74, v8 offset:59392
    s_waitcnt lgkmcnt(10)
    v_dot2_f32_bf16 v12, v64, s14, v12
    v_dot2_f32_bf16 v14, v64, s15, v14
    ds_read_b32 v75, v8 offset:60416
    s_waitcnt lgkmcnt(10)
    v_dot2_f32_bf16 v13, v65, s14, v13
    v_dot2_f32_bf16 v15, v65, s15, v15
    ds_read_b32 v64, v8 offset:61440
    s_waitcnt lgkmcnt(10)
    v_dot2_f32_bf16 v12, v66, s14, v12
    v_dot2_f32_bf16 v14, v66, s15, v14
    ds_read_b32 v65, v8 offset:62464
    s_waitcnt lgkmcnt(10)
    v_dot2_f32_bf16 v13, v67, s14, v13
    v_dot2_f32_bf16 v15, v67, s15, v15
    ds_read_b32 v66, v8 offset:63488
    s_waitcnt lgkmcnt(10)
    v_dot2_f32_bf16 v12, v68, s14, v12
    v_dot2_f32_bf16 v14, v68, s15, v14
    ds_read_b32 v67, v8 offset:64512
    s_waitcnt lgkmcnt(10)
    v_dot2_f32_bf16 v13, v69, s14, v13
    v_dot2_f32_bf16 v15, v69, s15, v15
    ds_read_b32 v68, v10 offset:0
    s_waitcnt lgkmcnt(10)
    v_dot2_f32_bf16 v12, v70, s14, v12
    v_dot2_f32_bf16 v14, v70, s15, v14
    ds_read_b32 v69, v10 offset:1024
    s_waitcnt lgkmcnt(10)
    v_dot2_f32_bf16 v13, v71, s14, v13
    v_dot2_f32_bf16 v15, v71, s15, v15
    ds_read_b32 v70, v10 offset:2048
    s_waitcnt lgkmcnt(10)
    v_dot2_f32_bf16 v12, v72, s14, v12
    v_dot2_f32_bf16 v14, v72, s15, v14
    ds_read_b32 v71, v10 offset:3072
    s_waitcnt lgkmcnt(10)
    v_dot2_f32_bf16 v13, v73, s14, v13
    v_dot2_f32_bf16 v15, v73, s15, v15
    ds_read_b32 v72, v10 offset:4096
    s_waitcnt lgkmcnt(10)
    v_dot2_f32_bf16 v12, v74, s14, v12
    v_dot2_f32_bf16 v14, v74, s15, v14
    ds_read_b32 v73, v10 offset:5120
    s_waitcnt lgkmcnt(10)
    v_dot2_f32_bf16 v13, v75, s14, v13
    v_dot2_f32_bf16 v15, v75, s15, v15
    ds_read_b32 v74, v10 offset:6144
    s_waitcnt lgkmcnt(10)
    v_dot2_f32_bf16 v12, v64, s14, v12
    v_dot2_f32_bf16 v14, v64, s15, v14
    ds_read_b32 v75, v10 offset:7168
    s_waitcnt lgkmcnt(10)
    v_dot2_f32_bf16 v13, v65, s14, v13
    v_dot2_f32_bf16 v15, v65, s15, v15
    s_waitcnt lgkmcnt(9)
    v_dot2_f32_bf16 v12, v66, s14, v12
    v_dot2_f32_bf16 v14, v66, s15, v14
    s_waitcnt lgkmcnt(8)
    v_dot2_f32_bf16 v13, v67, s14, v13
    v_dot2_f32_bf16 v15, v67, s15, v15
    s_waitcnt lgkmcnt(7)
    v_dot2_f32_bf16 v12, v68, s14, v12
    v_dot2_f32_bf16 v14, v68, s15, v14
    s_waitcnt lgkmcnt(6)
    v_dot2_f32_bf16 v13, v69, s14, v13
    v_dot2_f32_bf16 v15, v69, s15, v15
    s_waitcnt lgkmcnt(5)
    v_dot2_f32_bf16 v12, v70, s14, v12
    v_dot2_f32_bf16 v14, v70, s15, v14
    s_waitcnt lgkmcnt(4)
    v_dot2_f32_bf16 v13, v71, s14, v13
    v_dot2_f32_bf16 v15, v71, s15, v15
    s_waitcnt lgkmcnt(3)
    v_dot2_f32_bf16 v12, v72, s14, v12
    v_dot2_f32_bf16 v14, v72, s15, v14
    s_waitcnt lgkmcnt(2)
    v_dot2_f32_bf16 v13, v73, s14, v13
    v_dot2_f32_bf16 v15, v73, s15, v15
    s_waitcnt lgkmcnt(1)
    v_dot2_f32_bf16 v12, v74, s14, v12
    v_dot2_f32_bf16 v14, v74, s15, v14
    s_waitcnt lgkmcnt(0)
    v_dot2_f32_bf16 v13, v75, s14, v13
    v_dot2_f32_bf16 v15, v75, s15, v15
    s_nop 3
    v_add_f32 v12, v12, v13
    v_add_f32 v13, v14, v15
    v_lshlrev_b32 v9, 8, v9
    v_and_b32 v10, 31, v0
    v_lshl_add_u32 v9, v10, 3, v9
    v_add_u32 v9, 73728, v9
    ds_write_b64 v9, v[12:13]
    s_waitcnt lgkmcnt(0)
    s_barrier
    v_and_b32 v9, 15, v1
    s_lshl_b32 s14, s3, 4
    v_add_u32 v9, s14, v9
    v_lshlrev_b32 v9, 2, v9
    v_add_u32 v9, 73728, v9
    ds_read_b32 v64, v9 offset:0
    ds_read_b32 v65, v9 offset:256
    ds_read_b32 v66, v9 offset:512
    ds_read_b32 v67, v9 offset:768
    ds_read_b32 v68, v9 offset:1024
    ds_read_b32 v69, v9 offset:1280
    ds_read_b32 v70, v9 offset:1536
    ds_read_b32 v71, v9 offset:1792
    s_waitcnt lgkmcnt(0)
    v_add_f32 v64, v64, v65
    v_add_f32 v64, v64, v66
    v_add_f32 v64, v64, v67
    v_add_f32 v64, v64, v68
    v_add_f32 v64, v64, v69
    v_add_f32 v64, v64, v70
    v_add_f32 v64, v64, v71
    v_mul_f32 v12, 0xbae38e39, v64
    s_lshl_b32 s10, s4, 2
    s_add_u32 s10, s10, s3
    s_mul_i32 s11, s10, 57
    s_lshr_b32 s11, s11, 11
    s_mul_i32 s12, s11, 36
    s_sub_u32 s12, s10, s12
    s_mul_i32 s14, s11, 648
    s_mul_i32 s11, s12, 43
    s_lshr_b32 s11, s11, 9
    s_mul_i32 s15, s11, 12
    s_sub_u32 s12, s12, s15
    s_mul_i32 s11, s11, 54
    s_add_u32 s14, s14, s11
    s_mul_i32 s11, s12, 86
    s_lshr_b32 s11, s11, 8
    s_mul_i32 s15, s11, 3
    s_sub_u32 s12, s12, s15
    s_mul_i32 s11, s11, 162
    s_add_u32 s14, s14, s11
    s_add_u32 s14, s14, s12
    s_lshl_b32 s14, s14, 10
    v_lshrrev_b32 v8, 4, v1
    v_bfe_u32 v9, v1, 2, 2
    v_lshl_add_u32 v8, v8, 3, v9
    v_lshlrev_b32 v8, 7, v8
    v_and_b32 v9, 3, v1
    v_lshl_add_u32 v8, v9, 3, v8
    s_lshl_b32 s15, s3, 5
    v_add_u32 v8, s15, v8
    v_add_u32 v10, 0xf000, v8
    ds_read_b64_tr_b16 v[64:65], v8 offset:0
    ds_read_b64_tr_b16 v[66:67], v8 offset:512
    ds_read_b64_tr_b16 v[68:69], v8 offset:4096
    ds_read_b64_tr_b16 v[70:71], v8 offset:4608
    ds_read_b64_tr_b16 v[72:73], v8 offset:8192
    ds_read_b64_tr_b16 v[74:75], v8 offset:8704
    ds_read_b64_tr_b16 v[76:77], v8 offset:12288
    ds_read_b64_tr_b16 v[78:79], v8 offset:12800
    ds_read_b64_tr_b16 v[80:81], v8 offset:16384
    ds_read_b64_tr_b16 v[82:83], v8 offset:16896
    ds_read_b64_tr_b16 v[84:85], v8 offset:20480
    ds_read_b64_tr_b16 v[86:87], v8 offset:20992
    s_waitcnt lgkmcnt(10)
    v_lshlrev_b32 v16, 16, v64
    v_and_b32 v17, 0xffff0000, v64
    v_pk_add_f32 v[16:17], v[16:17], v[12:13] op_sel_hi:[1,0]
    v_cvt_pk_bf16_f32 v96, v16, v17
    v_lshlrev_b32 v18, 16, v65
    v_and_b32 v19, 0xffff0000, v65
    v_pk_add_f32 v[18:19], v[18:19], v[12:13] op_sel_hi:[1,0]
    v_cvt_pk_bf16_f32 v97, v18, v19
    v_lshlrev_b32 v16, 16, v66
    v_and_b32 v17, 0xffff0000, v66
    v_pk_add_f32 v[16:17], v[16:17], v[12:13] op_sel_hi:[1,0]
    v_cvt_pk_bf16_f32 v98, v16, v17
    v_lshlrev_b32 v18, 16, v67
    v_and_b32 v19, 0xffff0000, v67
    v_pk_add_f32 v[18:19], v[18:19], v[12:13] op_sel_hi:[1,0]
    v_cvt_pk_bf16_f32 v99, v18, v19
    buffer_store_dwordx4 v[96:99], v2, s[64:67], s14 offen sc1
    s_add_u32 s14, s14, 3072
    ds_read_b64_tr_b16 v[64:65], v8 offset:24576
    ds_read_b64_tr_b16 v[66:67], v8 offset:25088
    s_waitcnt lgkmcnt(10)
    v_lshlrev_b32 v16, 16, v68
    v_and_b32 v17, 0xffff0000, v68
    v_pk_add_f32 v[16:17], v[16:17], v[12:13] op_sel_hi:[1,0]
    v_cvt_pk_bf16_f32 v100, v16, v17
    v_lshlrev_b32 v18, 16, v69
    v_and_b32 v19, 0xffff0000, v69
    v_pk_add_f32 v[18:19], v[18:19], v[12:13] op_sel_hi:[1,0]
    v_cvt_pk_bf16_f32 v101, v18, v19
    v_lshlrev_b32 v16, 16, v70
    v_and_b32 v17, 0xffff0000, v70
    v_pk_add_f32 v[16:17], v[16:17], v[12:13] op_sel_hi:[1,0]
    v_cvt_pk_bf16_f32 v102, v16, v17
    v_lshlrev_b32 v18, 16, v71
    v_and_b32 v19, 0xffff0000, v71
    v_pk_add_f32 v[18:19], v[18:19], v[12:13] op_sel_hi:[1,0]
    v_cvt_pk_bf16_f32 v103, v18, v19
    buffer_store_dwordx4 v[100:103], v2, s[64:67], s14 offen sc1
    s_add_u32 s14, s14, 3072
    ds_read_b64_tr_b16 v[68:69], v8 offset:28672
    ds_read_b64_tr_b16 v[70:71], v8 offset:29184
    s_waitcnt lgkmcnt(10)
    v_lshlrev_b32 v16, 16, v72
    v_and_b32 v17, 0xffff0000, v72
    v_pk_add_f32 v[16:17], v[16:17], v[12:13] op_sel_hi:[1,0]
    v_cvt_pk_bf16_f32 v104, v16, v17
    v_lshlrev_b32 v18, 16, v73
    v_and_b32 v19, 0xffff0000, v73
    v_pk_add_f32 v[18:19], v[18:19], v[12:13] op_sel_hi:[1,0]
    v_cvt_pk_bf16_f32 v105, v18, v19
    v_lshlrev_b32 v16, 16, v74
    v_and_b32 v17, 0xffff0000, v74
    v_pk_add_f32 v[16:17], v[16:17], v[12:13] op_sel_hi:[1,0]
    v_cvt_pk_bf16_f32 v106, v16, v17
    v_lshlrev_b32 v18, 16, v75
    v_and_b32 v19, 0xffff0000, v75
    v_pk_add_f32 v[18:19], v[18:19], v[12:13] op_sel_hi:[1,0]
    v_cvt_pk_bf16_f32 v107, v18, v19
    buffer_store_dwordx4 v[104:107], v2, s[64:67], s14 offen sc1
    s_add_u32 s14, s14, 3072
    ds_read_b64_tr_b16 v[72:73], v8 offset:32768
    ds_read_b64_tr_b16 v[74:75], v8 offset:33280
    s_waitcnt lgkmcnt(10)
    v_lshlrev_b32 v16, 16, v76
    v_and_b32 v17, 0xffff0000, v76
    v_pk_add_f32 v[16:17], v[16:17], v[12:13] op_sel_hi:[1,0]
    v_cvt_pk_bf16_f32 v108, v16, v17
    v_lshlrev_b32 v18, 16, v77
    v_and_b32 v19, 0xffff0000, v77
    v_pk_add_f32 v[18:19], v[18:19], v[12:13] op_sel_hi:[1,0]
    v_cvt_pk_bf16_f32 v109, v18, v19
    v_lshlrev_b32 v16, 16, v78
    v_and_b32 v17, 0xffff0000, v78
    v_pk_add_f32 v[16:17], v[16:17], v[12:13] op_sel_hi:[1,0]
    v_cvt_pk_bf16_f32 v110, v16, v17
    v_lshlrev_b32 v18, 16, v79
    v_and_b32 v19, 0xffff0000, v79
    v_pk_add_f32 v[18:19], v[18:19], v[12:13] op_sel_hi:[1,0]
    v_cvt_pk_bf16_f32 v111, v18, v19
    buffer_store_dwordx4 v[108:111], v2, s[64:67], s14 offen sc1
    s_add_u32 s14, s14, 3072
    ds_read_b64_tr_b16 v[76:77], v8 offset:36864
    ds_read_b64_tr_b16 v[78:79], v8 offset:37376
    s_waitcnt lgkmcnt(10)
    v_lshlrev_b32 v16, 16, v80
    v_and_b32 v17, 0xffff0000, v80
    v_pk_add_f32 v[16:17], v[16:17], v[12:13] op_sel_hi:[1,0]
    v_cvt_pk_bf16_f32 v96, v16, v17
    v_lshlrev_b32 v18, 16, v81
    v_and_b32 v19, 0xffff0000, v81
    v_pk_add_f32 v[18:19], v[18:19], v[12:13] op_sel_hi:[1,0]
    v_cvt_pk_bf16_f32 v97, v18, v19
    v_lshlrev_b32 v16, 16, v82
    v_and_b32 v17, 0xffff0000, v82
    v_pk_add_f32 v[16:17], v[16:17], v[12:13] op_sel_hi:[1,0]
    v_cvt_pk_bf16_f32 v98, v16, v17
    v_lshlrev_b32 v18, 16, v83
    v_and_b32 v19, 0xffff0000, v83
    v_pk_add_f32 v[18:19], v[18:19], v[12:13] op_sel_hi:[1,0]
    v_cvt_pk_bf16_f32 v99, v18, v19
    buffer_store_dwordx4 v[96:99], v2, s[64:67], s14 offen sc1
    s_add_u32 s14, s14, 3072
    ds_read_b64_tr_b16 v[80:81], v8 offset:40960
    ds_read_b64_tr_b16 v[82:83], v8 offset:41472
    s_waitcnt lgkmcnt(10)
    v_lshlrev_b32 v16, 16, v84
    v_and_b32 v17, 0xffff0000, v84
    v_pk_add_f32 v[16:17], v[16:17], v[12:13] op_sel_hi:[1,0]
    v_cvt_pk_bf16_f32 v100, v16, v17
    v_lshlrev_b32 v18, 16, v85
    v_and_b32 v19, 0xffff0000, v85
    v_pk_add_f32 v[18:19], v[18:19], v[12:13] op_sel_hi:[1,0]
    v_cvt_pk_bf16_f32 v101, v18, v19
    v_lshlrev_b32 v16, 16, v86
    v_and_b32 v17, 0xffff0000, v86
    v_pk_add_f32 v[16:17], v[16:17], v[12:13] op_sel_hi:[1,0]
    v_cvt_pk_bf16_f32 v102, v16, v17
    v_lshlrev_b32 v18, 16, v87
    v_and_b32 v19, 0xffff0000, v87
    v_pk_add_f32 v[18:19], v[18:19], v[12:13] op_sel_hi:[1,0]
    v_cvt_pk_bf16_f32 v103, v18, v19
    buffer_store_dwordx4 v[100:103], v2, s[64:67], s14 offen sc1
    s_add_u32 s14, s14, 3072
    ds_read_b64_tr_b16 v[84:85], v8 offset:45056
    ds_read_b64_tr_b16 v[86:87], v8 offset:45568
    s_waitcnt lgkmcnt(10)
    v_lshlrev_b32 v16, 16, v64
    v_and_b32 v17, 0xffff0000, v64
    v_pk_add_f32 v[16:17], v[16:17], v[12:13] op_sel_hi:[1,0]
    v_cvt_pk_bf16_f32 v104, v16, v17
    v_lshlrev_b32 v18, 16, v65
    v_and_b32 v19, 0xffff0000, v65
    v_pk_add_f32 v[18:19], v[18:19], v[12:13] op_sel_hi:[1,0]
    v_cvt_pk_bf16_f32 v105, v18, v19
    v_lshlrev_b32 v16, 16, v66
    v_and_b32 v17, 0xffff0000, v66
    v_pk_add_f32 v[16:17], v[16:17], v[12:13] op_sel_hi:[1,0]
    v_cvt_pk_bf16_f32 v106, v16, v17
    v_lshlrev_b32 v18, 16, v67
    v_and_b32 v19, 0xffff0000, v67
    v_pk_add_f32 v[18:19], v[18:19], v[12:13] op_sel_hi:[1,0]
    v_cvt_pk_bf16_f32 v107, v18, v19
    buffer_store_dwordx4 v[104:107], v2, s[64:67], s14 offen sc1
    s_add_u32 s14, s14, 3072
    ds_read_b64_tr_b16 v[64:65], v8 offset:49152
    ds_read_b64_tr_b16 v[66:67], v8 offset:49664
    s_waitcnt lgkmcnt(10)
    v_lshlrev_b32 v16, 16, v68
    v_and_b32 v17, 0xffff0000, v68
    v_pk_add_f32 v[16:17], v[16:17], v[12:13] op_sel_hi:[1,0]
    v_cvt_pk_bf16_f32 v108, v16, v17
    v_lshlrev_b32 v18, 16, v69
    v_and_b32 v19, 0xffff0000, v69
    v_pk_add_f32 v[18:19], v[18:19], v[12:13] op_sel_hi:[1,0]
    v_cvt_pk_bf16_f32 v109, v18, v19
    v_lshlrev_b32 v16, 16, v70
    v_and_b32 v17, 0xffff0000, v70
    v_pk_add_f32 v[16:17], v[16:17], v[12:13] op_sel_hi:[1,0]
    v_cvt_pk_bf16_f32 v110, v16, v17
    v_lshlrev_b32 v18, 16, v71
    v_and_b32 v19, 0xffff0000, v71
    v_pk_add_f32 v[18:19], v[18:19], v[12:13] op_sel_hi:[1,0]
    v_cvt_pk_bf16_f32 v111, v18, v19
    buffer_store_dwordx4 v[108:111], v2, s[64:67], s14 offen sc1
    s_add_u32 s14, s14, 3072
    ds_read_b64_tr_b16 v[68:69], v8 offset:53248
    ds_read_b64_tr_b16 v[70:71], v8 offset:53760
    s_waitcnt lgkmcnt(10)
    v_lshlrev_b32 v16, 16, v72
    v_and_b32 v17, 0xffff0000, v72
    v_pk_add_f32 v[16:17], v[16:17], v[12:13] op_sel_hi:[1,0]
    v_cvt_pk_bf16_f32 v96, v16, v17
    v_lshlrev_b32 v18, 16, v73
    v_and_b32 v19, 0xffff0000, v73
    v_pk_add_f32 v[18:19], v[18:19], v[12:13] op_sel_hi:[1,0]
    v_cvt_pk_bf16_f32 v97, v18, v19
    v_lshlrev_b32 v16, 16, v74
    v_and_b32 v17, 0xffff0000, v74
    v_pk_add_f32 v[16:17], v[16:17], v[12:13] op_sel_hi:[1,0]
    v_cvt_pk_bf16_f32 v98, v16, v17
    v_lshlrev_b32 v18, 16, v75
    v_and_b32 v19, 0xffff0000, v75
    v_pk_add_f32 v[18:19], v[18:19], v[12:13] op_sel_hi:[1,0]
    v_cvt_pk_bf16_f32 v99, v18, v19
    buffer_store_dwordx4 v[96:99], v2, s[64:67], s14 offen sc1
    s_add_u32 s14, s14, 3072
    ds_read_b64_tr_b16 v[72:73], v8 offset:57344
    ds_read_b64_tr_b16 v[74:75], v8 offset:57856
    s_waitcnt lgkmcnt(10)
    v_lshlrev_b32 v16, 16, v76
    v_and_b32 v17, 0xffff0000, v76
    v_pk_add_f32 v[16:17], v[16:17], v[12:13] op_sel_hi:[1,0]
    v_cvt_pk_bf16_f32 v100, v16, v17
    v_lshlrev_b32 v18, 16, v77
    v_and_b32 v19, 0xffff0000, v77
    v_pk_add_f32 v[18:19], v[18:19], v[12:13] op_sel_hi:[1,0]
    v_cvt_pk_bf16_f32 v101, v18, v19
    v_lshlrev_b32 v16, 16, v78
    v_and_b32 v17, 0xffff0000, v78
    v_pk_add_f32 v[16:17], v[16:17], v[12:13] op_sel_hi:[1,0]
    v_cvt_pk_bf16_f32 v102, v16, v17
    v_lshlrev_b32 v18, 16, v79
    v_and_b32 v19, 0xffff0000, v79
    v_pk_add_f32 v[18:19], v[18:19], v[12:13] op_sel_hi:[1,0]
    v_cvt_pk_bf16_f32 v103, v18, v19
    buffer_store_dwordx4 v[100:103], v2, s[64:67], s14 offen sc1
    s_add_u32 s14, s14, 3072
    ds_read_b64_tr_b16 v[76:77], v10 offset:0
    ds_read_b64_tr_b16 v[78:79], v10 offset:512
    s_waitcnt lgkmcnt(10)
    v_lshlrev_b32 v16, 16, v80
    v_and_b32 v17, 0xffff0000, v80
    v_pk_add_f32 v[16:17], v[16:17], v[12:13] op_sel_hi:[1,0]
    v_cvt_pk_bf16_f32 v104, v16, v17
    v_lshlrev_b32 v18, 16, v81
    v_and_b32 v19, 0xffff0000, v81
    v_pk_add_f32 v[18:19], v[18:19], v[12:13] op_sel_hi:[1,0]
    v_cvt_pk_bf16_f32 v105, v18, v19
    v_lshlrev_b32 v16, 16, v82
    v_and_b32 v17, 0xffff0000, v82
    v_pk_add_f32 v[16:17], v[16:17], v[12:13] op_sel_hi:[1,0]
    v_cvt_pk_bf16_f32 v106, v16, v17
    v_lshlrev_b32 v18, 16, v83
    v_and_b32 v19, 0xffff0000, v83
    v_pk_add_f32 v[18:19], v[18:19], v[12:13] op_sel_hi:[1,0]
    v_cvt_pk_bf16_f32 v107, v18, v19
    buffer_store_dwordx4 v[104:107], v2, s[64:67], s14 offen sc1
    s_add_u32 s14, s14, 3072
    ds_read_b64_tr_b16 v[80:81], v10 offset:4096
    ds_read_b64_tr_b16 v[82:83], v10 offset:4608
    s_waitcnt lgkmcnt(10)
    v_lshlrev_b32 v16, 16, v84
    v_and_b32 v17, 0xffff0000, v84
    v_pk_add_f32 v[16:17], v[16:17], v[12:13] op_sel_hi:[1,0]
    v_cvt_pk_bf16_f32 v108, v16, v17
    v_lshlrev_b32 v18, 16, v85
    v_and_b32 v19, 0xffff0000, v85
    v_pk_add_f32 v[18:19], v[18:19], v[12:13] op_sel_hi:[1,0]
    v_cvt_pk_bf16_f32 v109, v18, v19
    v_lshlrev_b32 v16, 16, v86
    v_and_b32 v17, 0xffff0000, v86
    v_pk_add_f32 v[16:17], v[16:17], v[12:13] op_sel_hi:[1,0]
    v_cvt_pk_bf16_f32 v110, v16, v17
    v_lshlrev_b32 v18, 16, v87
    v_and_b32 v19, 0xffff0000, v87
    v_pk_add_f32 v[18:19], v[18:19], v[12:13] op_sel_hi:[1,0]
    v_cvt_pk_bf16_f32 v111, v18, v19
    buffer_store_dwordx4 v[108:111], v2, s[64:67], s14 offen sc1
    s_add_u32 s14, s14, 3072
    ds_read_b64_tr_b16 v[84:85], v10 offset:8192
    ds_read_b64_tr_b16 v[86:87], v10 offset:8704
    s_waitcnt lgkmcnt(10)
    v_lshlrev_b32 v16, 16, v64
    v_and_b32 v17, 0xffff0000, v64
    v_pk_add_f32 v[16:17], v[16:17], v[12:13] op_sel_hi:[1,0]
    v_cvt_pk_bf16_f32 v96, v16, v17
    v_lshlrev_b32 v18, 16, v65
    v_and_b32 v19, 0xffff0000, v65
    v_pk_add_f32 v[18:19], v[18:19], v[12:13] op_sel_hi:[1,0]
    v_cvt_pk_bf16_f32 v97, v18, v19
    v_lshlrev_b32 v16, 16, v66
    v_and_b32 v17, 0xffff0000, v66
    v_pk_add_f32 v[16:17], v[16:17], v[12:13] op_sel_hi:[1,0]
    v_cvt_pk_bf16_f32 v98, v16, v17
    v_lshlrev_b32 v18, 16, v67
    v_and_b32 v19, 0xffff0000, v67
    v_pk_add_f32 v[18:19], v[18:19], v[12:13] op_sel_hi:[1,0]
    v_cvt_pk_bf16_f32 v99, v18, v19
    buffer_store_dwordx4 v[96:99], v2, s[64:67], s14 offen sc1
    s_add_u32 s14, s14, 3072
    s_waitcnt lgkmcnt(8)
    v_lshlrev_b32 v16, 16, v68
    v_and_b32 v17, 0xffff0000, v68
    v_pk_add_f32 v[16:17], v[16:17], v[12:13] op_sel_hi:[1,0]
    v_cvt_pk_bf16_f32 v100, v16, v17
    v_lshlrev_b32 v18, 16, v69
    v_and_b32 v19, 0xffff0000, v69
    v_pk_add_f32 v[18:19], v[18:19], v[12:13] op_sel_hi:[1,0]
    v_cvt_pk_bf16_f32 v101, v18, v19
    v_lshlrev_b32 v16, 16, v70
    v_and_b32 v17, 0xffff0000, v70
    v_pk_add_f32 v[16:17], v[16:17], v[12:13] op_sel_hi:[1,0]
    v_cvt_pk_bf16_f32 v102, v16, v17
    v_lshlrev_b32 v18, 16, v71
    v_and_b32 v19, 0xffff0000, v71
    v_pk_add_f32 v[18:19], v[18:19], v[12:13] op_sel_hi:[1,0]
    v_cvt_pk_bf16_f32 v103, v18, v19
    buffer_store_dwordx4 v[100:103], v2, s[64:67], s14 offen sc1
    s_add_u32 s14, s14, 3072
    s_waitcnt lgkmcnt(6)
    v_lshlrev_b32 v16, 16, v72
    v_and_b32 v17, 0xffff0000, v72
    v_pk_add_f32 v[16:17], v[16:17], v[12:13] op_sel_hi:[1,0]
    v_cvt_pk_bf16_f32 v104, v16, v17
    v_lshlrev_b32 v18, 16, v73
    v_and_b32 v19, 0xffff0000, v73
    v_pk_add_f32 v[18:19], v[18:19], v[12:13] op_sel_hi:[1,0]
    v_cvt_pk_bf16_f32 v105, v18, v19
    v_lshlrev_b32 v16, 16, v74
    v_and_b32 v17, 0xffff0000, v74
    v_pk_add_f32 v[16:17], v[16:17], v[12:13] op_sel_hi:[1,0]
    v_cvt_pk_bf16_f32 v106, v16, v17
    v_lshlrev_b32 v18, 16, v75
    v_and_b32 v19, 0xffff0000, v75
    v_pk_add_f32 v[18:19], v[18:19], v[12:13] op_sel_hi:[1,0]
    v_cvt_pk_bf16_f32 v107, v18, v19
    buffer_store_dwordx4 v[104:107], v2, s[64:67], s14 offen sc1
    s_add_u32 s14, s14, 3072
    s_waitcnt lgkmcnt(4)
    v_lshlrev_b32 v16, 16, v76
    v_and_b32 v17, 0xffff0000, v76
    v_pk_add_f32 v[16:17], v[16:17], v[12:13] op_sel_hi:[1,0]
    v_cvt_pk_bf16_f32 v108, v16, v17
    v_lshlrev_b32 v18, 16, v77
    v_and_b32 v19, 0xffff0000, v77
    v_pk_add_f32 v[18:19], v[18:19], v[12:13] op_sel_hi:[1,0]
    v_cvt_pk_bf16_f32 v109, v18, v19
    v_lshlrev_b32 v16, 16, v78
    v_and_b32 v17, 0xffff0000, v78
    v_pk_add_f32 v[16:17], v[16:17], v[12:13] op_sel_hi:[1,0]
    v_cvt_pk_bf16_f32 v110, v16, v17
    v_lshlrev_b32 v18, 16, v79
    v_and_b32 v19, 0xffff0000, v79
    v_pk_add_f32 v[18:19], v[18:19], v[12:13] op_sel_hi:[1,0]
    v_cvt_pk_bf16_f32 v111, v18, v19
    buffer_store_dwordx4 v[108:111], v2, s[64:67], s14 offen sc1
    s_add_u32 s14, s14, 3072
    s_waitcnt lgkmcnt(2)
    v_lshlrev_b32 v16, 16, v80
    v_and_b32 v17, 0xffff0000, v80
    v_pk_add_f32 v[16:17], v[16:17], v[12:13] op_sel_hi:[1,0]
    v_cvt_pk_bf16_f32 v96, v16, v17
    v_lshlrev_b32 v18, 16, v81
    v_and_b32 v19, 0xffff0000, v81
    v_pk_add_f32 v[18:19], v[18:19], v[12:13] op_sel_hi:[1,0]
    v_cvt_pk_bf16_f32 v97, v18, v19
    v_lshlrev_b32 v16, 16, v82
    v_and_b32 v17, 0xffff0000, v82
    v_pk_add_f32 v[16:17], v[16:17], v[12:13] op_sel_hi:[1,0]
    v_cvt_pk_bf16_f32 v98, v16, v17
    v_lshlrev_b32 v18, 16, v83
    v_and_b32 v19, 0xffff0000, v83
    v_pk_add_f32 v[18:19], v[18:19], v[12:13] op_sel_hi:[1,0]
    v_cvt_pk_bf16_f32 v99, v18, v19
    buffer_store_dwordx4 v[96:99], v2, s[64:67], s14 offen sc1
    s_add_u32 s14, s14, 3072
    s_waitcnt lgkmcnt(0)
    v_lshlrev_b32 v16, 16, v84
    v_and_b32 v17, 0xffff0000, v84
    v_pk_add_f32 v[16:17], v[16:17], v[12:13] op_sel_hi:[1,0]
    v_cvt_pk_bf16_f32 v100, v16, v17
    v_lshlrev_b32 v18, 16, v85
    v_and_b32 v19, 0xffff0000, v85
    v_pk_add_f32 v[18:19], v[18:19], v[12:13] op_sel_hi:[1,0]
    v_cvt_pk_bf16_f32 v101, v18, v19
    v_lshlrev_b32 v16, 16, v86
    v_and_b32 v17, 0xffff0000, v86
    v_pk_add_f32 v[16:17], v[16:17], v[12:13] op_sel_hi:[1,0]
    v_cvt_pk_bf16_f32 v102, v16, v17
    v_lshlrev_b32 v18, 16, v87
    v_and_b32 v19, 0xffff0000, v87
    v_pk_add_f32 v[18:19], v[18:19], v[12:13] op_sel_hi:[1,0]
    v_cvt_pk_bf16_f32 v103, v18, v19
    buffer_store_dwordx4 v[100:103], v2, s[64:67], s14 offen sc1
    s_branch K2_XEND
K2_CAT1:
    s_cmp_ge_u32 s4, 72
    s_cbranch_scc1 K2_CAT2
    v_lshrrev_b32 v8, 3, v1
    v_mul_u32_u24 v8, 9216, v8
    v_and_b32 v9, 7, v1
    v_lshl_add_u32 v8, v9, 4, v8
    s_mul_i32 s12, s3, 1327104
    s_lshl_b32 s13, s4, 7
    s_add_u32 s12, s12, s13
    s_mul_i32 s13, s3, 18432
    s_add_u32 m0, s13, 0
    s_add_u32 s14, s12, 0
    buffer_load_dwordx4 v8, s[48:51], s14 offen nt lds
    s_add_u32 m0, s13, 1024
    s_add_u32 s14, s12, 73728
    buffer_load_dwordx4 v8, s[48:51], s14 offen nt lds
    s_add_u32 m0, s13, 2048
    s_add_u32 s14, s12, 147456
    buffer_load_dwordx4 v8, s[48:51], s14 offen nt lds
    s_add_u32 m0, s13, 3072
    s_add_u32 s14, s12, 221184
    buffer_load_dwordx4 v8, s[48:51], s14 offen nt lds
    s_add_u32 m0, s13, 4096
    s_add_u32 s14, s12, 294912
    buffer_load_dwordx4 v8, s[48:51], s14 offen nt lds
    s_add_u32 m0, s13, 5120
    s_add_u32 s14, s12, 368640
    buffer_load_dwordx4 v8, s[48:51], s14 offen nt lds
    s_add_u32 m0, s13, 6144
    s_add_u32 s14, s12, 442368
    buffer_load_dwordx4 v8, s[48:51], s14 offen nt lds
    s_add_u32 m0, s13, 7168
    s_add_u32 s14, s12, 516096
    buffer_load_dwordx4 v8, s[48:51], s14 offen nt lds
    s_add_u32 m0, s13, 8192
    s_add_u32 s14, s12, 589824
    buffer_load_dwordx4 v8, s[48:51], s14 offen nt lds
    s_add_u32 m0, s13, 9216
    s_add_u32 s14, s12, 663552
    buffer_load_dwordx4 v8, s[48:51], s14 offen nt lds
    s_add_u32 m0, s13, 10240
    s_add_u32 s14, s12, 737280
    buffer_load_dwordx4 v8, s[48:51], s14 offen nt lds
    s_add_u32 m0, s13, 11264
    s_add_u32 s14, s12, 811008
    buffer_load_dwordx4 v8, s[48:51], s14 offen nt lds
    s_add_u32 m0, s13, 12288
    s_add_u32 s14, s12, 884736
    buffer_load_dwordx4 v8, s[48:51], s14 offen nt lds
    s_add_u32 m0, s13, 13312
    s_add_u32 s14, s12, 958464
    buffer_load_dwordx4 v8, s[48:51], s14 offen nt lds
    s_add_u32 m0, s13, 14336
    s_add_u32 s14, s12, 1032192
    buffer_load_dwordx4 v8, s[48:51], s14 offen nt lds
    s_add_u32 m0, s13, 15360
    s_add_u32 s14, s12, 1105920
    buffer_load_dwordx4 v8, s[48:51], s14 offen nt lds
    s_add_u32 m0, s13, 16384
    s_add_u32 s14, s12, 1179648
    buffer_load_dwordx4 v8, s[48:51], s14 offen nt lds
    s_add_u32 m0, s13, 17408
    s_add_u32 s14, s12, 1253376
    buffer_load_dwordx4 v8, s[48:51], s14 offen nt lds
    s_mov_b32 s76, s16
    s_mov_b32 s77, s17
    s_mov_b32 s78, 2359296
    s_mov_b32 s79, 0x20000
    s_lshr_b32 s15, s4, 3
    s_lshl_b32 s15, s15, 2
    s_add_u32 s15, s15, s3
    s_mul_i32 s15, s15, 6
    s_add_u32 s9, s15, 0
    s_mul_i32 s10, s9, 57
    s_lshr_b32 s10, s10, 11
    s_mul_i32 s11, s10, 36
    s_sub_u32 s11, s9, s11
    s_lshl_b32 s10, s10, 3
    s_and_b32 s12, s4, 7
    s_add_u32 s10, s10, s12
    s_mul_i32 s10, s10, 36
    s_add_u32 s10, s10, s11
    s_lshl_b32 s10, s10, 10
    v_add_u32 v18, s10, v2
    buffer_load_dwordx4 v[136:139], v18, s[76:79], 0 offen
    s_add_u32 s9, s15, 1
    s_mul_i32 s10, s9, 57
    s_lshr_b32 s10, s10, 11
    s_mul_i32 s11, s10, 36
    s_sub_u32 s11, s9, s11
    s_lshl_b32 s10, s10, 3
    s_and_b32 s12, s4, 7
    s_add_u32 s10, s10, s12
    s_mul_i32 s10, s10, 36
    s_add_u32 s10, s10, s11
    s_lshl_b32 s10, s10, 10
    v_add_u32 v18, s10, v2
    buffer_load_dwordx4 v[136:139], v18, s[76:79], 0 offen
    s_add_u32 s9, s15, 2
    s_mul_i32 s10, s9, 57
    s_lshr_b32 s10, s10, 11
    s_mul_i32 s11, s10, 36
    s_sub_u32 s11, s9, s11
    s_lshl_b32 s10, s10, 3
    s_and_b32 s12, s4, 7
    s_add_u32 s10, s10, s12
    s_mul_i32 s10, s10, 36
    s_add_u32 s10, s10, s11
    s_lshl_b32 s10, s10, 10
    v_add_u32 v18, s10, v2
    buffer_load_dwordx4 v[136:139], v18, s[76:79], 0 offen
    s_add_u32 s9, s15, 3
    s_mul_i32 s10, s9, 57
    s_lshr_b32 s10, s10, 11
    s_mul_i32 s11, s10, 36
    s_sub_u32 s11, s9, s11
    s_lshl_b32 s10, s10, 3
    s_and_b32 s12, s4, 7
    s_add_u32 s10, s10, s12
    s_mul_i32 s10, s10, 36
    s_add_u32 s10, s10, s11
    s_lshl_b32 s10, s10, 10
    v_add_u32 v18, s10, v2
    buffer_load_dwordx4 v[136:139], v18, s[76:79], 0 offen
    s_add_u32 s9, s15, 4
    s_mul_i32 s10, s9, 57
    s_lshr_b32 s10, s10, 11
    s_mul_i32 s11, s10, 36
    s_sub_u32 s11, s9, s11
    s_lshl_b32 s10, s10, 3
    s_and_b32 s12, s4, 7
    s_add_u32 s10, s10, s12
    s_mul_i32 s10, s10, 36
    s_add_u32 s10, s10, s11
    s_lshl_b32 s10, s10, 10
    v_add_u32 v18, s10, v2
    buffer_load_dwordx4 v[136:139], v18, s[76:79], 0 offen
    s_add_u32 s9, s15, 5
    s_mul_i32 s10, s9, 57
    s_lshr_b32 s10, s10, 11
    s_mul_i32 s11, s10, 36
    s_sub_u32 s11, s9, s11
    s_lshl_b32 s10, s10, 3
    s_and_b32 s12, s4, 7
    s_add_u32 s10, s10, s12
    s_mul_i32 s10, s10, 36
    s_add_u32 s10, s10, s11
    s_lshl_b32 s10, s10, 10
    v_add_u32 v18, s10, v2
    buffer_load_dwordx4 v[136:139], v18, s[76:79], 0 offen
    s_sub_u32 s16, s4, 58
    s_mov_b32 s72, s40
    s_mov_b32 s73, s41
    s_mov_b32 s74, 3981312
    s_mov_b32 s75, 0x20000
    s_mov_b32 s76, s38
    s_mov_b32 s77, s39
    s_mov_b32 s78, 1152
    s_mov_b32 s79, 0x20000
    s_mov_b32 s56, s46
    s_mov_b32 s57, s47
    s_mov_b32 s58, 13824
    s_mov_b32 s59, 0x20000
    v_lshrrev_b32 v250, 3, v1
    s_mul_i32 s8, s3, 144
    v_add_u32 v250, s8, v250
    v_and_b32 v251, 7, v1
    v_lshlrev_b32 v251, 4, v251
    s_lshl_b32 s8, s16, 7
    v_add_u32 v251, s8, v251
    v_mul_u32_u24 v252, 6912, v250
    v_add_u32 v252, v252, v251
    v_lshlrev_b32 v253, 1, v250
    buffer_load_ushort v216, v253, s[76:79], 0 offen offset:0
    buffer_load_ushort v217, v253, s[76:79], 0 offen offset:16
    buffer_load_ushort v218, v253, s[76:79], 0 offen offset:32
    buffer_load_ushort v219, v253, s[76:79], 0 offen offset:48
    buffer_load_ushort v220, v253, s[76:79], 0 offen offset:64
    buffer_load_ushort v221, v253, s[76:79], 0 offen offset:80
    buffer_load_ushort v222, v253, s[76:79], 0 offen offset:96
    buffer_load_ushort v223, v253, s[76:79], 0 offen offset:112
    buffer_load_ushort v224, v253, s[76:79], 0 offen offset:128
    buffer_load_ushort v225, v253, s[76:79], 0 offen offset:144
    buffer_load_ushort v226, v253, s[76:79], 0 offen offset:160
    buffer_load_ushort v227, v253, s[76:79], 0 offen offset:176
    buffer_load_ushort v228, v253, s[76:79], 0 offen offset:192
    buffer_load_ushort v229, v253, s[76:79], 0 offen offset:208
    buffer_load_ushort v230, v253, s[76:79], 0 offen offset:224
    buffer_load_ushort v231, v253, s[76:79], 0 offen offset:240
    buffer_load_ushort v232, v253, s[76:79], 0 offen offset:256
    buffer_load_ushort v233, v253, s[76:79], 0 offen offset:272
    buffer_load_dwordx4 v[144:147], v252, s[72:75], 0 offen nt
    v_add_u32 v252, 55296, v252
    buffer_load_dwordx4 v[148:151], v252, s[72:75], 0 offen nt
    v_add_u32 v252, 55296, v252
    buffer_load_dwordx4 v[152:155], v252, s[72:75], 0 offen nt
    v_add_u32 v252, 55296, v252
    buffer_load_dwordx4 v[156:159], v252, s[72:75], 0 offen nt
    v_add_u32 v252, 55296, v252
    buffer_load_dwordx4 v[160:163], v252, s[72:75], 0 offen nt
    v_add_u32 v252, 55296, v252
    buffer_load_dwordx4 v[164:167], v252, s[72:75], 0 offen nt
    v_add_u32 v252, 55296, v252
    buffer_load_dwordx4 v[168:171], v252, s[72:75], 0 offen nt
    v_add_u32 v252, 55296, v252
    buffer_load_dwordx4 v[172:175], v252, s[72:75], 0 offen nt
    v_add_u32 v252, 55296, v252
    buffer_load_dwordx4 v[176:179], v252, s[72:75], 0 offen nt
    v_add_u32 v252, 55296, v252
    buffer_load_dwordx4 v[180:183], v252, s[72:75], 0 offen nt
    v_add_u32 v252, 55296, v252
    buffer_load_dwordx4 v[184:187], v252, s[72:75], 0 offen nt
    v_add_u32 v252, 55296, v252
    buffer_load_dwordx4 v[188:191], v252, s[72:75], 0 offen nt
    v_add_u32 v252, 55296, v252
    buffer_load_dwordx4 v[192:195], v252, s[72:75], 0 offen nt
    v_add_u32 v252, 55296, v252
    buffer_load_dwordx4 v[196:199], v252, s[72:75], 0 offen nt
    v_add_u32 v252, 55296, v252
    buffer_load_dwordx4 v[200:203], v252, s[72:75], 0 offen nt
    v_add_u32 v252, 55296, v252
    buffer_load_dwordx4 v[204:207], v252, s[72:75], 0 offen nt
    v_add_u32 v252, 55296, v252
    buffer_load_dwordx4 v[208:211], v252, s[72:75], 0 offen nt
    v_add_u32 v252, 55296, v252
    buffer_load_dwordx4 v[212:215], v252, s[72:75], 0 offen nt
    s_waitcnt vmcnt(42)
    s_barrier
    v_and_b32 v8, 31, v0
    v_lshlrev_b32 v8, 2, v8
    v_lshrrev_b32 v9, 5, v0
    v_lshl_add_u32 v8, v9, 7, v8
    v_add_u32 v10, 0x10000, v8
    s_mov_b32 s14, 0x00003f80
    s_mov_b32 s15, 0x3f800000
    v_mov_b32 v12, 0
    v_mov_b32 v13, 0
    v_mov_b32 v14, 0
    v_mov_b32 v15, 0
    ds_read_b32 v64, v8 offset:0
    ds_read_b32 v65, v8 offset:1024
    ds_read_b32 v66, v8 offset:2048
    ds_read_b32 v67, v8 offset:3072
    ds_read_b32 v68, v8 offset:4096
    ds_read_b32 v69, v8 offset:5120
    ds_read_b32 v70, v8 offset:6144
    ds_read_b32 v71, v8 offset:7168
    ds_read_b32 v72, v8 offset:8192
    ds_read_b32 v73, v8 offset:9216
    ds_read_b32 v74, v8 offset:10240
    s_waitcnt lgkmcnt(10)
    v_dot2_f32_bf16 v12, v64, s14, v12
    v_dot2_f32_bf16 v14, v64, s15, v14
    ds_read_b32 v75, v8 offset:11264
    s_waitcnt lgkmcnt(10)
    v_dot2_f32_bf16 v13, v65, s14, v13
    v_dot2_f32_bf16 v15, v65, s15, v15
    ds_read_b32 v64, v8 offset:12288
    s_waitcnt lgkmcnt(10)
    v_dot2_f32_bf16 v12, v66, s14, v12
    v_dot2_f32_bf16 v14, v66, s15, v14
    ds_read_b32 v65, v8 offset:13312
    s_waitcnt lgkmcnt(10)
    v_dot2_f32_bf16 v13, v67, s14, v13
    v_dot2_f32_bf16 v15, v67, s15, v15
    ds_read_b32 v66, v8 offset:14336
    s_waitcnt lgkmcnt(10)
    v_dot2_f32_bf16 v12, v68, s14, v12
    v_dot2_f32_bf16 v14, v68, s15, v14
    ds_read_b32 v67, v8 offset:15360
    s_waitcnt lgkmcnt(10)
    v_dot2_f32_bf16 v13, v69, s14, v13
    v_dot2_f32_bf16 v15, v69, s15, v15
    ds_read_b32 v68, v8 offset:16384
    s_waitcnt lgkmcnt(10)
    v_dot2_f32_bf16 v12, v70, s14, v12
    v_dot2_f32_bf16 v14, v70, s15, v14
    ds_read_b32 v69, v8 offset:17408
    s_waitcnt lgkmcnt(10)
    v_dot2_f32_bf16 v13, v71, s14, v13
    v_dot2_f32_bf16 v15, v71, s15, v15
    ds_read_b32 v70, v8 offset:18432
    s_waitcnt lgkmcnt(10)
    v_dot2_f32_bf16 v12, v72, s14, v12
    v_dot2_f32_bf16 v14, v72, s15, v14
    ds_read_b32 v71, v8 offset:19456
    s_waitcnt lgkmcnt(10)
    v_dot2_f32_bf16 v13, v73, s14, v13
    v_dot2_f32_bf16 v15, v73, s15, v15
    ds_read_b32 v72, v8 offset:20480
    s_waitcnt lgkmcnt(10)
    v_dot2_f32_bf16 v12, v74, s14, v12
    v_dot2_f32_bf16 v14, v74, s15, v14
    ds_read_b32 v73, v8 offset:21504
    s_waitcnt lgkmcnt(10)
    v_dot2_f32_bf16 v13, v75, s14, v13
    v_dot2_f32_bf16 v15, v75, s15, v15
    ds_read_b32 v74, v8 offset:22528
    s_waitcnt lgkmcnt(10)
    v_dot2_f32_bf16 v12, v64, s14, v12
    v_dot2_f32_bf16 v14, v64, s15, v14
    ds_read_b32 v75, v8 offset:23552
    s_waitcnt lgkmcnt(10)
    v_dot2_f32_bf16 v13, v65, s14, v13
    v_dot2_f32_bf16 v15, v65, s15, v15
    ds_read_b32 v64, v8 offset:24576
    s_waitcnt lgkmcnt(10)
    v_dot2_f32_bf16 v12, v66, s14, v12
    v_dot2_f32_bf16 v14, v66, s15, v14
    ds_read_b32 v65, v8 offset:25600
    s_waitcnt lgkmcnt(10)
    v_dot2_f32_bf16 v13, v67, s14, v13
    v_dot2_f32_bf16 v15, v67, s15, v15
    ds_read_b32 v66, v8 offset:26624
    s_waitcnt lgkmcnt(10)
    v_dot2_f32_bf16 v12, v68, s14, v12
    v_dot2_f32_bf16 v14, v68, s15, v14
    ds_read_b32 v67, v8 offset:27648
    s_waitcnt lgkmcnt(10)
    v_dot2_f32_bf16 v13, v69, s14, v13
    v_dot2_f32_bf16 v15, v69, s15, v15
    ds_read_b32 v68, v8 offset:28672
    s_waitcnt lgkmcnt(10)
    v_dot2_f32_bf16 v12, v70, s14, v12
    v_dot2_f32_bf16 v14, v70, s15, v14
    ds_read_b32 v69, v8 offset:29696
    s_waitcnt lgkmcnt(10)
    v_dot2_f32_bf16 v13, v71, s14, v13
    v_dot2_f32_bf16 v15, v71, s15, v15
    ds_read_b32 v70, v8 offset:30720
    s_waitcnt lgkmcnt(10)
    v_dot2_f32_bf16 v12, v72, s14, v12
    v_dot2_f32_bf16 v14, v72, s15, v14
    ds_read_b32 v71, v8 offset:31744
    s_waitcnt lgkmcnt(10)
    v_dot2_f32_bf16 v13, v73, s14, v13
    v_dot2_f32_bf16 v15, v73, s15, v15
    ds_read_b32 v72, v8 offset:32768
    s_waitcnt lgkmcnt(10)
    v_dot2_f32_bf16 v12, v74, s14, v12
    v_dot2_f32_bf16 v14, v74, s15, v14
    ds_read_b32 v73, v8 offset:33792
    s_waitcnt lgkmcnt(10)
    v_dot2_f32_bf16 v13, v75, s14, v13
    v_dot2_f32_bf16 v15, v75, s15, v15
    ds_read_b32 v74, v8 offset:34816
    s_waitcnt lgkmcnt(10)
    v_dot2_f32_bf16 v12, v64, s14, v12
    v_dot2_f32_bf16 v14, v64, s15, v14
    ds_read_b32 v75, v8 offset:35840
    s_waitcnt lgkmcnt(10)
    v_dot2_f32_bf16 v13, v65, s14, v13
    v_dot2_f32_bf16 v15, v65, s15, v15
    ds_read_b32 v64, v8 offset:36864
    s_waitcnt lgkmcnt(10)
    v_dot2_f32_bf16 v12, v66, s14, v12
    v_dot2_f32_bf16 v14, v66, s15, v14
    ds_read_b32 v65, v8 offset:37888
    s_waitcnt lgkmcnt(10)
    v_dot2_f32_bf16 v13, v67, s14, v13
    v_dot2_f32_bf16 v15, v67, s15, v15
    ds_read_b32 v66, v8 offset:38912
    s_waitcnt lgkmcnt(10)
    v_dot2_f32_bf16 v12, v68, s14, v12
    v_dot2_f32_bf16 v14, v68, s15, v14
    ds_read_b32 v67, v8 offset:39936
    s_waitcnt lgkmcnt(10)
    v_dot2_f32_bf16 v13, v69, s14, v13
    v_dot2_f32_bf16 v15, v69, s15, v15
    ds_read_b32 v68, v8 offset:40960
    s_waitcnt lgkmcnt(10)
    v_dot2_f32_bf16 v12, v70, s14, v12
    v_dot2_f32_bf16 v14, v70, s15, v14
    ds_read_b32 v69, v8 offset:41984
    s_waitcnt lgkmcnt(10)
    v_dot2_f32_bf16 v13, v71, s14, v13
    v_dot2_f32_bf16 v15, v71, s15, v15
    ds_read_b32 v70, v8 offset:43008
    s_waitcnt lgkmcnt(10)
    v_dot2_f32_bf16 v12, v72, s14, v12
    v_dot2_f32_bf16 v14, v72, s15, v14
    ds_read_b32 v71, v8 offset:44032
    s_waitcnt lgkmcnt(10)
    v_dot2_f32_bf16 v13, v73, s14, v13
    v_dot2_f32_bf16 v15, v73, s15, v15
    ds_read_b32 v72, v8 offset:45056
    s_waitcnt lgkmcnt(10)
    v_dot2_f32_bf16 v12, v74, s14, v12
    v_dot2_f32_bf16 v14, v74, s15, v14
    ds_read_b32 v73, v8 offset:46080
    s_waitcnt lgkmcnt(10)
    v_dot2_f32_bf16 v13, v75, s14, v13
    v_dot2_f32_bf16 v15, v75, s15, v15
    ds_read_b32 v74, v8 offset:47104
    s_waitcnt lgkmcnt(10)
    v_dot2_f32_bf16 v12, v64, s14, v12
    v_dot2_f32_bf16 v14, v64, s15, v14
    ds_read_b32 v75, v8 offset:48128
    s_waitcnt lgkmcnt(10)
    v_dot2_f32_bf16 v13, v65, s14, v13
    v_dot2_f32_bf16 v15, v65, s15, v15
    ds_read_b32 v64, v8 offset:49152
    s_waitcnt lgkmcnt(10)
    v_dot2_f32_bf16 v12, v66, s14, v12
    v_dot2_f32_bf16 v14, v66, s15, v14
    ds_read_b32 v65, v8 offset:50176
    s_waitcnt lgkmcnt(10)
    v_dot2_f32_bf16 v13, v67, s14, v13
    v_dot2_f32_bf16 v15, v67, s15, v15
    ds_read_b32 v66, v8 offset:51200
    s_waitcnt lgkmcnt(10)
    v_dot2_f32_bf16 v12, v68, s14, v12
    v_dot2_f32_bf16 v14, v68, s15, v14
    ds_read_b32 v67, v8 offset:52224
    s_waitcnt lgkmcnt(10)
    v_dot2_f32_bf16 v13, v69, s14, v13
    v_dot2_f32_bf16 v15, v69, s15, v15
    ds_read_b32 v68, v8 offset:53248
    s_waitcnt lgkmcnt(10)
    v_dot2_f32_bf16 v12, v70, s14, v12
    v_dot2_f32_bf16 v14, v70, s15, v14
    ds_read_b32 v69, v8 offset:54272
    s_waitcnt lgkmcnt(10)
    v_dot2_f32_bf16 v13, v71, s14, v13
    v_dot2_f32_bf16 v15, v71, s15, v15
    ds_read_b32 v70, v8 offset:55296
    s_waitcnt lgkmcnt(10)
    v_dot2_f32_bf16 v12, v72, s14, v12
    v_dot2_f32_bf16 v14, v72, s15, v14
    ds_read_b32 v71, v8 offset:56320
    s_waitcnt lgkmcnt(10)
    v_dot2_f32_bf16 v13, v73, s14, v13
    v_dot2_f32_bf16 v15, v73, s15, v15
    ds_read_b32 v72, v8 offset:57344
    s_waitcnt lgkmcnt(10)
    v_dot2_f32_bf16 v12, v74, s14, v12
    v_dot2_f32_bf16 v14, v74, s15, v14
    ds_read_b32 v73, v8 offset:58368
    s_waitcnt lgkmcnt(10)
    v_dot2_f32_bf16 v13, v75, s14, v13
    v_dot2_f32_bf16 v15, v75, s15, v15
    ds_read_b32 v74, v8 offset:59392
    s_waitcnt lgkmcnt(10)
    v_dot2_f32_bf16 v12, v64, s14, v12
    v_dot2_f32_bf16 v14, v64, s15, v14
    ds_read_b32 v75, v8 offset:60416
    s_waitcnt lgkmcnt(10)
    v_dot2_f32_bf16 v13, v65, s14, v13
    v_dot2_f32_bf16 v15, v65, s15, v15
    ds_read_b32 v64, v8 offset:61440
    s_waitcnt lgkmcnt(10)
    v_dot2_f32_bf16 v12, v66, s14, v12
    v_dot2_f32_bf16 v14, v66, s15, v14
    ds_read_b32 v65, v8 offset:62464
    s_waitcnt lgkmcnt(10)
    v_dot2_f32_bf16 v13, v67, s14, v13
    v_dot2_f32_bf16 v15, v67, s15, v15
    ds_read_b32 v66, v8 offset:63488
    s_waitcnt lgkmcnt(10)
    v_dot2_f32_bf16 v12, v68, s14, v12
    v_dot2_f32_bf16 v14, v68, s15, v14
    ds_read_b32 v67, v8 offset:64512
    s_waitcnt lgkmcnt(10)
    v_dot2_f32_bf16 v13, v69, s14, v13
    v_dot2_f32_bf16 v15, v69, s15, v15
    ds_read_b32 v68, v10 offset:0
    s_waitcnt lgkmcnt(10)
    v_dot2_f32_bf16 v12, v70, s14, v12
    v_dot2_f32_bf16 v14, v70, s15, v14
    ds_read_b32 v69, v10 offset:1024
    s_waitcnt lgkmcnt(10)
    v_dot2_f32_bf16 v13, v71, s14, v13
    v_dot2_f32_bf16 v15, v71, s15, v15
    ds_read_b32 v70, v10 offset:2048
    s_waitcnt lgkmcnt(10)
    v_dot2_f32_bf16 v12, v72, s14, v12
    v_dot2_f32_bf16 v14, v72, s15, v14
    ds_read_b32 v71, v10 offset:3072
    s_waitcnt lgkmcnt(10)
    v_dot2_f32_bf16 v13, v73, s14, v13
    v_dot2_f32_bf16 v15, v73, s15, v15
    ds_read_b32 v72, v10 offset:4096
    s_waitcnt lgkmcnt(10)
    v_dot2_f32_bf16 v12, v74, s14, v12
    v_dot2_f32_bf16 v14, v74, s15, v14
    ds_read_b32 v73, v10 offset:5120
    s_waitcnt lgkmcnt(10)
    v_dot2_f32_bf16 v13, v75, s14, v13
    v_dot2_f32_bf16 v15, v75, s15, v15
    ds_read_b32 v74, v10 offset:6144
    s_waitcnt lgkmcnt(10)
    v_dot2_f32_bf16 v12, v64, s14, v12
    v_dot2_f32_bf16 v14, v64, s15, v14
    ds_read_b32 v75, v10 offset:7168
    s_waitcnt lgkmcnt(10)
    v_dot2_f32_bf16 v13, v65, s14, v13
    v_dot2_f32_bf16 v15, v65, s15, v15
    s_waitcnt lgkmcnt(9)
    v_dot2_f32_bf16 v12, v66, s14, v12
    v_dot2_f32_bf16 v14, v66, s15, v14
    s_waitcnt lgkmcnt(8)
    v_dot2_f32_bf16 v13, v67, s14, v13
    v_dot2_f32_bf16 v15, v67, s15, v15
    s_waitcnt lgkmcnt(7)
    v_dot2_f32_bf16 v12, v68, s14, v12
    v_dot2_f32_bf16 v14, v68, s15, v14
    s_waitcnt lgkmcnt(6)
    v_dot2_f32_bf16 v13, v69, s14, v13
    v_dot2_f32_bf16 v15, v69, s15, v15
    s_waitcnt lgkmcnt(5)
    v_dot2_f32_bf16 v12, v70, s14, v12
    v_dot2_f32_bf16 v14, v70, s15, v14
    s_waitcnt lgkmcnt(4)
    v_dot2_f32_bf16 v13, v71, s14, v13
    v_dot2_f32_bf16 v15, v71, s15, v15
    s_waitcnt lgkmcnt(3)
    v_dot2_f32_bf16 v12, v72, s14, v12
    v_dot2_f32_bf16 v14, v72, s15, v14
    s_waitcnt lgkmcnt(2)
    v_dot2_f32_bf16 v13, v73, s14, v13
    v_dot2_f32_bf16 v15, v73, s15, v15
    s_waitcnt lgkmcnt(1)
    v_dot2_f32_bf16 v12, v74, s14, v12
    v_dot2_f32_bf16 v14, v74, s15, v14
    s_waitcnt lgkmcnt(0)
    v_dot2_f32_bf16 v13, v75, s14, v13
    v_dot2_f32_bf16 v15, v75, s15, v15
    s_nop 3
    v_add_f32 v12, v12, v13
    v_add_f32 v13, v14, v15
    v_lshlrev_b32 v9, 8, v9
    v_and_b32 v10, 31, v0
    v_lshl_add_u32 v9, v10, 3, v9
    v_add_u32 v9, 73728, v9
    ds_write_b64 v9, v[12:13]
    s_waitcnt lgkmcnt(0)
    s_barrier
    v_and_b32 v9, 15, v1
    s_lshl_b32 s14, s3, 4
    v_add_u32 v9, s14, v9
    v_lshlrev_b32 v9, 2, v9
    v_add_u32 v9, 73728, v9
    ds_read_b32 v64, v9 offset:0
    ds_read_b32 v65, v9 offset:256
    ds_read_b32 v66, v9 offset:512
    ds_read_b32 v67, v9 offset:768
    ds_read_b32 v68, v9 offset:1024
    ds_read_b32 v69, v9 offset:1280
    ds_read_b32 v70, v9 offset:1536
    ds_read_b32 v71, v9 offset:1792
    s_waitcnt lgkmcnt(0)
    v_add_f32 v64, v64, v65
    v_add_f32 v64, v64, v66
    v_add_f32 v64, v64, v67
    v_add_f32 v64, v64, v68
    v_add_f32 v64, v64, v69
    v_add_f32 v64, v64, v70
    v_add_f32 v64, v64, v71
    v_mul_f32 v12, 0xbae38e39, v64
    s_lshl_b32 s10, s4, 2
    s_add_u32 s10, s10, s3
    s_mul_i32 s11, s10, 57
    s_lshr_b32 s11, s11, 11
    s_mul_i32 s12, s11, 36
    s_sub_u32 s12, s10, s12
    s_mul_i32 s14, s11, 648
    s_mul_i32 s11, s12, 43
    s_lshr_b32 s11, s11, 9
    s_mul_i32 s15, s11, 12
    s_sub_u32 s12, s12, s15
    s_mul_i32 s11, s11, 54
    s_add_u32 s14, s14, s11
    s_mul_i32 s11, s12, 86
    s_lshr_b32 s11, s11, 8
    s_mul_i32 s15, s11, 3
    s_sub_u32 s12, s12, s15
    s_mul_i32 s11, s11, 162
    s_add_u32 s14, s14, s11
    s_add_u32 s14, s14, s12
    s_lshl_b32 s14, s14, 10
    v_lshrrev_b32 v8, 4, v1
    v_bfe_u32 v9, v1, 2, 2
    v_lshl_add_u32 v8, v8, 3, v9
    v_lshlrev_b32 v8, 7, v8
    v_and_b32 v9, 3, v1
    v_lshl_add_u32 v8, v9, 3, v8
    s_lshl_b32 s15, s3, 5
    v_add_u32 v8, s15, v8
    v_add_u32 v10, 0xf000, v8
    ds_read_b64_tr_b16 v[64:65], v8 offset:0
    ds_read_b64_tr_b16 v[66:67], v8 offset:512
    ds_read_b64_tr_b16 v[68:69], v8 offset:4096
    ds_read_b64_tr_b16 v[70:71], v8 offset:4608
    ds_read_b64_tr_b16 v[72:73], v8 offset:8192
    ds_read_b64_tr_b16 v[74:75], v8 offset:8704
    ds_read_b64_tr_b16 v[76:77], v8 offset:12288
    ds_read_b64_tr_b16 v[78:79], v8 offset:12800
    ds_read_b64_tr_b16 v[80:81], v8 offset:16384
    ds_read_b64_tr_b16 v[82:83], v8 offset:16896
    ds_read_b64_tr_b16 v[84:85], v8 offset:20480
    ds_read_b64_tr_b16 v[86:87], v8 offset:20992
    s_waitcnt lgkmcnt(10)
    v_lshlrev_b32 v16, 16, v64
    v_and_b32 v17, 0xffff0000, v64
    v_pk_add_f32 v[16:17], v[16:17], v[12:13] op_sel_hi:[1,0]
    v_cvt_pk_bf16_f32 v96, v16, v17
    v_lshlrev_b32 v18, 16, v65
    v_and_b32 v19, 0xffff0000, v65
    v_pk_add_f32 v[18:19], v[18:19], v[12:13] op_sel_hi:[1,0]
    v_cvt_pk_bf16_f32 v97, v18, v19
    v_lshlrev_b32 v16, 16, v66
    v_and_b32 v17, 0xffff0000, v66
    v_pk_add_f32 v[16:17], v[16:17], v[12:13] op_sel_hi:[1,0]
    v_cvt_pk_bf16_f32 v98, v16, v17
    v_lshlrev_b32 v18, 16, v67
    v_and_b32 v19, 0xffff0000, v67
    v_pk_add_f32 v[18:19], v[18:19], v[12:13] op_sel_hi:[1,0]
    v_cvt_pk_bf16_f32 v99, v18, v19
    buffer_store_dwordx4 v[96:99], v2, s[64:67], s14 offen sc1
    s_add_u32 s14, s14, 3072
    ds_read_b64_tr_b16 v[64:65], v8 offset:24576
    ds_read_b64_tr_b16 v[66:67], v8 offset:25088
    s_waitcnt lgkmcnt(10)
    v_lshlrev_b32 v16, 16, v68
    v_and_b32 v17, 0xffff0000, v68
    v_pk_add_f32 v[16:17], v[16:17], v[12:13] op_sel_hi:[1,0]
    v_cvt_pk_bf16_f32 v100, v16, v17
    v_lshlrev_b32 v18, 16, v69
    v_and_b32 v19, 0xffff0000, v69
    v_pk_add_f32 v[18:19], v[18:19], v[12:13] op_sel_hi:[1,0]
    v_cvt_pk_bf16_f32 v101, v18, v19
    v_lshlrev_b32 v16, 16, v70
    v_and_b32 v17, 0xffff0000, v70
    v_pk_add_f32 v[16:17], v[16:17], v[12:13] op_sel_hi:[1,0]
    v_cvt_pk_bf16_f32 v102, v16, v17
    v_lshlrev_b32 v18, 16, v71
    v_and_b32 v19, 0xffff0000, v71
    v_pk_add_f32 v[18:19], v[18:19], v[12:13] op_sel_hi:[1,0]
    v_cvt_pk_bf16_f32 v103, v18, v19
    buffer_store_dwordx4 v[100:103], v2, s[64:67], s14 offen sc1
    s_add_u32 s14, s14, 3072
    ds_read_b64_tr_b16 v[68:69], v8 offset:28672
    ds_read_b64_tr_b16 v[70:71], v8 offset:29184
    s_waitcnt lgkmcnt(10)
    v_lshlrev_b32 v16, 16, v72
    v_and_b32 v17, 0xffff0000, v72
    v_pk_add_f32 v[16:17], v[16:17], v[12:13] op_sel_hi:[1,0]
    v_cvt_pk_bf16_f32 v104, v16, v17
    v_lshlrev_b32 v18, 16, v73
    v_and_b32 v19, 0xffff0000, v73
    v_pk_add_f32 v[18:19], v[18:19], v[12:13] op_sel_hi:[1,0]
    v_cvt_pk_bf16_f32 v105, v18, v19
    v_lshlrev_b32 v16, 16, v74
    v_and_b32 v17, 0xffff0000, v74
    v_pk_add_f32 v[16:17], v[16:17], v[12:13] op_sel_hi:[1,0]
    v_cvt_pk_bf16_f32 v106, v16, v17
    v_lshlrev_b32 v18, 16, v75
    v_and_b32 v19, 0xffff0000, v75
    v_pk_add_f32 v[18:19], v[18:19], v[12:13] op_sel_hi:[1,0]
    v_cvt_pk_bf16_f32 v107, v18, v19
    buffer_store_dwordx4 v[104:107], v2, s[64:67], s14 offen sc1
    s_add_u32 s14, s14, 3072
    ds_read_b64_tr_b16 v[72:73], v8 offset:32768
    ds_read_b64_tr_b16 v[74:75], v8 offset:33280
    s_waitcnt lgkmcnt(10)
    v_lshlrev_b32 v16, 16, v76
    v_and_b32 v17, 0xffff0000, v76
    v_pk_add_f32 v[16:17], v[16:17], v[12:13] op_sel_hi:[1,0]
    v_cvt_pk_bf16_f32 v108, v16, v17
    v_lshlrev_b32 v18, 16, v77
    v_and_b32 v19, 0xffff0000, v77
    v_pk_add_f32 v[18:19], v[18:19], v[12:13] op_sel_hi:[1,0]
    v_cvt_pk_bf16_f32 v109, v18, v19
    v_lshlrev_b32 v16, 16, v78
    v_and_b32 v17, 0xffff0000, v78
    v_pk_add_f32 v[16:17], v[16:17], v[12:13] op_sel_hi:[1,0]
    v_cvt_pk_bf16_f32 v110, v16, v17
    v_lshlrev_b32 v18, 16, v79
    v_and_b32 v19, 0xffff0000, v79
    v_pk_add_f32 v[18:19], v[18:19], v[12:13] op_sel_hi:[1,0]
    v_cvt_pk_bf16_f32 v111, v18, v19
    buffer_store_dwordx4 v[108:111], v2, s[64:67], s14 offen sc1
    s_add_u32 s14, s14, 3072
    ds_read_b64_tr_b16 v[76:77], v8 offset:36864
    ds_read_b64_tr_b16 v[78:79], v8 offset:37376
    s_waitcnt lgkmcnt(10)
    v_lshlrev_b32 v16, 16, v80
    v_and_b32 v17, 0xffff0000, v80
    v_pk_add_f32 v[16:17], v[16:17], v[12:13] op_sel_hi:[1,0]
    v_cvt_pk_bf16_f32 v96, v16, v17
    v_lshlrev_b32 v18, 16, v81
    v_and_b32 v19, 0xffff0000, v81
    v_pk_add_f32 v[18:19], v[18:19], v[12:13] op_sel_hi:[1,0]
    v_cvt_pk_bf16_f32 v97, v18, v19
    v_lshlrev_b32 v16, 16, v82
    v_and_b32 v17, 0xffff0000, v82
    v_pk_add_f32 v[16:17], v[16:17], v[12:13] op_sel_hi:[1,0]
    v_cvt_pk_bf16_f32 v98, v16, v17
    v_lshlrev_b32 v18, 16, v83
    v_and_b32 v19, 0xffff0000, v83
    v_pk_add_f32 v[18:19], v[18:19], v[12:13] op_sel_hi:[1,0]
    v_cvt_pk_bf16_f32 v99, v18, v19
    buffer_store_dwordx4 v[96:99], v2, s[64:67], s14 offen sc1
    s_add_u32 s14, s14, 3072
    ds_read_b64_tr_b16 v[80:81], v8 offset:40960
    ds_read_b64_tr_b16 v[82:83], v8 offset:41472
    s_waitcnt lgkmcnt(10)
    v_lshlrev_b32 v16, 16, v84
    v_and_b32 v17, 0xffff0000, v84
    v_pk_add_f32 v[16:17], v[16:17], v[12:13] op_sel_hi:[1,0]
    v_cvt_pk_bf16_f32 v100, v16, v17
    v_lshlrev_b32 v18, 16, v85
    v_and_b32 v19, 0xffff0000, v85
    v_pk_add_f32 v[18:19], v[18:19], v[12:13] op_sel_hi:[1,0]
    v_cvt_pk_bf16_f32 v101, v18, v19
    v_lshlrev_b32 v16, 16, v86
    v_and_b32 v17, 0xffff0000, v86
    v_pk_add_f32 v[16:17], v[16:17], v[12:13] op_sel_hi:[1,0]
    v_cvt_pk_bf16_f32 v102, v16, v17
    v_lshlrev_b32 v18, 16, v87
    v_and_b32 v19, 0xffff0000, v87
    v_pk_add_f32 v[18:19], v[18:19], v[12:13] op_sel_hi:[1,0]
    v_cvt_pk_bf16_f32 v103, v18, v19
    buffer_store_dwordx4 v[100:103], v2, s[64:67], s14 offen sc1
    s_add_u32 s14, s14, 3072
    ds_read_b64_tr_b16 v[84:85], v8 offset:45056
    ds_read_b64_tr_b16 v[86:87], v8 offset:45568
    s_waitcnt lgkmcnt(10)
    v_lshlrev_b32 v16, 16, v64
    v_and_b32 v17, 0xffff0000, v64
    v_pk_add_f32 v[16:17], v[16:17], v[12:13] op_sel_hi:[1,0]
    v_cvt_pk_bf16_f32 v104, v16, v17
    v_lshlrev_b32 v18, 16, v65
    v_and_b32 v19, 0xffff0000, v65
    v_pk_add_f32 v[18:19], v[18:19], v[12:13] op_sel_hi:[1,0]
    v_cvt_pk_bf16_f32 v105, v18, v19
    v_lshlrev_b32 v16, 16, v66
    v_and_b32 v17, 0xffff0000, v66
    v_pk_add_f32 v[16:17], v[16:17], v[12:13] op_sel_hi:[1,0]
    v_cvt_pk_bf16_f32 v106, v16, v17
    v_lshlrev_b32 v18, 16, v67
    v_and_b32 v19, 0xffff0000, v67
    v_pk_add_f32 v[18:19], v[18:19], v[12:13] op_sel_hi:[1,0]
    v_cvt_pk_bf16_f32 v107, v18, v19
    buffer_store_dwordx4 v[104:107], v2, s[64:67], s14 offen sc1
    s_add_u32 s14, s14, 3072
    ds_read_b64_tr_b16 v[64:65], v8 offset:49152
    ds_read_b64_tr_b16 v[66:67], v8 offset:49664
    s_waitcnt lgkmcnt(10)
    v_lshlrev_b32 v16, 16, v68
    v_and_b32 v17, 0xffff0000, v68
    v_pk_add_f32 v[16:17], v[16:17], v[12:13] op_sel_hi:[1,0]
    v_cvt_pk_bf16_f32 v108, v16, v17
    v_lshlrev_b32 v18, 16, v69
    v_and_b32 v19, 0xffff0000, v69
    v_pk_add_f32 v[18:19], v[18:19], v[12:13] op_sel_hi:[1,0]
    v_cvt_pk_bf16_f32 v109, v18, v19
    v_lshlrev_b32 v16, 16, v70
    v_and_b32 v17, 0xffff0000, v70
    v_pk_add_f32 v[16:17], v[16:17], v[12:13] op_sel_hi:[1,0]
    v_cvt_pk_bf16_f32 v110, v16, v17
    v_lshlrev_b32 v18, 16, v71
    v_and_b32 v19, 0xffff0000, v71
    v_pk_add_f32 v[18:19], v[18:19], v[12:13] op_sel_hi:[1,0]
    v_cvt_pk_bf16_f32 v111, v18, v19
    buffer_store_dwordx4 v[108:111], v2, s[64:67], s14 offen sc1
    s_add_u32 s14, s14, 3072
    ds_read_b64_tr_b16 v[68:69], v8 offset:53248
    ds_read_b64_tr_b16 v[70:71], v8 offset:53760
    s_waitcnt lgkmcnt(10)
    v_lshlrev_b32 v16, 16, v72
    v_and_b32 v17, 0xffff0000, v72
    v_pk_add_f32 v[16:17], v[16:17], v[12:13] op_sel_hi:[1,0]
    v_cvt_pk_bf16_f32 v96, v16, v17
    v_lshlrev_b32 v18, 16, v73
    v_and_b32 v19, 0xffff0000, v73
    v_pk_add_f32 v[18:19], v[18:19], v[12:13] op_sel_hi:[1,0]
    v_cvt_pk_bf16_f32 v97, v18, v19
    v_lshlrev_b32 v16, 16, v74
    v_and_b32 v17, 0xffff0000, v74
    v_pk_add_f32 v[16:17], v[16:17], v[12:13] op_sel_hi:[1,0]
    v_cvt_pk_bf16_f32 v98, v16, v17
    v_lshlrev_b32 v18, 16, v75
    v_and_b32 v19, 0xffff0000, v75
    v_pk_add_f32 v[18:19], v[18:19], v[12:13] op_sel_hi:[1,0]
    v_cvt_pk_bf16_f32 v99, v18, v19
    buffer_store_dwordx4 v[96:99], v2, s[64:67], s14 offen sc1
    s_add_u32 s14, s14, 3072
    ds_read_b64_tr_b16 v[72:73], v8 offset:57344
    ds_read_b64_tr_b16 v[74:75], v8 offset:57856
    s_waitcnt lgkmcnt(10)
    v_lshlrev_b32 v16, 16, v76
    v_and_b32 v17, 0xffff0000, v76
    v_pk_add_f32 v[16:17], v[16:17], v[12:13] op_sel_hi:[1,0]
    v_cvt_pk_bf16_f32 v100, v16, v17
    v_lshlrev_b32 v18, 16, v77
    v_and_b32 v19, 0xffff0000, v77
    v_pk_add_f32 v[18:19], v[18:19], v[12:13] op_sel_hi:[1,0]
    v_cvt_pk_bf16_f32 v101, v18, v19
    v_lshlrev_b32 v16, 16, v78
    v_and_b32 v17, 0xffff0000, v78
    v_pk_add_f32 v[16:17], v[16:17], v[12:13] op_sel_hi:[1,0]
    v_cvt_pk_bf16_f32 v102, v16, v17
    v_lshlrev_b32 v18, 16, v79
    v_and_b32 v19, 0xffff0000, v79
    v_pk_add_f32 v[18:19], v[18:19], v[12:13] op_sel_hi:[1,0]
    v_cvt_pk_bf16_f32 v103, v18, v19
    buffer_store_dwordx4 v[100:103], v2, s[64:67], s14 offen sc1
    s_add_u32 s14, s14, 3072
    ds_read_b64_tr_b16 v[76:77], v10 offset:0
    ds_read_b64_tr_b16 v[78:79], v10 offset:512
    s_waitcnt lgkmcnt(10)
    v_lshlrev_b32 v16, 16, v80
    v_and_b32 v17, 0xffff0000, v80
    v_pk_add_f32 v[16:17], v[16:17], v[12:13] op_sel_hi:[1,0]
    v_cvt_pk_bf16_f32 v104, v16, v17
    v_lshlrev_b32 v18, 16, v81
    v_and_b32 v19, 0xffff0000, v81
    v_pk_add_f32 v[18:19], v[18:19], v[12:13] op_sel_hi:[1,0]
    v_cvt_pk_bf16_f32 v105, v18, v19
    v_lshlrev_b32 v16, 16, v82
    v_and_b32 v17, 0xffff0000, v82
    v_pk_add_f32 v[16:17], v[16:17], v[12:13] op_sel_hi:[1,0]
    v_cvt_pk_bf16_f32 v106, v16, v17
    v_lshlrev_b32 v18, 16, v83
    v_and_b32 v19, 0xffff0000, v83
    v_pk_add_f32 v[18:19], v[18:19], v[12:13] op_sel_hi:[1,0]
    v_cvt_pk_bf16_f32 v107, v18, v19
    buffer_store_dwordx4 v[104:107], v2, s[64:67], s14 offen sc1
    s_add_u32 s14, s14, 3072
    ds_read_b64_tr_b16 v[80:81], v10 offset:4096
    ds_read_b64_tr_b16 v[82:83], v10 offset:4608
    s_waitcnt lgkmcnt(10)
    v_lshlrev_b32 v16, 16, v84
    v_and_b32 v17, 0xffff0000, v84
    v_pk_add_f32 v[16:17], v[16:17], v[12:13] op_sel_hi:[1,0]
    v_cvt_pk_bf16_f32 v108, v16, v17
    v_lshlrev_b32 v18, 16, v85
    v_and_b32 v19, 0xffff0000, v85
    v_pk_add_f32 v[18:19], v[18:19], v[12:13] op_sel_hi:[1,0]
    v_cvt_pk_bf16_f32 v109, v18, v19
    v_lshlrev_b32 v16, 16, v86
    v_and_b32 v17, 0xffff0000, v86
    v_pk_add_f32 v[16:17], v[16:17], v[12:13] op_sel_hi:[1,0]
    v_cvt_pk_bf16_f32 v110, v16, v17
    v_lshlrev_b32 v18, 16, v87
    v_and_b32 v19, 0xffff0000, v87
    v_pk_add_f32 v[18:19], v[18:19], v[12:13] op_sel_hi:[1,0]
    v_cvt_pk_bf16_f32 v111, v18, v19
    buffer_store_dwordx4 v[108:111], v2, s[64:67], s14 offen sc1
    s_add_u32 s14, s14, 3072
    ds_read_b64_tr_b16 v[84:85], v10 offset:8192
    ds_read_b64_tr_b16 v[86:87], v10 offset:8704
    s_waitcnt lgkmcnt(10)
    v_lshlrev_b32 v16, 16, v64
    v_and_b32 v17, 0xffff0000, v64
    v_pk_add_f32 v[16:17], v[16:17], v[12:13] op_sel_hi:[1,0]
    v_cvt_pk_bf16_f32 v96, v16, v17
    v_lshlrev_b32 v18, 16, v65
    v_and_b32 v19, 0xffff0000, v65
    v_pk_add_f32 v[18:19], v[18:19], v[12:13] op_sel_hi:[1,0]
    v_cvt_pk_bf16_f32 v97, v18, v19
    v_lshlrev_b32 v16, 16, v66
    v_and_b32 v17, 0xffff0000, v66
    v_pk_add_f32 v[16:17], v[16:17], v[12:13] op_sel_hi:[1,0]
    v_cvt_pk_bf16_f32 v98, v16, v17
    v_lshlrev_b32 v18, 16, v67
    v_and_b32 v19, 0xffff0000, v67
    v_pk_add_f32 v[18:19], v[18:19], v[12:13] op_sel_hi:[1,0]
    v_cvt_pk_bf16_f32 v99, v18, v19
    buffer_store_dwordx4 v[96:99], v2, s[64:67], s14 offen sc1
    s_add_u32 s14, s14, 3072
    s_waitcnt lgkmcnt(8)
    v_lshlrev_b32 v16, 16, v68
    v_and_b32 v17, 0xffff0000, v68
    v_pk_add_f32 v[16:17], v[16:17], v[12:13] op_sel_hi:[1,0]
    v_cvt_pk_bf16_f32 v100, v16, v17
    v_lshlrev_b32 v18, 16, v69
    v_and_b32 v19, 0xffff0000, v69
    v_pk_add_f32 v[18:19], v[18:19], v[12:13] op_sel_hi:[1,0]
    v_cvt_pk_bf16_f32 v101, v18, v19
    v_lshlrev_b32 v16, 16, v70
    v_and_b32 v17, 0xffff0000, v70
    v_pk_add_f32 v[16:17], v[16:17], v[12:13] op_sel_hi:[1,0]
    v_cvt_pk_bf16_f32 v102, v16, v17
    v_lshlrev_b32 v18, 16, v71
    v_and_b32 v19, 0xffff0000, v71
    v_pk_add_f32 v[18:19], v[18:19], v[12:13] op_sel_hi:[1,0]
    v_cvt_pk_bf16_f32 v103, v18, v19
    buffer_store_dwordx4 v[100:103], v2, s[64:67], s14 offen sc1
    s_add_u32 s14, s14, 3072
    s_waitcnt lgkmcnt(6)
    v_lshlrev_b32 v16, 16, v72
    v_and_b32 v17, 0xffff0000, v72
    v_pk_add_f32 v[16:17], v[16:17], v[12:13] op_sel_hi:[1,0]
    v_cvt_pk_bf16_f32 v104, v16, v17
    v_lshlrev_b32 v18, 16, v73
    v_and_b32 v19, 0xffff0000, v73
    v_pk_add_f32 v[18:19], v[18:19], v[12:13] op_sel_hi:[1,0]
    v_cvt_pk_bf16_f32 v105, v18, v19
    v_lshlrev_b32 v16, 16, v74
    v_and_b32 v17, 0xffff0000, v74
    v_pk_add_f32 v[16:17], v[16:17], v[12:13] op_sel_hi:[1,0]
    v_cvt_pk_bf16_f32 v106, v16, v17
    v_lshlrev_b32 v18, 16, v75
    v_and_b32 v19, 0xffff0000, v75
    v_pk_add_f32 v[18:19], v[18:19], v[12:13] op_sel_hi:[1,0]
    v_cvt_pk_bf16_f32 v107, v18, v19
    buffer_store_dwordx4 v[104:107], v2, s[64:67], s14 offen sc1
    s_add_u32 s14, s14, 3072
    s_waitcnt lgkmcnt(4)
    v_lshlrev_b32 v16, 16, v76
    v_and_b32 v17, 0xffff0000, v76
    v_pk_add_f32 v[16:17], v[16:17], v[12:13] op_sel_hi:[1,0]
    v_cvt_pk_bf16_f32 v108, v16, v17
    v_lshlrev_b32 v18, 16, v77
    v_and_b32 v19, 0xffff0000, v77
    v_pk_add_f32 v[18:19], v[18:19], v[12:13] op_sel_hi:[1,0]
    v_cvt_pk_bf16_f32 v109, v18, v19
    v_lshlrev_b32 v16, 16, v78
    v_and_b32 v17, 0xffff0000, v78
    v_pk_add_f32 v[16:17], v[16:17], v[12:13] op_sel_hi:[1,0]
    v_cvt_pk_bf16_f32 v110, v16, v17
    v_lshlrev_b32 v18, 16, v79
    v_and_b32 v19, 0xffff0000, v79
    v_pk_add_f32 v[18:19], v[18:19], v[12:13] op_sel_hi:[1,0]
    v_cvt_pk_bf16_f32 v111, v18, v19
    buffer_store_dwordx4 v[108:111], v2, s[64:67], s14 offen sc1
    s_add_u32 s14, s14, 3072
    s_waitcnt lgkmcnt(2)
    v_lshlrev_b32 v16, 16, v80
    v_and_b32 v17, 0xffff0000, v80
    v_pk_add_f32 v[16:17], v[16:17], v[12:13] op_sel_hi:[1,0]
    v_cvt_pk_bf16_f32 v96, v16, v17
    v_lshlrev_b32 v18, 16, v81
    v_and_b32 v19, 0xffff0000, v81
    v_pk_add_f32 v[18:19], v[18:19], v[12:13] op_sel_hi:[1,0]
    v_cvt_pk_bf16_f32 v97, v18, v19
    v_lshlrev_b32 v16, 16, v82
    v_and_b32 v17, 0xffff0000, v82
    v_pk_add_f32 v[16:17], v[16:17], v[12:13] op_sel_hi:[1,0]
    v_cvt_pk_bf16_f32 v98, v16, v17
    v_lshlrev_b32 v18, 16, v83
    v_and_b32 v19, 0xffff0000, v83
    v_pk_add_f32 v[18:19], v[18:19], v[12:13] op_sel_hi:[1,0]
    v_cvt_pk_bf16_f32 v99, v18, v19
    buffer_store_dwordx4 v[96:99], v2, s[64:67], s14 offen sc1
    s_add_u32 s14, s14, 3072
    s_waitcnt lgkmcnt(0)
    v_lshlrev_b32 v16, 16, v84
    v_and_b32 v17, 0xffff0000, v84
    v_pk_add_f32 v[16:17], v[16:17], v[12:13] op_sel_hi:[1,0]
    v_cvt_pk_bf16_f32 v100, v16, v17
    v_lshlrev_b32 v18, 16, v85
    v_and_b32 v19, 0xffff0000, v85
    v_pk_add_f32 v[18:19], v[18:19], v[12:13] op_sel_hi:[1,0]
    v_cvt_pk_bf16_f32 v101, v18, v19
    v_lshlrev_b32 v16, 16, v86
    v_and_b32 v17, 0xffff0000, v86
    v_pk_add_f32 v[16:17], v[16:17], v[12:13] op_sel_hi:[1,0]
    v_cvt_pk_bf16_f32 v102, v16, v17
    v_lshlrev_b32 v18, 16, v87
    v_and_b32 v19, 0xffff0000, v87
    v_pk_add_f32 v[18:19], v[18:19], v[12:13] op_sel_hi:[1,0]
    v_cvt_pk_bf16_f32 v103, v18, v19
    buffer_store_dwordx4 v[100:103], v2, s[64:67], s14 offen sc1
    s_waitcnt vmcnt(36)
    v_lshlrev_b32 v216, 16, v216
    v_mul_f32 v234, 0xbfb8aa3b, v216
    v_exp_f32 v234, v234
    s_nop 0
    v_add_f32 v234, 1.0, v234
    v_rcp_f32 v234, v234
    s_nop 0
    v_mul_f32 v216, v216, v234
    v_lshlrev_b32 v217, 16, v217
    v_mul_f32 v235, 0xbfb8aa3b, v217
    v_exp_f32 v235, v235
    s_nop 0
    v_add_f32 v235, 1.0, v235
    v_rcp_f32 v235, v235
    s_nop 0
    v_mul_f32 v217, v217, v235
    v_lshlrev_b32 v218, 16, v218
    v_mul_f32 v234, 0xbfb8aa3b, v218
    v_exp_f32 v234, v234
    s_nop 0
    v_add_f32 v234, 1.0, v234
    v_rcp_f32 v234, v234
    s_nop 0
    v_mul_f32 v218, v218, v234
    v_lshlrev_b32 v219, 16, v219
    v_mul_f32 v235, 0xbfb8aa3b, v219
    v_exp_f32 v235, v235
    s_nop 0
    v_add_f32 v235, 1.0, v235
    v_rcp_f32 v235, v235
    s_nop 0
    v_mul_f32 v219, v219, v235
    v_lshlrev_b32 v220, 16, v220
    v_mul_f32 v234, 0xbfb8aa3b, v220
    v_exp_f32 v234, v234
    s_nop 0
    v_add_f32 v234, 1.0, v234
    v_rcp_f32 v234, v234
    s_nop 0
    v_mul_f32 v220, v220, v234
    v_lshlrev_b32 v221, 16, v221
    v_mul_f32 v235, 0xbfb8aa3b, v221
    v_exp_f32 v235, v235
    s_nop 0
    v_add_f32 v235, 1.0, v235
    v_rcp_f32 v235, v235
    s_nop 0
    v_mul_f32 v221, v221, v235
    v_lshlrev_b32 v222, 16, v222
    v_mul_f32 v234, 0xbfb8aa3b, v222
    v_exp_f32 v234, v234
    s_nop 0
    v_add_f32 v234, 1.0, v234
    v_rcp_f32 v234, v234
    s_nop 0
    v_mul_f32 v222, v222, v234
    v_lshlrev_b32 v223, 16, v223
    v_mul_f32 v235, 0xbfb8aa3b, v223
    v_exp_f32 v235, v235
    s_nop 0
    v_add_f32 v235, 1.0, v235
    v_rcp_f32 v235, v235
    s_nop 0
    v_mul_f32 v223, v223, v235
    v_lshlrev_b32 v224, 16, v224
    v_mul_f32 v234, 0xbfb8aa3b, v224
    v_exp_f32 v234, v234
    s_nop 0
    v_add_f32 v234, 1.0, v234
    v_rcp_f32 v234, v234
    s_nop 0
    v_mul_f32 v224, v224, v234
    v_lshlrev_b32 v225, 16, v225
    v_mul_f32 v235, 0xbfb8aa3b, v225
    v_exp_f32 v235, v235
    s_nop 0
    v_add_f32 v235, 1.0, v235
    v_rcp_f32 v235, v235
    s_nop 0
    v_mul_f32 v225, v225, v235
    v_lshlrev_b32 v226, 16, v226
    v_mul_f32 v234, 0xbfb8aa3b, v226
    v_exp_f32 v234, v234
    s_nop 0
    v_add_f32 v234, 1.0, v234
    v_rcp_f32 v234, v234
    s_nop 0
    v_mul_f32 v226, v226, v234
    v_lshlrev_b32 v227, 16, v227
    v_mul_f32 v235, 0xbfb8aa3b, v227
    v_exp_f32 v235, v235
    s_nop 0
    v_add_f32 v235, 1.0, v235
    v_rcp_f32 v235, v235
    s_nop 0
    v_mul_f32 v227, v227, v235
    v_lshlrev_b32 v228, 16, v228
    v_mul_f32 v234, 0xbfb8aa3b, v228
    v_exp_f32 v234, v234
    s_nop 0
    v_add_f32 v234, 1.0, v234
    v_rcp_f32 v234, v234
    s_nop 0
    v_mul_f32 v228, v228, v234
    v_lshlrev_b32 v229, 16, v229
    v_mul_f32 v235, 0xbfb8aa3b, v229
    v_exp_f32 v235, v235
    s_nop 0
    v_add_f32 v235, 1.0, v235
    v_rcp_f32 v235, v235
    s_nop 0
    v_mul_f32 v229, v229, v235
    v_lshlrev_b32 v230, 16, v230
    v_mul_f32 v234, 0xbfb8aa3b, v230
    v_exp_f32 v234, v234
    s_nop 0
    v_add_f32 v234, 1.0, v234
    v_rcp_f32 v234, v234
    s_nop 0
    v_mul_f32 v230, v230, v234
    v_lshlrev_b32 v231, 16, v231
    v_mul_f32 v235, 0xbfb8aa3b, v231
    v_exp_f32 v235, v235
    s_nop 0
    v_add_f32 v235, 1.0, v235
    v_rcp_f32 v235, v235
    s_nop 0
    v_mul_f32 v231, v231, v235
    v_lshlrev_b32 v232, 16, v232
    v_mul_f32 v234, 0xbfb8aa3b, v232
    v_exp_f32 v234, v234
    s_nop 0
    v_add_f32 v234, 1.0, v234
    v_rcp_f32 v234, v234
    s_nop 0
    v_mul_f32 v232, v232, v234
    v_lshlrev_b32 v233, 16, v233
    v_mul_f32 v235, 0xbfb8aa3b, v233
    v_exp_f32 v235, v235
    s_nop 0
    v_add_f32 v235, 1.0, v235
    v_rcp_f32 v235, v235
    s_nop 0
    v_mul_f32 v233, v233, v235
    v_mov_b32 v242, 0
    v_mov_b32 v243, 0
    v_mov_b32 v244, 0
    v_mov_b32 v245, 0
    v_mov_b32 v246, 0
    v_mov_b32 v247, 0
    v_mov_b32 v248, 0
    v_mov_b32 v249, 0
    s_waitcnt vmcnt(35)
    v_lshlrev_b32 v238, 16, v144
    v_and_b32 v239, 0xffff0000, v144
    v_pk_fma_f32 v[242:243], v[238:239], v[216:217], v[242:243] op_sel_hi:[1,0,1]
    v_lshlrev_b32 v240, 16, v145
    v_and_b32 v241, 0xffff0000, v145
    v_pk_fma_f32 v[244:245], v[240:241], v[216:217], v[244:245] op_sel_hi:[1,0,1]
    v_lshlrev_b32 v238, 16, v146
    v_and_b32 v239, 0xffff0000, v146
    v_pk_fma_f32 v[246:247], v[238:239], v[216:217], v[246:247] op_sel_hi:[1,0,1]
    v_lshlrev_b32 v240, 16, v147
    v_and_b32 v241, 0xffff0000, v147
    v_pk_fma_f32 v[248:249], v[240:241], v[216:217], v[248:249] op_sel_hi:[1,0,1]
    s_waitcnt vmcnt(34)
    v_mov_b32 v236, v217
    v_lshlrev_b32 v238, 16, v148
    v_and_b32 v239, 0xffff0000, v148
    v_pk_fma_f32 v[242:243], v[238:239], v[236:237], v[242:243] op_sel_hi:[1,0,1]
    v_lshlrev_b32 v240, 16, v149
    v_and_b32 v241, 0xffff0000, v149
    v_pk_fma_f32 v[244:245], v[240:241], v[236:237], v[244:245] op_sel_hi:[1,0,1]
    v_lshlrev_b32 v238, 16, v150
    v_and_b32 v239, 0xffff0000, v150
    v_pk_fma_f32 v[246:247], v[238:239], v[236:237], v[246:247] op_sel_hi:[1,0,1]
    v_lshlrev_b32 v240, 16, v151
    v_and_b32 v241, 0xffff0000, v151
    v_pk_fma_f32 v[248:249], v[240:241], v[236:237], v[248:249] op_sel_hi:[1,0,1]
    s_waitcnt vmcnt(33)
    v_lshlrev_b32 v238, 16, v152
    v_and_b32 v239, 0xffff0000, v152
    v_pk_fma_f32 v[242:243], v[238:239], v[218:219], v[242:243] op_sel_hi:[1,0,1]
    v_lshlrev_b32 v240, 16, v153
    v_and_b32 v241, 0xffff0000, v153
    v_pk_fma_f32 v[244:245], v[240:241], v[218:219], v[244:245] op_sel_hi:[1,0,1]
    v_lshlrev_b32 v238, 16, v154
    v_and_b32 v239, 0xffff0000, v154
    v_pk_fma_f32 v[246:247], v[238:239], v[218:219], v[246:247] op_sel_hi:[1,0,1]
    v_lshlrev_b32 v240, 16, v155
    v_and_b32 v241, 0xffff0000, v155
    v_pk_fma_f32 v[248:249], v[240:241], v[218:219], v[248:249] op_sel_hi:[1,0,1]
    s_waitcnt vmcnt(32)
    v_mov_b32 v236, v219
    v_lshlrev_b32 v238, 16, v156
    v_and_b32 v239, 0xffff0000, v156
    v_pk_fma_f32 v[242:243], v[238:239], v[236:237], v[242:243] op_sel_hi:[1,0,1]
    v_lshlrev_b32 v240, 16, v157
    v_and_b32 v241, 0xffff0000, v157
    v_pk_fma_f32 v[244:245], v[240:241], v[236:237], v[244:245] op_sel_hi:[1,0,1]
    v_lshlrev_b32 v238, 16, v158
    v_and_b32 v239, 0xffff0000, v158
    v_pk_fma_f32 v[246:247], v[238:239], v[236:237], v[246:247] op_sel_hi:[1,0,1]
    v_lshlrev_b32 v240, 16, v159
    v_and_b32 v241, 0xffff0000, v159
    v_pk_fma_f32 v[248:249], v[240:241], v[236:237], v[248:249] op_sel_hi:[1,0,1]
    s_waitcnt vmcnt(31)
    v_lshlrev_b32 v238, 16, v160
    v_and_b32 v239, 0xffff0000, v160
    v_pk_fma_f32 v[242:243], v[238:239], v[220:221], v[242:243] op_sel_hi:[1,0,1]
    v_lshlrev_b32 v240, 16, v161
    v_and_b32 v241, 0xffff0000, v161
    v_pk_fma_f32 v[244:245], v[240:241], v[220:221], v[244:245] op_sel_hi:[1,0,1]
    v_lshlrev_b32 v238, 16, v162
    v_and_b32 v239, 0xffff0000, v162
    v_pk_fma_f32 v[246:247], v[238:239], v[220:221], v[246:247] op_sel_hi:[1,0,1]
    v_lshlrev_b32 v240, 16, v163
    v_and_b32 v241, 0xffff0000, v163
    v_pk_fma_f32 v[248:249], v[240:241], v[220:221], v[248:249] op_sel_hi:[1,0,1]
    s_waitcnt vmcnt(30)
    v_mov_b32 v236, v221
    v_lshlrev_b32 v238, 16, v164
    v_and_b32 v239, 0xffff0000, v164
    v_pk_fma_f32 v[242:243], v[238:239], v[236:237], v[242:243] op_sel_hi:[1,0,1]
    v_lshlrev_b32 v240, 16, v165
    v_and_b32 v241, 0xffff0000, v165
    v_pk_fma_f32 v[244:245], v[240:241], v[236:237], v[244:245] op_sel_hi:[1,0,1]
    v_lshlrev_b32 v238, 16, v166
    v_and_b32 v239, 0xffff0000, v166
    v_pk_fma_f32 v[246:247], v[238:239], v[236:237], v[246:247] op_sel_hi:[1,0,1]
    v_lshlrev_b32 v240, 16, v167
    v_and_b32 v241, 0xffff0000, v167
    v_pk_fma_f32 v[248:249], v[240:241], v[236:237], v[248:249] op_sel_hi:[1,0,1]
    s_waitcnt vmcnt(29)
    v_lshlrev_b32 v238, 16, v168
    v_and_b32 v239, 0xffff0000, v168
    v_pk_fma_f32 v[242:243], v[238:239], v[222:223], v[242:243] op_sel_hi:[1,0,1]
    v_lshlrev_b32 v240, 16, v169
    v_and_b32 v241, 0xffff0000, v169
    v_pk_fma_f32 v[244:245], v[240:241], v[222:223], v[244:245] op_sel_hi:[1,0,1]
    v_lshlrev_b32 v238, 16, v170
    v_and_b32 v239, 0xffff0000, v170
    v_pk_fma_f32 v[246:247], v[238:239], v[222:223], v[246:247] op_sel_hi:[1,0,1]
    v_lshlrev_b32 v240, 16, v171
    v_and_b32 v241, 0xffff0000, v171
    v_pk_fma_f32 v[248:249], v[240:241], v[222:223], v[248:249] op_sel_hi:[1,0,1]
    s_waitcnt vmcnt(28)
    v_mov_b32 v236, v223
    v_lshlrev_b32 v238, 16, v172
    v_and_b32 v239, 0xffff0000, v172
    v_pk_fma_f32 v[242:243], v[238:239], v[236:237], v[242:243] op_sel_hi:[1,0,1]
    v_lshlrev_b32 v240, 16, v173
    v_and_b32 v241, 0xffff0000, v173
    v_pk_fma_f32 v[244:245], v[240:241], v[236:237], v[244:245] op_sel_hi:[1,0,1]
    v_lshlrev_b32 v238, 16, v174
    v_and_b32 v239, 0xffff0000, v174
    v_pk_fma_f32 v[246:247], v[238:239], v[236:237], v[246:247] op_sel_hi:[1,0,1]
    v_lshlrev_b32 v240, 16, v175
    v_and_b32 v241, 0xffff0000, v175
    v_pk_fma_f32 v[248:249], v[240:241], v[236:237], v[248:249] op_sel_hi:[1,0,1]
    s_waitcnt vmcnt(27)
    v_lshlrev_b32 v238, 16, v176
    v_and_b32 v239, 0xffff0000, v176
    v_pk_fma_f32 v[242:243], v[238:239], v[224:225], v[242:243] op_sel_hi:[1,0,1]
    v_lshlrev_b32 v240, 16, v177
    v_and_b32 v241, 0xffff0000, v177
    v_pk_fma_f32 v[244:245], v[240:241], v[224:225], v[244:245] op_sel_hi:[1,0,1]
    v_lshlrev_b32 v238, 16, v178
    v_and_b32 v239, 0xffff0000, v178
    v_pk_fma_f32 v[246:247], v[238:239], v[224:225], v[246:247] op_sel_hi:[1,0,1]
    v_lshlrev_b32 v240, 16, v179
    v_and_b32 v241, 0xffff0000, v179
    v_pk_fma_f32 v[248:249], v[240:241], v[224:225], v[248:249] op_sel_hi:[1,0,1]
    s_waitcnt vmcnt(26)
    v_mov_b32 v236, v225
    v_lshlrev_b32 v238, 16, v180
    v_and_b32 v239, 0xffff0000, v180
    v_pk_fma_f32 v[242:243], v[238:239], v[236:237], v[242:243] op_sel_hi:[1,0,1]
    v_lshlrev_b32 v240, 16, v181
    v_and_b32 v241, 0xffff0000, v181
    v_pk_fma_f32 v[244:245], v[240:241], v[236:237], v[244:245] op_sel_hi:[1,0,1]
    v_lshlrev_b32 v238, 16, v182
    v_and_b32 v239, 0xffff0000, v182
    v_pk_fma_f32 v[246:247], v[238:239], v[236:237], v[246:247] op_sel_hi:[1,0,1]
    v_lshlrev_b32 v240, 16, v183
    v_and_b32 v241, 0xffff0000, v183
    v_pk_fma_f32 v[248:249], v[240:241], v[236:237], v[248:249] op_sel_hi:[1,0,1]
    s_waitcnt vmcnt(25)
    v_lshlrev_b32 v238, 16, v184
    v_and_b32 v239, 0xffff0000, v184
    v_pk_fma_f32 v[242:243], v[238:239], v[226:227], v[242:243] op_sel_hi:[1,0,1]
    v_lshlrev_b32 v240, 16, v185
    v_and_b32 v241, 0xffff0000, v185
    v_pk_fma_f32 v[244:245], v[240:241], v[226:227], v[244:245] op_sel_hi:[1,0,1]
    v_lshlrev_b32 v238, 16, v186
    v_and_b32 v239, 0xffff0000, v186
    v_pk_fma_f32 v[246:247], v[238:239], v[226:227], v[246:247] op_sel_hi:[1,0,1]
    v_lshlrev_b32 v240, 16, v187
    v_and_b32 v241, 0xffff0000, v187
    v_pk_fma_f32 v[248:249], v[240:241], v[226:227], v[248:249] op_sel_hi:[1,0,1]
    s_waitcnt vmcnt(24)
    v_mov_b32 v236, v227
    v_lshlrev_b32 v238, 16, v188
    v_and_b32 v239, 0xffff0000, v188
    v_pk_fma_f32 v[242:243], v[238:239], v[236:237], v[242:243] op_sel_hi:[1,0,1]
    v_lshlrev_b32 v240, 16, v189
    v_and_b32 v241, 0xffff0000, v189
    v_pk_fma_f32 v[244:245], v[240:241], v[236:237], v[244:245] op_sel_hi:[1,0,1]
    v_lshlrev_b32 v238, 16, v190
    v_and_b32 v239, 0xffff0000, v190
    v_pk_fma_f32 v[246:247], v[238:239], v[236:237], v[246:247] op_sel_hi:[1,0,1]
    v_lshlrev_b32 v240, 16, v191
    v_and_b32 v241, 0xffff0000, v191
    v_pk_fma_f32 v[248:249], v[240:241], v[236:237], v[248:249] op_sel_hi:[1,0,1]
    s_waitcnt vmcnt(23)
    v_lshlrev_b32 v238, 16, v192
    v_and_b32 v239, 0xffff0000, v192
    v_pk_fma_f32 v[242:243], v[238:239], v[228:229], v[242:243] op_sel_hi:[1,0,1]
    v_lshlrev_b32 v240, 16, v193
    v_and_b32 v241, 0xffff0000, v193
    v_pk_fma_f32 v[244:245], v[240:241], v[228:229], v[244:245] op_sel_hi:[1,0,1]
    v_lshlrev_b32 v238, 16, v194
    v_and_b32 v239, 0xffff0000, v194
    v_pk_fma_f32 v[246:247], v[238:239], v[228:229], v[246:247] op_sel_hi:[1,0,1]
    v_lshlrev_b32 v240, 16, v195
    v_and_b32 v241, 0xffff0000, v195
    v_pk_fma_f32 v[248:249], v[240:241], v[228:229], v[248:249] op_sel_hi:[1,0,1]
    s_waitcnt vmcnt(22)
    v_mov_b32 v236, v229
    v_lshlrev_b32 v238, 16, v196
    v_and_b32 v239, 0xffff0000, v196
    v_pk_fma_f32 v[242:243], v[238:239], v[236:237], v[242:243] op_sel_hi:[1,0,1]
    v_lshlrev_b32 v240, 16, v197
    v_and_b32 v241, 0xffff0000, v197
    v_pk_fma_f32 v[244:245], v[240:241], v[236:237], v[244:245] op_sel_hi:[1,0,1]
    v_lshlrev_b32 v238, 16, v198
    v_and_b32 v239, 0xffff0000, v198
    v_pk_fma_f32 v[246:247], v[238:239], v[236:237], v[246:247] op_sel_hi:[1,0,1]
    v_lshlrev_b32 v240, 16, v199
    v_and_b32 v241, 0xffff0000, v199
    v_pk_fma_f32 v[248:249], v[240:241], v[236:237], v[248:249] op_sel_hi:[1,0,1]
    s_waitcnt vmcnt(21)
    v_lshlrev_b32 v238, 16, v200
    v_and_b32 v239, 0xffff0000, v200
    v_pk_fma_f32 v[242:243], v[238:239], v[230:231], v[242:243] op_sel_hi:[1,0,1]
    v_lshlrev_b32 v240, 16, v201
    v_and_b32 v241, 0xffff0000, v201
    v_pk_fma_f32 v[244:245], v[240:241], v[230:231], v[244:245] op_sel_hi:[1,0,1]
    v_lshlrev_b32 v238, 16, v202
    v_and_b32 v239, 0xffff0000, v202
    v_pk_fma_f32 v[246:247], v[238:239], v[230:231], v[246:247] op_sel_hi:[1,0,1]
    v_lshlrev_b32 v240, 16, v203
    v_and_b32 v241, 0xffff0000, v203
    v_pk_fma_f32 v[248:249], v[240:241], v[230:231], v[248:249] op_sel_hi:[1,0,1]
    s_waitcnt vmcnt(20)
    v_mov_b32 v236, v231
    v_lshlrev_b32 v238, 16, v204
    v_and_b32 v239, 0xffff0000, v204
    v_pk_fma_f32 v[242:243], v[238:239], v[236:237], v[242:243] op_sel_hi:[1,0,1]
    v_lshlrev_b32 v240, 16, v205
    v_and_b32 v241, 0xffff0000, v205
    v_pk_fma_f32 v[244:245], v[240:241], v[236:237], v[244:245] op_sel_hi:[1,0,1]
    v_lshlrev_b32 v238, 16, v206
    v_and_b32 v239, 0xffff0000, v206
    v_pk_fma_f32 v[246:247], v[238:239], v[236:237], v[246:247] op_sel_hi:[1,0,1]
    v_lshlrev_b32 v240, 16, v207
    v_and_b32 v241, 0xffff0000, v207
    v_pk_fma_f32 v[248:249], v[240:241], v[236:237], v[248:249] op_sel_hi:[1,0,1]
    s_waitcnt vmcnt(19)
    v_lshlrev_b32 v238, 16, v208
    v_and_b32 v239, 0xffff0000, v208
    v_pk_fma_f32 v[242:243], v[238:239], v[232:233], v[242:243] op_sel_hi:[1,0,1]
    v_lshlrev_b32 v240, 16, v209
    v_and_b32 v241, 0xffff0000, v209
    v_pk_fma_f32 v[244:245], v[240:241], v[232:233], v[244:245] op_sel_hi:[1,0,1]
    v_lshlrev_b32 v238, 16, v210
    v_and_b32 v239, 0xffff0000, v210
    v_pk_fma_f32 v[246:247], v[238:239], v[232:233], v[246:247] op_sel_hi:[1,0,1]
    v_lshlrev_b32 v240, 16, v211
    v_and_b32 v241, 0xffff0000, v211
    v_pk_fma_f32 v[248:249], v[240:241], v[232:233], v[248:249] op_sel_hi:[1,0,1]
    s_waitcnt vmcnt(18)
    v_mov_b32 v236, v233
    v_lshlrev_b32 v238, 16, v212
    v_and_b32 v239, 0xffff0000, v212
    v_pk_fma_f32 v[242:243], v[238:239], v[236:237], v[242:243] op_sel_hi:[1,0,1]
    v_lshlrev_b32 v240, 16, v213
    v_and_b32 v241, 0xffff0000, v213
    v_pk_fma_f32 v[244:245], v[240:241], v[236:237], v[244:245] op_sel_hi:[1,0,1]
    v_lshlrev_b32 v238, 16, v214
    v_and_b32 v239, 0xffff0000, v214
    v_pk_fma_f32 v[246:247], v[238:239], v[236:237], v[246:247] op_sel_hi:[1,0,1]
    v_lshlrev_b32 v240, 16, v215
    v_and_b32 v241, 0xffff0000, v215
    v_pk_fma_f32 v[248:249], v[240:241], v[236:237], v[248:249] op_sel_hi:[1,0,1]
    s_nop 1
    v_add_f32_dpp v242, v242, v242 row_ror:8 row_mask:0xf bank_mask:0xf
    v_add_f32_dpp v243, v243, v243 row_ror:8 row_mask:0xf bank_mask:0xf
    v_add_f32_dpp v244, v244, v244 row_ror:8 row_mask:0xf bank_mask:0xf
    v_add_f32_dpp v245, v245, v245 row_ror:8 row_mask:0xf bank_mask:0xf
    v_add_f32_dpp v246, v246, v246 row_ror:8 row_mask:0xf bank_mask:0xf
    v_add_f32_dpp v247, v247, v247 row_ror:8 row_mask:0xf bank_mask:0xf
    v_add_f32_dpp v248, v248, v248 row_ror:8 row_mask:0xf bank_mask:0xf
    v_add_f32_dpp v249, v249, v249 row_ror:8 row_mask:0xf bank_mask:0xf
    v_lshrrev_b32 v250, 4, v1
    s_lshl_b32 s8, s3, 2
    v_add_u32 v250, s8, v250
    v_lshlrev_b32 v250, 8, v250
    v_and_b32 v251, 7, v1
    v_lshlrev_b32 v251, 5, v251
    v_add_u32 v250, v250, v251
    v_add_u32 v250, 77824, v250
    v_and_b32 v251, 8, v1
    v_cmp_eq_u32 vcc, 0, v251
    s_and_saveexec_b64 s[8:9], vcc
    ds_write_b128 v250, v[242:245] offset:0
    ds_write_b128 v250, v[246:249] offset:16
    s_mov_b64 exec, s[8:9]
    s_waitcnt lgkmcnt(0)
    s_barrier
    v_cmp_gt_u32 vcc, 64, v0
    s_and_saveexec_b64 s[8:9], vcc
    s_cbranch_execz K2_ME1
    v_lshlrev_b32 v250, 2, v0
    v_add_u32 v251, 77824, v250
    ds_read_b32 v144, v251 offset:0
    ds_read_b32 v145, v251 offset:256
    ds_read_b32 v146, v251 offset:512
    ds_read_b32 v147, v251 offset:768
    ds_read_b32 v148, v251 offset:1024
    ds_read_b32 v149, v251 offset:1280
    ds_read_b32 v150, v251 offset:1536
    ds_read_b32 v151, v251 offset:1792
    ds_read_b32 v152, v251 offset:2048
    ds_read_b32 v153, v251 offset:2304
    ds_read_b32 v154, v251 offset:2560
    ds_read_b32 v155, v251 offset:2816
    ds_read_b32 v156, v251 offset:3072
    ds_read_b32 v157, v251 offset:3328
    ds_read_b32 v158, v251 offset:3584
    ds_read_b32 v159, v251 offset:3840
    s_waitcnt lgkmcnt(0)
    v_add_f32 v144, v144, v145
    v_add_f32 v144, v144, v146
    v_add_f32 v144, v144, v147
    v_add_f32 v144, v144, v148
    v_add_f32 v144, v144, v149
    v_add_f32 v144, v144, v150
    v_add_f32 v144, v144, v151
    v_add_f32 v144, v144, v152
    v_add_f32 v144, v144, v153
    v_add_f32 v144, v144, v154
    v_add_f32 v144, v144, v155
    v_add_f32 v144, v144, v156
    v_add_f32 v144, v144, v157
    v_add_f32 v144, v144, v158
    v_add_f32 v144, v144, v159
    s_lshl_b32 s10, s16, 8
    v_add_u32 v250, s10, v250
    buffer_store_dword v144, v250, s[56:59], 0 offen
K2_ME1:
    s_mov_b64 exec, -1
    s_branch K2_XEND
K2_CAT2:
    s_cmp_ge_u32 s4, 108
    s_cbranch_scc1 K2_CAT3
    s_sub_u32 s15, s4, 72
    s_cmp_ge_u32 s15, 18
    s_cbranch_scc1 W12b_2
    s_mov_b32 s52, s30
    s_mov_b32 s53, s31
    s_mov_b32 s54, 663552
    s_mov_b32 s55, 0x20000
    s_add_u32 s68, s46, 4734976
    s_addc_u32 s69, s47, 0
    s_mov_b32 s70, 663552
    s_mov_b32 s71, 0x20000
    s_branch W12g_3
W12b_2:
    s_mov_b32 s52, s32
    s_mov_b32 s53, s33
    s_mov_b32 s54, 663552
    s_mov_b32 s55, 0x20000
    s_add_u32 s68, s46, 5398528
    s_addc_u32 s69, s47, 0
    s_mov_b32 s70, 663552
    s_mov_b32 s71, 0x20000
    s_sub_u32 s15, s15, 18
W12g_3:
    s_mul_i32 s10, s15, 36864
    s_mul_i32 s8, s3, 9216
    s_add_u32 s8, s8, 36864
    s_add_u32 m0, s8, 0
    s_add_u32 s9, s10, 0
    buffer_load_dwordx4 v4, s[52:55], s9 offen nt lds
    s_add_u32 m0, s8, 1024
    s_add_u32 s9, s10, 1024
    buffer_load_dwordx4 v4, s[52:55], s9 offen nt lds
    s_add_u32 m0, s8, 2048
    s_add_u32 s9, s10, 2048
    buffer_load_dwordx4 v4, s[52:55], s9 offen nt lds
    s_add_u32 m0, s8, 3072
    s_add_u32 s9, s10, 3072
    buffer_load_dwordx4 v4, s[52:55], s9 offen nt lds
    s_add_u32 m0, s8, 4096
    s_add_u32 s9, s10, 4096
    buffer_load_dwordx4 v4, s[52:55], s9 offen nt lds
    s_add_u32 m0, s8, 5120
    s_add_u32 s9, s10, 5120
    buffer_load_dwordx4 v4, s[52:55], s9 offen nt lds
    s_add_u32 m0, s8, 6144
    s_add_u32 s9, s10, 6144
    buffer_load_dwordx4 v4, s[52:55], s9 offen nt lds
    s_add_u32 m0, s8, 7168
    s_add_u32 s9, s10, 7168
    buffer_load_dwordx4 v4, s[52:55], s9 offen nt lds
    s_add_u32 m0, s8, 8192
    s_add_u32 s9, s10, 8192
    buffer_load_dwordx4 v4, s[52:55], s9 offen nt lds
    s_mul_i32 s21, s3, 165888
    s_lshl_b32 s12, s15, 10
    s_add_u32 s21, s21, s12
    s_mov_b32 s76, s16
    s_mov_b32 s77, s17
    s_mov_b32 s78, 2359296
    s_mov_b32 s79, 0x20000
    s_lshr_b32 s15, s4, 3
    s_lshl_b32 s15, s15, 2
    s_add_u32 s15, s15, s3
    s_mul_i32 s15, s15, 6
    s_add_u32 s9, s15, 0
    s_mul_i32 s10, s9, 57
    s_lshr_b32 s10, s10, 11
    s_mul_i32 s11, s10, 36
    s_sub_u32 s11, s9, s11
    s_lshl_b32 s10, s10, 3
    s_and_b32 s12, s4, 7
    s_add_u32 s10, s10, s12
    s_mul_i32 s10, s10, 36
    s_add_u32 s10, s10, s11
    s_lshl_b32 s10, s10, 10
    v_add_u32 v18, s10, v2
    buffer_load_dwordx4 v[136:139], v18, s[76:79], 0 offen
    s_add_u32 s9, s15, 1
    s_mul_i32 s10, s9, 57
    s_lshr_b32 s10, s10, 11
    s_mul_i32 s11, s10, 36
    s_sub_u32 s11, s9, s11
    s_lshl_b32 s10, s10, 3
    s_and_b32 s12, s4, 7
    s_add_u32 s10, s10, s12
    s_mul_i32 s10, s10, 36
    s_add_u32 s10, s10, s11
    s_lshl_b32 s10, s10, 10
    v_add_u32 v18, s10, v2
    buffer_load_dwordx4 v[136:139], v18, s[76:79], 0 offen
    s_add_u32 s9, s15, 2
    s_mul_i32 s10, s9, 57
    s_lshr_b32 s10, s10, 11
    s_mul_i32 s11, s10, 36
    s_sub_u32 s11, s9, s11
    s_lshl_b32 s10, s10, 3
    s_and_b32 s12, s4, 7
    s_add_u32 s10, s10, s12
    s_mul_i32 s10, s10, 36
    s_add_u32 s10, s10, s11
    s_lshl_b32 s10, s10, 10
    v_add_u32 v18, s10, v2
    buffer_load_dwordx4 v[136:139], v18, s[76:79], 0 offen
    s_add_u32 s9, s15, 3
    s_mul_i32 s10, s9, 57
    s_lshr_b32 s10, s10, 11
    s_mul_i32 s11, s10, 36
    s_sub_u32 s11, s9, s11
    s_lshl_b32 s10, s10, 3
    s_and_b32 s12, s4, 7
    s_add_u32 s10, s10, s12
    s_mul_i32 s10, s10, 36
    s_add_u32 s10, s10, s11
    s_lshl_b32 s10, s10, 10
    v_add_u32 v18, s10, v2
    buffer_load_dwordx4 v[136:139], v18, s[76:79], 0 offen
    s_add_u32 s9, s15, 4
    s_mul_i32 s10, s9, 57
    s_lshr_b32 s10, s10, 11
    s_mul_i32 s11, s10, 36
    s_sub_u32 s11, s9, s11
    s_lshl_b32 s10, s10, 3
    s_and_b32 s12, s4, 7
    s_add_u32 s10, s10, s12
    s_mul_i32 s10, s10, 36
    s_add_u32 s10, s10, s11
    s_lshl_b32 s10, s10, 10
    v_add_u32 v18, s10, v2
    buffer_load_dwordx4 v[136:139], v18, s[76:79], 0 offen
    s_add_u32 s9, s15, 5
    s_mul_i32 s10, s9, 57
    s_lshr_b32 s10, s10, 11
    s_mul_i32 s11, s10, 36
    s_sub_u32 s11, s9, s11
    s_lshl_b32 s10, s10, 3
    s_and_b32 s12, s4, 7
    s_add_u32 s10, s10, s12
    s_mul_i32 s10, s10, 36
    s_add_u32 s10, s10, s11
    s_lshl_b32 s10, s10, 10
    v_add_u32 v18, s10, v2
    buffer_load_dwordx4 v[136:139], v18, s[76:79], 0 offen
    s_sub_u32 s16, s4, 58
    s_mov_b32 s72, s40
    s_mov_b32 s73, s41
    s_mov_b32 s74, 3981312
    s_mov_b32 s75, 0x20000
    s_mov_b32 s76, s38
    s_mov_b32 s77, s39
    s_mov_b32 s78, 1152
    s_mov_b32 s79, 0x20000
    s_mov_b32 s56, s46
    s_mov_b32 s57, s47
    s_mov_b32 s58, 13824
    s_mov_b32 s59, 0x20000
    v_lshrrev_b32 v250, 3, v1
    s_mul_i32 s8, s3, 144
    v_add_u32 v250, s8, v250
    v_and_b32 v251, 7, v1
    v_lshlrev_b32 v251, 4, v251
    s_lshl_b32 s8, s16, 7
    v_add_u32 v251, s8, v251
    v_mul_u32_u24 v252, 6912, v250
    v_add_u32 v252, v252, v251
    v_lshlrev_b32 v253, 1, v250
    buffer_load_ushort v216, v253, s[76:79], 0 offen offset:0
    buffer_load_ushort v217, v253, s[76:79], 0 offen offset:16
    buffer_load_ushort v218, v253, s[76:79], 0 offen offset:32
    buffer_load_ushort v219, v253, s[76:79], 0 offen offset:48
    buffer_load_ushort v220, v253, s[76:79], 0 offen offset:64
    buffer_load_ushort v221, v253, s[76:79], 0 offen offset:80
    buffer_load_ushort v222, v253, s[76:79], 0 offen offset:96
    buffer_load_ushort v223, v253, s[76:79], 0 offen offset:112
    buffer_load_ushort v224, v253, s[76:79], 0 offen offset:128
    buffer_load_ushort v225, v253, s[76:79], 0 offen offset:144
    buffer_load_ushort v226, v253, s[76:79], 0 offen offset:160
    buffer_load_ushort v227, v253, s[76:79], 0 offen offset:176
    buffer_load_ushort v228, v253, s[76:79], 0 offen offset:192
    buffer_load_ushort v229, v253, s[76:79], 0 offen offset:208
    buffer_load_ushort v230, v253, s[76:79], 0 offen offset:224
    buffer_load_ushort v231, v253, s[76:79], 0 offen offset:240
    buffer_load_ushort v232, v253, s[76:79], 0 offen offset:256
    buffer_load_ushort v233, v253, s[76:79], 0 offen offset:272
    buffer_load_dwordx4 v[144:147], v252, s[72:75], 0 offen nt
    v_add_u32 v252, 55296, v252
    buffer_load_dwordx4 v[148:151], v252, s[72:75], 0 offen nt
    v_add_u32 v252, 55296, v252
    buffer_load_dwordx4 v[152:155], v252, s[72:75], 0 offen nt
    v_add_u32 v252, 55296, v252
    buffer_load_dwordx4 v[156:159], v252, s[72:75], 0 offen nt
    v_add_u32 v252, 55296, v252
    buffer_load_dwordx4 v[160:163], v252, s[72:75], 0 offen nt
    v_add_u32 v252, 55296, v252
    buffer_load_dwordx4 v[164:167], v252, s[72:75], 0 offen nt
    v_add_u32 v252, 55296, v252
    buffer_load_dwordx4 v[168:171], v252, s[72:75], 0 offen nt
    v_add_u32 v252, 55296, v252
    buffer_load_dwordx4 v[172:175], v252, s[72:75], 0 offen nt
    v_add_u32 v252, 55296, v252
    buffer_load_dwordx4 v[176:179], v252, s[72:75], 0 offen nt
    v_add_u32 v252, 55296, v252
    buffer_load_dwordx4 v[180:183], v252, s[72:75], 0 offen nt
    v_add_u32 v252, 55296, v252
    buffer_load_dwordx4 v[184:187], v252, s[72:75], 0 offen nt
    v_add_u32 v252, 55296, v252
    buffer_load_dwordx4 v[188:191], v252, s[72:75], 0 offen nt
    v_add_u32 v252, 55296, v252
    buffer_load_dwordx4 v[192:195], v252, s[72:75], 0 offen nt
    v_add_u32 v252, 55296, v252
    buffer_load_dwordx4 v[196:199], v252, s[72:75], 0 offen nt
    v_add_u32 v252, 55296, v252
    buffer_load_dwordx4 v[200:203], v252, s[72:75], 0 offen nt
    v_add_u32 v252, 55296, v252
    buffer_load_dwordx4 v[204:207], v252, s[72:75], 0 offen nt
    v_add_u32 v252, 55296, v252
    buffer_load_dwordx4 v[208:211], v252, s[72:75], 0 offen nt
    v_add_u32 v252, 55296, v252
    buffer_load_dwordx4 v[212:215], v252, s[72:75], 0 offen nt
    s_waitcnt vmcnt(42)
    s_barrier
    s_mul_i32 s8, s3, 288
    s_add_u32 s8, s8, 36864
    v_add_u32 v7, s8, v5
    ds_read_b64_tr_b16 v[100:101], v7 offset:0
    ds_read_b64_tr_b16 v[102:103], v7 offset:4608
    ds_read_b64_tr_b16 v[104:105], v7 offset:32
    ds_read_b64_tr_b16 v[106:107], v7 offset:4640
    ds_read_b64_tr_b16 v[108:109], v7 offset:64
    ds_read_b64_tr_b16 v[110:111], v7 offset:4672
    ds_read_b64_tr_b16 v[112:113], v7 offset:96
    ds_read_b64_tr_b16 v[114:115], v7 offset:4704
    ds_read_b64_tr_b16 v[116:117], v7 offset:128
    ds_read_b64_tr_b16 v[118:119], v7 offset:4736
    ds_read_b64_tr_b16 v[120:121], v7 offset:160
    ds_read_b64_tr_b16 v[122:123], v7 offset:4768
    ds_read_b64_tr_b16 v[124:125], v7 offset:192
    ds_read_b64_tr_b16 v[126:127], v7 offset:4800
    ds_read_b64_tr_b16 v[128:129], v7 offset:224
    ds_read_b64_tr_b16 v[130:131], v7 offset:4832
    ds_read_b64_tr_b16 v[132:133], v7 offset:256
    ds_read_b64_tr_b16 v[134:135], v7 offset:4864
    s_add_u32 s9, s21, 0
    s_waitcnt lgkmcnt(15)
    buffer_store_dwordx4 v[100:103], v2, s[68:71], s9 offen sc1
    s_add_u32 s9, s21, 18432
    s_waitcnt lgkmcnt(14)
    buffer_store_dwordx4 v[104:107], v2, s[68:71], s9 offen sc1
    s_add_u32 s9, s21, 36864
    s_waitcnt lgkmcnt(12)
    buffer_store_dwordx4 v[108:111], v2, s[68:71], s9 offen sc1
    s_add_u32 s9, s21, 55296
    s_waitcnt lgkmcnt(10)
    buffer_store_dwordx4 v[112:115], v2, s[68:71], s9 offen sc1
    s_add_u32 s9, s21, 73728
    s_waitcnt lgkmcnt(8)
    buffer_store_dwordx4 v[116:119], v2, s[68:71], s9 offen sc1
    s_add_u32 s9, s21, 92160
    s_waitcnt lgkmcnt(6)
    buffer_store_dwordx4 v[120:123], v2, s[68:71], s9 offen sc1
    s_add_u32 s9, s21, 110592
    s_waitcnt lgkmcnt(4)
    buffer_store_dwordx4 v[124:127], v2, s[68:71], s9 offen sc1
    s_add_u32 s9, s21, 129024
    s_waitcnt lgkmcnt(2)
    buffer_store_dwordx4 v[128:131], v2, s[68:71], s9 offen sc1
    s_add_u32 s9, s21, 147456
    s_waitcnt lgkmcnt(0)
    buffer_store_dwordx4 v[132:135], v2, s[68:71], s9 offen sc1
    s_waitcnt vmcnt(27)
    v_lshlrev_b32 v216, 16, v216
    v_mul_f32 v234, 0xbfb8aa3b, v216
    v_exp_f32 v234, v234
    s_nop 0
    v_add_f32 v234, 1.0, v234
    v_rcp_f32 v234, v234
    s_nop 0
    v_mul_f32 v216, v216, v234
    v_lshlrev_b32 v217, 16, v217
    v_mul_f32 v235, 0xbfb8aa3b, v217
    v_exp_f32 v235, v235
    s_nop 0
    v_add_f32 v235, 1.0, v235
    v_rcp_f32 v235, v235
    s_nop 0
    v_mul_f32 v217, v217, v235
    v_lshlrev_b32 v218, 16, v218
    v_mul_f32 v234, 0xbfb8aa3b, v218
    v_exp_f32 v234, v234
    s_nop 0
    v_add_f32 v234, 1.0, v234
    v_rcp_f32 v234, v234
    s_nop 0
    v_mul_f32 v218, v218, v234
    v_lshlrev_b32 v219, 16, v219
    v_mul_f32 v235, 0xbfb8aa3b, v219
    v_exp_f32 v235, v235
    s_nop 0
    v_add_f32 v235, 1.0, v235
    v_rcp_f32 v235, v235
    s_nop 0
    v_mul_f32 v219, v219, v235
    v_lshlrev_b32 v220, 16, v220
    v_mul_f32 v234, 0xbfb8aa3b, v220
    v_exp_f32 v234, v234
    s_nop 0
    v_add_f32 v234, 1.0, v234
    v_rcp_f32 v234, v234
    s_nop 0
    v_mul_f32 v220, v220, v234
    v_lshlrev_b32 v221, 16, v221
    v_mul_f32 v235, 0xbfb8aa3b, v221
    v_exp_f32 v235, v235
    s_nop 0
    v_add_f32 v235, 1.0, v235
    v_rcp_f32 v235, v235
    s_nop 0
    v_mul_f32 v221, v221, v235
    v_lshlrev_b32 v222, 16, v222
    v_mul_f32 v234, 0xbfb8aa3b, v222
    v_exp_f32 v234, v234
    s_nop 0
    v_add_f32 v234, 1.0, v234
    v_rcp_f32 v234, v234
    s_nop 0
    v_mul_f32 v222, v222, v234
    v_lshlrev_b32 v223, 16, v223
    v_mul_f32 v235, 0xbfb8aa3b, v223
    v_exp_f32 v235, v235
    s_nop 0
    v_add_f32 v235, 1.0, v235
    v_rcp_f32 v235, v235
    s_nop 0
    v_mul_f32 v223, v223, v235
    v_lshlrev_b32 v224, 16, v224
    v_mul_f32 v234, 0xbfb8aa3b, v224
    v_exp_f32 v234, v234
    s_nop 0
    v_add_f32 v234, 1.0, v234
    v_rcp_f32 v234, v234
    s_nop 0
    v_mul_f32 v224, v224, v234
    v_lshlrev_b32 v225, 16, v225
    v_mul_f32 v235, 0xbfb8aa3b, v225
    v_exp_f32 v235, v235
    s_nop 0
    v_add_f32 v235, 1.0, v235
    v_rcp_f32 v235, v235
    s_nop 0
    v_mul_f32 v225, v225, v235
    v_lshlrev_b32 v226, 16, v226
    v_mul_f32 v234, 0xbfb8aa3b, v226
    v_exp_f32 v234, v234
    s_nop 0
    v_add_f32 v234, 1.0, v234
    v_rcp_f32 v234, v234
    s_nop 0
    v_mul_f32 v226, v226, v234
    v_lshlrev_b32 v227, 16, v227
    v_mul_f32 v235, 0xbfb8aa3b, v227
    v_exp_f32 v235, v235
    s_nop 0
    v_add_f32 v235, 1.0, v235
    v_rcp_f32 v235, v235
    s_nop 0
    v_mul_f32 v227, v227, v235
    v_lshlrev_b32 v228, 16, v228
    v_mul_f32 v234, 0xbfb8aa3b, v228
    v_exp_f32 v234, v234
    s_nop 0
    v_add_f32 v234, 1.0, v234
    v_rcp_f32 v234, v234
    s_nop 0
    v_mul_f32 v228, v228, v234
    v_lshlrev_b32 v229, 16, v229
    v_mul_f32 v235, 0xbfb8aa3b, v229
    v_exp_f32 v235, v235
    s_nop 0
    v_add_f32 v235, 1.0, v235
    v_rcp_f32 v235, v235
    s_nop 0
    v_mul_f32 v229, v229, v235
    v_lshlrev_b32 v230, 16, v230
    v_mul_f32 v234, 0xbfb8aa3b, v230
    v_exp_f32 v234, v234
    s_nop 0
    v_add_f32 v234, 1.0, v234
    v_rcp_f32 v234, v234
    s_nop 0
    v_mul_f32 v230, v230, v234
    v_lshlrev_b32 v231, 16, v231
    v_mul_f32 v235, 0xbfb8aa3b, v231
    v_exp_f32 v235, v235
    s_nop 0
    v_add_f32 v235, 1.0, v235
    v_rcp_f32 v235, v235
    s_nop 0
    v_mul_f32 v231, v231, v235
    v_lshlrev_b32 v232, 16, v232
    v_mul_f32 v234, 0xbfb8aa3b, v232
    v_exp_f32 v234, v234
    s_nop 0
    v_add_f32 v234, 1.0, v234
    v_rcp_f32 v234, v234
    s_nop 0
    v_mul_f32 v232, v232, v234
    v_lshlrev_b32 v233, 16, v233
    v_mul_f32 v235, 0xbfb8aa3b, v233
    v_exp_f32 v235, v235
    s_nop 0
    v_add_f32 v235, 1.0, v235
    v_rcp_f32 v235, v235
    s_nop 0
    v_mul_f32 v233, v233, v235
    v_mov_b32 v242, 0
    v_mov_b32 v243, 0
    v_mov_b32 v244, 0
    v_mov_b32 v245, 0
    v_mov_b32 v246, 0
    v_mov_b32 v247, 0
    v_mov_b32 v248, 0
    v_mov_b32 v249, 0
    s_waitcnt vmcnt(26)
    v_lshlrev_b32 v238, 16, v144
    v_and_b32 v239, 0xffff0000, v144
    v_pk_fma_f32 v[242:243], v[238:239], v[216:217], v[242:243] op_sel_hi:[1,0,1]
    v_lshlrev_b32 v240, 16, v145
    v_and_b32 v241, 0xffff0000, v145
    v_pk_fma_f32 v[244:245], v[240:241], v[216:217], v[244:245] op_sel_hi:[1,0,1]
    v_lshlrev_b32 v238, 16, v146
    v_and_b32 v239, 0xffff0000, v146
    v_pk_fma_f32 v[246:247], v[238:239], v[216:217], v[246:247] op_sel_hi:[1,0,1]
    v_lshlrev_b32 v240, 16, v147
    v_and_b32 v241, 0xffff0000, v147
    v_pk_fma_f32 v[248:249], v[240:241], v[216:217], v[248:249] op_sel_hi:[1,0,1]
    s_waitcnt vmcnt(25)
    v_mov_b32 v236, v217
    v_lshlrev_b32 v238, 16, v148
    v_and_b32 v239, 0xffff0000, v148
    v_pk_fma_f32 v[242:243], v[238:239], v[236:237], v[242:243] op_sel_hi:[1,0,1]
    v_lshlrev_b32 v240, 16, v149
    v_and_b32 v241, 0xffff0000, v149
    v_pk_fma_f32 v[244:245], v[240:241], v[236:237], v[244:245] op_sel_hi:[1,0,1]
    v_lshlrev_b32 v238, 16, v150
    v_and_b32 v239, 0xffff0000, v150
    v_pk_fma_f32 v[246:247], v[238:239], v[236:237], v[246:247] op_sel_hi:[1,0,1]
    v_lshlrev_b32 v240, 16, v151
    v_and_b32 v241, 0xffff0000, v151
    v_pk_fma_f32 v[248:249], v[240:241], v[236:237], v[248:249] op_sel_hi:[1,0,1]
    s_waitcnt vmcnt(24)
    v_lshlrev_b32 v238, 16, v152
    v_and_b32 v239, 0xffff0000, v152
    v_pk_fma_f32 v[242:243], v[238:239], v[218:219], v[242:243] op_sel_hi:[1,0,1]
    v_lshlrev_b32 v240, 16, v153
    v_and_b32 v241, 0xffff0000, v153
    v_pk_fma_f32 v[244:245], v[240:241], v[218:219], v[244:245] op_sel_hi:[1,0,1]
    v_lshlrev_b32 v238, 16, v154
    v_and_b32 v239, 0xffff0000, v154
    v_pk_fma_f32 v[246:247], v[238:239], v[218:219], v[246:247] op_sel_hi:[1,0,1]
    v_lshlrev_b32 v240, 16, v155
    v_and_b32 v241, 0xffff0000, v155
    v_pk_fma_f32 v[248:249], v[240:241], v[218:219], v[248:249] op_sel_hi:[1,0,1]
    s_waitcnt vmcnt(23)
    v_mov_b32 v236, v219
    v_lshlrev_b32 v238, 16, v156
    v_and_b32 v239, 0xffff0000, v156
    v_pk_fma_f32 v[242:243], v[238:239], v[236:237], v[242:243] op_sel_hi:[1,0,1]
    v_lshlrev_b32 v240, 16, v157
    v_and_b32 v241, 0xffff0000, v157
    v_pk_fma_f32 v[244:245], v[240:241], v[236:237], v[244:245] op_sel_hi:[1,0,1]
    v_lshlrev_b32 v238, 16, v158
    v_and_b32 v239, 0xffff0000, v158
    v_pk_fma_f32 v[246:247], v[238:239], v[236:237], v[246:247] op_sel_hi:[1,0,1]
    v_lshlrev_b32 v240, 16, v159
    v_and_b32 v241, 0xffff0000, v159
    v_pk_fma_f32 v[248:249], v[240:241], v[236:237], v[248:249] op_sel_hi:[1,0,1]
    s_waitcnt vmcnt(22)
    v_lshlrev_b32 v238, 16, v160
    v_and_b32 v239, 0xffff0000, v160
    v_pk_fma_f32 v[242:243], v[238:239], v[220:221], v[242:243] op_sel_hi:[1,0,1]
    v_lshlrev_b32 v240, 16, v161
    v_and_b32 v241, 0xffff0000, v161
    v_pk_fma_f32 v[244:245], v[240:241], v[220:221], v[244:245] op_sel_hi:[1,0,1]
    v_lshlrev_b32 v238, 16, v162
    v_and_b32 v239, 0xffff0000, v162
    v_pk_fma_f32 v[246:247], v[238:239], v[220:221], v[246:247] op_sel_hi:[1,0,1]
    v_lshlrev_b32 v240, 16, v163
    v_and_b32 v241, 0xffff0000, v163
    v_pk_fma_f32 v[248:249], v[240:241], v[220:221], v[248:249] op_sel_hi:[1,0,1]
    s_waitcnt vmcnt(21)
    v_mov_b32 v236, v221
    v_lshlrev_b32 v238, 16, v164
    v_and_b32 v239, 0xffff0000, v164
    v_pk_fma_f32 v[242:243], v[238:239], v[236:237], v[242:243] op_sel_hi:[1,0,1]
    v_lshlrev_b32 v240, 16, v165
    v_and_b32 v241, 0xffff0000, v165
    v_pk_fma_f32 v[244:245], v[240:241], v[236:237], v[244:245] op_sel_hi:[1,0,1]
    v_lshlrev_b32 v238, 16, v166
    v_and_b32 v239, 0xffff0000, v166
    v_pk_fma_f32 v[246:247], v[238:239], v[236:237], v[246:247] op_sel_hi:[1,0,1]
    v_lshlrev_b32 v240, 16, v167
    v_and_b32 v241, 0xffff0000, v167
    v_pk_fma_f32 v[248:249], v[240:241], v[236:237], v[248:249] op_sel_hi:[1,0,1]
    s_waitcnt vmcnt(20)
    v_lshlrev_b32 v238, 16, v168
    v_and_b32 v239, 0xffff0000, v168
    v_pk_fma_f32 v[242:243], v[238:239], v[222:223], v[242:243] op_sel_hi:[1,0,1]
    v_lshlrev_b32 v240, 16, v169
    v_and_b32 v241, 0xffff0000, v169
    v_pk_fma_f32 v[244:245], v[240:241], v[222:223], v[244:245] op_sel_hi:[1,0,1]
    v_lshlrev_b32 v238, 16, v170
    v_and_b32 v239, 0xffff0000, v170
    v_pk_fma_f32 v[246:247], v[238:239], v[222:223], v[246:247] op_sel_hi:[1,0,1]
    v_lshlrev_b32 v240, 16, v171
    v_and_b32 v241, 0xffff0000, v171
    v_pk_fma_f32 v[248:249], v[240:241], v[222:223], v[248:249] op_sel_hi:[1,0,1]
    s_waitcnt vmcnt(19)
    v_mov_b32 v236, v223
    v_lshlrev_b32 v238, 16, v172
    v_and_b32 v239, 0xffff0000, v172
    v_pk_fma_f32 v[242:243], v[238:239], v[236:237], v[242:243] op_sel_hi:[1,0,1]
    v_lshlrev_b32 v240, 16, v173
    v_and_b32 v241, 0xffff0000, v173
    v_pk_fma_f32 v[244:245], v[240:241], v[236:237], v[244:245] op_sel_hi:[1,0,1]
    v_lshlrev_b32 v238, 16, v174
    v_and_b32 v239, 0xffff0000, v174
    v_pk_fma_f32 v[246:247], v[238:239], v[236:237], v[246:247] op_sel_hi:[1,0,1]
    v_lshlrev_b32 v240, 16, v175
    v_and_b32 v241, 0xffff0000, v175
    v_pk_fma_f32 v[248:249], v[240:241], v[236:237], v[248:249] op_sel_hi:[1,0,1]
    s_waitcnt vmcnt(18)
    v_lshlrev_b32 v238, 16, v176
    v_and_b32 v239, 0xffff0000, v176
    v_pk_fma_f32 v[242:243], v[238:239], v[224:225], v[242:243] op_sel_hi:[1,0,1]
    v_lshlrev_b32 v240, 16, v177
    v_and_b32 v241, 0xffff0000, v177
    v_pk_fma_f32 v[244:245], v[240:241], v[224:225], v[244:245] op_sel_hi:[1,0,1]
    v_lshlrev_b32 v238, 16, v178
    v_and_b32 v239, 0xffff0000, v178
    v_pk_fma_f32 v[246:247], v[238:239], v[224:225], v[246:247] op_sel_hi:[1,0,1]
    v_lshlrev_b32 v240, 16, v179
    v_and_b32 v241, 0xffff0000, v179
    v_pk_fma_f32 v[248:249], v[240:241], v[224:225], v[248:249] op_sel_hi:[1,0,1]
    s_waitcnt vmcnt(17)
    v_mov_b32 v236, v225
    v_lshlrev_b32 v238, 16, v180
    v_and_b32 v239, 0xffff0000, v180
    v_pk_fma_f32 v[242:243], v[238:239], v[236:237], v[242:243] op_sel_hi:[1,0,1]
    v_lshlrev_b32 v240, 16, v181
    v_and_b32 v241, 0xffff0000, v181
    v_pk_fma_f32 v[244:245], v[240:241], v[236:237], v[244:245] op_sel_hi:[1,0,1]
    v_lshlrev_b32 v238, 16, v182
    v_and_b32 v239, 0xffff0000, v182
    v_pk_fma_f32 v[246:247], v[238:239], v[236:237], v[246:247] op_sel_hi:[1,0,1]
    v_lshlrev_b32 v240, 16, v183
    v_and_b32 v241, 0xffff0000, v183
    v_pk_fma_f32 v[248:249], v[240:241], v[236:237], v[248:249] op_sel_hi:[1,0,1]
    s_waitcnt vmcnt(16)
    v_lshlrev_b32 v238, 16, v184
    v_and_b32 v239, 0xffff0000, v184
    v_pk_fma_f32 v[242:243], v[238:239], v[226:227], v[242:243] op_sel_hi:[1,0,1]
    v_lshlrev_b32 v240, 16, v185
    v_and_b32 v241, 0xffff0000, v185
    v_pk_fma_f32 v[244:245], v[240:241], v[226:227], v[244:245] op_sel_hi:[1,0,1]
    v_lshlrev_b32 v238, 16, v186
    v_and_b32 v239, 0xffff0000, v186
    v_pk_fma_f32 v[246:247], v[238:239], v[226:227], v[246:247] op_sel_hi:[1,0,1]
    v_lshlrev_b32 v240, 16, v187
    v_and_b32 v241, 0xffff0000, v187
    v_pk_fma_f32 v[248:249], v[240:241], v[226:227], v[248:249] op_sel_hi:[1,0,1]
    s_waitcnt vmcnt(15)
    v_mov_b32 v236, v227
    v_lshlrev_b32 v238, 16, v188
    v_and_b32 v239, 0xffff0000, v188
    v_pk_fma_f32 v[242:243], v[238:239], v[236:237], v[242:243] op_sel_hi:[1,0,1]
    v_lshlrev_b32 v240, 16, v189
    v_and_b32 v241, 0xffff0000, v189
    v_pk_fma_f32 v[244:245], v[240:241], v[236:237], v[244:245] op_sel_hi:[1,0,1]
    v_lshlrev_b32 v238, 16, v190
    v_and_b32 v239, 0xffff0000, v190
    v_pk_fma_f32 v[246:247], v[238:239], v[236:237], v[246:247] op_sel_hi:[1,0,1]
    v_lshlrev_b32 v240, 16, v191
    v_and_b32 v241, 0xffff0000, v191
    v_pk_fma_f32 v[248:249], v[240:241], v[236:237], v[248:249] op_sel_hi:[1,0,1]
    s_waitcnt vmcnt(14)
    v_lshlrev_b32 v238, 16, v192
    v_and_b32 v239, 0xffff0000, v192
    v_pk_fma_f32 v[242:243], v[238:239], v[228:229], v[242:243] op_sel_hi:[1,0,1]
    v_lshlrev_b32 v240, 16, v193
    v_and_b32 v241, 0xffff0000, v193
    v_pk_fma_f32 v[244:245], v[240:241], v[228:229], v[244:245] op_sel_hi:[1,0,1]
    v_lshlrev_b32 v238, 16, v194
    v_and_b32 v239, 0xffff0000, v194
    v_pk_fma_f32 v[246:247], v[238:239], v[228:229], v[246:247] op_sel_hi:[1,0,1]
    v_lshlrev_b32 v240, 16, v195
    v_and_b32 v241, 0xffff0000, v195
    v_pk_fma_f32 v[248:249], v[240:241], v[228:229], v[248:249] op_sel_hi:[1,0,1]
    s_waitcnt vmcnt(13)
    v_mov_b32 v236, v229
    v_lshlrev_b32 v238, 16, v196
    v_and_b32 v239, 0xffff0000, v196
    v_pk_fma_f32 v[242:243], v[238:239], v[236:237], v[242:243] op_sel_hi:[1,0,1]
    v_lshlrev_b32 v240, 16, v197
    v_and_b32 v241, 0xffff0000, v197
    v_pk_fma_f32 v[244:245], v[240:241], v[236:237], v[244:245] op_sel_hi:[1,0,1]
    v_lshlrev_b32 v238, 16, v198
    v_and_b32 v239, 0xffff0000, v198
    v_pk_fma_f32 v[246:247], v[238:239], v[236:237], v[246:247] op_sel_hi:[1,0,1]
    v_lshlrev_b32 v240, 16, v199
    v_and_b32 v241, 0xffff0000, v199
    v_pk_fma_f32 v[248:249], v[240:241], v[236:237], v[248:249] op_sel_hi:[1,0,1]
    s_waitcnt vmcnt(12)
    v_lshlrev_b32 v238, 16, v200
    v_and_b32 v239, 0xffff0000, v200
    v_pk_fma_f32 v[242:243], v[238:239], v[230:231], v[242:243] op_sel_hi:[1,0,1]
    v_lshlrev_b32 v240, 16, v201
    v_and_b32 v241, 0xffff0000, v201
    v_pk_fma_f32 v[244:245], v[240:241], v[230:231], v[244:245] op_sel_hi:[1,0,1]
    v_lshlrev_b32 v238, 16, v202
    v_and_b32 v239, 0xffff0000, v202
    v_pk_fma_f32 v[246:247], v[238:239], v[230:231], v[246:247] op_sel_hi:[1,0,1]
    v_lshlrev_b32 v240, 16, v203
    v_and_b32 v241, 0xffff0000, v203
    v_pk_fma_f32 v[248:249], v[240:241], v[230:231], v[248:249] op_sel_hi:[1,0,1]
    s_waitcnt vmcnt(11)
    v_mov_b32 v236, v231
    v_lshlrev_b32 v238, 16, v204
    v_and_b32 v239, 0xffff0000, v204
    v_pk_fma_f32 v[242:243], v[238:239], v[236:237], v[242:243] op_sel_hi:[1,0,1]
    v_lshlrev_b32 v240, 16, v205
    v_and_b32 v241, 0xffff0000, v205
    v_pk_fma_f32 v[244:245], v[240:241], v[236:237], v[244:245] op_sel_hi:[1,0,1]
    v_lshlrev_b32 v238, 16, v206
    v_and_b32 v239, 0xffff0000, v206
    v_pk_fma_f32 v[246:247], v[238:239], v[236:237], v[246:247] op_sel_hi:[1,0,1]
    v_lshlrev_b32 v240, 16, v207
    v_and_b32 v241, 0xffff0000, v207
    v_pk_fma_f32 v[248:249], v[240:241], v[236:237], v[248:249] op_sel_hi:[1,0,1]
    s_waitcnt vmcnt(10)
    v_lshlrev_b32 v238, 16, v208
    v_and_b32 v239, 0xffff0000, v208
    v_pk_fma_f32 v[242:243], v[238:239], v[232:233], v[242:243] op_sel_hi:[1,0,1]
    v_lshlrev_b32 v240, 16, v209
    v_and_b32 v241, 0xffff0000, v209
    v_pk_fma_f32 v[244:245], v[240:241], v[232:233], v[244:245] op_sel_hi:[1,0,1]
    v_lshlrev_b32 v238, 16, v210
    v_and_b32 v239, 0xffff0000, v210
    v_pk_fma_f32 v[246:247], v[238:239], v[232:233], v[246:247] op_sel_hi:[1,0,1]
    v_lshlrev_b32 v240, 16, v211
    v_and_b32 v241, 0xffff0000, v211
    v_pk_fma_f32 v[248:249], v[240:241], v[232:233], v[248:249] op_sel_hi:[1,0,1]
    s_waitcnt vmcnt(9)
    v_mov_b32 v236, v233
    v_lshlrev_b32 v238, 16, v212
    v_and_b32 v239, 0xffff0000, v212
    v_pk_fma_f32 v[242:243], v[238:239], v[236:237], v[242:243] op_sel_hi:[1,0,1]
    v_lshlrev_b32 v240, 16, v213
    v_and_b32 v241, 0xffff0000, v213
    v_pk_fma_f32 v[244:245], v[240:241], v[236:237], v[244:245] op_sel_hi:[1,0,1]
    v_lshlrev_b32 v238, 16, v214
    v_and_b32 v239, 0xffff0000, v214
    v_pk_fma_f32 v[246:247], v[238:239], v[236:237], v[246:247] op_sel_hi:[1,0,1]
    v_lshlrev_b32 v240, 16, v215
    v_and_b32 v241, 0xffff0000, v215
    v_pk_fma_f32 v[248:249], v[240:241], v[236:237], v[248:249] op_sel_hi:[1,0,1]
    s_nop 1
    v_add_f32_dpp v242, v242, v242 row_ror:8 row_mask:0xf bank_mask:0xf
    v_add_f32_dpp v243, v243, v243 row_ror:8 row_mask:0xf bank_mask:0xf
    v_add_f32_dpp v244, v244, v244 row_ror:8 row_mask:0xf bank_mask:0xf
    v_add_f32_dpp v245, v245, v245 row_ror:8 row_mask:0xf bank_mask:0xf
    v_add_f32_dpp v246, v246, v246 row_ror:8 row_mask:0xf bank_mask:0xf
    v_add_f32_dpp v247, v247, v247 row_ror:8 row_mask:0xf bank_mask:0xf
    v_add_f32_dpp v248, v248, v248 row_ror:8 row_mask:0xf bank_mask:0xf
    v_add_f32_dpp v249, v249, v249 row_ror:8 row_mask:0xf bank_mask:0xf
    v_lshrrev_b32 v250, 4, v1
    s_lshl_b32 s8, s3, 2
    v_add_u32 v250, s8, v250
    v_lshlrev_b32 v250, 8, v250
    v_and_b32 v251, 7, v1
    v_lshlrev_b32 v251, 5, v251
    v_add_u32 v250, v250, v251
    v_add_u32 v250, 77824, v250
    v_and_b32 v251, 8, v1
    v_cmp_eq_u32 vcc, 0, v251
    s_and_saveexec_b64 s[8:9], vcc
    ds_write_b128 v250, v[242:245] offset:0
    ds_write_b128 v250, v[246:249] offset:16
    s_mov_b64 exec, s[8:9]
    s_waitcnt lgkmcnt(0)
    s_barrier
    v_cmp_gt_u32 vcc, 64, v0
    s_and_saveexec_b64 s[8:9], vcc
    s_cbranch_execz K2_ME2
    v_lshlrev_b32 v250, 2, v0
    v_add_u32 v251, 77824, v250
    ds_read_b32 v144, v251 offset:0
    ds_read_b32 v145, v251 offset:256
    ds_read_b32 v146, v251 offset:512
    ds_read_b32 v147, v251 offset:768
    ds_read_b32 v148, v251 offset:1024
    ds_read_b32 v149, v251 offset:1280
    ds_read_b32 v150, v251 offset:1536
    ds_read_b32 v151, v251 offset:1792
    ds_read_b32 v152, v251 offset:2048
    ds_read_b32 v153, v251 offset:2304
    ds_read_b32 v154, v251 offset:2560
    ds_read_b32 v155, v251 offset:2816
    ds_read_b32 v156, v251 offset:3072
    ds_read_b32 v157, v251 offset:3328
    ds_read_b32 v158, v251 offset:3584
    ds_read_b32 v159, v251 offset:3840
    s_waitcnt lgkmcnt(0)
    v_add_f32 v144, v144, v145
    v_add_f32 v144, v144, v146
    v_add_f32 v144, v144, v147
    v_add_f32 v144, v144, v148
    v_add_f32 v144, v144, v149
    v_add_f32 v144, v144, v150
    v_add_f32 v144, v144, v151
    v_add_f32 v144, v144, v152
    v_add_f32 v144, v144, v153
    v_add_f32 v144, v144, v154
    v_add_f32 v144, v144, v155
    v_add_f32 v144, v144, v156
    v_add_f32 v144, v144, v157
    v_add_f32 v144, v144, v158
    v_add_f32 v144, v144, v159
    s_lshl_b32 s10, s16, 8
    v_add_u32 v250, s10, v250
    buffer_store_dword v144, v250, s[56:59], 0 offen
K2_ME2:
    s_mov_b64 exec, -1
    s_branch K2_XEND
K2_CAT3:
    s_mov_b32 s76, s16
    s_mov_b32 s77, s17
    s_mov_b32 s78, 2359296
    s_mov_b32 s79, 0x20000
    s_lshr_b32 s15, s4, 3
    s_lshl_b32 s15, s15, 2
    s_add_u32 s15, s15, s3
    s_mul_i32 s15, s15, 6
    s_add_u32 s9, s15, 0
    s_mul_i32 s10, s9, 57
    s_lshr_b32 s10, s10, 11
    s_mul_i32 s11, s10, 36
    s_sub_u32 s11, s9, s11
    s_lshl_b32 s10, s10, 3
    s_and_b32 s12, s4, 7
    s_add_u32 s10, s10, s12
    s_mul_i32 s10, s10, 36
    s_add_u32 s10, s10, s11
    s_lshl_b32 s10, s10, 10
    v_add_u32 v18, s10, v2
    buffer_load_dwordx4 v[136:139], v18, s[76:79], 0 offen
    s_add_u32 s9, s15, 1
    s_mul_i32 s10, s9, 57
    s_lshr_b32 s10, s10, 11
    s_mul_i32 s11, s10, 36
    s_sub_u32 s11, s9, s11
    s_lshl_b32 s10, s10, 3
    s_and_b32 s12, s4, 7
    s_add_u32 s10, s10, s12
    s_mul_i32 s10, s10, 36
    s_add_u32 s10, s10, s11
    s_lshl_b32 s10, s10, 10
    v_add_u32 v18, s10, v2
    buffer_load_dwordx4 v[136:139], v18, s[76:79], 0 offen
    s_add_u32 s9, s15, 2
    s_mul_i32 s10, s9, 57
    s_lshr_b32 s10, s10, 11
    s_mul_i32 s11, s10, 36
    s_sub_u32 s11, s9, s11
    s_lshl_b32 s10, s10, 3
    s_and_b32 s12, s4, 7
    s_add_u32 s10, s10, s12
    s_mul_i32 s10, s10, 36
    s_add_u32 s10, s10, s11
    s_lshl_b32 s10, s10, 10
    v_add_u32 v18, s10, v2
    buffer_load_dwordx4 v[136:139], v18, s[76:79], 0 offen
    s_add_u32 s9, s15, 3
    s_mul_i32 s10, s9, 57
    s_lshr_b32 s10, s10, 11
    s_mul_i32 s11, s10, 36
    s_sub_u32 s11, s9, s11
    s_lshl_b32 s10, s10, 3
    s_and_b32 s12, s4, 7
    s_add_u32 s10, s10, s12
    s_mul_i32 s10, s10, 36
    s_add_u32 s10, s10, s11
    s_lshl_b32 s10, s10, 10
    v_add_u32 v18, s10, v2
    buffer_load_dwordx4 v[136:139], v18, s[76:79], 0 offen
    s_add_u32 s9, s15, 4
    s_mul_i32 s10, s9, 57
    s_lshr_b32 s10, s10, 11
    s_mul_i32 s11, s10, 36
    s_sub_u32 s11, s9, s11
    s_lshl_b32 s10, s10, 3
    s_and_b32 s12, s4, 7
    s_add_u32 s10, s10, s12
    s_mul_i32 s10, s10, 36
    s_add_u32 s10, s10, s11
    s_lshl_b32 s10, s10, 10
    v_add_u32 v18, s10, v2
    buffer_load_dwordx4 v[136:139], v18, s[76:79], 0 offen
    s_add_u32 s9, s15, 5
    s_mul_i32 s10, s9, 57
    s_lshr_b32 s10, s10, 11
    s_mul_i32 s11, s10, 36
    s_sub_u32 s11, s9, s11
    s_lshl_b32 s10, s10, 3
    s_and_b32 s12, s4, 7
    s_add_u32 s10, s10, s12
    s_mul_i32 s10, s10, 36
    s_add_u32 s10, s10, s11
    s_lshl_b32 s10, s10, 10
    v_add_u32 v18, s10, v2
    buffer_load_dwordx4 v[136:139], v18, s[76:79], 0 offen
    s_sub_u32 s16, s4, 58
    s_mov_b32 s72, s40
    s_mov_b32 s73, s41
    s_mov_b32 s74, 3981312
    s_mov_b32 s75, 0x20000
    s_mov_b32 s76, s38
    s_mov_b32 s77, s39
    s_mov_b32 s78, 1152
    s_mov_b32 s79, 0x20000
    s_mov_b32 s56, s46
    s_mov_b32 s57, s47
    s_mov_b32 s58, 13824
    s_mov_b32 s59, 0x20000
    v_lshrrev_b32 v250, 3, v1
    s_mul_i32 s8, s3, 144
    v_add_u32 v250, s8, v250
    v_and_b32 v251, 7, v1
    v_lshlrev_b32 v251, 4, v251
    s_lshl_b32 s8, s16, 7
    v_add_u32 v251, s8, v251
    v_mul_u32_u24 v252, 6912, v250
    v_add_u32 v252, v252, v251
    v_lshlrev_b32 v253, 1, v250
    buffer_load_ushort v216, v253, s[76:79], 0 offen offset:0
    buffer_load_ushort v217, v253, s[76:79], 0 offen offset:16
    buffer_load_ushort v218, v253, s[76:79], 0 offen offset:32
    buffer_load_ushort v219, v253, s[76:79], 0 offen offset:48
    buffer_load_ushort v220, v253, s[76:79], 0 offen offset:64
    buffer_load_ushort v221, v253, s[76:79], 0 offen offset:80
    buffer_load_ushort v222, v253, s[76:79], 0 offen offset:96
    buffer_load_ushort v223, v253, s[76:79], 0 offen offset:112
    buffer_load_ushort v224, v253, s[76:79], 0 offen offset:128
    buffer_load_ushort v225, v253, s[76:79], 0 offen offset:144
    buffer_load_ushort v226, v253, s[76:79], 0 offen offset:160
    buffer_load_ushort v227, v253, s[76:79], 0 offen offset:176
    buffer_load_ushort v228, v253, s[76:79], 0 offen offset:192
    buffer_load_ushort v229, v253, s[76:79], 0 offen offset:208
    buffer_load_ushort v230, v253, s[76:79], 0 offen offset:224
    buffer_load_ushort v231, v253, s[76:79], 0 offen offset:240
    buffer_load_ushort v232, v253, s[76:79], 0 offen offset:256
    buffer_load_ushort v233, v253, s[76:79], 0 offen offset:272
    buffer_load_dwordx4 v[144:147], v252, s[72:75], 0 offen nt
    v_add_u32 v252, 55296, v252
    buffer_load_dwordx4 v[148:151], v252, s[72:75], 0 offen nt
    v_add_u32 v252, 55296, v252
    buffer_load_dwordx4 v[152:155], v252, s[72:75], 0 offen nt
    v_add_u32 v252, 55296, v252
    buffer_load_dwordx4 v[156:159], v252, s[72:75], 0 offen nt
    v_add_u32 v252, 55296, v252
    buffer_load_dwordx4 v[160:163], v252, s[72:75], 0 offen nt
    v_add_u32 v252, 55296, v252
    buffer_load_dwordx4 v[164:167], v252, s[72:75], 0 offen nt
    v_add_u32 v252, 55296, v252
    buffer_load_dwordx4 v[168:171], v252, s[72:75], 0 offen nt
    v_add_u32 v252, 55296, v252
    buffer_load_dwordx4 v[172:175], v252, s[72:75], 0 offen nt
    v_add_u32 v252, 55296, v252
    buffer_load_dwordx4 v[176:179], v252, s[72:75], 0 offen nt
    v_add_u32 v252, 55296, v252
    buffer_load_dwordx4 v[180:183], v252, s[72:75], 0 offen nt
    v_add_u32 v252, 55296, v252
    buffer_load_dwordx4 v[184:187], v252, s[72:75], 0 offen nt
    v_add_u32 v252, 55296, v252
    buffer_load_dwordx4 v[188:191], v252, s[72:75], 0 offen nt
    v_add_u32 v252, 55296, v252
    buffer_load_dwordx4 v[192:195], v252, s[72:75], 0 offen nt
    v_add_u32 v252, 55296, v252
    buffer_load_dwordx4 v[196:199], v252, s[72:75], 0 offen nt
    v_add_u32 v252, 55296, v252
    buffer_load_dwordx4 v[200:203], v252, s[72:75], 0 offen nt
    v_add_u32 v252, 55296, v252
    buffer_load_dwordx4 v[204:207], v252, s[72:75], 0 offen nt
    v_add_u32 v252, 55296, v252
    buffer_load_dwordx4 v[208:211], v252, s[72:75], 0 offen nt
    v_add_u32 v252, 55296, v252
    buffer_load_dwordx4 v[212:215], v252, s[72:75], 0 offen nt
    s_waitcnt vmcnt(18)
    v_lshlrev_b32 v216, 16, v216
    v_mul_f32 v234, 0xbfb8aa3b, v216
    v_exp_f32 v234, v234
    s_nop 0
    v_add_f32 v234, 1.0, v234
    v_rcp_f32 v234, v234
    s_nop 0
    v_mul_f32 v216, v216, v234
    v_lshlrev_b32 v217, 16, v217
    v_mul_f32 v235, 0xbfb8aa3b, v217
    v_exp_f32 v235, v235
    s_nop 0
    v_add_f32 v235, 1.0, v235
    v_rcp_f32 v235, v235
    s_nop 0
    v_mul_f32 v217, v217, v235
    v_lshlrev_b32 v218, 16, v218
    v_mul_f32 v234, 0xbfb8aa3b, v218
    v_exp_f32 v234, v234
    s_nop 0
    v_add_f32 v234, 1.0, v234
    v_rcp_f32 v234, v234
    s_nop 0
    v_mul_f32 v218, v218, v234
    v_lshlrev_b32 v219, 16, v219
    v_mul_f32 v235, 0xbfb8aa3b, v219
    v_exp_f32 v235, v235
    s_nop 0
    v_add_f32 v235, 1.0, v235
    v_rcp_f32 v235, v235
    s_nop 0
    v_mul_f32 v219, v219, v235
    v_lshlrev_b32 v220, 16, v220
    v_mul_f32 v234, 0xbfb8aa3b, v220
    v_exp_f32 v234, v234
    s_nop 0
    v_add_f32 v234, 1.0, v234
    v_rcp_f32 v234, v234
    s_nop 0
    v_mul_f32 v220, v220, v234
    v_lshlrev_b32 v221, 16, v221
    v_mul_f32 v235, 0xbfb8aa3b, v221
    v_exp_f32 v235, v235
    s_nop 0
    v_add_f32 v235, 1.0, v235
    v_rcp_f32 v235, v235
    s_nop 0
    v_mul_f32 v221, v221, v235
    v_lshlrev_b32 v222, 16, v222
    v_mul_f32 v234, 0xbfb8aa3b, v222
    v_exp_f32 v234, v234
    s_nop 0
    v_add_f32 v234, 1.0, v234
    v_rcp_f32 v234, v234
    s_nop 0
    v_mul_f32 v222, v222, v234
    v_lshlrev_b32 v223, 16, v223
    v_mul_f32 v235, 0xbfb8aa3b, v223
    v_exp_f32 v235, v235
    s_nop 0
    v_add_f32 v235, 1.0, v235
    v_rcp_f32 v235, v235
    s_nop 0
    v_mul_f32 v223, v223, v235
    v_lshlrev_b32 v224, 16, v224
    v_mul_f32 v234, 0xbfb8aa3b, v224
    v_exp_f32 v234, v234
    s_nop 0
    v_add_f32 v234, 1.0, v234
    v_rcp_f32 v234, v234
    s_nop 0
    v_mul_f32 v224, v224, v234
    v_lshlrev_b32 v225, 16, v225
    v_mul_f32 v235, 0xbfb8aa3b, v225
    v_exp_f32 v235, v235
    s_nop 0
    v_add_f32 v235, 1.0, v235
    v_rcp_f32 v235, v235
    s_nop 0
    v_mul_f32 v225, v225, v235
    v_lshlrev_b32 v226, 16, v226
    v_mul_f32 v234, 0xbfb8aa3b, v226
    v_exp_f32 v234, v234
    s_nop 0
    v_add_f32 v234, 1.0, v234
    v_rcp_f32 v234, v234
    s_nop 0
    v_mul_f32 v226, v226, v234
    v_lshlrev_b32 v227, 16, v227
    v_mul_f32 v235, 0xbfb8aa3b, v227
    v_exp_f32 v235, v235
    s_nop 0
    v_add_f32 v235, 1.0, v235
    v_rcp_f32 v235, v235
    s_nop 0
    v_mul_f32 v227, v227, v235
    v_lshlrev_b32 v228, 16, v228
    v_mul_f32 v234, 0xbfb8aa3b, v228
    v_exp_f32 v234, v234
    s_nop 0
    v_add_f32 v234, 1.0, v234
    v_rcp_f32 v234, v234
    s_nop 0
    v_mul_f32 v228, v228, v234
    v_lshlrev_b32 v229, 16, v229
    v_mul_f32 v235, 0xbfb8aa3b, v229
    v_exp_f32 v235, v235
    s_nop 0
    v_add_f32 v235, 1.0, v235
    v_rcp_f32 v235, v235
    s_nop 0
    v_mul_f32 v229, v229, v235
    v_lshlrev_b32 v230, 16, v230
    v_mul_f32 v234, 0xbfb8aa3b, v230
    v_exp_f32 v234, v234
    s_nop 0
    v_add_f32 v234, 1.0, v234
    v_rcp_f32 v234, v234
    s_nop 0
    v_mul_f32 v230, v230, v234
    v_lshlrev_b32 v231, 16, v231
    v_mul_f32 v235, 0xbfb8aa3b, v231
    v_exp_f32 v235, v235
    s_nop 0
    v_add_f32 v235, 1.0, v235
    v_rcp_f32 v235, v235
    s_nop 0
    v_mul_f32 v231, v231, v235
    v_lshlrev_b32 v232, 16, v232
    v_mul_f32 v234, 0xbfb8aa3b, v232
    v_exp_f32 v234, v234
    s_nop 0
    v_add_f32 v234, 1.0, v234
    v_rcp_f32 v234, v234
    s_nop 0
    v_mul_f32 v232, v232, v234
    v_lshlrev_b32 v233, 16, v233
    v_mul_f32 v235, 0xbfb8aa3b, v233
    v_exp_f32 v235, v235
    s_nop 0
    v_add_f32 v235, 1.0, v235
    v_rcp_f32 v235, v235
    s_nop 0
    v_mul_f32 v233, v233, v235
    v_mov_b32 v242, 0
    v_mov_b32 v243, 0
    v_mov_b32 v244, 0
    v_mov_b32 v245, 0
    v_mov_b32 v246, 0
    v_mov_b32 v247, 0
    v_mov_b32 v248, 0
    v_mov_b32 v249, 0
    s_waitcnt vmcnt(17)
    v_lshlrev_b32 v238, 16, v144
    v_and_b32 v239, 0xffff0000, v144
    v_pk_fma_f32 v[242:243], v[238:239], v[216:217], v[242:243] op_sel_hi:[1,0,1]
    v_lshlrev_b32 v240, 16, v145
    v_and_b32 v241, 0xffff0000, v145
    v_pk_fma_f32 v[244:245], v[240:241], v[216:217], v[244:245] op_sel_hi:[1,0,1]
    v_lshlrev_b32 v238, 16, v146
    v_and_b32 v239, 0xffff0000, v146
    v_pk_fma_f32 v[246:247], v[238:239], v[216:217], v[246:247] op_sel_hi:[1,0,1]
    v_lshlrev_b32 v240, 16, v147
    v_and_b32 v241, 0xffff0000, v147
    v_pk_fma_f32 v[248:249], v[240:241], v[216:217], v[248:249] op_sel_hi:[1,0,1]
    s_waitcnt vmcnt(16)
    v_mov_b32 v236, v217
    v_lshlrev_b32 v238, 16, v148
    v_and_b32 v239, 0xffff0000, v148
    v_pk_fma_f32 v[242:243], v[238:239], v[236:237], v[242:243] op_sel_hi:[1,0,1]
    v_lshlrev_b32 v240, 16, v149
    v_and_b32 v241, 0xffff0000, v149
    v_pk_fma_f32 v[244:245], v[240:241], v[236:237], v[244:245] op_sel_hi:[1,0,1]
    v_lshlrev_b32 v238, 16, v150
    v_and_b32 v239, 0xffff0000, v150
    v_pk_fma_f32 v[246:247], v[238:239], v[236:237], v[246:247] op_sel_hi:[1,0,1]
    v_lshlrev_b32 v240, 16, v151
    v_and_b32 v241, 0xffff0000, v151
    v_pk_fma_f32 v[248:249], v[240:241], v[236:237], v[248:249] op_sel_hi:[1,0,1]
    s_waitcnt vmcnt(15)
    v_lshlrev_b32 v238, 16, v152
    v_and_b32 v239, 0xffff0000, v152
    v_pk_fma_f32 v[242:243], v[238:239], v[218:219], v[242:243] op_sel_hi:[1,0,1]
    v_lshlrev_b32 v240, 16, v153
    v_and_b32 v241, 0xffff0000, v153
    v_pk_fma_f32 v[244:245], v[240:241], v[218:219], v[244:245] op_sel_hi:[1,0,1]
    v_lshlrev_b32 v238, 16, v154
    v_and_b32 v239, 0xffff0000, v154
    v_pk_fma_f32 v[246:247], v[238:239], v[218:219], v[246:247] op_sel_hi:[1,0,1]
    v_lshlrev_b32 v240, 16, v155
    v_and_b32 v241, 0xffff0000, v155
    v_pk_fma_f32 v[248:249], v[240:241], v[218:219], v[248:249] op_sel_hi:[1,0,1]
    s_waitcnt vmcnt(14)
    v_mov_b32 v236, v219
    v_lshlrev_b32 v238, 16, v156
    v_and_b32 v239, 0xffff0000, v156
    v_pk_fma_f32 v[242:243], v[238:239], v[236:237], v[242:243] op_sel_hi:[1,0,1]
    v_lshlrev_b32 v240, 16, v157
    v_and_b32 v241, 0xffff0000, v157
    v_pk_fma_f32 v[244:245], v[240:241], v[236:237], v[244:245] op_sel_hi:[1,0,1]
    v_lshlrev_b32 v238, 16, v158
    v_and_b32 v239, 0xffff0000, v158
    v_pk_fma_f32 v[246:247], v[238:239], v[236:237], v[246:247] op_sel_hi:[1,0,1]
    v_lshlrev_b32 v240, 16, v159
    v_and_b32 v241, 0xffff0000, v159
    v_pk_fma_f32 v[248:249], v[240:241], v[236:237], v[248:249] op_sel_hi:[1,0,1]
    s_waitcnt vmcnt(13)
    v_lshlrev_b32 v238, 16, v160
    v_and_b32 v239, 0xffff0000, v160
    v_pk_fma_f32 v[242:243], v[238:239], v[220:221], v[242:243] op_sel_hi:[1,0,1]
    v_lshlrev_b32 v240, 16, v161
    v_and_b32 v241, 0xffff0000, v161
    v_pk_fma_f32 v[244:245], v[240:241], v[220:221], v[244:245] op_sel_hi:[1,0,1]
    v_lshlrev_b32 v238, 16, v162
    v_and_b32 v239, 0xffff0000, v162
    v_pk_fma_f32 v[246:247], v[238:239], v[220:221], v[246:247] op_sel_hi:[1,0,1]
    v_lshlrev_b32 v240, 16, v163
    v_and_b32 v241, 0xffff0000, v163
    v_pk_fma_f32 v[248:249], v[240:241], v[220:221], v[248:249] op_sel_hi:[1,0,1]
    s_waitcnt vmcnt(12)
    v_mov_b32 v236, v221
    v_lshlrev_b32 v238, 16, v164
    v_and_b32 v239, 0xffff0000, v164
    v_pk_fma_f32 v[242:243], v[238:239], v[236:237], v[242:243] op_sel_hi:[1,0,1]
    v_lshlrev_b32 v240, 16, v165
    v_and_b32 v241, 0xffff0000, v165
    v_pk_fma_f32 v[244:245], v[240:241], v[236:237], v[244:245] op_sel_hi:[1,0,1]
    v_lshlrev_b32 v238, 16, v166
    v_and_b32 v239, 0xffff0000, v166
    v_pk_fma_f32 v[246:247], v[238:239], v[236:237], v[246:247] op_sel_hi:[1,0,1]
    v_lshlrev_b32 v240, 16, v167
    v_and_b32 v241, 0xffff0000, v167
    v_pk_fma_f32 v[248:249], v[240:241], v[236:237], v[248:249] op_sel_hi:[1,0,1]
    s_waitcnt vmcnt(11)
    v_lshlrev_b32 v238, 16, v168
    v_and_b32 v239, 0xffff0000, v168
    v_pk_fma_f32 v[242:243], v[238:239], v[222:223], v[242:243] op_sel_hi:[1,0,1]
    v_lshlrev_b32 v240, 16, v169
    v_and_b32 v241, 0xffff0000, v169
    v_pk_fma_f32 v[244:245], v[240:241], v[222:223], v[244:245] op_sel_hi:[1,0,1]
    v_lshlrev_b32 v238, 16, v170
    v_and_b32 v239, 0xffff0000, v170
    v_pk_fma_f32 v[246:247], v[238:239], v[222:223], v[246:247] op_sel_hi:[1,0,1]
    v_lshlrev_b32 v240, 16, v171
    v_and_b32 v241, 0xffff0000, v171
    v_pk_fma_f32 v[248:249], v[240:241], v[222:223], v[248:249] op_sel_hi:[1,0,1]
    s_waitcnt vmcnt(10)
    v_mov_b32 v236, v223
    v_lshlrev_b32 v238, 16, v172
    v_and_b32 v239, 0xffff0000, v172
    v_pk_fma_f32 v[242:243], v[238:239], v[236:237], v[242:243] op_sel_hi:[1,0,1]
    v_lshlrev_b32 v240, 16, v173
    v_and_b32 v241, 0xffff0000, v173
    v_pk_fma_f32 v[244:245], v[240:241], v[236:237], v[244:245] op_sel_hi:[1,0,1]
    v_lshlrev_b32 v238, 16, v174
    v_and_b32 v239, 0xffff0000, v174
    v_pk_fma_f32 v[246:247], v[238:239], v[236:237], v[246:247] op_sel_hi:[1,0,1]
    v_lshlrev_b32 v240, 16, v175
    v_and_b32 v241, 0xffff0000, v175
    v_pk_fma_f32 v[248:249], v[240:241], v[236:237], v[248:249] op_sel_hi:[1,0,1]
    s_waitcnt vmcnt(9)
    v_lshlrev_b32 v238, 16, v176
    v_and_b32 v239, 0xffff0000, v176
    v_pk_fma_f32 v[242:243], v[238:239], v[224:225], v[242:243] op_sel_hi:[1,0,1]
    v_lshlrev_b32 v240, 16, v177
    v_and_b32 v241, 0xffff0000, v177
    v_pk_fma_f32 v[244:245], v[240:241], v[224:225], v[244:245] op_sel_hi:[1,0,1]
    v_lshlrev_b32 v238, 16, v178
    v_and_b32 v239, 0xffff0000, v178
    v_pk_fma_f32 v[246:247], v[238:239], v[224:225], v[246:247] op_sel_hi:[1,0,1]
    v_lshlrev_b32 v240, 16, v179
    v_and_b32 v241, 0xffff0000, v179
    v_pk_fma_f32 v[248:249], v[240:241], v[224:225], v[248:249] op_sel_hi:[1,0,1]
    s_waitcnt vmcnt(8)
    v_mov_b32 v236, v225
    v_lshlrev_b32 v238, 16, v180
    v_and_b32 v239, 0xffff0000, v180
    v_pk_fma_f32 v[242:243], v[238:239], v[236:237], v[242:243] op_sel_hi:[1,0,1]
    v_lshlrev_b32 v240, 16, v181
    v_and_b32 v241, 0xffff0000, v181
    v_pk_fma_f32 v[244:245], v[240:241], v[236:237], v[244:245] op_sel_hi:[1,0,1]
    v_lshlrev_b32 v238, 16, v182
    v_and_b32 v239, 0xffff0000, v182
    v_pk_fma_f32 v[246:247], v[238:239], v[236:237], v[246:247] op_sel_hi:[1,0,1]
    v_lshlrev_b32 v240, 16, v183
    v_and_b32 v241, 0xffff0000, v183
    v_pk_fma_f32 v[248:249], v[240:241], v[236:237], v[248:249] op_sel_hi:[1,0,1]
    s_waitcnt vmcnt(7)
    v_lshlrev_b32 v238, 16, v184
    v_and_b32 v239, 0xffff0000, v184
    v_pk_fma_f32 v[242:243], v[238:239], v[226:227], v[242:243] op_sel_hi:[1,0,1]
    v_lshlrev_b32 v240, 16, v185
    v_and_b32 v241, 0xffff0000, v185
    v_pk_fma_f32 v[244:245], v[240:241], v[226:227], v[244:245] op_sel_hi:[1,0,1]
    v_lshlrev_b32 v238, 16, v186
    v_and_b32 v239, 0xffff0000, v186
    v_pk_fma_f32 v[246:247], v[238:239], v[226:227], v[246:247] op_sel_hi:[1,0,1]
    v_lshlrev_b32 v240, 16, v187
    v_and_b32 v241, 0xffff0000, v187
    v_pk_fma_f32 v[248:249], v[240:241], v[226:227], v[248:249] op_sel_hi:[1,0,1]
    s_waitcnt vmcnt(6)
    v_mov_b32 v236, v227
    v_lshlrev_b32 v238, 16, v188
    v_and_b32 v239, 0xffff0000, v188
    v_pk_fma_f32 v[242:243], v[238:239], v[236:237], v[242:243] op_sel_hi:[1,0,1]
    v_lshlrev_b32 v240, 16, v189
    v_and_b32 v241, 0xffff0000, v189
    v_pk_fma_f32 v[244:245], v[240:241], v[236:237], v[244:245] op_sel_hi:[1,0,1]
    v_lshlrev_b32 v238, 16, v190
    v_and_b32 v239, 0xffff0000, v190
    v_pk_fma_f32 v[246:247], v[238:239], v[236:237], v[246:247] op_sel_hi:[1,0,1]
    v_lshlrev_b32 v240, 16, v191
    v_and_b32 v241, 0xffff0000, v191
    v_pk_fma_f32 v[248:249], v[240:241], v[236:237], v[248:249] op_sel_hi:[1,0,1]
    s_waitcnt vmcnt(5)
    v_lshlrev_b32 v238, 16, v192
    v_and_b32 v239, 0xffff0000, v192
    v_pk_fma_f32 v[242:243], v[238:239], v[228:229], v[242:243] op_sel_hi:[1,0,1]
    v_lshlrev_b32 v240, 16, v193
    v_and_b32 v241, 0xffff0000, v193
    v_pk_fma_f32 v[244:245], v[240:241], v[228:229], v[244:245] op_sel_hi:[1,0,1]
    v_lshlrev_b32 v238, 16, v194
    v_and_b32 v239, 0xffff0000, v194
    v_pk_fma_f32 v[246:247], v[238:239], v[228:229], v[246:247] op_sel_hi:[1,0,1]
    v_lshlrev_b32 v240, 16, v195
    v_and_b32 v241, 0xffff0000, v195
    v_pk_fma_f32 v[248:249], v[240:241], v[228:229], v[248:249] op_sel_hi:[1,0,1]
    s_waitcnt vmcnt(4)
    v_mov_b32 v236, v229
    v_lshlrev_b32 v238, 16, v196
    v_and_b32 v239, 0xffff0000, v196
    v_pk_fma_f32 v[242:243], v[238:239], v[236:237], v[242:243] op_sel_hi:[1,0,1]
    v_lshlrev_b32 v240, 16, v197
    v_and_b32 v241, 0xffff0000, v197
    v_pk_fma_f32 v[244:245], v[240:241], v[236:237], v[244:245] op_sel_hi:[1,0,1]
    v_lshlrev_b32 v238, 16, v198
    v_and_b32 v239, 0xffff0000, v198
    v_pk_fma_f32 v[246:247], v[238:239], v[236:237], v[246:247] op_sel_hi:[1,0,1]
    v_lshlrev_b32 v240, 16, v199
    v_and_b32 v241, 0xffff0000, v199
    v_pk_fma_f32 v[248:249], v[240:241], v[236:237], v[248:249] op_sel_hi:[1,0,1]
    s_waitcnt vmcnt(3)
    v_lshlrev_b32 v238, 16, v200
    v_and_b32 v239, 0xffff0000, v200
    v_pk_fma_f32 v[242:243], v[238:239], v[230:231], v[242:243] op_sel_hi:[1,0,1]
    v_lshlrev_b32 v240, 16, v201
    v_and_b32 v241, 0xffff0000, v201
    v_pk_fma_f32 v[244:245], v[240:241], v[230:231], v[244:245] op_sel_hi:[1,0,1]
    v_lshlrev_b32 v238, 16, v202
    v_and_b32 v239, 0xffff0000, v202
    v_pk_fma_f32 v[246:247], v[238:239], v[230:231], v[246:247] op_sel_hi:[1,0,1]
    v_lshlrev_b32 v240, 16, v203
    v_and_b32 v241, 0xffff0000, v203
    v_pk_fma_f32 v[248:249], v[240:241], v[230:231], v[248:249] op_sel_hi:[1,0,1]
    s_waitcnt vmcnt(2)
    v_mov_b32 v236, v231
    v_lshlrev_b32 v238, 16, v204
    v_and_b32 v239, 0xffff0000, v204
    v_pk_fma_f32 v[242:243], v[238:239], v[236:237], v[242:243] op_sel_hi:[1,0,1]
    v_lshlrev_b32 v240, 16, v205
    v_and_b32 v241, 0xffff0000, v205
    v_pk_fma_f32 v[244:245], v[240:241], v[236:237], v[244:245] op_sel_hi:[1,0,1]
    v_lshlrev_b32 v238, 16, v206
    v_and_b32 v239, 0xffff0000, v206
    v_pk_fma_f32 v[246:247], v[238:239], v[236:237], v[246:247] op_sel_hi:[1,0,1]
    v_lshlrev_b32 v240, 16, v207
    v_and_b32 v241, 0xffff0000, v207
    v_pk_fma_f32 v[248:249], v[240:241], v[236:237], v[248:249] op_sel_hi:[1,0,1]
    s_waitcnt vmcnt(1)
    v_lshlrev_b32 v238, 16, v208
    v_and_b32 v239, 0xffff0000, v208
    v_pk_fma_f32 v[242:243], v[238:239], v[232:233], v[242:243] op_sel_hi:[1,0,1]
    v_lshlrev_b32 v240, 16, v209
    v_and_b32 v241, 0xffff0000, v209
    v_pk_fma_f32 v[244:245], v[240:241], v[232:233], v[244:245] op_sel_hi:[1,0,1]
    v_lshlrev_b32 v238, 16, v210
    v_and_b32 v239, 0xffff0000, v210
    v_pk_fma_f32 v[246:247], v[238:239], v[232:233], v[246:247] op_sel_hi:[1,0,1]
    v_lshlrev_b32 v240, 16, v211
    v_and_b32 v241, 0xffff0000, v211
    v_pk_fma_f32 v[248:249], v[240:241], v[232:233], v[248:249] op_sel_hi:[1,0,1]
    s_waitcnt vmcnt(0)
    v_mov_b32 v236, v233
    v_lshlrev_b32 v238, 16, v212
    v_and_b32 v239, 0xffff0000, v212
    v_pk_fma_f32 v[242:243], v[238:239], v[236:237], v[242:243] op_sel_hi:[1,0,1]
    v_lshlrev_b32 v240, 16, v213
    v_and_b32 v241, 0xffff0000, v213
    v_pk_fma_f32 v[244:245], v[240:241], v[236:237], v[244:245] op_sel_hi:[1,0,1]
    v_lshlrev_b32 v238, 16, v214
    v_and_b32 v239, 0xffff0000, v214
    v_pk_fma_f32 v[246:247], v[238:239], v[236:237], v[246:247] op_sel_hi:[1,0,1]
    v_lshlrev_b32 v240, 16, v215
    v_and_b32 v241, 0xffff0000, v215
    v_pk_fma_f32 v[248:249], v[240:241], v[236:237], v[248:249] op_sel_hi:[1,0,1]
    s_nop 1
    v_add_f32_dpp v242, v242, v242 row_ror:8 row_mask:0xf bank_mask:0xf
    v_add_f32_dpp v243, v243, v243 row_ror:8 row_mask:0xf bank_mask:0xf
    v_add_f32_dpp v244, v244, v244 row_ror:8 row_mask:0xf bank_mask:0xf
    v_add_f32_dpp v245, v245, v245 row_ror:8 row_mask:0xf bank_mask:0xf
    v_add_f32_dpp v246, v246, v246 row_ror:8 row_mask:0xf bank_mask:0xf
    v_add_f32_dpp v247, v247, v247 row_ror:8 row_mask:0xf bank_mask:0xf
    v_add_f32_dpp v248, v248, v248 row_ror:8 row_mask:0xf bank_mask:0xf
    v_add_f32_dpp v249, v249, v249 row_ror:8 row_mask:0xf bank_mask:0xf
    v_lshrrev_b32 v250, 4, v1
    s_lshl_b32 s8, s3, 2
    v_add_u32 v250, s8, v250
    v_lshlrev_b32 v250, 8, v250
    v_and_b32 v251, 7, v1
    v_lshlrev_b32 v251, 5, v251
    v_add_u32 v250, v250, v251
    v_add_u32 v250, 77824, v250
    v_and_b32 v251, 8, v1
    v_cmp_eq_u32 vcc, 0, v251
    s_and_saveexec_b64 s[8:9], vcc
    ds_write_b128 v250, v[242:245] offset:0
    ds_write_b128 v250, v[246:249] offset:16
    s_mov_b64 exec, s[8:9]
    s_waitcnt lgkmcnt(0)
    s_barrier
    v_cmp_gt_u32 vcc, 64, v0
    s_and_saveexec_b64 s[8:9], vcc
    s_cbranch_execz K2_ME3
    v_lshlrev_b32 v250, 2, v0
    v_add_u32 v251, 77824, v250
    ds_read_b32 v144, v251 offset:0
    ds_read_b32 v145, v251 offset:256
    ds_read_b32 v146, v251 offset:512
    ds_read_b32 v147, v251 offset:768
    ds_read_b32 v148, v251 offset:1024
    ds_read_b32 v149, v251 offset:1280
    ds_read_b32 v150, v251 offset:1536
    ds_read_b32 v151, v251 offset:1792
    ds_read_b32 v152, v251 offset:2048
    ds_read_b32 v153, v251 offset:2304
    ds_read_b32 v154, v251 offset:2560
    ds_read_b32 v155, v251 offset:2816
    ds_read_b32 v156, v251 offset:3072
    ds_read_b32 v157, v251 offset:3328
    ds_read_b32 v158, v251 offset:3584
    ds_read_b32 v159, v251 offset:3840
    s_waitcnt lgkmcnt(0)
    v_add_f32 v144, v144, v145
    v_add_f32 v144, v144, v146
    v_add_f32 v144, v144, v147
    v_add_f32 v144, v144, v148
    v_add_f32 v144, v144, v149
    v_add_f32 v144, v144, v150
    v_add_f32 v144, v144, v151
    v_add_f32 v144, v144, v152
    v_add_f32 v144, v144, v153
    v_add_f32 v144, v144, v154
    v_add_f32 v144, v144, v155
    v_add_f32 v144, v144, v156
    v_add_f32 v144, v144, v157
    v_add_f32 v144, v144, v158
    v_add_f32 v144, v144, v159
    s_lshl_b32 s10, s16, 8
    v_add_u32 v250, s10, v250
    buffer_store_dword v144, v250, s[56:59], 0 offen
K2_ME3:
    s_mov_b64 exec, -1
    s_branch K2_XEND
K2_XEND:
    s_cmp_lg_u32 s4, 0
    s_cbranch_scc1 K2_NOGP
    s_add_u32 s72, s46, 23756800
    s_addc_u32 s73, s47, 0
    s_mov_b32 s74, 2363904
    s_mov_b32 s75, 0x20000
    v_mov_b32 v16, 0
    v_mov_b32 v17, 0
    v_mov_b32 v18, 0
    v_mov_b32 v19, 0
    v_lshrrev_b32 v20, 1, v0
    v_mul_u32_u24 v20, 32832, v20
    v_and_b32 v21, 1, v0
    v_mul_u32_u24 v21, 32800, v21
    v_add_u32 v20, v20, v21
    buffer_store_dwordx4 v[16:19], v20, s[72:75], 0 offen offset:0
    buffer_store_dwordx4 v[16:19], v20, s[72:75], 0 offen offset:16
K2_NOGP:
    s_cmp_lg_u32 s4, 1
    s_cbranch_scc1 K2_NOFZ
    s_add_u32 s72, s46, 45387776
    s_addc_u32 s73, s47, 0
    s_mov_b32 s74, 131072
    s_mov_b32 s75, 0x20000
    v_lshlrev_b32 v16, 7, v0
    v_mov_b32 v17, 0
    buffer_store_dword v17, v16, s[72:75], 0 offen sc1
    v_add_u32 v16, 32768, v16
    buffer_store_dword v17, v16, s[72:75], 0 offen sc1
    v_add_u32 v16, 65536, v16
    buffer_store_dword v17, v16, s[72:75], 0 offen sc1
K2_NOFZ:
K2_END:
    s_endpgm
.text
.globl k3_kernel
.p2align 8
.type k3_kernel,@function
k3_kernel:
    s_cmp_ge_u32 s2, 256
    s_cbranch_scc1 K3_END
    s_load_dwordx16 s[16:31], s[0:1], 0
    s_load_dwordx16 s[32:47], s[0:1], 64
    v_lshrrev_b32 v1, 6, v0
    s_nop 0
    v_readfirstlane_b32 s3, v1
    v_and_b32 v1, 63, v0
    s_lshr_b32 s4, s2, 6
    s_and_b32 s5, s2, 63
    v_and_b32 v2, 15, v1
    v_lshrrev_b32 v3, 4, v1
    s_lshl_b32 s6, s5, 5
    s_lshl_b32 s7, s3, 2
    s_add_u32 s6, s6, s7
    v_add_u32 v4, s6, v3
    v_lshlrev_b32 v5, 4, v1
    s_mul_i32 s9, s5, 36864
    s_lshl_b32 s10, s3, 2
    v_add_u32 v6, s10, v3
    v_and_b32 v7, 15, v6
    v_xor_b32 v7, v7, v2
    v_lshlrev_b32 v7, 4, v7
    v_lshlrev_b32 v6, 14, v6
    s_lshl_b32 s10, s5, 8
    v_add3_u32 v6, v6, v7, s10
    s_mul_i32 s8, s4, 9
    s_add_u32 s8, s8, s3
    s_mul_i32 s8, s8, 18432
    v_lshlrev_b32 v8, 4, v1
    v_lshlrev_b32 v9, 4, v1
    s_cmp_lt_u32 s3, 8
    s_cbranch_scc1 K3_P0
    s_setprio 3
K3_P0:
    s_waitcnt lgkmcnt(0)
    s_mov_b32 s48, s16
    s_mov_b32 s49, s17
    s_mov_b32 s50, 2359296
    s_mov_b32 s51, 0x20000
    s_add_u32 s52, s46, 2375680
    s_addc_u32 s53, s47, 0
    s_mov_b32 s54, 2359296
    s_mov_b32 s55, 0x20000
    s_add_u32 s56, s46, 4734976
    s_addc_u32 s57, s47, 0
    s_mov_b32 s58, 663552
    s_mov_b32 s59, 0x20000
    s_mov_b32 s60, s46
    s_mov_b32 s61, s47
    s_mov_b32 s62, 13824
    s_mov_b32 s63, 0x20000
    s_cmp_ge_u32 s3, 8
    s_cbranch_scc1 K3_W8
    s_lshl_b32 s10, s3, 10
    s_add_u32 s11, s10, 0
    s_add_u32 m0, s11, 46080
    s_add_u32 s12, s11, s9
    buffer_load_dwordx4 v5, s[48:51], s12 offen nt lds
    s_add_u32 m0, s11, 82944
    s_mov_b32 s12, 0
    buffer_load_dwordx4 v6, s[52:55], s12 offen lds
    s_lshl_b32 s10, s3, 10
    s_add_u32 s11, s10, 8192
    s_add_u32 m0, s11, 46080
    s_add_u32 s12, s11, s9
    buffer_load_dwordx4 v5, s[48:51], s12 offen nt lds
    s_add_u32 m0, s11, 82944
    s_mov_b32 s12, 524288
    buffer_load_dwordx4 v6, s[52:55], s12 offen lds
    s_lshl_b32 s10, s3, 10
    s_add_u32 s11, s10, 16384
    s_add_u32 m0, s11, 46080
    s_add_u32 s12, s11, s9
    buffer_load_dwordx4 v5, s[48:51], s12 offen nt lds
    s_add_u32 m0, s11, 82944
    s_mov_b32 s12, 1048576
    buffer_load_dwordx4 v6, s[52:55], s12 offen lds
    s_lshl_b32 s10, s3, 10
    s_add_u32 s11, s10, 24576
    s_add_u32 m0, s11, 46080
    s_add_u32 s12, s11, s9
    buffer_load_dwordx4 v5, s[48:51], s12 offen nt lds
    s_add_u32 m0, s11, 82944
    s_mov_b32 s12, 1572864
    buffer_load_dwordx4 v6, s[52:55], s12 offen lds
    s_cmp_ge_u32 s3, 4
    s_cbranch_scc1 K3_DMAD
    s_lshl_b32 s10, s3, 10
    s_add_u32 s11, s10, 32768
    s_add_u32 m0, s11, 46080
    s_add_u32 s12, s11, s9
    buffer_load_dwordx4 v5, s[48:51], s12 offen nt lds
    s_add_u32 m0, s11, 82944
    s_mov_b32 s12, 2097152
    buffer_load_dwordx4 v6, s[52:55], s12 offen lds
K3_DMAD:
    s_add_u32 s24, s8, 0
    s_add_u32 s25, s8, 4096
    s_add_u32 s26, s8, 8192
    s_add_u32 s27, s8, 12288
    s_add_u32 s28, s8, 16384
    v_lshlrev_b32 v5, 4, v1
    buffer_load_dwordx4 v[88:91], v5, s[56:59], s24 offen offset:0
    buffer_load_dwordx4 v[92:95], v5, s[56:59], s24 offen offset:1024
    buffer_load_dwordx4 v[96:99], v5, s[56:59], s24 offen offset:2048
    buffer_load_dwordx4 v[100:103], v5, s[56:59], s24 offen offset:3072
    buffer_load_dwordx4 v[104:107], v5, s[56:59], s25 offen offset:0
    buffer_load_dwordx4 v[108:111], v5, s[56:59], s25 offen offset:1024
    s_add_u32 s64, s46, 16678912
    s_addc_u32 s65, s47, 0
    s_mov_b32 s66, 2359296
    s_mov_b32 s67, 0x20000
    s_add_u32 s72, s46, 19038208
    s_addc_u32 s73, s47, 0
    s_mov_b32 s74, 2359296
    s_mov_b32 s75, 0x20000
    s_add_u32 s76, s46, 23756800
    s_addc_u32 s77, s47, 0
    s_mov_b32 s78, 2363904
    s_mov_b32 s79, 0x20000
    s_branch K3_NOMOD
K3_W8:
    v_cmp_gt_u32 vcc, 48, v1
    s_and_saveexec_b64 s[10:11], vcc
    v_add_u32 v10, 0, v9
    buffer_load_dwordx4 v[16:19], v10, s[60:63], 0 offen
    v_add_u32 v10, 2304, v9
    buffer_load_dwordx4 v[20:23], v10, s[60:63], 0 offen
    v_add_u32 v10, 4608, v9
    buffer_load_dwordx4 v[24:27], v10, s[60:63], 0 offen
    v_add_u32 v10, 6912, v9
    buffer_load_dwordx4 v[28:31], v10, s[60:63], 0 offen
    v_add_u32 v10, 9216, v9
    buffer_load_dwordx4 v[32:35], v10, s[60:63], 0 offen
    v_add_u32 v10, 768, v9
    buffer_load_dwordx4 v[36:39], v10, s[60:63], 0 offen
    v_add_u32 v10, 3072, v9
    buffer_load_dwordx4 v[40:43], v10, s[60:63], 0 offen
    v_add_u32 v10, 5376, v9
    buffer_load_dwordx4 v[44:47], v10, s[60:63], 0 offen
    v_add_u32 v10, 7680, v9
    buffer_load_dwordx4 v[48:51], v10, s[60:63], 0 offen
    v_add_u32 v10, 9984, v9
    buffer_load_dwordx4 v[52:55], v10, s[60:63], 0 offen
    v_add_u32 v10, 1536, v9
    buffer_load_dwordx4 v[56:59], v10, s[60:63], 0 offen
    v_add_u32 v10, 3840, v9
    buffer_load_dwordx4 v[60:63], v10, s[60:63], 0 offen
    v_add_u32 v10, 6144, v9
    buffer_load_dwordx4 v[64:67], v10, s[60:63], 0 offen
    v_add_u32 v10, 8448, v9
    buffer_load_dwordx4 v[68:71], v10, s[60:63], 0 offen
    v_add_u32 v10, 10752, v9
    buffer_load_dwordx4 v[72:75], v10, s[60:63], 0 offen
    s_waitcnt vmcnt(0)
    v_add_f32 v20, 1.0, v20
    v_mul_f32 v20, v20, v24
    v_mul_f32 v16, v16, v24
    v_add_f32 v32, 1.0, v32
    v_add_f32 v21, 1.0, v21
    v_mul_f32 v21, v21, v25
    v_mul_f32 v17, v17, v25
    v_add_f32 v33, 1.0, v33
    v_add_f32 v22, 1.0, v22
    v_mul_f32 v22, v22, v26
    v_mul_f32 v18, v18, v26
    v_add_f32 v34, 1.0, v34
    v_add_f32 v23, 1.0, v23
    v_mul_f32 v23, v23, v27
    v_mul_f32 v19, v19, v27
    v_add_f32 v35, 1.0, v35
    ds_write_b128 v9, v[20:23] offset:36864
    ds_write_b128 v9, v[16:19] offset:39168
    ds_write_b128 v9, v[32:35] offset:41472
    ds_write_b128 v9, v[28:31] offset:43776
    v_add_f32 v40, 1.0, v40
    v_mul_f32 v40, v40, v44
    v_mul_f32 v36, v36, v44
    v_add_f32 v52, 1.0, v52
    v_add_f32 v41, 1.0, v41
    v_mul_f32 v41, v41, v45
    v_mul_f32 v37, v37, v45
    v_add_f32 v53, 1.0, v53
    v_add_f32 v42, 1.0, v42
    v_mul_f32 v42, v42, v46
    v_mul_f32 v38, v38, v46
    v_add_f32 v54, 1.0, v54
    v_add_f32 v43, 1.0, v43
    v_mul_f32 v43, v43, v47
    v_mul_f32 v39, v39, v47
    v_add_f32 v55, 1.0, v55
    ds_write_b128 v9, v[40:43] offset:37632
    ds_write_b128 v9, v[36:39] offset:39936
    ds_write_b128 v9, v[52:55] offset:42240
    ds_write_b128 v9, v[48:51] offset:44544
    v_add_f32 v60, 1.0, v60
    v_mul_f32 v60, v60, v64
    v_mul_f32 v56, v56, v64
    v_add_f32 v72, 1.0, v72
    v_add_f32 v61, 1.0, v61
    v_mul_f32 v61, v61, v65
    v_mul_f32 v57, v57, v65
    v_add_f32 v73, 1.0, v73
    v_add_f32 v62, 1.0, v62
    v_mul_f32 v62, v62, v66
    v_mul_f32 v58, v58, v66
    v_add_f32 v74, 1.0, v74
    v_add_f32 v63, 1.0, v63
    v_mul_f32 v63, v63, v67
    v_mul_f32 v59, v59, v67
    v_add_f32 v75, 1.0, v75
    ds_write_b128 v9, v[60:63] offset:38400
    ds_write_b128 v9, v[56:59] offset:40704
    ds_write_b128 v9, v[72:75] offset:43008
    ds_write_b128 v9, v[68:71] offset:45312
    s_mov_b64 exec, s[10:11]
    s_waitcnt lgkmcnt(0)
    s_barrier
    s_setprio 0
    buffer_load_dwordx4 v[88:91], v8, s[56:59], s8 offen offset:0
    buffer_load_dwordx4 v[92:95], v8, s[56:59], s8 offen offset:1024
    buffer_load_dwordx4 v[96:99], v8, s[56:59], s8 offen offset:2048
    buffer_load_dwordx4 v[100:103], v8, s[56:59], s8 offen offset:3072
    s_add_u32 s8, s8, 4096
    buffer_load_dwordx4 v[104:107], v8, s[56:59], s8 offen offset:0
    buffer_load_dwordx4 v[108:111], v8, s[56:59], s8 offen offset:1024
    buffer_load_dwordx4 v[112:115], v8, s[56:59], s8 offen offset:2048
    buffer_load_dwordx4 v[116:119], v8, s[56:59], s8 offen offset:3072
    s_add_u32 s8, s8, 4096
    buffer_load_dwordx4 v[120:123], v8, s[56:59], s8 offen offset:0
    buffer_load_dwordx4 v[124:127], v8, s[56:59], s8 offen offset:1024
    buffer_load_dwordx4 v[128:131], v8, s[56:59], s8 offen offset:2048
    buffer_load_dwordx4 v[132:135], v8, s[56:59], s8 offen offset:3072
    s_add_u32 s8, s8, 4096
    buffer_load_dwordx4 v[136:139], v8, s[56:59], s8 offen offset:0
    buffer_load_dwordx4 v[140:143], v8, s[56:59], s8 offen offset:1024
    buffer_load_dwordx4 v[144:147], v8, s[56:59], s8 offen offset:2048
    buffer_load_dwordx4 v[148:151], v8, s[56:59], s8 offen offset:3072
    s_add_u32 s8, s8, 4096
    buffer_load_dwordx4 v[152:155], v8, s[56:59], s8 offen offset:0
    buffer_load_dwordx4 v[156:159], v8, s[56:59], s8 offen offset:1024
    s_add_u32 s76, s46, 23756800
    s_addc_u32 s77, s47, 0
    s_mov_b32 s78, 2363904
    s_mov_b32 s79, 0x20000
    s_add_u32 s20, s46, 5398528
    s_addc_u32 s21, s47, 0
    s_mov_b32 s22, 663552
    s_mov_b32 s23, 0x20000
    s_lshr_b32 s9, s2, 3
    s_mul_i32 s9, s9, 20736
    buffer_load_dwordx4 v[16:19], v9, s[20:23], s9 offen offset:0
    buffer_load_dwordx4 v[16:19], v9, s[20:23], s9 offen offset:1024
    buffer_load_dwordx4 v[16:19], v9, s[20:23], s9 offen offset:2048
    buffer_load_dwordx4 v[16:19], v9, s[20:23], s9 offen offset:3072
    s_add_u32 s9, s9, 4096
    buffer_load_dwordx4 v[16:19], v9, s[20:23], s9 offen offset:0
    buffer_load_dwordx4 v[16:19], v9, s[20:23], s9 offen offset:1024
    buffer_load_dwordx4 v[16:19], v9, s[20:23], s9 offen offset:2048
    buffer_load_dwordx4 v[16:19], v9, s[20:23], s9 offen offset:3072
    s_add_u32 s9, s9, 4096
    buffer_load_dwordx4 v[16:19], v9, s[20:23], s9 offen offset:0
    buffer_load_dwordx4 v[16:19], v9, s[20:23], s9 offen offset:1024
    buffer_load_dwordx4 v[16:19], v9, s[20:23], s9 offen offset:2048
    buffer_load_dwordx4 v[16:19], v9, s[20:23], s9 offen offset:3072
    s_add_u32 s9, s9, 4096
    buffer_load_dwordx4 v[16:19], v9, s[20:23], s9 offen offset:0
    buffer_load_dwordx4 v[16:19], v9, s[20:23], s9 offen offset:1024
    buffer_load_dwordx4 v[16:19], v9, s[20:23], s9 offen offset:2048
    buffer_load_dwordx4 v[16:19], v9, s[20:23], s9 offen offset:3072
    s_add_u32 s9, s9, 4096
    buffer_load_dwordx4 v[16:19], v9, s[20:23], s9 offen offset:0
    buffer_load_dwordx4 v[16:19], v9, s[20:23], s9 offen offset:1024
    buffer_load_dwordx4 v[16:19], v9, s[20:23], s9 offen offset:2048
    buffer_load_dwordx4 v[16:19], v9, s[20:23], s9 offen offset:3072
    s_add_u32 s9, s9, 4096
    buffer_load_dwordx4 v[16:19], v9, s[20:23], s9 offen offset:0
    s_branch K3_GEMM
K3_NOMOD:
    s_waitcnt vmcnt(6)
    s_barrier
    s_lshl_b32 s7, s3, 2
    v_add_u32 v6, s7, v3
    buffer_load_dwordx4 v[112:115], v5, s[56:59], s25 offen offset:2048
    v_mul_u32_u24 v7, 1152, v6
    v_lshl_add_u32 v7, v2, 3, v7
    v_lshrrev_b32 v8, 1, v6
    v_xor_b32 v8, v8, v2
    v_lshlrev_b32 v8, 4, v8
    v_lshl_add_u32 v8, v2, 8, v8
    v_and_b32 v6, 1, v6
    v_lshl_add_u32 v8, v6, 3, v8
    ds_read_b64 v[52:53], v7 offset:46080
    ds_read_b64 v[54:55], v7 offset:46208
    ds_read_b64 v[56:57], v7 offset:46336
    ds_read_b64 v[58:59], v7 offset:46464
    ds_read_b64 v[60:61], v7 offset:46592
    ds_read_b64 v[62:63], v7 offset:46720
    ds_read_b64 v[64:65], v7 offset:46848
    ds_read_b64 v[66:67], v7 offset:46976
    ds_read_b64 v[68:69], v7 offset:47104
    v_add_u32 v8, 82944, v8
    ds_read_b64 v[70:71], v8 offset:0
    ds_read_b64 v[72:73], v8 offset:4096
    ds_read_b64 v[74:75], v8 offset:8192
    ds_read_b64 v[76:77], v8 offset:12288
    ds_read_b64 v[78:79], v8 offset:16384
    ds_read_b64 v[80:81], v8 offset:20480
    ds_read_b64 v[82:83], v8 offset:24576
    ds_read_b64 v[84:85], v8 offset:28672
    ds_read_b64 v[86:87], v8 offset:32768
    s_waitcnt lgkmcnt(9)
    v_lshlrev_b32 v16, 16, v52
    v_and_b32 v17, 0xffff0000, v52
    v_lshlrev_b32 v18, 16, v53
    v_and_b32 v19, 0xffff0000, v53
    v_lshlrev_b32 v20, 16, v54
    v_and_b32 v21, 0xffff0000, v54
    v_lshlrev_b32 v22, 16, v55
    v_and_b32 v23, 0xffff0000, v55
    v_lshlrev_b32 v24, 16, v56
    v_and_b32 v25, 0xffff0000, v56
    v_lshlrev_b32 v26, 16, v57
    v_and_b32 v27, 0xffff0000, v57
    v_lshlrev_b32 v28, 16, v58
    buffer_load_dwordx4 v[116:119], v5, s[56:59], s25 offen offset:3072
    v_and_b32 v29, 0xffff0000, v58
    v_lshlrev_b32 v30, 16, v59
    v_and_b32 v31, 0xffff0000, v59
    v_lshlrev_b32 v32, 16, v60
    v_and_b32 v33, 0xffff0000, v60
    v_lshlrev_b32 v34, 16, v61
    v_and_b32 v35, 0xffff0000, v61
    v_lshlrev_b32 v36, 16, v62
    v_and_b32 v37, 0xffff0000, v62
    v_lshlrev_b32 v38, 16, v63
    v_and_b32 v39, 0xffff0000, v63
    v_lshlrev_b32 v40, 16, v64
    v_and_b32 v41, 0xffff0000, v64
    v_lshlrev_b32 v42, 16, v65
    v_and_b32 v43, 0xffff0000, v65
    v_lshlrev_b32 v44, 16, v66
    v_and_b32 v45, 0xffff0000, v66
    v_lshlrev_b32 v46, 16, v67
    v_and_b32 v47, 0xffff0000, v67
    v_lshlrev_b32 v48, 16, v68
    buffer_load_dwordx4 v[120:123], v5, s[56:59], s26 offen offset:0
    v_and_b32 v49, 0xffff0000, v68
    v_lshlrev_b32 v50, 16, v69
    v_and_b32 v51, 0xffff0000, v69
    s_waitcnt lgkmcnt(0)
    v_lshlrev_b32 v14, 4, v2
    ds_read_b128 v[52:55], v14 offset:36864
    ds_read_b128 v[56:59], v14 offset:39168
    ds_read_b128 v[60:63], v14 offset:37120
    ds_read_b128 v[64:67], v14 offset:39424
    v_pk_add_f32 v[10:11], v[16:17], v[18:19]
    v_pk_add_f32 v[6:7], v[20:21], v[22:23]
    v_pk_mul_f32 v[12:13], v[16:17], v[16:17]
    v_pk_mul_f32 v[8:9], v[18:19], v[18:19]
    v_pk_fma_f32 v[12:13], v[20:21], v[20:21], v[12:13]
    v_pk_fma_f32 v[8:9], v[22:23], v[22:23], v[8:9]
    v_pk_add_f32 v[10:11], v[10:11], v[24:25]
    v_pk_fma_f32 v[12:13], v[24:25], v[24:25], v[12:13]
    v_pk_add_f32 v[6:7], v[6:7], v[26:27]
    v_pk_fma_f32 v[8:9], v[26:27], v[26:27], v[8:9]
    v_pk_add_f32 v[10:11], v[10:11], v[28:29]
    v_pk_fma_f32 v[12:13], v[28:29], v[28:29], v[12:13]
    v_pk_add_f32 v[6:7], v[6:7], v[30:31]
    v_pk_fma_f32 v[8:9], v[30:31], v[30:31], v[8:9]
    v_pk_add_f32 v[10:11], v[10:11], v[32:33]
    v_pk_fma_f32 v[12:13], v[32:33], v[32:33], v[12:13]
    v_pk_add_f32 v[6:7], v[6:7], v[34:35]
    v_pk_fma_f32 v[8:9], v[34:35], v[34:35], v[8:9]
    v_pk_add_f32 v[10:11], v[10:11], v[36:37]
    buffer_load_dwordx4 v[124:127], v5, s[56:59], s26 offen offset:1024
    v_pk_fma_f32 v[12:13], v[36:37], v[36:37], v[12:13]
    v_pk_add_f32 v[6:7], v[6:7], v[38:39]
    v_pk_fma_f32 v[8:9], v[38:39], v[38:39], v[8:9]
    v_pk_add_f32 v[10:11], v[10:11], v[40:41]
    v_pk_fma_f32 v[12:13], v[40:41], v[40:41], v[12:13]
    v_pk_add_f32 v[6:7], v[6:7], v[42:43]
    v_pk_fma_f32 v[8:9], v[42:43], v[42:43], v[8:9]
    v_pk_add_f32 v[10:11], v[10:11], v[44:45]
    v_pk_fma_f32 v[12:13], v[44:45], v[44:45], v[12:13]
    v_pk_add_f32 v[6:7], v[6:7], v[46:47]
    v_pk_fma_f32 v[8:9], v[46:47], v[46:47], v[8:9]
    v_pk_add_f32 v[10:11], v[10:11], v[48:49]
    v_pk_fma_f32 v[12:13], v[48:49], v[48:49], v[12:13]
    v_pk_add_f32 v[6:7], v[6:7], v[50:51]
    v_pk_fma_f32 v[8:9], v[50:51], v[50:51], v[8:9]
    v_pk_add_f32 v[10:11], v[10:11], v[6:7]
    v_pk_add_f32 v[12:13], v[12:13], v[8:9]
    v_add_f32 v10, v10, v11
    v_add_f32 v12, v12, v13
    s_nop 1
    v_add_f32_dpp v10, v10, v10 row_ror:8 row_mask:0xf bank_mask:0xf
    v_add_f32_dpp v12, v12, v12 row_ror:8 row_mask:0xf bank_mask:0xf
    s_nop 1
    v_add_f32_dpp v10, v10, v10 row_ror:4 row_mask:0xf bank_mask:0xf
    v_add_f32_dpp v12, v12, v12 row_ror:4 row_mask:0xf bank_mask:0xf
    s_nop 1
    v_add_f32_dpp v10, v10, v10 row_ror:2 row_mask:0xf bank_mask:0xf
    v_add_f32_dpp v12, v12, v12 row_ror:2 row_mask:0xf bank_mask:0xf
    s_nop 1
    v_add_f32_dpp v10, v10, v10 row_ror:1 row_mask:0xf bank_mask:0xf
    v_add_f32_dpp v12, v12, v12 row_ror:1 row_mask:0xf bank_mask:0xf
    v_mul_f32 v10, 0x3ae38e39, v10
    buffer_load_dwordx4 v[128:131], v5, s[56:59], s26 offen offset:2048
    v_mul_f32 v12, 0x3ae38e39, v12
    v_fma_f32 v12, -v10, v10, v12
    v_max_f32 v12, 0, v12
    v_add_f32 v12, 0x3727c5ac, v12
    v_rsq_f32 v12, v12
    s_nop 0
    v_mul_f32 v10, v10, v12
    v_sub_f32 v10, 0, v10
    ds_read_b128 v[160:163], v14 offset:37376
    ds_read_b128 v[164:167], v14 offset:39680
    s_waitcnt lgkmcnt(4)
    v_pk_fma_f32 v[68:69], v[16:17], v[12:13], v[10:11] op_sel_hi:[1,0,0]
    v_pk_fma_f32 v[6:7], v[18:19], v[12:13], v[10:11] op_sel_hi:[1,0,0]
    v_lshlrev_b32 v8, 16, v70
    v_and_b32 v9, 0xffff0000, v70
    v_pk_fma_f32 v[68:69], v[68:69], v[52:53], v[56:57]
    v_pk_fma_f32 v[6:7], v[6:7], v[54:55], v[58:59]
    v_pk_fma_f32 v[16:17], v[8:9], v[68:69], v[16:17]
    v_lshlrev_b32 v8, 16, v71
    v_and_b32 v9, 0xffff0000, v71
    v_pk_fma_f32 v[18:19], v[8:9], v[6:7], v[18:19]
    ds_read_b128 v[52:55], v14 offset:37632
    ds_read_b128 v[56:59], v14 offset:39936
    s_waitcnt lgkmcnt(4)
    v_pk_fma_f32 v[68:69], v[20:21], v[12:13], v[10:11] op_sel_hi:[1,0,0]
    v_pk_fma_f32 v[6:7], v[22:23], v[12:13], v[10:11] op_sel_hi:[1,0,0]
    v_lshlrev_b32 v8, 16, v72
    v_and_b32 v9, 0xffff0000, v72
    v_pk_fma_f32 v[68:69], v[68:69], v[60:61], v[64:65]
    v_pk_fma_f32 v[6:7], v[6:7], v[62:63], v[66:67]
    v_pk_fma_f32 v[20:21], v[8:9], v[68:69], v[20:21]
    buffer_load_dwordx4 v[132:135], v5, s[56:59], s26 offen offset:3072
    v_lshlrev_b32 v8, 16, v73
    v_and_b32 v9, 0xffff0000, v73
    v_pk_fma_f32 v[22:23], v[8:9], v[6:7], v[22:23]
    ds_read_b128 v[60:63], v14 offset:37888
    ds_read_b128 v[64:67], v14 offset:40192
    s_waitcnt lgkmcnt(4)
    v_pk_fma_f32 v[68:69], v[24:25], v[12:13], v[10:11] op_sel_hi:[1,0,0]
    v_pk_fma_f32 v[6:7], v[26:27], v[12:13], v[10:11] op_sel_hi:[1,0,0]
    v_lshlrev_b32 v8, 16, v74
    v_and_b32 v9, 0xffff0000, v74
    v_pk_fma_f32 v[68:69], v[68:69], v[160:161], v[164:165]
    v_pk_fma_f32 v[6:7], v[6:7], v[162:163], v[166:167]
    v_pk_fma_f32 v[24:25], v[8:9], v[68:69], v[24:25]
    v_lshlrev_b32 v8, 16, v75
    v_and_b32 v9, 0xffff0000, v75
    v_pk_fma_f32 v[26:27], v[8:9], v[6:7], v[26:27]
    ds_read_b128 v[160:163], v14 offset:38144
    ds_read_b128 v[164:167], v14 offset:40448
    s_waitcnt lgkmcnt(4)
    v_pk_fma_f32 v[68:69], v[28:29], v[12:13], v[10:11] op_sel_hi:[1,0,0]
    v_pk_fma_f32 v[6:7], v[30:31], v[12:13], v[10:11] op_sel_hi:[1,0,0]
    v_lshlrev_b32 v8, 16, v76
    v_and_b32 v9, 0xffff0000, v76
    v_pk_fma_f32 v[68:69], v[68:69], v[52:53], v[56:57]
    v_pk_fma_f32 v[6:7], v[6:7], v[54:55], v[58:59]
    v_pk_fma_f32 v[28:29], v[8:9], v[68:69], v[28:29]
    v_lshlrev_b32 v8, 16, v77
    v_and_b32 v9, 0xffff0000, v77
    buffer_load_dwordx4 v[136:139], v5, s[56:59], s27 offen offset:0
    v_pk_fma_f32 v[30:31], v[8:9], v[6:7], v[30:31]
    ds_read_b128 v[52:55], v14 offset:38400
    ds_read_b128 v[56:59], v14 offset:40704
    s_waitcnt lgkmcnt(4)
    v_pk_fma_f32 v[68:69], v[32:33], v[12:13], v[10:11] op_sel_hi:[1,0,0]
    v_pk_fma_f32 v[6:7], v[34:35], v[12:13], v[10:11] op_sel_hi:[1,0,0]
    v_lshlrev_b32 v8, 16, v78
    v_and_b32 v9, 0xffff0000, v78
    v_pk_fma_f32 v[68:69], v[68:69], v[60:61], v[64:65]
    v_pk_fma_f32 v[6:7], v[6:7], v[62:63], v[66:67]
    v_pk_fma_f32 v[32:33], v[8:9], v[68:69], v[32:33]
    v_lshlrev_b32 v8, 16, v79
    v_and_b32 v9, 0xffff0000, v79
    v_pk_fma_f32 v[34:35], v[8:9], v[6:7], v[34:35]
    ds_read_b128 v[60:63], v14 offset:38656
    ds_read_b128 v[64:67], v14 offset:40960
    s_waitcnt lgkmcnt(4)
    v_pk_fma_f32 v[68:69], v[36:37], v[12:13], v[10:11] op_sel_hi:[1,0,0]
    v_pk_fma_f32 v[6:7], v[38:39], v[12:13], v[10:11] op_sel_hi:[1,0,0]
    v_lshlrev_b32 v8, 16, v80
    v_and_b32 v9, 0xffff0000, v80
    v_pk_fma_f32 v[68:69], v[68:69], v[160:161], v[164:165]
    v_pk_fma_f32 v[6:7], v[6:7], v[162:163], v[166:167]
    v_pk_fma_f32 v[36:37], v[8:9], v[68:69], v[36:37]
    v_lshlrev_b32 v8, 16, v81
    v_and_b32 v9, 0xffff0000, v81
    v_pk_fma_f32 v[38:39], v[8:9], v[6:7], v[38:39]
    ds_read_b128 v[160:163], v14 offset:38912
    ds_read_b128 v[164:167], v14 offset:41216
    s_waitcnt lgkmcnt(4)
    v_pk_fma_f32 v[68:69], v[40:41], v[12:13], v[10:11] op_sel_hi:[1,0,0]
    v_pk_fma_f32 v[6:7], v[42:43], v[12:13], v[10:11] op_sel_hi:[1,0,0]
    buffer_load_dwordx4 v[140:143], v5, s[56:59], s27 offen offset:1024
    v_lshlrev_b32 v8, 16, v82
    v_and_b32 v9, 0xffff0000, v82
    v_pk_fma_f32 v[68:69], v[68:69], v[52:53], v[56:57]
    v_pk_fma_f32 v[6:7], v[6:7], v[54:55], v[58:59]
    v_pk_fma_f32 v[40:41], v[8:9], v[68:69], v[40:41]
    v_lshlrev_b32 v8, 16, v83
    v_and_b32 v9, 0xffff0000, v83
    v_pk_fma_f32 v[42:43], v[8:9], v[6:7], v[42:43]
    s_waitcnt lgkmcnt(2)
    v_pk_fma_f32 v[68:69], v[44:45], v[12:13], v[10:11] op_sel_hi:[1,0,0]
    v_pk_fma_f32 v[6:7], v[46:47], v[12:13], v[10:11] op_sel_hi:[1,0,0]
    v_lshlrev_b32 v8, 16, v84
    v_and_b32 v9, 0xffff0000, v84
    v_pk_fma_f32 v[68:69], v[68:69], v[60:61], v[64:65]
    v_pk_fma_f32 v[6:7], v[6:7], v[62:63], v[66:67]
    v_pk_fma_f32 v[44:45], v[8:9], v[68:69], v[44:45]
    v_lshlrev_b32 v8, 16, v85
    v_and_b32 v9, 0xffff0000, v85
    v_pk_fma_f32 v[46:47], v[8:9], v[6:7], v[46:47]
    s_waitcnt lgkmcnt(0)
    v_pk_fma_f32 v[68:69], v[48:49], v[12:13], v[10:11] op_sel_hi:[1,0,0]
    v_pk_fma_f32 v[6:7], v[50:51], v[12:13], v[10:11] op_sel_hi:[1,0,0]
    v_lshlrev_b32 v8, 16, v86
    v_and_b32 v9, 0xffff0000, v86
    v_pk_fma_f32 v[68:69], v[68:69], v[160:161], v[164:165]
    buffer_load_dwordx4 v[144:147], v5, s[56:59], s27 offen offset:2048
    v_pk_fma_f32 v[6:7], v[6:7], v[162:163], v[166:167]
    v_pk_fma_f32 v[48:49], v[8:9], v[68:69], v[48:49]
    v_lshlrev_b32 v8, 16, v87
    v_and_b32 v9, 0xffff0000, v87
    v_pk_fma_f32 v[50:51], v[8:9], v[6:7], v[50:51]
    ds_read_b128 v[52:55], v14 offset:41472
    ds_read_b128 v[56:59], v14 offset:43776
    ds_read_b128 v[60:63], v14 offset:41728
    ds_read_b128 v[64:67], v14 offset:44032
    v_lshrrev_b32 v15, 1, v2
    v_lshlrev_b32 v15, 15, v15
    v_lshlrev_b32 v7, 4, v4
    v_add_u32 v15, v15, v7
    v_and_b32 v7, 1, v2
    v_lshlrev_b32 v7, 3, v7
    v_add_u32 v15, v15, v7
    s_cmp_lg_u32 s4, 0
    s_cbranch_scc1 K3_ST_X1_1
    v_cvt_pk_bf16_f32 v70, v16, v17
    v_cvt_pk_bf16_f32 v71, v18, v19
    v_cvt_pk_bf16_f32 v72, v20, v21
    v_cvt_pk_bf16_f32 v73, v22, v23
    v_cvt_pk_bf16_f32 v74, v24, v25
    v_cvt_pk_bf16_f32 v75, v26, v27
    s_branch K3_ST_X1_D
K3_ST_X1_1:
    s_cmp_lg_u32 s4, 1
    s_cbranch_scc1 K3_ST_X1_2
    v_cvt_pk_bf16_f32 v70, v28, v29
    v_cvt_pk_bf16_f32 v71, v30, v31
    v_cvt_pk_bf16_f32 v72, v32, v33
    v_cvt_pk_bf16_f32 v73, v34, v35
    s_branch K3_ST_X1_D
K3_ST_X1_2:
    s_cmp_lg_u32 s4, 2
    s_cbranch_scc1 K3_ST_X1_3
    v_cvt_pk_bf16_f32 v70, v36, v37
    v_cvt_pk_bf16_f32 v71, v38, v39
    v_cvt_pk_bf16_f32 v72, v40, v41
    v_cvt_pk_bf16_f32 v73, v42, v43
    s_branch K3_ST_X1_D
K3_ST_X1_3:
    v_cvt_pk_bf16_f32 v70, v44, v45
    v_cvt_pk_bf16_f32 v71, v46, v47
    v_cvt_pk_bf16_f32 v72, v48, v49
    v_cvt_pk_bf16_f32 v73, v50, v51
K3_ST_X1_D:
    v_pk_add_f32 v[10:11], v[16:17], v[18:19]
    v_pk_add_f32 v[6:7], v[20:21], v[22:23]
    v_pk_mul_f32 v[12:13], v[16:17], v[16:17]
    v_pk_mul_f32 v[8:9], v[18:19], v[18:19]
    v_pk_fma_f32 v[12:13], v[20:21], v[20:21], v[12:13]
    v_pk_fma_f32 v[8:9], v[22:23], v[22:23], v[8:9]
    v_pk_add_f32 v[10:11], v[10:11], v[24:25]
    v_pk_fma_f32 v[12:13], v[24:25], v[24:25], v[12:13]
    v_pk_add_f32 v[6:7], v[6:7], v[26:27]
    v_pk_fma_f32 v[8:9], v[26:27], v[26:27], v[8:9]
    buffer_load_dwordx4 v[148:151], v5, s[56:59], s27 offen offset:3072
    v_pk_add_f32 v[10:11], v[10:11], v[28:29]
    v_pk_fma_f32 v[12:13], v[28:29], v[28:29], v[12:13]
    v_pk_add_f32 v[6:7], v[6:7], v[30:31]
    v_pk_fma_f32 v[8:9], v[30:31], v[30:31], v[8:9]
    v_pk_add_f32 v[10:11], v[10:11], v[32:33]
    v_pk_fma_f32 v[12:13], v[32:33], v[32:33], v[12:13]
    v_pk_add_f32 v[6:7], v[6:7], v[34:35]
    v_pk_fma_f32 v[8:9], v[34:35], v[34:35], v[8:9]
    v_pk_add_f32 v[10:11], v[10:11], v[36:37]
    v_pk_fma_f32 v[12:13], v[36:37], v[36:37], v[12:13]
    v_pk_add_f32 v[6:7], v[6:7], v[38:39]
    v_pk_fma_f32 v[8:9], v[38:39], v[38:39], v[8:9]
    v_pk_add_f32 v[10:11], v[10:11], v[40:41]
    v_pk_fma_f32 v[12:13], v[40:41], v[40:41], v[12:13]
    v_pk_add_f32 v[6:7], v[6:7], v[42:43]
    v_pk_fma_f32 v[8:9], v[42:43], v[42:43], v[8:9]
    v_pk_add_f32 v[10:11], v[10:11], v[44:45]
    v_pk_fma_f32 v[12:13], v[44:45], v[44:45], v[12:13]
    v_pk_add_f32 v[6:7], v[6:7], v[46:47]
    v_pk_fma_f32 v[8:9], v[46:47], v[46:47], v[8:9]
    v_pk_add_f32 v[10:11], v[10:11], v[48:49]
    buffer_load_dwordx4 v[152:155], v5, s[56:59], s28 offen offset:0
    v_pk_fma_f32 v[12:13], v[48:49], v[48:49], v[12:13]
    v_pk_add_f32 v[6:7], v[6:7], v[50:51]
    v_pk_fma_f32 v[8:9], v[50:51], v[50:51], v[8:9]
    v_pk_add_f32 v[10:11], v[10:11], v[6:7]
    v_pk_add_f32 v[12:13], v[12:13], v[8:9]
    v_add_f32 v10, v10, v11
    v_add_f32 v12, v12, v13
    s_nop 1
    v_add_f32_dpp v10, v10, v10 row_ror:8 row_mask:0xf bank_mask:0xf
    v_add_f32_dpp v12, v12, v12 row_ror:8 row_mask:0xf bank_mask:0xf
    s_nop 1
    v_add_f32_dpp v10, v10, v10 row_ror:4 row_mask:0xf bank_mask:0xf
    v_add_f32_dpp v12, v12, v12 row_ror:4 row_mask:0xf bank_mask:0xf
    s_nop 1
    v_add_f32_dpp v10, v10, v10 row_ror:2 row_mask:0xf bank_mask:0xf
    v_add_f32_dpp v12, v12, v12 row_ror:2 row_mask:0xf bank_mask:0xf
    s_nop 1
    v_add_f32_dpp v10, v10, v10 row_ror:1 row_mask:0xf bank_mask:0xf
    v_add_f32_dpp v12, v12, v12 row_ror:1 row_mask:0xf bank_mask:0xf
    v_mul_f32 v10, 0x3ae38e39, v10
    v_mul_f32 v12, 0x3ae38e39, v12
    v_fma_f32 v12, -v10, v10, v12
    v_max_f32 v12, 0, v12
    v_add_f32 v12, 0x3727c5ac, v12
    v_rsq_f32 v12, v12
    s_nop 0
    v_mul_f32 v10, v10, v12
    v_sub_f32 v10, 0, v10
    ds_read_b128 v[160:163], v14 offset:41984
    ds_read_b128 v[164:167], v14 offset:44288
    s_waitcnt lgkmcnt(4)
    v_pk_fma_f32 v[16:17], v[16:17], v[12:13], v[10:11] op_sel_hi:[1,0,0]
    v_pk_fma_f32 v[18:19], v[18:19], v[12:13], v[10:11] op_sel_hi:[1,0,0]
    v_pk_fma_f32 v[16:17], v[16:17], v[52:53], v[56:57]
    v_pk_fma_f32 v[18:19], v[18:19], v[54:55], v[58:59]
    ds_read_b128 v[52:55], v14 offset:42240
    ds_read_b128 v[56:59], v14 offset:44544
    s_waitcnt lgkmcnt(4)
    v_pk_fma_f32 v[20:21], v[20:21], v[12:13], v[10:11] op_sel_hi:[1,0,0]
    v_pk_fma_f32 v[22:23], v[22:23], v[12:13], v[10:11] op_sel_hi:[1,0,0]
    v_pk_fma_f32 v[20:21], v[20:21], v[60:61], v[64:65]
    v_pk_fma_f32 v[22:23], v[22:23], v[62:63], v[66:67]
    ds_read_b128 v[60:63], v14 offset:42496
    ds_read_b128 v[64:67], v14 offset:44800
    s_waitcnt lgkmcnt(4)
    v_pk_fma_f32 v[24:25], v[24:25], v[12:13], v[10:11] op_sel_hi:[1,0,0]
    buffer_load_dwordx4 v[156:159], v5, s[56:59], s28 offen offset:1024
    v_pk_fma_f32 v[26:27], v[26:27], v[12:13], v[10:11] op_sel_hi:[1,0,0]
    v_pk_fma_f32 v[24:25], v[24:25], v[160:161], v[164:165]
    v_pk_fma_f32 v[26:27], v[26:27], v[162:163], v[166:167]
    ds_read_b128 v[160:163], v14 offset:42752
    ds_read_b128 v[164:167], v14 offset:45056
    s_waitcnt lgkmcnt(4)
    v_pk_fma_f32 v[28:29], v[28:29], v[12:13], v[10:11] op_sel_hi:[1,0,0]
    v_pk_fma_f32 v[30:31], v[30:31], v[12:13], v[10:11] op_sel_hi:[1,0,0]
    v_pk_fma_f32 v[28:29], v[28:29], v[52:53], v[56:57]
    v_pk_fma_f32 v[30:31], v[30:31], v[54:55], v[58:59]
    ds_read_b128 v[52:55], v14 offset:43008
    ds_read_b128 v[56:59], v14 offset:45312
    s_waitcnt lgkmcnt(4)
    v_pk_fma_f32 v[32:33], v[32:33], v[12:13], v[10:11] op_sel_hi:[1,0,0]
    v_pk_fma_f32 v[34:35], v[34:35], v[12:13], v[10:11] op_sel_hi:[1,0,0]
    v_pk_fma_f32 v[32:33], v[32:33], v[60:61], v[64:65]
    v_pk_fma_f32 v[34:35], v[34:35], v[62:63], v[66:67]
    ds_read_b128 v[60:63], v14 offset:43264
    ds_read_b128 v[64:67], v14 offset:45568
    s_waitcnt lgkmcnt(4)
    v_pk_fma_f32 v[36:37], v[36:37], v[12:13], v[10:11] op_sel_hi:[1,0,0]
    v_pk_fma_f32 v[38:39], v[38:39], v[12:13], v[10:11] op_sel_hi:[1,0,0]
    v_pk_fma_f32 v[36:37], v[36:37], v[160:161], v[164:165]
    v_pk_fma_f32 v[38:39], v[38:39], v[162:163], v[166:167]
    ds_read_b128 v[160:163], v14 offset:43520
    ds_read_b128 v[164:167], v14 offset:45824
    s_waitcnt lgkmcnt(4)
    v_pk_fma_f32 v[40:41], v[40:41], v[12:13], v[10:11] op_sel_hi:[1,0,0]
    v_pk_fma_f32 v[42:43], v[42:43], v[12:13], v[10:11] op_sel_hi:[1,0,0]
    v_pk_fma_f32 v[40:41], v[40:41], v[52:53], v[56:57]
    v_pk_fma_f32 v[42:43], v[42:43], v[54:55], v[58:59]
    s_waitcnt lgkmcnt(2)
    v_pk_fma_f32 v[44:45], v[44:45], v[12:13], v[10:11] op_sel_hi:[1,0,0]
    v_pk_fma_f32 v[46:47], v[46:47], v[12:13], v[10:11] op_sel_hi:[1,0,0]
    v_pk_fma_f32 v[44:45], v[44:45], v[60:61], v[64:65]
    v_pk_fma_f32 v[46:47], v[46:47], v[62:63], v[66:67]
    s_waitcnt lgkmcnt(0)
    v_pk_fma_f32 v[48:49], v[48:49], v[12:13], v[10:11] op_sel_hi:[1,0,0]
    v_pk_fma_f32 v[50:51], v[50:51], v[12:13], v[10:11] op_sel_hi:[1,0,0]
    v_pk_fma_f32 v[48:49], v[48:49], v[160:161], v[164:165]
    v_pk_fma_f32 v[50:51], v[50:51], v[162:163], v[166:167]
    s_cmp_lg_u32 s4, 0
    s_cbranch_scc1 K3_ST_X1S_1
    s_mov_b32 s9, 0
    buffer_store_dwordx2 v[70:71], v15, s[64:67], s9 offen sc1
    s_mov_b32 s9, 262144
    buffer_store_dwordx2 v[72:73], v15, s[64:67], s9 offen sc1
    s_mov_b32 s9, 524288
    buffer_store_dwordx2 v[74:75], v15, s[64:67], s9 offen sc1
    s_branch K3_ST_X1S_D
K3_ST_X1S_1:
    s_cmp_lg_u32 s4, 1
    s_cbranch_scc1 K3_ST_X1S_2
    s_mov_b32 s9, 786432
    buffer_store_dwordx2 v[70:71], v15, s[64:67], s9 offen sc1
    s_mov_b32 s9, 1048576
    buffer_store_dwordx2 v[72:73], v15, s[64:67], s9 offen sc1
    s_branch K3_ST_X1S_D
K3_ST_X1S_2:
    s_cmp_lg_u32 s4, 2
    s_cbranch_scc1 K3_ST_X1S_3
    s_mov_b32 s9, 1310720
    buffer_store_dwordx2 v[70:71], v15, s[64:67], s9 offen sc1
    s_mov_b32 s9, 1572864
    buffer_store_dwordx2 v[72:73], v15, s[64:67], s9 offen sc1
    s_branch K3_ST_X1S_D
K3_ST_X1S_3:
    s_mov_b32 s9, 1835008
    buffer_store_dwordx2 v[70:71], v15, s[64:67], s9 offen sc1
    s_mov_b32 s9, 2097152
    buffer_store_dwordx2 v[72:73], v15, s[64:67], s9 offen sc1
K3_ST_X1S_D:
    s_cmp_lg_u32 s4, 0
    s_cbranch_scc1 K3_ST_H2_1
    v_cvt_pk_bf16_f32 v78, v16, v17
    v_cvt_pk_bf16_f32 v79, v18, v19
    s_mov_b32 s9, 0
    buffer_store_dwordx2 v[78:79], v15, s[72:75], s9 offen sc1
    v_cvt_pk_bf16_f32 v80, v20, v21
    v_cvt_pk_bf16_f32 v81, v22, v23
    s_mov_b32 s9, 262144
    buffer_store_dwordx2 v[80:81], v15, s[72:75], s9 offen sc1
    v_cvt_pk_bf16_f32 v82, v24, v25
    v_cvt_pk_bf16_f32 v83, v26, v27
    s_mov_b32 s9, 524288
    buffer_store_dwordx2 v[82:83], v15, s[72:75], s9 offen sc1
    s_branch K3_ST_H2_D
K3_ST_H2_1:
    s_cmp_lg_u32 s4, 1
    s_cbranch_scc1 K3_ST_H2_2
    v_cvt_pk_bf16_f32 v78, v28, v29
    v_cvt_pk_bf16_f32 v79, v30, v31
    s_mov_b32 s9, 786432
    buffer_store_dwordx2 v[78:79], v15, s[72:75], s9 offen sc1
    v_cvt_pk_bf16_f32 v80, v32, v33
    v_cvt_pk_bf16_f32 v81, v34, v35
    s_mov_b32 s9, 1048576
    buffer_store_dwordx2 v[80:81], v15, s[72:75], s9 offen sc1
    s_branch K3_ST_H2_D
K3_ST_H2_2:
    s_cmp_lg_u32 s4, 2
    s_cbranch_scc1 K3_ST_H2_3
    v_cvt_pk_bf16_f32 v78, v36, v37
    v_cvt_pk_bf16_f32 v79, v38, v39
    s_mov_b32 s9, 1310720
    buffer_store_dwordx2 v[78:79], v15, s[72:75], s9 offen sc1
    v_cvt_pk_bf16_f32 v80, v40, v41
    v_cvt_pk_bf16_f32 v81, v42, v43
    s_mov_b32 s9, 1572864
    buffer_store_dwordx2 v[80:81], v15, s[72:75], s9 offen sc1
    s_branch K3_ST_H2_D
K3_ST_H2_3:
    v_cvt_pk_bf16_f32 v78, v44, v45
    v_cvt_pk_bf16_f32 v79, v46, v47
    s_mov_b32 s9, 1835008
    buffer_store_dwordx2 v[78:79], v15, s[72:75], s9 offen sc1
    v_cvt_pk_bf16_f32 v80, v48, v49
    v_cvt_pk_bf16_f32 v81, v50, v51
    s_mov_b32 s9, 2097152
    buffer_store_dwordx2 v[80:81], v15, s[72:75], s9 offen sc1
K3_ST_H2_D:
    v_pk_add_f32 v[10:11], v[16:17], v[18:19]
    v_pk_add_f32 v[6:7], v[20:21], v[22:23]
    v_pk_mul_f32 v[12:13], v[16:17], v[16:17]
    v_pk_mul_f32 v[8:9], v[18:19], v[18:19]
    v_pk_fma_f32 v[12:13], v[20:21], v[20:21], v[12:13]
    v_pk_fma_f32 v[8:9], v[22:23], v[22:23], v[8:9]
    v_pk_add_f32 v[10:11], v[10:11], v[24:25]
    v_pk_fma_f32 v[12:13], v[24:25], v[24:25], v[12:13]
    v_pk_add_f32 v[6:7], v[6:7], v[26:27]
    v_pk_fma_f32 v[8:9], v[26:27], v[26:27], v[8:9]
    v_pk_add_f32 v[10:11], v[10:11], v[28:29]
    v_pk_fma_f32 v[12:13], v[28:29], v[28:29], v[12:13]
    v_pk_add_f32 v[6:7], v[6:7], v[30:31]
    v_pk_fma_f32 v[8:9], v[30:31], v[30:31], v[8:9]
    v_pk_add_f32 v[10:11], v[10:11], v[32:33]
    v_pk_fma_f32 v[12:13], v[32:33], v[32:33], v[12:13]
    v_pk_add_f32 v[6:7], v[6:7], v[34:35]
    v_pk_fma_f32 v[8:9], v[34:35], v[34:35], v[8:9]
    v_pk_add_f32 v[10:11], v[10:11], v[36:37]
    v_pk_fma_f32 v[12:13], v[36:37], v[36:37], v[12:13]
    v_pk_add_f32 v[6:7], v[6:7], v[38:39]
    v_pk_fma_f32 v[8:9], v[38:39], v[38:39], v[8:9]
    v_pk_add_f32 v[10:11], v[10:11], v[40:41]
    v_pk_fma_f32 v[12:13], v[40:41], v[40:41], v[12:13]
    v_pk_add_f32 v[6:7], v[6:7], v[42:43]
    v_pk_fma_f32 v[8:9], v[42:43], v[42:43], v[8:9]
    v_pk_add_f32 v[10:11], v[10:11], v[44:45]
    v_pk_fma_f32 v[12:13], v[44:45], v[44:45], v[12:13]
    v_pk_add_f32 v[6:7], v[6:7], v[46:47]
    v_pk_fma_f32 v[8:9], v[46:47], v[46:47], v[8:9]
    v_pk_add_f32 v[10:11], v[10:11], v[48:49]
    v_pk_fma_f32 v[12:13], v[48:49], v[48:49], v[12:13]
    v_pk_add_f32 v[6:7], v[6:7], v[50:51]
    v_pk_fma_f32 v[8:9], v[50:51], v[50:51], v[8:9]
    v_pk_add_f32 v[10:11], v[10:11], v[6:7]
    v_pk_add_f32 v[12:13], v[12:13], v[8:9]
    v_add_f32 v10, v10, v11
    v_add_f32 v12, v12, v13
    s_nop 1
    v_add_f32_dpp v10, v10, v10 row_ror:8 row_mask:0xf bank_mask:0xf
    v_add_f32_dpp v12, v12, v12 row_ror:8 row_mask:0xf bank_mask:0xf
    s_nop 1
    v_add_f32_dpp v10, v10, v10 row_ror:4 row_mask:0xf bank_mask:0xf
    v_add_f32_dpp v12, v12, v12 row_ror:4 row_mask:0xf bank_mask:0xf
    s_nop 1
    v_add_f32_dpp v10, v10, v10 row_ror:2 row_mask:0xf bank_mask:0xf
    v_add_f32_dpp v12, v12, v12 row_ror:2 row_mask:0xf bank_mask:0xf
    s_nop 1
    v_add_f32_dpp v10, v10, v10 row_ror:1 row_mask:0xf bank_mask:0xf
    v_add_f32_dpp v12, v12, v12 row_ror:1 row_mask:0xf bank_mask:0xf
    v_mul_f32 v10, 0x3ae38e39, v10
    v_mul_f32 v12, 0x3ae38e39, v12
    v_fma_f32 v12, -v10, v10, v12
    v_max_f32 v12, 0, v12
    v_add_f32 v12, 0x3727c5ac, v12
    v_rsq_f32 v12, v12
    s_nop 0
    v_mul_f32 v10, v10, v12
    v_sub_f32 v10, 0, v10
    s_lshl_b32 s7, s3, 2
    v_add_u32 v6, s7, v3
    v_lshrrev_b32 v7, 1, v2
    v_and_b32 v8, 15, v6
    v_xor_b32 v8, v8, v7
    v_lshlrev_b32 v8, 4, v8
    v_lshrrev_b32 v6, 4, v6
    v_lshlrev_b32 v6, 8, v6
    v_lshlrev_b32 v7, 9, v7
    v_add3_u32 v8, v8, v6, v7
    v_and_b32 v7, 1, v2
    v_lshlrev_b32 v7, 3, v7
    v_add_u32 v8, v8, v7
    v_pk_fma_f32 v[16:17], v[16:17], v[12:13], v[10:11] op_sel_hi:[1,0,0]
    v_pk_fma_f32 v[18:19], v[18:19], v[12:13], v[10:11] op_sel_hi:[1,0,0]
    v_cvt_pk_bf16_f32 v52, v16, v17
    v_cvt_pk_bf16_f32 v53, v18, v19
    ds_write_b64 v8, v[52:53] offset:0
    v_pk_fma_f32 v[20:21], v[20:21], v[12:13], v[10:11] op_sel_hi:[1,0,0]
    v_pk_fma_f32 v[22:23], v[22:23], v[12:13], v[10:11] op_sel_hi:[1,0,0]
    v_cvt_pk_bf16_f32 v54, v20, v21
    v_cvt_pk_bf16_f32 v55, v22, v23
    ds_write_b64 v8, v[54:55] offset:4096
    v_pk_fma_f32 v[24:25], v[24:25], v[12:13], v[10:11] op_sel_hi:[1,0,0]
    v_pk_fma_f32 v[26:27], v[26:27], v[12:13], v[10:11] op_sel_hi:[1,0,0]
    v_cvt_pk_bf16_f32 v56, v24, v25
    v_cvt_pk_bf16_f32 v57, v26, v27
    ds_write_b64 v8, v[56:57] offset:8192
    v_pk_fma_f32 v[28:29], v[28:29], v[12:13], v[10:11] op_sel_hi:[1,0,0]
    v_pk_fma_f32 v[30:31], v[30:31], v[12:13], v[10:11] op_sel_hi:[1,0,0]
    v_cvt_pk_bf16_f32 v58, v28, v29
    v_cvt_pk_bf16_f32 v59, v30, v31
    ds_write_b64 v8, v[58:59] offset:12288
    v_pk_fma_f32 v[32:33], v[32:33], v[12:13], v[10:11] op_sel_hi:[1,0,0]
    v_pk_fma_f32 v[34:35], v[34:35], v[12:13], v[10:11] op_sel_hi:[1,0,0]
    v_cvt_pk_bf16_f32 v52, v32, v33
    v_cvt_pk_bf16_f32 v53, v34, v35
    ds_write_b64 v8, v[52:53] offset:16384
    v_pk_fma_f32 v[36:37], v[36:37], v[12:13], v[10:11] op_sel_hi:[1,0,0]
    v_pk_fma_f32 v[38:39], v[38:39], v[12:13], v[10:11] op_sel_hi:[1,0,0]
    v_cvt_pk_bf16_f32 v54, v36, v37
    v_cvt_pk_bf16_f32 v55, v38, v39
    ds_write_b64 v8, v[54:55] offset:20480
    v_pk_fma_f32 v[40:41], v[40:41], v[12:13], v[10:11] op_sel_hi:[1,0,0]
    v_pk_fma_f32 v[42:43], v[42:43], v[12:13], v[10:11] op_sel_hi:[1,0,0]
    v_cvt_pk_bf16_f32 v56, v40, v41
    v_cvt_pk_bf16_f32 v57, v42, v43
    ds_write_b64 v8, v[56:57] offset:24576
    v_pk_fma_f32 v[44:45], v[44:45], v[12:13], v[10:11] op_sel_hi:[1,0,0]
    v_pk_fma_f32 v[46:47], v[46:47], v[12:13], v[10:11] op_sel_hi:[1,0,0]
    v_cvt_pk_bf16_f32 v58, v44, v45
    v_cvt_pk_bf16_f32 v59, v46, v47
    ds_write_b64 v8, v[58:59] offset:28672
    v_pk_fma_f32 v[48:49], v[48:49], v[12:13], v[10:11] op_sel_hi:[1,0,0]
    v_pk_fma_f32 v[50:51], v[50:51], v[12:13], v[10:11] op_sel_hi:[1,0,0]
    v_cvt_pk_bf16_f32 v52, v48, v49
    v_cvt_pk_bf16_f32 v53, v50, v51
    ds_write_b64 v8, v[52:53] offset:32768
    s_waitcnt lgkmcnt(0)
K3_GEMM:
    s_barrier
    v_xor_b32 v6, v2, v3
    v_lshlrev_b32 v6, 4, v6
    v_lshlrev_b32 v7, 9, v3
    v_add_u32 v6, v6, v7
    v_xor_b32 v7, 64, v6
    ds_read_b128 v[16:19], v6 offset:0
    ds_read_b128 v[20:23], v6 offset:256
    ds_read_b128 v[24:27], v7 offset:2048
    ds_read_b128 v[28:31], v7 offset:2304
    ds_read_b128 v[32:35], v6 offset:4096
    ds_read_b128 v[36:39], v6 offset:4352
    s_cmp_eq_u32 s3, 8
    s_cbranch_scc1 K3_W8W
    s_waitcnt vmcnt(4)
    s_branch K3_WOK
K3_W8W:
    s_waitcnt vmcnt(21)
K3_WOK:
    ds_read_b128 v[40:43], v7 offset:6144
    ds_read_b128 v[44:47], v7 offset:6400
    s_waitcnt lgkmcnt(6)
    v_mfma_f32_16x16x32_bf16 v[52:55], v[88:91], v[16:19], 0
    v_mfma_f32_16x16x32_bf16 v[56:59], v[88:91], v[20:23], 0
    ds_read_b128 v[16:19], v6 offset:8192
    ds_read_b128 v[20:23], v6 offset:8448
    s_waitcnt lgkmcnt(6)
    v_mfma_f32_16x16x32_bf16 v[52:55], v[92:95], v[24:27], v[52:55]
    v_mfma_f32_16x16x32_bf16 v[56:59], v[92:95], v[28:31], v[56:59]
    ds_read_b128 v[24:27], v7 offset:10240
    ds_read_b128 v[28:31], v7 offset:10496
    s_waitcnt lgkmcnt(6)
    v_mfma_f32_16x16x32_bf16 v[52:55], v[96:99], v[32:35], v[52:55]
    v_mfma_f32_16x16x32_bf16 v[56:59], v[96:99], v[36:39], v[56:59]
    ds_read_b128 v[32:35], v6 offset:12288
    ds_read_b128 v[36:39], v6 offset:12544
    s_waitcnt lgkmcnt(6)
    v_mfma_f32_16x16x32_bf16 v[52:55], v[100:103], v[40:43], v[52:55]
    v_mfma_f32_16x16x32_bf16 v[56:59], v[100:103], v[44:47], v[56:59]
    ds_read_b128 v[40:43], v7 offset:14336
    ds_read_b128 v[44:47], v7 offset:14592
    s_waitcnt lgkmcnt(6)
    v_mfma_f32_16x16x32_bf16 v[52:55], v[104:107], v[16:19], v[52:55]
    v_mfma_f32_16x16x32_bf16 v[56:59], v[104:107], v[20:23], v[56:59]
    ds_read_b128 v[16:19], v6 offset:16384
    ds_read_b128 v[20:23], v6 offset:16640
    s_waitcnt lgkmcnt(6)
    v_mfma_f32_16x16x32_bf16 v[52:55], v[108:111], v[24:27], v[52:55]
    v_mfma_f32_16x16x32_bf16 v[56:59], v[108:111], v[28:31], v[56:59]
    ds_read_b128 v[24:27], v7 offset:18432
    ds_read_b128 v[28:31], v7 offset:18688
    s_waitcnt lgkmcnt(6)
    v_mfma_f32_16x16x32_bf16 v[52:55], v[112:115], v[32:35], v[52:55]
    v_mfma_f32_16x16x32_bf16 v[56:59], v[112:115], v[36:39], v[56:59]
    ds_read_b128 v[32:35], v6 offset:20480
    ds_read_b128 v[36:39], v6 offset:20736
    s_waitcnt lgkmcnt(6)
    v_mfma_f32_16x16x32_bf16 v[52:55], v[116:119], v[40:43], v[52:55]
    v_mfma_f32_16x16x32_bf16 v[56:59], v[116:119], v[44:47], v[56:59]
    ds_read_b128 v[40:43], v7 offset:22528
    ds_read_b128 v[44:47], v7 offset:22784
    s_waitcnt lgkmcnt(6)
    v_mfma_f32_16x16x32_bf16 v[52:55], v[120:123], v[16:19], v[52:55]
    v_mfma_f32_16x16x32_bf16 v[56:59], v[120:123], v[20:23], v[56:59]
    ds_read_b128 v[16:19], v6 offset:24576
    ds_read_b128 v[20:23], v6 offset:24832
    s_waitcnt lgkmcnt(6)
    v_mfma_f32_16x16x32_bf16 v[52:55], v[124:127], v[24:27], v[52:55]
    v_mfma_f32_16x16x32_bf16 v[56:59], v[124:127], v[28:31], v[56:59]
    ds_read_b128 v[24:27], v7 offset:26624
    ds_read_b128 v[28:31], v7 offset:26880
    s_waitcnt lgkmcnt(6)
    v_mfma_f32_16x16x32_bf16 v[52:55], v[128:131], v[32:35], v[52:55]
    v_mfma_f32_16x16x32_bf16 v[56:59], v[128:131], v[36:39], v[56:59]
    ds_read_b128 v[32:35], v6 offset:28672
    ds_read_b128 v[36:39], v6 offset:28928
    s_waitcnt lgkmcnt(6)
    v_mfma_f32_16x16x32_bf16 v[52:55], v[132:135], v[40:43], v[52:55]
    v_mfma_f32_16x16x32_bf16 v[56:59], v[132:135], v[44:47], v[56:59]
    ds_read_b128 v[40:43], v7 offset:30720
    ds_read_b128 v[44:47], v7 offset:30976
    s_waitcnt lgkmcnt(6)
    v_mfma_f32_16x16x32_bf16 v[52:55], v[136:139], v[16:19], v[52:55]
    v_mfma_f32_16x16x32_bf16 v[56:59], v[136:139], v[20:23], v[56:59]
    ds_read_b128 v[16:19], v6 offset:32768
    ds_read_b128 v[20:23], v6 offset:33024
    s_waitcnt lgkmcnt(6)
    v_mfma_f32_16x16x32_bf16 v[52:55], v[140:143], v[24:27], v[52:55]
    v_mfma_f32_16x16x32_bf16 v[56:59], v[140:143], v[28:31], v[56:59]
    ds_read_b128 v[24:27], v7 offset:34816
    ds_read_b128 v[28:31], v7 offset:35072
    s_waitcnt lgkmcnt(6)
    v_mfma_f32_16x16x32_bf16 v[52:55], v[144:147], v[32:35], v[52:55]
    v_mfma_f32_16x16x32_bf16 v[56:59], v[144:147], v[36:39], v[56:59]
    s_waitcnt lgkmcnt(4)
    v_mfma_f32_16x16x32_bf16 v[52:55], v[148:151], v[40:43], v[52:55]
    v_mfma_f32_16x16x32_bf16 v[56:59], v[148:151], v[44:47], v[56:59]
    s_waitcnt lgkmcnt(2)
    v_mfma_f32_16x16x32_bf16 v[52:55], v[152:155], v[16:19], v[52:55]
    v_mfma_f32_16x16x32_bf16 v[56:59], v[152:155], v[20:23], v[56:59]
    s_waitcnt lgkmcnt(0)
    v_mfma_f32_16x16x32_bf16 v[52:55], v[156:159], v[24:27], v[52:55]
    v_mfma_f32_16x16x32_bf16 v[56:59], v[156:159], v[28:31], v[56:59]
    s_mov_b32 s70, 0xc0135761
    s_mov_b32 s71, 0xbdd2d3e8
    v_mov_b32 v9, s70
    s_mul_i32 s8, s4, 9
    s_add_u32 s8, s8, s3
    s_lshl_b32 s8, s8, 1
    v_lshrrev_b32 v10, 1, v3
    v_add_u32 v10, s8, v10
    v_mul_u32_u24 v10, 32832, v10
    s_lshl_b32 s6, s5, 5
    v_add_u32 v11, s6, v2
    v_lshlrev_b32 v11, 4, v11
    v_add3_u32 v10, v10, v11, 32
    v_and_b32 v11, 1, v3
    v_lshlrev_b32 v11, 8, v11
    v_add_u32 v10, v10, v11
    s_nop 4
    v_mul_f32 v16, v52, v52
    v_mul_f32 v17, v53, v53
    v_mul_f32 v18, v54, v54
    v_mul_f32 v19, v55, v55
    v_mul_f32 v20, v56, v56
    v_mul_f32 v21, v57, v57
    v_mul_f32 v22, v58, v58
    v_mul_f32 v23, v59, v59
    v_fma_f32 v16, v16, s71, v9
    v_fma_f32 v17, v17, s71, v9
    v_fma_f32 v18, v18, s71, v9
    v_fma_f32 v19, v19, s71, v9
    v_fma_f32 v20, v20, s71, v9
    v_fma_f32 v21, v21, s71, v9
    v_fma_f32 v22, v22, s71, v9
    v_fma_f32 v23, v23, s71, v9
    v_mul_f32 v16, v16, v52
    v_mul_f32 v17, v17, v53
    v_mul_f32 v18, v18, v54
    v_mul_f32 v19, v19, v55
    v_mul_f32 v20, v20, v56
    v_mul_f32 v21, v21, v57
    v_mul_f32 v22, v22, v58
    v_mul_f32 v23, v23, v59
    v_exp_f32 v16, v16
    v_exp_f32 v17, v17
    v_exp_f32 v18, v18
    v_exp_f32 v19, v19
    v_exp_f32 v20, v20
    v_exp_f32 v21, v21
    v_exp_f32 v22, v22
    v_exp_f32 v23, v23
    v_add_f32 v16, 1.0, v16
    v_add_f32 v17, 1.0, v17
    v_add_f32 v18, 1.0, v18
    v_add_f32 v19, 1.0, v19
    v_add_f32 v20, 1.0, v20
    v_add_f32 v21, 1.0, v21
    v_add_f32 v22, 1.0, v22
    v_add_f32 v23, 1.0, v23
    v_rcp_f32 v16, v16
    v_rcp_f32 v17, v17
    v_rcp_f32 v18, v18
    v_rcp_f32 v19, v19
    v_rcp_f32 v20, v20
    v_rcp_f32 v21, v21
    v_rcp_f32 v22, v22
    v_rcp_f32 v23, v23
    v_mul_f32 v52, v52, v16
    v_mul_f32 v53, v53, v17
    v_mul_f32 v54, v54, v18
    v_mul_f32 v55, v55, v19
    v_mul_f32 v56, v56, v20
    v_mul_f32 v57, v57, v21
    v_mul_f32 v58, v58, v22
    v_mul_f32 v59, v59, v23
    v_cvt_pk_bf16_f32 v24, v52, v53
    v_cvt_pk_bf16_f32 v25, v54, v55
    v_cvt_pk_bf16_f32 v26, v56, v57
    v_cvt_pk_bf16_f32 v27, v58, v59
    s_nop 1
    v_permlane16_swap_b32 v24, v26
    v_permlane16_swap_b32 v25, v27
    buffer_store_dwordx4 v[24:27], v10, s[76:79], 0 offen sc1
    s_add_u32 s56, s46, 5398528
    s_addc_u32 s57, s47, 0
    s_mov_b32 s58, 663552
    s_mov_b32 s59, 0x20000
    s_add_u32 s72, s46, 19038208
    s_addc_u32 s73, s47, 0
    s_mov_b32 s74, 2359296
    s_mov_b32 s75, 0x20000
    s_add_u32 s64, s46, 21397504
    s_addc_u32 s65, s47, 0
    s_mov_b32 s66, 2359296
    s_mov_b32 s67, 0x20000
    s_add_u32 s48, s46, 45387776
    s_addc_u32 s49, s47, 0
    s_mov_b32 s50, 32768
    s_mov_b32 s51, 0x20000
    s_mul_i32 s8, s4, 9
    s_add_u32 s8, s8, s3
    s_mul_i32 s8, s8, 18432
    v_lshlrev_b32 v14, 4, v1
    s_add_u32 s24, s8, 0
    s_add_u32 s25, s8, 4096
    s_add_u32 s26, s8, 8192
    s_add_u32 s27, s8, 12288
    s_add_u32 s28, s8, 16384
    s_cmp_lg_u32 s3, 0
    s_cbranch_scc1 K3_W2N
    buffer_load_dwordx4 v[88:91], v14, s[56:59], s24 offen offset:0
    buffer_load_dwordx4 v[92:95], v14, s[56:59], s24 offen offset:1024
    buffer_load_dwordx4 v[96:99], v14, s[56:59], s24 offen offset:2048
    buffer_load_dwordx4 v[100:103], v14, s[56:59], s24 offen offset:3072
    buffer_load_dwordx4 v[104:107], v14, s[56:59], s25 offen offset:0
    buffer_load_dwordx4 v[108:111], v14, s[56:59], s25 offen offset:1024
    buffer_load_dwordx4 v[112:115], v14, s[56:59], s25 offen offset:2048
    buffer_load_dwordx4 v[116:119], v14, s[56:59], s25 offen offset:3072
    buffer_load_dwordx4 v[120:123], v14, s[56:59], s26 offen offset:0
    buffer_load_dwordx4 v[124:127], v14, s[56:59], s26 offen offset:1024
    buffer_load_dwordx4 v[128:131], v14, s[56:59], s26 offen offset:2048
    buffer_load_dwordx4 v[132:135], v14, s[56:59], s26 offen offset:3072
    buffer_load_dwordx4 v[136:139], v14, s[56:59], s27 offen offset:0
    buffer_load_dwordx4 v[140:143], v14, s[56:59], s27 offen offset:1024
    buffer_load_dwordx4 v[144:147], v14, s[56:59], s27 offen offset:2048
    buffer_load_dwordx4 v[148:151], v14, s[56:59], s27 offen offset:3072
    buffer_load_dwordx4 v[152:155], v14, s[56:59], s28 offen offset:0
    buffer_load_dwordx4 v[156:159], v14, s[56:59], s28 offen offset:1024
K3_W2N:
    s_lshl_b32 s6, s5, 5
    s_lshl_b32 s7, s3, 3
    s_add_u32 s7, s7, 0
    v_add_u32 v4, s7, v3
    v_mul_u32_u24 v5, 57, v4
    v_lshrrev_b32 v5, 10, v5
    v_lshrrev_b32 v6, 1, v5
    v_add_u32 v6, 1, v6
    v_and_b32 v5, 1, v5
    v_cmp_eq_u32 vcc, 1, v5
    v_sub_u32 v7, 0, v6
    s_nop 0
    v_cndmask_b32 v6, v7, v6, vcc
    v_add_u32 v6, v6, v2
    v_add_u32 v6, s6, v6
    v_add_u32 v6, 2, v6
    v_lshlrev_b32 v6, 4, v6
    v_mul_u32_u24 v4, 32832, v4
    v_add_u32 v8, v4, v6
    s_lshl_b32 s7, s3, 3
    s_add_u32 s7, s7, 4
    v_add_u32 v4, s7, v3
    v_mul_u32_u24 v5, 57, v4
    v_lshrrev_b32 v5, 10, v5
    v_lshrrev_b32 v6, 1, v5
    v_add_u32 v6, 1, v6
    v_and_b32 v5, 1, v5
    v_cmp_eq_u32 vcc, 1, v5
    v_sub_u32 v7, 0, v6
    s_nop 0
    v_cndmask_b32 v6, v7, v6, vcc
    v_add_u32 v6, v6, v2
    v_add_u32 v6, s6, v6
    v_add_u32 v6, 2, v6
    v_lshlrev_b32 v6, 4, v6
    v_mul_u32_u24 v4, 32832, v4
    v_add_u32 v9, v4, v6
    s_mul_i32 s8, s4, 9
    s_add_u32 s8, s8, s3
    s_lshl_b32 s8, s8, 1
    v_lshrrev_b32 v11, 1, v3
    v_add_u32 v11, s8, v11
    v_lshlrev_b32 v11, 15, v11
    v_add_u32 v12, s6, v2
    v_lshlrev_b32 v12, 4, v12
    v_add_u32 v11, v11, v12
    v_and_b32 v12, 1, v3
    v_lshlrev_b32 v12, 3, v12
    v_add_u32 v11, v11, v12
    s_cmp_lg_u32 s3, 0
    s_cbranch_scc1 K3_PW1
    s_waitcnt vmcnt(18)
    s_branch K3_PW2
K3_PW1:
    s_waitcnt vmcnt(0)
K3_PW2:
    s_barrier
    s_cmp_lg_u32 s3, 0
    s_cbranch_scc1 K3_NOFLAG
    s_lshl_b32 s9, s2, 7
    v_mov_b32 v20, s9
    v_mov_b32 v21, 1
    s_mov_b64 exec, 1
    buffer_store_dword v21, v20, s[48:51], 0 offen sc1
    s_mov_b64 exec, -1
K3_NOFLAG:
    s_cmp_eq_u32 s3, 0
    s_cbranch_scc1 K3_DOPOLL
    buffer_load_dwordx4 v[88:91], v14, s[56:59], s24 offen offset:0
    buffer_load_dwordx4 v[92:95], v14, s[56:59], s24 offen offset:1024
    buffer_load_dwordx4 v[96:99], v14, s[56:59], s24 offen offset:2048
    buffer_load_dwordx4 v[100:103], v14, s[56:59], s24 offen offset:3072
    buffer_load_dwordx4 v[104:107], v14, s[56:59], s25 offen offset:0
    buffer_load_dwordx4 v[108:111], v14, s[56:59], s25 offen offset:1024
    buffer_load_dwordx4 v[112:115], v14, s[56:59], s25 offen offset:2048
    buffer_load_dwordx4 v[116:119], v14, s[56:59], s25 offen offset:3072
    buffer_load_dwordx4 v[120:123], v14, s[56:59], s26 offen offset:0
    buffer_load_dwordx4 v[124:127], v14, s[56:59], s26 offen offset:1024
    buffer_load_dwordx4 v[128:131], v14, s[56:59], s26 offen offset:2048
    buffer_load_dwordx4 v[132:135], v14, s[56:59], s26 offen offset:3072
    buffer_load_dwordx4 v[136:139], v14, s[56:59], s27 offen offset:0
    buffer_load_dwordx4 v[140:143], v14, s[56:59], s27 offen offset:1024
    buffer_load_dwordx4 v[144:147], v14, s[56:59], s27 offen offset:2048
    buffer_load_dwordx4 v[148:151], v14, s[56:59], s27 offen offset:3072
    buffer_load_dwordx4 v[152:155], v14, s[56:59], s28 offen offset:0
    buffer_load_dwordx4 v[156:159], v14, s[56:59], s28 offen offset:1024
    s_branch K3_NOPOLL
K3_DOPOLL:
    v_lshrrev_b32 v20, 2, v1
    v_add_u32 v20, s5, v20
    v_subrev_u32 v20, 1, v20
    v_cmp_gt_u32 vcc, 64, v20
    v_cmp_gt_u32 s[10:11], 12, v1
    s_and_b64 s[10:11], s[10:11], vcc
    v_and_b32 v21, 3, v1
    v_lshl_add_u32 v20, v21, 6, v20
    v_lshlrev_b32 v20, 7, v20
    s_mov_b64 exec, s[10:11]
    s_mov_b32 s12, 400000
K3_POLL:
    buffer_load_dword v21, v20, s[48:51], 0 offen sc1
    s_waitcnt vmcnt(0)
    v_cmp_ne_u32 vcc, 1, v21
    s_cbranch_vccz K3_POLLOK
    s_sleep 1
    s_sub_u32 s12, s12, 1
    s_cmp_lg_u32 s12, 0
    s_cbranch_scc1 K3_POLL
K3_POLLOK:
    s_mov_b64 exec, -1
K3_NOPOLL:
    s_barrier
    buffer_load_dwordx4 v[16:19], v8, s[76:79], 0 offen offset:0 sc1
    buffer_load_dwordx4 v[20:23], v8, s[76:79], 0 offen offset:256 sc1
    buffer_load_dwordx4 v[24:27], v9, s[76:79], 0 offen offset:0 sc1
    buffer_load_dwordx4 v[28:31], v9, s[76:79], 0 offen offset:256 sc1
    buffer_load_dwordx2 v[32:33], v11, s[72:75], 0 offen offset:0 sc1
    buffer_load_dwordx2 v[34:35], v11, s[72:75], 0 offen offset:256 sc1
    s_lshl_b32 s7, s3, 12
    v_add_u32 v13, s7, v14
    v_add_u32 v13, 46080, v13
    v_add_u32 v14, 46080, v14
    s_waitcnt vmcnt(5)
    ds_write_b128 v13, v[16:19] offset:0
    s_waitcnt vmcnt(4)
    ds_write_b128 v13, v[20:23] offset:1024
    s_waitcnt vmcnt(3)
    ds_write_b128 v13, v[24:27] offset:2048
    s_waitcnt vmcnt(2)
    ds_write_b128 v13, v[28:31] offset:3072
    s_waitcnt lgkmcnt(0)
    s_barrier
    ds_read_b128 v[36:39], v14 offset:0
    ds_read_b128 v[40:43], v14 offset:1024
    ds_read_b128 v[44:47], v14 offset:2048
    ds_read_b128 v[48:51], v14 offset:3072
    s_waitcnt vmcnt(0)
    s_add_u32 s76, s46, 6062080
    s_addc_u32 s77, s47, 0
    s_mov_b32 s78, 5308416
    s_mov_b32 s79, 0x20000
    s_and_b32 s9, s2, 1
    s_lshl_b32 s9, s9, 4
    s_lshr_b32 s10, s2, 4
    s_add_u32 s9, s9, s10
    s_mul_i32 s9, s9, 165888
    s_lshr_b32 s10, s2, 3
    s_and_b32 s10, s10, 1
    s_mul_i32 s10, s10, 12288
    s_add_u32 s9, s9, s10
    s_lshl_b32 s10, s3, 12
    s_add_u32 s9, s9, s10
    s_cmp_ge_u32 s3, 3
    s_cbranch_scc1 K3_NOPF5
    v_lshlrev_b32 v20, 4, v1
    buffer_load_dwordx4 v[24:27], v20, s[76:79], s9 offen offset:0
    buffer_load_dwordx4 v[24:27], v20, s[76:79], s9 offen offset:1024
    buffer_load_dwordx4 v[24:27], v20, s[76:79], s9 offen offset:2048
    buffer_load_dwordx4 v[24:27], v20, s[76:79], s9 offen offset:3072
K3_NOPF5:
    ds_read_b128 v[52:55], v14 offset:4096
    ds_read_b128 v[56:59], v14 offset:5120
    s_waitcnt lgkmcnt(4)
    v_mfma_f32_16x16x32_bf16 v[60:63], v[88:91], v[36:39], 0
    v_mfma_f32_16x16x32_bf16 v[64:67], v[88:91], v[40:43], 0
    ds_read_b128 v[36:39], v14 offset:6144
    ds_read_b128 v[40:43], v14 offset:7168
    s_waitcnt lgkmcnt(4)
    v_mfma_f32_16x16x32_bf16 v[60:63], v[92:95], v[44:47], v[60:63]
    v_mfma_f32_16x16x32_bf16 v[64:67], v[92:95], v[48:51], v[64:67]
    ds_read_b128 v[44:47], v14 offset:8192
    ds_read_b128 v[48:51], v14 offset:9216
    s_waitcnt lgkmcnt(4)
    v_mfma_f32_16x16x32_bf16 v[60:63], v[96:99], v[52:55], v[60:63]
    v_mfma_f32_16x16x32_bf16 v[64:67], v[96:99], v[56:59], v[64:67]
    ds_read_b128 v[52:55], v14 offset:10240
    ds_read_b128 v[56:59], v14 offset:11264
    s_waitcnt lgkmcnt(4)
    v_mfma_f32_16x16x32_bf16 v[60:63], v[100:103], v[36:39], v[60:63]
    v_mfma_f32_16x16x32_bf16 v[64:67], v[100:103], v[40:43], v[64:67]
    ds_read_b128 v[36:39], v14 offset:12288
    ds_read_b128 v[40:43], v14 offset:13312
    s_waitcnt lgkmcnt(4)
    v_mfma_f32_16x16x32_bf16 v[60:63], v[104:107], v[44:47], v[60:63]
    v_mfma_f32_16x16x32_bf16 v[64:67], v[104:107], v[48:51], v[64:67]
    ds_read_b128 v[44:47], v14 offset:14336
    ds_read_b128 v[48:51], v14 offset:15360
    s_waitcnt lgkmcnt(4)
    v_mfma_f32_16x16x32_bf16 v[60:63], v[108:111], v[52:55], v[60:63]
    v_mfma_f32_16x16x32_bf16 v[64:67], v[108:111], v[56:59], v[64:67]
    ds_read_b128 v[52:55], v14 offset:16384
    ds_read_b128 v[56:59], v14 offset:17408
    s_waitcnt lgkmcnt(4)
    v_mfma_f32_16x16x32_bf16 v[60:63], v[112:115], v[36:39], v[60:63]
    v_mfma_f32_16x16x32_bf16 v[64:67], v[112:115], v[40:43], v[64:67]
    ds_read_b128 v[36:39], v14 offset:18432
    ds_read_b128 v[40:43], v14 offset:19456
    s_waitcnt lgkmcnt(4)
    v_mfma_f32_16x16x32_bf16 v[60:63], v[116:119], v[44:47], v[60:63]
    v_mfma_f32_16x16x32_bf16 v[64:67], v[116:119], v[48:51], v[64:67]
    ds_read_b128 v[44:47], v14 offset:20480
    ds_read_b128 v[48:51], v14 offset:21504
    s_waitcnt lgkmcnt(4)
    v_mfma_f32_16x16x32_bf16 v[60:63], v[120:123], v[52:55], v[60:63]
    v_mfma_f32_16x16x32_bf16 v[64:67], v[120:123], v[56:59], v[64:67]
    ds_read_b128 v[52:55], v14 offset:22528
    ds_read_b128 v[56:59], v14 offset:23552
    s_waitcnt lgkmcnt(4)
    v_mfma_f32_16x16x32_bf16 v[60:63], v[124:127], v[36:39], v[60:63]
    v_mfma_f32_16x16x32_bf16 v[64:67], v[124:127], v[40:43], v[64:67]
    ds_read_b128 v[36:39], v14 offset:24576
    ds_read_b128 v[40:43], v14 offset:25600
    s_waitcnt lgkmcnt(4)
    v_mfma_f32_16x16x32_bf16 v[60:63], v[128:131], v[44:47], v[60:63]
    v_mfma_f32_16x16x32_bf16 v[64:67], v[128:131], v[48:51], v[64:67]
    ds_read_b128 v[44:47], v14 offset:26624
    ds_read_b128 v[48:51], v14 offset:27648
    s_waitcnt lgkmcnt(4)
    v_mfma_f32_16x16x32_bf16 v[60:63], v[132:135], v[52:55], v[60:63]
    v_mfma_f32_16x16x32_bf16 v[64:67], v[132:135], v[56:59], v[64:67]
    ds_read_b128 v[52:55], v14 offset:28672
    ds_read_b128 v[56:59], v14 offset:29696
    s_waitcnt lgkmcnt(4)
    v_mfma_f32_16x16x32_bf16 v[60:63], v[136:139], v[36:39], v[60:63]
    v_mfma_f32_16x16x32_bf16 v[64:67], v[136:139], v[40:43], v[64:67]
    ds_read_b128 v[36:39], v14 offset:30720
    ds_read_b128 v[40:43], v14 offset:31744
    s_waitcnt lgkmcnt(4)
    v_mfma_f32_16x16x32_bf16 v[60:63], v[140:143], v[44:47], v[60:63]
    v_mfma_f32_16x16x32_bf16 v[64:67], v[140:143], v[48:51], v[64:67]
    ds_read_b128 v[44:47], v14 offset:32768
    ds_read_b128 v[48:51], v14 offset:33792
    s_waitcnt lgkmcnt(4)
    v_mfma_f32_16x16x32_bf16 v[60:63], v[144:147], v[52:55], v[60:63]
    v_mfma_f32_16x16x32_bf16 v[64:67], v[144:147], v[56:59], v[64:67]
    ds_read_b128 v[52:55], v14 offset:34816
    ds_read_b128 v[56:59], v14 offset:35840
    s_waitcnt lgkmcnt(4)
    v_mfma_f32_16x16x32_bf16 v[60:63], v[148:151], v[36:39], v[60:63]
    v_mfma_f32_16x16x32_bf16 v[64:67], v[148:151], v[40:43], v[64:67]
    s_waitcnt lgkmcnt(2)
    v_mfma_f32_16x16x32_bf16 v[60:63], v[152:155], v[44:47], v[60:63]
    v_mfma_f32_16x16x32_bf16 v[64:67], v[152:155], v[48:51], v[64:67]
    s_waitcnt lgkmcnt(0)
    v_mfma_f32_16x16x32_bf16 v[60:63], v[156:159], v[52:55], v[60:63]
    v_mfma_f32_16x16x32_bf16 v[64:67], v[156:159], v[56:59], v[64:67]
    v_lshlrev_b32 v16, 16, v32
    v_and_b32 v17, 0xffff0000, v32
    v_lshlrev_b32 v18, 16, v33
    v_and_b32 v19, 0xffff0000, v33
    v_lshlrev_b32 v20, 16, v34
    v_and_b32 v21, 0xffff0000, v34
    v_lshlrev_b32 v22, 16, v35
    v_and_b32 v23, 0xffff0000, v35
    s_nop 1
    v_add_f32 v16, v16, v60
    v_add_f32 v17, v17, v61
    v_add_f32 v18, v18, v62
    v_add_f32 v19, v19, v63
    v_cvt_pk_bf16_f32 v68, v16, v17
    v_cvt_pk_bf16_f32 v69, v18, v19
    v_add_f32 v20, v20, v64
    v_add_f32 v21, v21, v65
    v_add_f32 v22, v22, v66
    v_add_f32 v23, v23, v67
    v_cvt_pk_bf16_f32 v70, v20, v21
    v_cvt_pk_bf16_f32 v71, v22, v23
    v_and_b32 v12, 1, v3
    v_mul_u32_u24 v12, 248, v12
    v_add_u32 v11, v11, v12
    s_nop 0
    v_permlane16_swap_b32 v68, v70
    v_permlane16_swap_b32 v69, v71
    buffer_store_dwordx4 v[68:71], v11, s[64:67], 0 offen sc1
K3_END:
    s_endpgm
.text
.globl k5_kernel
.p2align 8
.type k5_kernel,@function
k5_kernel:
    s_cmp_ge_u32 s2, 256
    s_cbranch_scc1 K5_END
    s_load_dwordx16 s[16:31], s[0:1], 0
    s_load_dwordx16 s[32:47], s[0:1], 64
    v_lshrrev_b32 v1, 6, v0
    s_nop 0
    v_readfirstlane_b32 s3, v1
    v_and_b32 v1, 63, v0
    s_and_b32 s6, s2, 1
    s_lshl_b32 s6, s6, 2
    s_lshr_b32 s7, s2, 3
    s_and_b32 s4, s7, 3
    s_add_u32 s4, s4, s6
    s_bfe_u32 s6, s2, 0x20001
    s_lshl_b32 s6, s6, 3
    s_lshr_b32 s5, s2, 5
    s_add_u32 s5, s5, s6
    v_and_b32 v2, 15, v1
    v_lshrrev_b32 v3, 4, v1
    s_waitcnt lgkmcnt(0)
    s_add_u32 s48, s46, 21397504
    s_addc_u32 s49, s47, 0
    s_mov_b32 s50, 2359296
    s_mov_b32 s51, 0x20000
    s_add_u32 s52, s46, 6062080
    s_addc_u32 s53, s47, 0
    s_mov_b32 s54, 10616832
    s_mov_b32 s55, 0x20000
    s_add_u32 s56, s46, 26124288
    s_addc_u32 s57, s47, 0
    s_mov_b32 s58, 18874368
    s_mov_b32 s59, 0x20000
    v_lshlrev_b32 v4, 4, v1
    s_lshl_b32 s6, s5, 10
    s_mul_i32 s7, s3, 589824
    s_add_u32 s6, s6, s7
    s_mul_i32 s7, s3, 18432
    s_add_u32 m0, s7, 0
    s_add_u32 s8, s6, 0
    buffer_load_dwordx4 v4, s[48:51], s8 offen lds
    s_add_u32 m0, s7, 1024
    s_add_u32 s8, s6, 32768
    buffer_load_dwordx4 v4, s[48:51], s8 offen lds
    s_add_u32 m0, s7, 2048
    s_add_u32 s8, s6, 65536
    buffer_load_dwordx4 v4, s[48:51], s8 offen lds
    s_add_u32 m0, s7, 3072
    s_add_u32 s8, s6, 98304
    buffer_load_dwordx4 v4, s[48:51], s8 offen lds
    s_add_u32 m0, s7, 4096
    s_add_u32 s8, s6, 131072
    buffer_load_dwordx4 v4, s[48:51], s8 offen lds
    s_add_u32 m0, s7, 5120
    s_add_u32 s8, s6, 163840
    buffer_load_dwordx4 v4, s[48:51], s8 offen lds
    s_add_u32 m0, s7, 6144
    s_add_u32 s8, s6, 196608
    buffer_load_dwordx4 v4, s[48:51], s8 offen lds
    s_add_u32 m0, s7, 7168
    s_add_u32 s8, s6, 229376
    buffer_load_dwordx4 v4, s[48:51], s8 offen lds
    s_add_u32 m0, s7, 8192
    s_add_u32 s8, s6, 262144
    buffer_load_dwordx4 v4, s[48:51], s8 offen lds
    s_add_u32 m0, s7, 9216
    s_add_u32 s8, s6, 294912
    buffer_load_dwordx4 v4, s[48:51], s8 offen lds
    s_add_u32 m0, s7, 10240
    s_add_u32 s8, s6, 327680
    buffer_load_dwordx4 v4, s[48:51], s8 offen lds
    s_add_u32 m0, s7, 11264
    s_add_u32 s8, s6, 360448
    buffer_load_dwordx4 v4, s[48:51], s8 offen lds
    s_add_u32 m0, s7, 12288
    s_add_u32 s8, s6, 393216
    buffer_load_dwordx4 v4, s[48:51], s8 offen lds
    s_add_u32 m0, s7, 13312
    s_add_u32 s8, s6, 425984
    buffer_load_dwordx4 v4, s[48:51], s8 offen lds
    s_add_u32 m0, s7, 14336
    s_add_u32 s8, s6, 458752
    buffer_load_dwordx4 v4, s[48:51], s8 offen lds
    s_add_u32 m0, s7, 15360
    s_add_u32 s8, s6, 491520
    buffer_load_dwordx4 v4, s[48:51], s8 offen lds
    s_add_u32 m0, s7, 16384
    s_add_u32 s8, s6, 524288
    buffer_load_dwordx4 v4, s[48:51], s8 offen lds
    s_add_u32 m0, s7, 17408
    s_add_u32 s8, s6, 557056
    buffer_load_dwordx4 v4, s[48:51], s8 offen lds
    s_lshl_b32 s9, s4, 2
    s_add_u32 s9, s9, s3
    s_mul_i32 s9, s9, 165888
    v_lshlrev_b32 v6, 4, v1
    s_add_u32 s24, s9, 0
    s_add_u32 s25, s9, 3072
    s_add_u32 s26, s9, 6144
    s_add_u32 s27, s9, 9216
    s_add_u32 s28, s9, 12288
    s_add_u32 s29, s9, 15360
    s_add_u32 s30, s9, 18432
    s_add_u32 s31, s9, 21504
    s_add_u32 s32, s9, 24576
    s_add_u32 s33, s9, 27648
    s_add_u32 s9, s9, 30720
    v_lshlrev_b32 v7, 10, v3
    v_lshlrev_b32 v8, 4, v2
    v_add_u32 v7, v7, v8
    v_add_u32 v8, 0x10000, v7
    v_add_u32 v9, 73728, v7
    v_add_u32 v10, 139264, v7
    s_mul_i32 s10, s3, 3
    s_add_u32 s10, s10, 0
    s_lshr_b32 s11, s10, 1
    s_lshl_b32 s11, s11, 12
    s_and_b32 s10, s10, 1
    s_lshl_b32 s10, s10, 3
    s_add_u32 s10, s10, s11
    v_add_u32 v11, s10, v9
    s_mul_i32 s10, s3, 3
    s_add_u32 s10, s10, 1
    s_lshr_b32 s11, s10, 1
    s_lshl_b32 s11, s11, 12
    s_and_b32 s10, s10, 1
    s_lshl_b32 s10, s10, 3
    s_add_u32 s10, s10, s11
    v_add_u32 v12, s10, v9
    s_mul_i32 s10, s3, 3
    s_add_u32 s10, s10, 2
    s_lshr_b32 s11, s10, 1
    s_lshl_b32 s11, s11, 12
    s_and_b32 s10, s10, 1
    s_lshl_b32 s10, s10, 3
    s_add_u32 s10, s10, s11
    v_add_u32 v13, s10, v9
    s_lshl_b32 s10, s4, 5
    s_add_u32 s10, s10, s5
    s_lshl_b32 s10, s10, 2
    s_add_u32 s10, s10, s3
    s_mul_i32 s12, s10, 18432
    s_mov_b32 s70, 0xc0135761
    s_mov_b32 s71, 0xbdd2d3e8
    v_mov_b32 v14, s70
    s_mov_b32 s13, 0x3f803f80
    buffer_load_dwordx4 a[0:3], v6, s[52:55], s24 offen offset:0
    buffer_load_dwordx4 a[4:7], v6, s[52:55], s24 offen offset:1024
    buffer_load_dwordx4 a[8:11], v6, s[52:55], s24 offen offset:2048
    buffer_load_dwordx4 a[12:15], v6, s[52:55], s25 offen offset:0
    buffer_load_dwordx4 a[16:19], v6, s[52:55], s25 offen offset:1024
    buffer_load_dwordx4 a[20:23], v6, s[52:55], s25 offen offset:2048
    buffer_load_dwordx4 a[24:27], v6, s[52:55], s26 offen offset:0
    buffer_load_dwordx4 a[28:31], v6, s[52:55], s26 offen offset:1024
    buffer_load_dwordx4 a[32:35], v6, s[52:55], s26 offen offset:2048
    buffer_load_dwordx4 a[36:39], v6, s[52:55], s27 offen offset:0
    buffer_load_dwordx4 a[40:43], v6, s[52:55], s27 offen offset:1024
    buffer_load_dwordx4 a[44:47], v6, s[52:55], s27 offen offset:2048
    s_lshl_b32 s10, s3, 8
    v_add_u32 v15, s10, v7
    v_add_u32 v5, 0x10000, v15
    v_lshlrev_b32 v4, 4, v2
    v_add_u32 v4, 147456, v4
    v_and_b32 v16, 3, v1
    v_cmp_eq_u32 s[74:75], 1, v16
    v_cmp_eq_u32 s[76:77], 2, v16
    v_cmp_eq_u32 s[78:79], 3, v16
    v_lshrrev_b32 v16, 2, v2
    v_cmp_eq_u32 s[72:73], v16, v3
    v_mov_b32 v24, 0x3f803f80
    v_mov_b32 v25, 0x3f803f80
    v_mov_b32 v26, 0x3f803f80
    v_mov_b32 v27, 0x3f803f80
    s_waitcnt vmcnt(12)
    s_barrier
    ds_read_b128 v[32:35], v7 offset:0
    ds_read_b128 v[36:39], v7 offset:256
    ds_read_b128 v[40:43], v7 offset:512
    ds_read_b128 v[44:47], v7 offset:768
    s_waitcnt vmcnt(9) lgkmcnt(0)
    v_mfma_f32_16x16x32_bf16 v[64:67], a[0:3], v[32:35], 0
    ds_read_b128 v[48:51], v7 offset:4096
    v_mfma_f32_16x16x32_bf16 v[68:71], a[4:7], v[32:35], 0
    ds_read_b128 v[52:55], v7 offset:4352
    v_mfma_f32_16x16x32_bf16 v[72:75], a[8:11], v[32:35], 0
    ds_read_b128 v[56:59], v7 offset:4608
    v_mfma_f32_16x16x32_bf16 v[76:79], a[0:3], v[36:39], 0
    ds_read_b128 v[60:63], v7 offset:4864
    v_mfma_f32_16x16x32_bf16 v[80:83], a[4:7], v[36:39], 0
    buffer_load_dwordx4 a[120:123], v6, s[52:55], s9 offen offset:0
    v_mfma_f32_16x16x32_bf16 v[84:87], a[8:11], v[36:39], 0
    buffer_load_dwordx4 a[48:51], v6, s[52:55], s28 offen offset:0
    buffer_load_dwordx4 a[124:127], v6, s[52:55], s9 offen offset:1024
    v_mfma_f32_16x16x32_bf16 v[88:91], a[0:3], v[40:43], 0
    buffer_load_dwordx4 a[52:55], v6, s[52:55], s28 offen offset:1024
    v_mfma_f32_16x16x32_bf16 v[92:95], a[4:7], v[40:43], 0
    buffer_load_dwordx4 a[128:131], v6, s[52:55], s9 offen offset:2048
    v_mfma_f32_16x16x32_bf16 v[96:99], a[8:11], v[40:43], 0
    buffer_load_dwordx4 a[56:59], v6, s[52:55], s28 offen offset:2048
    v_mfma_f32_16x16x32_bf16 v[100:103], a[0:3], v[44:47], 0
    s_add_u32 s9, s9, 3072
    v_mfma_f32_16x16x32_bf16 v[104:107], a[4:7], v[44:47], 0
    buffer_load_dwordx4 a[60:63], v6, s[52:55], s29 offen offset:0
    v_mfma_f32_16x16x32_bf16 v[108:111], a[8:11], v[44:47], 0
    ds_read_b128 v[16:19], v15 offset:0
    ds_read_b128 v[20:23], v15 offset:4096
    s_waitcnt vmcnt(13) lgkmcnt(2)
    v_mfma_f32_16x16x32_bf16 v[64:67], a[12:15], v[48:51], v[64:67]
    ds_read_b128 v[32:35], v7 offset:8192
    v_mfma_f32_16x16x32_bf16 v[68:71], a[16:19], v[48:51], v[68:71]
    ds_read_b128 v[36:39], v7 offset:8448
    ds_read_b128 v[40:43], v7 offset:8704
    v_mfma_f32_16x16x32_bf16 v[72:75], a[20:23], v[48:51], v[72:75]
    ds_read_b128 v[44:47], v7 offset:8960
    buffer_load_dwordx4 a[0:3], v6, s[52:55], s9 offen offset:0
    v_mfma_f32_16x16x32_bf16 v[76:79], a[12:15], v[52:55], v[76:79]
    buffer_load_dwordx4 a[64:67], v6, s[52:55], s29 offen offset:1024
    buffer_load_dwordx4 a[68:71], v6, s[52:55], s29 offen offset:2048
    v_mfma_f32_16x16x32_bf16 v[80:83], a[16:19], v[52:55], v[80:83]
    buffer_load_dwordx4 a[72:75], v6, s[52:55], s30 offen offset:0
    v_mfma_f32_16x16x32_bf16 v[84:87], a[20:23], v[52:55], v[84:87]
    buffer_load_dwordx4 a[4:7], v6, s[52:55], s9 offen offset:1024
    buffer_load_dwordx4 a[76:79], v6, s[52:55], s30 offen offset:1024
    v_mfma_f32_16x16x32_bf16 v[88:91], a[12:15], v[56:59], v[88:91]
    buffer_load_dwordx4 a[80:83], v6, s[52:55], s30 offen offset:2048
    s_waitcnt lgkmcnt(5)
    v_mfma_f32_16x16x32_bf16 v[92:95], a[16:19], v[56:59], v[92:95]
    buffer_load_dwordx4 a[8:11], v6, s[52:55], s9 offen offset:2048
    v_mfma_f32_16x16x32_bf16 v[208:211], v[24:27], v[16:19], 0
    v_mfma_f32_16x16x32_bf16 v[96:99], a[20:23], v[56:59], v[96:99]
    v_mfma_f32_16x16x32_bf16 v[212:215], v[16:19], v[16:19], 0
    v_mfma_f32_16x16x32_bf16 v[100:103], a[12:15], v[60:63], v[100:103]
    ds_read_b128 v[16:19], v15 offset:8192
    s_add_u32 s9, s9, 3072
    v_mfma_f32_16x16x32_bf16 v[104:107], a[16:19], v[60:63], v[104:107]
    s_waitcnt lgkmcnt(5)
    v_mfma_f32_16x16x32_bf16 v[208:211], v[24:27], v[20:23], v[208:211]
    v_mfma_f32_16x16x32_bf16 v[108:111], a[20:23], v[60:63], v[108:111]
    v_mfma_f32_16x16x32_bf16 v[212:215], v[20:23], v[20:23], v[212:215]
    ds_read_b128 v[20:23], v15 offset:12288
    s_waitcnt vmcnt(18) lgkmcnt(2)
    v_mfma_f32_16x16x32_bf16 v[64:67], a[24:27], v[32:35], v[64:67]
    ds_read_b128 v[48:51], v7 offset:12288
    v_mfma_f32_16x16x32_bf16 v[68:71], a[28:31], v[32:35], v[68:71]
    ds_read_b128 v[52:55], v7 offset:12544
    ds_read_b128 v[56:59], v7 offset:12800
    v_mfma_f32_16x16x32_bf16 v[72:75], a[32:35], v[32:35], v[72:75]
    ds_read_b128 v[60:63], v7 offset:13056
    buffer_load_dwordx4 a[12:15], v6, s[52:55], s9 offen offset:0
    v_mfma_f32_16x16x32_bf16 v[76:79], a[24:27], v[36:39], v[76:79]
    buffer_load_dwordx4 a[84:87], v6, s[52:55], s31 offen offset:0
    v_mfma_f32_16x16x32_bf16 v[80:83], a[28:31], v[36:39], v[80:83]
    buffer_load_dwordx4 a[88:91], v6, s[52:55], s31 offen offset:1024
    buffer_load_dwordx4 a[92:95], v6, s[52:55], s31 offen offset:2048
    v_mfma_f32_16x16x32_bf16 v[84:87], a[32:35], v[36:39], v[84:87]
    buffer_load_dwordx4 a[16:19], v6, s[52:55], s9 offen offset:1024
    buffer_load_dwordx4 a[96:99], v6, s[52:55], s32 offen offset:0
    v_mfma_f32_16x16x32_bf16 v[88:91], a[24:27], v[40:43], v[88:91]
    s_waitcnt lgkmcnt(5)
    v_mfma_f32_16x16x32_bf16 v[92:95], a[28:31], v[40:43], v[92:95]
    v_mfma_f32_16x16x32_bf16 v[208:211], v[24:27], v[16:19], v[208:211]
    buffer_load_dwordx4 a[20:23], v6, s[52:55], s9 offen offset:2048
    v_mfma_f32_16x16x32_bf16 v[96:99], a[32:35], v[40:43], v[96:99]
    v_mfma_f32_16x16x32_bf16 v[212:215], v[16:19], v[16:19], v[212:215]
    ds_read_b128 v[16:19], v15 offset:16384
    v_mfma_f32_16x16x32_bf16 v[100:103], a[24:27], v[44:47], v[100:103]
    s_waitcnt lgkmcnt(5)
    v_mfma_f32_16x16x32_bf16 v[104:107], a[28:31], v[44:47], v[104:107]
    s_add_u32 s9, s9, 3072
    v_mfma_f32_16x16x32_bf16 v[208:211], v[24:27], v[20:23], v[208:211]
    v_mfma_f32_16x16x32_bf16 v[108:111], a[32:35], v[44:47], v[108:111]
    v_mfma_f32_16x16x32_bf16 v[212:215], v[20:23], v[20:23], v[212:215]
    ds_read_b128 v[20:23], v15 offset:20480
    s_waitcnt vmcnt(22) lgkmcnt(2)
    v_mfma_f32_16x16x32_bf16 v[64:67], a[36:39], v[48:51], v[64:67]
    ds_read_b128 v[32:35], v7 offset:16384
    v_mfma_f32_16x16x32_bf16 v[68:71], a[40:43], v[48:51], v[68:71]
    ds_read_b128 v[36:39], v7 offset:16640
    ds_read_b128 v[40:43], v7 offset:16896
    v_mfma_f32_16x16x32_bf16 v[72:75], a[44:47], v[48:51], v[72:75]
    ds_read_b128 v[44:47], v7 offset:17152
    buffer_load_dwordx4 a[24:27], v6, s[52:55], s9 offen offset:0
    v_mfma_f32_16x16x32_bf16 v[76:79], a[36:39], v[52:55], v[76:79]
    buffer_load_dwordx4 a[100:103], v6, s[52:55], s32 offen offset:1024
    buffer_load_dwordx4 a[104:107], v6, s[52:55], s32 offen offset:2048
    v_mfma_f32_16x16x32_bf16 v[80:83], a[40:43], v[52:55], v[80:83]
    buffer_load_dwordx4 a[108:111], v6, s[52:55], s33 offen offset:0
    v_mfma_f32_16x16x32_bf16 v[84:87], a[44:47], v[52:55], v[84:87]
    buffer_load_dwordx4 a[28:31], v6, s[52:55], s9 offen offset:1024
    buffer_load_dwordx4 a[112:115], v6, s[52:55], s33 offen offset:1024
    v_mfma_f32_16x16x32_bf16 v[88:91], a[36:39], v[56:59], v[88:91]
    buffer_load_dwordx4 a[116:119], v6, s[52:55], s33 offen offset:2048
    s_waitcnt lgkmcnt(5)
    v_mfma_f32_16x16x32_bf16 v[92:95], a[40:43], v[56:59], v[92:95]
    buffer_load_dwordx4 a[32:35], v6, s[52:55], s9 offen offset:2048
    v_mfma_f32_16x16x32_bf16 v[208:211], v[24:27], v[16:19], v[208:211]
    v_mfma_f32_16x16x32_bf16 v[96:99], a[44:47], v[56:59], v[96:99]
    v_mfma_f32_16x16x32_bf16 v[212:215], v[16:19], v[16:19], v[212:215]
    v_mfma_f32_16x16x32_bf16 v[100:103], a[36:39], v[60:63], v[100:103]
    ds_read_b128 v[16:19], v15 offset:24576
    s_add_u32 s9, s9, 3072
    v_mfma_f32_16x16x32_bf16 v[104:107], a[40:43], v[60:63], v[104:107]
    s_waitcnt lgkmcnt(5)
    v_mfma_f32_16x16x32_bf16 v[208:211], v[24:27], v[20:23], v[208:211]
    v_mfma_f32_16x16x32_bf16 v[108:111], a[44:47], v[60:63], v[108:111]
    v_mfma_f32_16x16x32_bf16 v[212:215], v[20:23], v[20:23], v[212:215]
    ds_read_b128 v[20:23], v15 offset:28672
    s_waitcnt vmcnt(24) lgkmcnt(2)
    v_mfma_f32_16x16x32_bf16 v[64:67], a[48:51], v[32:35], v[64:67]
    ds_read_b128 v[48:51], v7 offset:20480
    v_mfma_f32_16x16x32_bf16 v[68:71], a[52:55], v[32:35], v[68:71]
    ds_read_b128 v[52:55], v7 offset:20736
    v_mfma_f32_16x16x32_bf16 v[72:75], a[56:59], v[32:35], v[72:75]
    ds_read_b128 v[56:59], v7 offset:20992
    ds_read_b128 v[60:63], v7 offset:21248
    v_mfma_f32_16x16x32_bf16 v[76:79], a[48:51], v[36:39], v[76:79]
    buffer_load_dwordx4 a[36:39], v6, s[52:55], s9 offen offset:0
    v_mfma_f32_16x16x32_bf16 v[80:83], a[52:55], v[36:39], v[80:83]
    s_waitcnt lgkmcnt(5)
    v_mfma_f32_16x16x32_bf16 v[84:87], a[56:59], v[36:39], v[84:87]
    v_mfma_f32_16x16x32_bf16 v[208:211], v[24:27], v[16:19], v[208:211]
    buffer_load_dwordx4 a[40:43], v6, s[52:55], s9 offen offset:1024
    v_mfma_f32_16x16x32_bf16 v[88:91], a[48:51], v[40:43], v[88:91]
    v_mfma_f32_16x16x32_bf16 v[212:215], v[16:19], v[16:19], v[212:215]
    v_mfma_f32_16x16x32_bf16 v[92:95], a[52:55], v[40:43], v[92:95]
    ds_read_b128 v[16:19], v15 offset:32768
    v_mfma_f32_16x16x32_bf16 v[96:99], a[56:59], v[40:43], v[96:99]
    buffer_load_dwordx4 a[44:47], v6, s[52:55], s9 offen offset:2048
    s_waitcnt lgkmcnt(5)
    v_mfma_f32_16x16x32_bf16 v[100:103], a[48:51], v[44:47], v[100:103]
    v_mfma_f32_16x16x32_bf16 v[208:211], v[24:27], v[20:23], v[208:211]
    v_mfma_f32_16x16x32_bf16 v[104:107], a[52:55], v[44:47], v[104:107]
    s_add_u32 s9, s9, 3072
    v_mfma_f32_16x16x32_bf16 v[108:111], a[56:59], v[44:47], v[108:111]
    v_mfma_f32_16x16x32_bf16 v[212:215], v[20:23], v[20:23], v[212:215]
    ds_read_b128 v[20:23], v15 offset:36864
    s_waitcnt vmcnt(23) lgkmcnt(2)
    v_mfma_f32_16x16x32_bf16 v[64:67], a[60:63], v[48:51], v[64:67]
    ds_read_b128 v[32:35], v7 offset:24576
    v_mfma_f32_16x16x32_bf16 v[68:71], a[64:67], v[48:51], v[68:71]
    ds_read_b128 v[36:39], v7 offset:24832
    v_mfma_f32_16x16x32_bf16 v[72:75], a[68:71], v[48:51], v[72:75]
    ds_read_b128 v[40:43], v7 offset:25088
    ds_read_b128 v[44:47], v7 offset:25344
    v_mfma_f32_16x16x32_bf16 v[76:79], a[60:63], v[52:55], v[76:79]
    buffer_load_dwordx4 a[48:51], v6, s[52:55], s9 offen offset:0
    v_mfma_f32_16x16x32_bf16 v[80:83], a[64:67], v[52:55], v[80:83]
    s_waitcnt lgkmcnt(5)
    v_mfma_f32_16x16x32_bf16 v[84:87], a[68:71], v[52:55], v[84:87]
    v_mfma_f32_16x16x32_bf16 v[208:211], v[24:27], v[16:19], v[208:211]
    buffer_load_dwordx4 a[52:55], v6, s[52:55], s9 offen offset:1024
    v_mfma_f32_16x16x32_bf16 v[88:91], a[60:63], v[56:59], v[88:91]
    v_mfma_f32_16x16x32_bf16 v[212:215], v[16:19], v[16:19], v[212:215]
    v_mfma_f32_16x16x32_bf16 v[92:95], a[64:67], v[56:59], v[92:95]
    ds_read_b128 v[16:19], v15 offset:40960
    v_mfma_f32_16x16x32_bf16 v[96:99], a[68:71], v[56:59], v[96:99]
    buffer_load_dwordx4 a[56:59], v6, s[52:55], s9 offen offset:2048
    s_waitcnt lgkmcnt(5)
    v_mfma_f32_16x16x32_bf16 v[100:103], a[60:63], v[60:63], v[100:103]
    v_mfma_f32_16x16x32_bf16 v[208:211], v[24:27], v[20:23], v[208:211]
    v_mfma_f32_16x16x32_bf16 v[104:107], a[64:67], v[60:63], v[104:107]
    s_add_u32 s9, s9, 3072
    v_mfma_f32_16x16x32_bf16 v[108:111], a[68:71], v[60:63], v[108:111]
    v_mfma_f32_16x16x32_bf16 v[212:215], v[20:23], v[20:23], v[212:215]
    ds_read_b128 v[20:23], v15 offset:45056
    s_waitcnt vmcnt(22) lgkmcnt(2)
    v_mfma_f32_16x16x32_bf16 v[64:67], a[72:75], v[32:35], v[64:67]
    ds_read_b128 v[48:51], v7 offset:28672
    v_mfma_f32_16x16x32_bf16 v[68:71], a[76:79], v[32:35], v[68:71]
    ds_read_b128 v[52:55], v7 offset:28928
    v_mfma_f32_16x16x32_bf16 v[72:75], a[80:83], v[32:35], v[72:75]
    ds_read_b128 v[56:59], v7 offset:29184
    ds_read_b128 v[60:63], v7 offset:29440
    v_mfma_f32_16x16x32_bf16 v[76:79], a[72:75], v[36:39], v[76:79]
    buffer_load_dwordx4 a[60:63], v6, s[52:55], s9 offen offset:0
    v_mfma_f32_16x16x32_bf16 v[80:83], a[76:79], v[36:39], v[80:83]
    s_waitcnt lgkmcnt(5)
    v_mfma_f32_16x16x32_bf16 v[84:87], a[80:83], v[36:39], v[84:87]
    v_mfma_f32_16x16x32_bf16 v[208:211], v[24:27], v[16:19], v[208:211]
    buffer_load_dwordx4 a[64:67], v6, s[52:55], s9 offen offset:1024
    v_mfma_f32_16x16x32_bf16 v[88:91], a[72:75], v[40:43], v[88:91]
    v_mfma_f32_16x16x32_bf16 v[212:215], v[16:19], v[16:19], v[212:215]
    v_mfma_f32_16x16x32_bf16 v[92:95], a[76:79], v[40:43], v[92:95]
    ds_read_b128 v[16:19], v15 offset:49152
    v_mfma_f32_16x16x32_bf16 v[96:99], a[80:83], v[40:43], v[96:99]
    buffer_load_dwordx4 a[68:71], v6, s[52:55], s9 offen offset:2048
    s_waitcnt lgkmcnt(5)
    v_mfma_f32_16x16x32_bf16 v[100:103], a[72:75], v[44:47], v[100:103]
    v_mfma_f32_16x16x32_bf16 v[208:211], v[24:27], v[20:23], v[208:211]
    v_mfma_f32_16x16x32_bf16 v[104:107], a[76:79], v[44:47], v[104:107]
    s_add_u32 s9, s9, 3072
    v_mfma_f32_16x16x32_bf16 v[108:111], a[80:83], v[44:47], v[108:111]
    v_mfma_f32_16x16x32_bf16 v[212:215], v[20:23], v[20:23], v[212:215]
    ds_read_b128 v[20:23], v15 offset:53248
    s_waitcnt vmcnt(20) lgkmcnt(2)
    v_mfma_f32_16x16x32_bf16 v[64:67], a[84:87], v[48:51], v[64:67]
    ds_read_b128 v[32:35], v7 offset:32768
    v_mfma_f32_16x16x32_bf16 v[68:71], a[88:91], v[48:51], v[68:71]
    ds_read_b128 v[36:39], v7 offset:33024
    v_mfma_f32_16x16x32_bf16 v[72:75], a[92:95], v[48:51], v[72:75]
    ds_read_b128 v[40:43], v7 offset:33280
    ds_read_b128 v[44:47], v7 offset:33536
    v_mfma_f32_16x16x32_bf16 v[76:79], a[84:87], v[52:55], v[76:79]
    buffer_load_dwordx4 a[72:75], v6, s[52:55], s9 offen offset:0
    v_mfma_f32_16x16x32_bf16 v[80:83], a[88:91], v[52:55], v[80:83]
    s_waitcnt lgkmcnt(5)
    v_mfma_f32_16x16x32_bf16 v[84:87], a[92:95], v[52:55], v[84:87]
    v_mfma_f32_16x16x32_bf16 v[208:211], v[24:27], v[16:19], v[208:211]
    buffer_load_dwordx4 a[76:79], v6, s[52:55], s9 offen offset:1024
    v_mfma_f32_16x16x32_bf16 v[88:91], a[84:87], v[56:59], v[88:91]
    v_mfma_f32_16x16x32_bf16 v[212:215], v[16:19], v[16:19], v[212:215]
    v_mfma_f32_16x16x32_bf16 v[92:95], a[88:91], v[56:59], v[92:95]
    ds_read_b128 v[16:19], v15 offset:57344
    v_mfma_f32_16x16x32_bf16 v[96:99], a[92:95], v[56:59], v[96:99]
    buffer_load_dwordx4 a[80:83], v6, s[52:55], s9 offen offset:2048
    s_waitcnt lgkmcnt(5)
    v_mfma_f32_16x16x32_bf16 v[100:103], a[84:87], v[60:63], v[100:103]
    v_mfma_f32_16x16x32_bf16 v[208:211], v[24:27], v[20:23], v[208:211]
    v_mfma_f32_16x16x32_bf16 v[104:107], a[88:91], v[60:63], v[104:107]
    s_add_u32 s9, s9, 3072
    v_mfma_f32_16x16x32_bf16 v[108:111], a[92:95], v[60:63], v[108:111]
    v_mfma_f32_16x16x32_bf16 v[212:215], v[20:23], v[20:23], v[212:215]
    ds_read_b128 v[20:23], v15 offset:61440
    s_waitcnt vmcnt(17) lgkmcnt(2)
    v_mfma_f32_16x16x32_bf16 v[64:67], a[96:99], v[32:35], v[64:67]
    ds_read_b128 v[48:51], v7 offset:36864
    v_mfma_f32_16x16x32_bf16 v[68:71], a[100:103], v[32:35], v[68:71]
    ds_read_b128 v[52:55], v7 offset:37120
    v_mfma_f32_16x16x32_bf16 v[72:75], a[104:107], v[32:35], v[72:75]
    ds_read_b128 v[56:59], v7 offset:37376
    ds_read_b128 v[60:63], v7 offset:37632
    v_mfma_f32_16x16x32_bf16 v[76:79], a[96:99], v[36:39], v[76:79]
    buffer_load_dwordx4 a[84:87], v6, s[52:55], s9 offen offset:0
    v_mfma_f32_16x16x32_bf16 v[80:83], a[100:103], v[36:39], v[80:83]
    s_waitcnt lgkmcnt(5)
    v_mfma_f32_16x16x32_bf16 v[84:87], a[104:107], v[36:39], v[84:87]
    v_mfma_f32_16x16x32_bf16 v[208:211], v[24:27], v[16:19], v[208:211]
    buffer_load_dwordx4 a[88:91], v6, s[52:55], s9 offen offset:1024
    v_mfma_f32_16x16x32_bf16 v[88:91], a[96:99], v[40:43], v[88:91]
    v_mfma_f32_16x16x32_bf16 v[212:215], v[16:19], v[16:19], v[212:215]
    v_mfma_f32_16x16x32_bf16 v[92:95], a[100:103], v[40:43], v[92:95]
    ds_read_b128 v[16:19], v5 offset:0
    v_mfma_f32_16x16x32_bf16 v[96:99], a[104:107], v[40:43], v[96:99]
    buffer_load_dwordx4 a[92:95], v6, s[52:55], s9 offen offset:2048
    s_waitcnt lgkmcnt(5)
    v_mfma_f32_16x16x32_bf16 v[100:103], a[96:99], v[44:47], v[100:103]
    v_mfma_f32_16x16x32_bf16 v[208:211], v[24:27], v[20:23], v[208:211]
    v_mfma_f32_16x16x32_bf16 v[104:107], a[100:103], v[44:47], v[104:107]
    s_add_u32 s9, s9, 3072
    v_mfma_f32_16x16x32_bf16 v[108:111], a[104:107], v[44:47], v[108:111]
    v_mfma_f32_16x16x32_bf16 v[212:215], v[20:23], v[20:23], v[212:215]
    ds_read_b128 v[20:23], v5 offset:4096
    s_waitcnt vmcnt(16) lgkmcnt(2)
    v_mfma_f32_16x16x32_bf16 v[64:67], a[108:111], v[48:51], v[64:67]
    ds_read_b128 v[32:35], v7 offset:40960
    v_mfma_f32_16x16x32_bf16 v[68:71], a[112:115], v[48:51], v[68:71]
    ds_read_b128 v[36:39], v7 offset:41216
    v_mfma_f32_16x16x32_bf16 v[72:75], a[116:119], v[48:51], v[72:75]
    ds_read_b128 v[40:43], v7 offset:41472
    v_mfma_f32_16x16x32_bf16 v[76:79], a[108:111], v[52:55], v[76:79]
    ds_read_b128 v[44:47], v7 offset:41728
    v_mfma_f32_16x16x32_bf16 v[80:83], a[112:115], v[52:55], v[80:83]
    buffer_load_dwordx4 a[96:99], v6, s[52:55], s9 offen offset:0
    v_mfma_f32_16x16x32_bf16 v[84:87], a[116:119], v[52:55], v[84:87]
    s_waitcnt lgkmcnt(5)
    buffer_load_dwordx4 a[100:103], v6, s[52:55], s9 offen offset:1024
    v_mfma_f32_16x16x32_bf16 v[88:91], a[108:111], v[56:59], v[88:91]
    v_mfma_f32_16x16x32_bf16 v[208:211], v[24:27], v[16:19], v[208:211]
    v_mfma_f32_16x16x32_bf16 v[92:95], a[112:115], v[56:59], v[92:95]
    buffer_load_dwordx4 a[104:107], v6, s[52:55], s9 offen offset:2048
    v_mfma_f32_16x16x32_bf16 v[96:99], a[116:119], v[56:59], v[96:99]
    v_mfma_f32_16x16x32_bf16 v[212:215], v[16:19], v[16:19], v[212:215]
    v_mfma_f32_16x16x32_bf16 v[100:103], a[108:111], v[60:63], v[100:103]
    s_add_u32 s9, s9, 3072
    v_mfma_f32_16x16x32_bf16 v[104:107], a[112:115], v[60:63], v[104:107]
    s_waitcnt lgkmcnt(4)
    v_mfma_f32_16x16x32_bf16 v[108:111], a[116:119], v[60:63], v[108:111]
    v_mfma_f32_16x16x32_bf16 v[208:211], v[24:27], v[20:23], v[208:211]
    v_mfma_f32_16x16x32_bf16 v[212:215], v[20:23], v[20:23], v[212:215]
    s_waitcnt lgkmcnt(0)
    v_mfma_f32_16x16x32_bf16 v[64:67], a[120:123], v[32:35], v[64:67]
    v_mfma_f32_16x16x32_bf16 v[68:71], a[124:127], v[32:35], v[68:71]
    ds_read_b128 v[48:51], v7 offset:45056
    v_mfma_f32_16x16x32_bf16 v[72:75], a[128:131], v[32:35], v[72:75]
    ds_read_b128 v[52:55], v7 offset:45312
    v_mfma_f32_16x16x32_bf16 v[76:79], a[120:123], v[36:39], v[76:79]
    v_mfma_f32_16x16x32_bf16 v[80:83], a[124:127], v[36:39], v[80:83]
    ds_read_b128 v[56:59], v7 offset:45568
    v_mfma_f32_16x16x32_bf16 v[84:87], a[128:131], v[36:39], v[84:87]
    ds_read_b128 v[60:63], v7 offset:45824
    v_mfma_f32_16x16x32_bf16 v[88:91], a[120:123], v[40:43], v[88:91]
    v_mfma_f32_16x16x32_bf16 v[92:95], a[124:127], v[40:43], v[92:95]
    buffer_load_dwordx4 a[108:111], v6, s[52:55], s9 offen offset:0
    v_mfma_f32_16x16x32_bf16 v[96:99], a[128:131], v[40:43], v[96:99]
    buffer_load_dwordx4 a[112:115], v6, s[52:55], s9 offen offset:1024
    v_mfma_f32_16x16x32_bf16 v[100:103], a[120:123], v[44:47], v[100:103]
    v_mfma_f32_16x16x32_bf16 v[104:107], a[124:127], v[44:47], v[104:107]
    buffer_load_dwordx4 a[116:119], v6, s[52:55], s9 offen offset:2048
    v_mfma_f32_16x16x32_bf16 v[108:111], a[128:131], v[44:47], v[108:111]
    s_add_u32 s9, s9, 3072
    s_waitcnt lgkmcnt(0)
    v_mfma_f32_16x16x32_bf16 v[64:67], a[0:3], v[48:51], v[64:67]
    ds_read_b128 v[32:35], v7 offset:49152
    v_mfma_f32_16x16x32_bf16 v[68:71], a[4:7], v[48:51], v[68:71]
    ds_read_b128 v[36:39], v7 offset:49408
    ds_read_b128 v[40:43], v7 offset:49664
    v_mfma_f32_16x16x32_bf16 v[72:75], a[8:11], v[48:51], v[72:75]
    ds_read_b128 v[44:47], v7 offset:49920
    buffer_load_dwordx4 a[120:123], v6, s[52:55], s9 offen offset:0
    v_mfma_f32_16x16x32_bf16 v[76:79], a[0:3], v[52:55], v[76:79]
    v_cndmask_b32 v16, v212, v213, s[74:75]
    v_cndmask_b32 v16, v16, v214, s[76:77]
    v_mfma_f32_16x16x32_bf16 v[80:83], a[4:7], v[52:55], v[80:83]
    v_cndmask_b32 v16, v16, v215, s[78:79]
    buffer_load_dwordx4 a[124:127], v6, s[52:55], s9 offen offset:1024
    v_mfma_f32_16x16x32_bf16 v[84:87], a[8:11], v[52:55], v[84:87]
    v_cndmask_b32 v18, 0, v16, s[72:73]
    v_mov_b32 v19, v18
    v_mfma_f32_16x16x32_bf16 v[88:91], a[0:3], v[56:59], v[88:91]
    s_nop 1
    v_mfma_f32_16x16x32_bf16 v[92:95], a[4:7], v[56:59], v[92:95]
    buffer_load_dwordx4 a[128:131], v6, s[52:55], s9 offen offset:2048
    v_permlane16_swap_b32 v18, v19
    v_mfma_f32_16x16x32_bf16 v[96:99], a[8:11], v[56:59], v[96:99]
    s_nop 1
    v_add_f32 v18, v18, v19
    v_mfma_f32_16x16x32_bf16 v[100:103], a[0:3], v[60:63], v[100:103]
    s_add_u32 s9, s9, 3072
    v_mov_b32 v19, v18
    v_mfma_f32_16x16x32_bf16 v[104:107], a[4:7], v[60:63], v[104:107]
    s_nop 1
    v_permlane32_swap_b32 v18, v19
    v_mfma_f32_16x16x32_bf16 v[108:111], a[8:11], v[60:63], v[108:111]
    s_nop 1
    v_add_f32 v18, v18, v19
    s_waitcnt lgkmcnt(0)
    v_mfma_f32_16x16x32_bf16 v[64:67], a[12:15], v[32:35], v[64:67]
    ds_read_b128 v[48:51], v7 offset:53248
    v_mfma_f32_16x16x32_bf16 v[68:71], a[16:19], v[32:35], v[68:71]
    ds_read_b128 v[52:55], v7 offset:53504
    ds_read_b128 v[56:59], v7 offset:53760
    v_mfma_f32_16x16x32_bf16 v[72:75], a[20:23], v[32:35], v[72:75]
    ds_read_b128 v[60:63], v7 offset:54016
    buffer_load_dwordx4 a[0:3], v6, s[52:55], s9 offen offset:0
    v_mfma_f32_16x16x32_bf16 v[76:79], a[12:15], v[36:39], v[76:79]
    v_mov_b32 v16, v208
    v_mul_f32 v16, 0x3ae38e39, v16
    v_mfma_f32_16x16x32_bf16 v[80:83], a[16:19], v[36:39], v[80:83]
    v_mul_f32 v18, 0x3ae38e39, v18
    buffer_load_dwordx4 a[4:7], v6, s[52:55], s9 offen offset:1024
    v_mfma_f32_16x16x32_bf16 v[84:87], a[20:23], v[36:39], v[84:87]
    v_fma_f32 v18, -v16, v16, v18
    v_max_f32 v18, 0, v18
    v_mfma_f32_16x16x32_bf16 v[88:91], a[12:15], v[40:43], v[88:91]
    v_add_f32 v18, 0x3727c5ac, v18
    v_mfma_f32_16x16x32_bf16 v[92:95], a[16:19], v[40:43], v[92:95]
    buffer_load_dwordx4 a[8:11], v6, s[52:55], s9 offen offset:2048
    v_rsq_f32 v18, v18
    v_mfma_f32_16x16x32_bf16 v[96:99], a[20:23], v[40:43], v[96:99]
    s_nop 0
    v_mul_f32 v20, s70, v18
    v_mfma_f32_16x16x32_bf16 v[100:103], a[12:15], v[44:47], v[100:103]
    s_add_u32 s9, s9, 3072
    v_mul_f32 v21, v18, v18
    v_mfma_f32_16x16x32_bf16 v[104:107], a[16:19], v[44:47], v[104:107]
    v_mul_f32 v21, v21, v18
    v_mul_f32 v21, s71, v21
    v_mfma_f32_16x16x32_bf16 v[108:111], a[20:23], v[44:47], v[108:111]
    v_sub_f32 v22, 0, v16
    v_mov_b32 v23, v18
    s_waitcnt vmcnt(27) lgkmcnt(0)
    v_mfma_f32_16x16x32_bf16 v[64:67], a[24:27], v[48:51], v[64:67]
    v_mfma_f32_16x16x32_bf16 v[68:71], a[28:31], v[48:51], v[68:71]
    ds_read_b128 v[32:35], v7 offset:57344
    v_mfma_f32_16x16x32_bf16 v[72:75], a[32:35], v[48:51], v[72:75]
    ds_read_b128 v[36:39], v7 offset:57600
    v_mfma_f32_16x16x32_bf16 v[76:79], a[24:27], v[52:55], v[76:79]
    ds_read_b128 v[40:43], v7 offset:57856
    v_mfma_f32_16x16x32_bf16 v[80:83], a[28:31], v[52:55], v[80:83]
    v_mfma_f32_16x16x32_bf16 v[84:87], a[32:35], v[52:55], v[84:87]
    ds_read_b128 v[44:47], v7 offset:58112
    v_mfma_f32_16x16x32_bf16 v[88:91], a[24:27], v[56:59], v[88:91]
    buffer_load_dwordx4 a[12:15], v6, s[52:55], s9 offen offset:0
    v_mfma_f32_16x16x32_bf16 v[92:95], a[28:31], v[56:59], v[92:95]
    s_lshl_b32 s10, s3, 8
    v_add_u32 v28, s10, v4
    ds_write_b128 v28, v[20:23]
    v_mfma_f32_16x16x32_bf16 v[96:99], a[32:35], v[56:59], v[96:99]
    v_mfma_f32_16x16x32_bf16 v[100:103], a[24:27], v[60:63], v[100:103]
    buffer_load_dwordx4 a[16:19], v6, s[52:55], s9 offen offset:1024
    v_mfma_f32_16x16x32_bf16 v[104:107], a[28:31], v[60:63], v[104:107]
    buffer_load_dwordx4 a[20:23], v6, s[52:55], s9 offen offset:2048
    v_mfma_f32_16x16x32_bf16 v[108:111], a[32:35], v[60:63], v[108:111]
    s_add_u32 s9, s9, 3072
    s_waitcnt lgkmcnt(0)
    s_barrier
    s_waitcnt vmcnt(27)
    v_mfma_f32_16x16x32_bf16 v[64:67], a[36:39], v[32:35], v[64:67]
    ds_read_b128 v[48:51], v7 offset:61440
    v_mfma_f32_16x16x32_bf16 v[68:71], a[40:43], v[32:35], v[68:71]
    ds_read_b128 v[52:55], v7 offset:61696
    v_mfma_f32_16x16x32_bf16 v[72:75], a[44:47], v[32:35], v[72:75]
    ds_read_b128 v[56:59], v7 offset:61952
    v_mfma_f32_16x16x32_bf16 v[76:79], a[36:39], v[36:39], v[76:79]
    ds_read_b128 v[60:63], v7 offset:62208
    v_mfma_f32_16x16x32_bf16 v[80:83], a[40:43], v[36:39], v[80:83]
    buffer_load_dwordx4 a[24:27], v6, s[52:55], s9 offen offset:0
    v_mfma_f32_16x16x32_bf16 v[84:87], a[44:47], v[36:39], v[84:87]
    ds_read_b64 v[244:245], v4 offset:0
    v_mfma_f32_16x16x32_bf16 v[88:91], a[36:39], v[40:43], v[88:91]
    buffer_load_dwordx4 a[28:31], v6, s[52:55], s9 offen offset:1024
    v_mfma_f32_16x16x32_bf16 v[92:95], a[40:43], v[40:43], v[92:95]
    ds_read_b64 v[246:247], v4 offset:256
    v_mfma_f32_16x16x32_bf16 v[96:99], a[44:47], v[40:43], v[96:99]
    buffer_load_dwordx4 a[32:35], v6, s[52:55], s9 offen offset:2048
    v_mfma_f32_16x16x32_bf16 v[100:103], a[36:39], v[44:47], v[100:103]
    ds_read_b64 v[248:249], v4 offset:512
    v_mfma_f32_16x16x32_bf16 v[104:107], a[40:43], v[44:47], v[104:107]
    s_add_u32 s9, s9, 3072
    v_mfma_f32_16x16x32_bf16 v[108:111], a[44:47], v[44:47], v[108:111]
    ds_read_b64 v[250:251], v4 offset:768
    s_waitcnt vmcnt(27) lgkmcnt(4)
    v_mfma_f32_16x16x32_bf16 v[64:67], a[48:51], v[48:51], v[64:67]
    v_mfma_f32_16x16x32_bf16 v[68:71], a[52:55], v[48:51], v[68:71]
    ds_read_b128 v[32:35], v8 offset:0
    v_mfma_f32_16x16x32_bf16 v[72:75], a[56:59], v[48:51], v[72:75]
    ds_read_b128 v[36:39], v8 offset:256
    v_mfma_f32_16x16x32_bf16 v[76:79], a[48:51], v[52:55], v[76:79]
    v_mfma_f32_16x16x32_bf16 v[80:83], a[52:55], v[52:55], v[80:83]
    ds_read_b128 v[40:43], v8 offset:512
    v_mfma_f32_16x16x32_bf16 v[84:87], a[56:59], v[52:55], v[84:87]
    ds_read_b128 v[44:47], v8 offset:768
    v_mfma_f32_16x16x32_bf16 v[88:91], a[48:51], v[56:59], v[88:91]
    v_mfma_f32_16x16x32_bf16 v[92:95], a[52:55], v[56:59], v[92:95]
    buffer_load_dwordx4 a[36:39], v6, s[52:55], s9 offen offset:0
    v_mfma_f32_16x16x32_bf16 v[96:99], a[56:59], v[56:59], v[96:99]
    buffer_load_dwordx4 a[40:43], v6, s[52:55], s9 offen offset:1024
    v_mfma_f32_16x16x32_bf16 v[100:103], a[48:51], v[60:63], v[100:103]
    v_mfma_f32_16x16x32_bf16 v[104:107], a[52:55], v[60:63], v[104:107]
    buffer_load_dwordx4 a[44:47], v6, s[52:55], s9 offen offset:2048
    v_mfma_f32_16x16x32_bf16 v[108:111], a[56:59], v[60:63], v[108:111]
    s_add_u32 s9, s9, 3072
    s_waitcnt vmcnt(27) lgkmcnt(0)
    v_mfma_f32_16x16x32_bf16 v[64:67], a[60:63], v[32:35], v[64:67]
    v_mfma_f32_16x16x32_bf16 v[68:71], a[64:67], v[32:35], v[68:71]
    ds_read_b128 v[48:51], v8 offset:4096
    v_mfma_f32_16x16x32_bf16 v[72:75], a[68:71], v[32:35], v[72:75]
    ds_read_b128 v[52:55], v8 offset:4352
    v_mfma_f32_16x16x32_bf16 v[76:79], a[60:63], v[36:39], v[76:79]
    v_mfma_f32_16x16x32_bf16 v[80:83], a[64:67], v[36:39], v[80:83]
    ds_read_b128 v[56:59], v8 offset:4608
    v_mfma_f32_16x16x32_bf16 v[84:87], a[68:71], v[36:39], v[84:87]
    ds_read_b128 v[60:63], v8 offset:4864
    v_mfma_f32_16x16x32_bf16 v[88:91], a[60:63], v[40:43], v[88:91]
    v_mfma_f32_16x16x32_bf16 v[92:95], a[64:67], v[40:43], v[92:95]
    buffer_load_dwordx4 a[48:51], v6, s[52:55], s9 offen offset:0
    v_mfma_f32_16x16x32_bf16 v[96:99], a[68:71], v[40:43], v[96:99]
    buffer_load_dwordx4 a[52:55], v6, s[52:55], s9 offen offset:1024
    v_mfma_f32_16x16x32_bf16 v[100:103], a[60:63], v[44:47], v[100:103]
    v_mfma_f32_16x16x32_bf16 v[104:107], a[64:67], v[44:47], v[104:107]
    buffer_load_dwordx4 a[56:59], v6, s[52:55], s9 offen offset:2048
    v_mfma_f32_16x16x32_bf16 v[108:111], a[68:71], v[44:47], v[108:111]
    s_add_u32 s9, s9, 3072
    s_waitcnt vmcnt(27) lgkmcnt(0)
    v_mfma_f32_16x16x32_bf16 v[64:67], a[72:75], v[48:51], v[64:67]
    v_mfma_f32_16x16x32_bf16 v[68:71], a[76:79], v[48:51], v[68:71]
    ds_read_b128 v[32:35], v7 offset:0
    v_mfma_f32_16x16x32_bf16 v[72:75], a[80:83], v[48:51], v[72:75]
    ds_read_b128 v[36:39], v7 offset:256
    v_mfma_f32_16x16x32_bf16 v[76:79], a[72:75], v[52:55], v[76:79]
    v_mfma_f32_16x16x32_bf16 v[80:83], a[76:79], v[52:55], v[80:83]
    ds_read_b128 v[40:43], v7 offset:512
    v_mfma_f32_16x16x32_bf16 v[84:87], a[80:83], v[52:55], v[84:87]
    ds_read_b128 v[44:47], v7 offset:768
    v_mfma_f32_16x16x32_bf16 v[88:91], a[72:75], v[56:59], v[88:91]
    v_mfma_f32_16x16x32_bf16 v[92:95], a[76:79], v[56:59], v[92:95]
    buffer_load_dwordx4 a[60:63], v6, s[52:55], s9 offen offset:0
    v_mfma_f32_16x16x32_bf16 v[96:99], a[80:83], v[56:59], v[96:99]
    buffer_load_dwordx4 a[64:67], v6, s[52:55], s9 offen offset:1024
    v_mfma_f32_16x16x32_bf16 v[100:103], a[72:75], v[60:63], v[100:103]
    v_mfma_f32_16x16x32_bf16 v[104:107], a[76:79], v[60:63], v[104:107]
    buffer_load_dwordx4 a[68:71], v6, s[52:55], s9 offen offset:2048
    v_mfma_f32_16x16x32_bf16 v[108:111], a[80:83], v[60:63], v[108:111]
    s_add_u32 s9, s9, 3072
    s_waitcnt vmcnt(27) lgkmcnt(0)
    v_mfma_f32_16x16x32_bf16 v[112:115], a[84:87], v[32:35], 0
    ds_read_b128 v[48:51], v7 offset:4096
    ds_read_b128 v[52:55], v7 offset:4352
    v_mfma_f32_16x16x32_bf16 v[116:119], a[88:91], v[32:35], 0
    ds_read_b128 v[56:59], v7 offset:4608
    ds_read_b128 v[60:63], v7 offset:4864
    v_mfma_f32_16x16x32_bf16 v[120:123], a[92:95], v[32:35], 0
    buffer_load_dwordx4 a[72:75], v6, s[52:55], s9 offen offset:0
    v_mul_f32 v16, v64, v64
    v_mfma_f32_16x16x32_bf16 v[124:127], a[84:87], v[36:39], 0
    v_mul_f32 v17, v65, v65
    v_mul_f32 v18, v66, v66
    v_mfma_f32_16x16x32_bf16 v[128:131], a[88:91], v[36:39], 0
    v_mul_f32 v19, v67, v67
    buffer_load_dwordx4 a[76:79], v6, s[52:55], s9 offen offset:1024
    v_fma_f32 v16, v16, v245, v244
    v_mfma_f32_16x16x32_bf16 v[132:135], a[92:95], v[36:39], 0
    v_fma_f32 v17, v17, v245, v244
    v_fma_f32 v18, v18, v245, v244
    v_mfma_f32_16x16x32_bf16 v[136:139], a[84:87], v[40:43], 0
    v_fma_f32 v19, v19, v245, v244
    v_mul_f32 v16, v16, v64
    v_mfma_f32_16x16x32_bf16 v[140:143], a[88:91], v[40:43], 0
    buffer_load_dwordx4 a[80:83], v6, s[52:55], s9 offen offset:2048
    v_mul_f32 v17, v17, v65
    v_mul_f32 v18, v18, v66
    v_mfma_f32_16x16x32_bf16 v[144:147], a[92:95], v[40:43], 0
    v_mul_f32 v19, v19, v67
    v_exp_f32 v16, v16
    v_mfma_f32_16x16x32_bf16 v[148:151], a[84:87], v[44:47], 0
    v_exp_f32 v17, v17
    s_add_u32 s9, s9, 3072
    v_exp_f32 v18, v18
    v_mfma_f32_16x16x32_bf16 v[152:155], a[88:91], v[44:47], 0
    v_exp_f32 v19, v19
    v_add_f32 v16, 1.0, v16
    v_mfma_f32_16x16x32_bf16 v[156:159], a[92:95], v[44:47], 0
    v_add_f32 v17, 1.0, v17
    v_add_f32 v18, 1.0, v18
    v_add_f32 v19, 1.0, v19
    s_waitcnt vmcnt(27) lgkmcnt(0)
    v_mfma_f32_16x16x32_bf16 v[112:115], a[96:99], v[48:51], v[112:115]
    ds_read_b128 v[32:35], v7 offset:8192
    ds_read_b128 v[36:39], v7 offset:8448
    v_mfma_f32_16x16x32_bf16 v[116:119], a[100:103], v[48:51], v[116:119]
    ds_read_b128 v[40:43], v7 offset:8704
    ds_read_b128 v[44:47], v7 offset:8960
    v_mfma_f32_16x16x32_bf16 v[120:123], a[104:107], v[48:51], v[120:123]
    buffer_load_dwordx4 a[84:87], v6, s[52:55], s9 offen offset:0
    v_rcp_f32 v16, v16
    v_rcp_f32 v17, v17
    v_mfma_f32_16x16x32_bf16 v[124:127], a[96:99], v[52:55], v[124:127]
    v_rcp_f32 v18, v18
    v_rcp_f32 v19, v19
    v_mfma_f32_16x16x32_bf16 v[128:131], a[100:103], v[52:55], v[128:131]
    v_mul_f32 v64, v64, v16
    buffer_load_dwordx4 a[88:91], v6, s[52:55], s9 offen offset:1024
    v_mul_f32 v65, v65, v17
    v_mfma_f32_16x16x32_bf16 v[132:135], a[104:107], v[52:55], v[132:135]
    v_mul_f32 v66, v66, v18
    v_mul_f32 v67, v67, v19
    v_mfma_f32_16x16x32_bf16 v[136:139], a[96:99], v[56:59], v[136:139]
    v_cvt_pk_bf16_f32 v16, v64, v65
    v_cvt_pk_bf16_f32 v17, v66, v67
    v_mfma_f32_16x16x32_bf16 v[140:143], a[100:103], v[56:59], v[140:143]
    buffer_load_dwordx4 a[92:95], v6, s[52:55], s9 offen offset:2048
    ds_write_b64 v11, v[16:17] offset:0
    v_mul_f32 v20, v68, v68
    v_mfma_f32_16x16x32_bf16 v[144:147], a[104:107], v[56:59], v[144:147]
    v_mul_f32 v21, v69, v69
    v_mul_f32 v22, v70, v70
    v_mfma_f32_16x16x32_bf16 v[148:151], a[96:99], v[60:63], v[148:151]
    v_mul_f32 v23, v71, v71
    s_add_u32 s9, s9, 3072
    v_fma_f32 v20, v20, v245, v244
    v_mfma_f32_16x16x32_bf16 v[152:155], a[100:103], v[60:63], v[152:155]
    v_fma_f32 v21, v21, v245, v244
    v_fma_f32 v22, v22, v245, v244
    v_mfma_f32_16x16x32_bf16 v[156:159], a[104:107], v[60:63], v[156:159]
    v_fma_f32 v23, v23, v245, v244
    v_mul_f32 v20, v20, v68
    v_mul_f32 v21, v21, v69
    s_waitcnt vmcnt(27) lgkmcnt(1)
    v_mfma_f32_16x16x32_bf16 v[112:115], a[108:111], v[32:35], v[112:115]
    ds_read_b128 v[48:51], v7 offset:12288
    ds_read_b128 v[52:55], v7 offset:12544
    v_mfma_f32_16x16x32_bf16 v[116:119], a[112:115], v[32:35], v[116:119]
    ds_read_b128 v[56:59], v7 offset:12800
    ds_read_b128 v[60:63], v7 offset:13056
    v_mfma_f32_16x16x32_bf16 v[120:123], a[116:119], v[32:35], v[120:123]
    buffer_load_dwordx4 a[96:99], v6, s[52:55], s9 offen offset:0
    v_mul_f32 v22, v22, v70
    v_mul_f32 v23, v23, v71
    v_mfma_f32_16x16x32_bf16 v[124:127], a[108:111], v[36:39], v[124:127]
    v_exp_f32 v20, v20
    v_exp_f32 v21, v21
    v_mfma_f32_16x16x32_bf16 v[128:131], a[112:115], v[36:39], v[128:131]
    v_exp_f32 v22, v22
    buffer_load_dwordx4 a[100:103], v6, s[52:55], s9 offen offset:1024
    v_exp_f32 v23, v23
    v_mfma_f32_16x16x32_bf16 v[132:135], a[116:119], v[36:39], v[132:135]
    v_add_f32 v20, 1.0, v20
    v_add_f32 v21, 1.0, v21
    v_mfma_f32_16x16x32_bf16 v[136:139], a[108:111], v[40:43], v[136:139]
    v_add_f32 v22, 1.0, v22
    v_add_f32 v23, 1.0, v23
    v_mfma_f32_16x16x32_bf16 v[140:143], a[112:115], v[40:43], v[140:143]
    buffer_load_dwordx4 a[104:107], v6, s[52:55], s9 offen offset:2048
    v_rcp_f32 v20, v20
    v_rcp_f32 v21, v21
    v_mfma_f32_16x16x32_bf16 v[144:147], a[116:119], v[40:43], v[144:147]
    v_rcp_f32 v22, v22
    v_rcp_f32 v23, v23
    v_mfma_f32_16x16x32_bf16 v[148:151], a[108:111], v[44:47], v[148:151]
    v_mul_f32 v68, v68, v20
    s_add_u32 s9, s9, 3072
    v_mul_f32 v69, v69, v21
    v_mfma_f32_16x16x32_bf16 v[152:155], a[112:115], v[44:47], v[152:155]
    v_mul_f32 v70, v70, v22
    v_mul_f32 v71, v71, v23
    v_mfma_f32_16x16x32_bf16 v[156:159], a[116:119], v[44:47], v[156:159]
    v_cvt_pk_bf16_f32 v20, v68, v69
    v_cvt_pk_bf16_f32 v21, v70, v71
    ds_write_b64 v12, v[20:21] offset:0
    s_waitcnt vmcnt(27) lgkmcnt(1)
    v_mfma_f32_16x16x32_bf16 v[112:115], a[120:123], v[48:51], v[112:115]
    ds_read_b128 v[32:35], v7 offset:16384
    ds_read_b128 v[36:39], v7 offset:16640
    v_mfma_f32_16x16x32_bf16 v[116:119], a[124:127], v[48:51], v[116:119]
    ds_read_b128 v[40:43], v7 offset:16896
    ds_read_b128 v[44:47], v7 offset:17152
    v_mfma_f32_16x16x32_bf16 v[120:123], a[128:131], v[48:51], v[120:123]
    buffer_load_dwordx4 a[108:111], v6, s[52:55], s9 offen offset:0
    v_mul_f32 v24, v72, v72
    v_mul_f32 v25, v73, v73
    v_mfma_f32_16x16x32_bf16 v[124:127], a[120:123], v[52:55], v[124:127]
    v_mul_f32 v26, v74, v74
    v_mul_f32 v27, v75, v75
    v_mfma_f32_16x16x32_bf16 v[128:131], a[124:127], v[52:55], v[128:131]
    v_fma_f32 v24, v24, v245, v244
    buffer_load_dwordx4 a[112:115], v6, s[52:55], s9 offen offset:1024
    v_mfma_f32_16x16x32_bf16 v[132:135], a[128:131], v[52:55], v[132:135]
    v_fma_f32 v25, v25, v245, v244
    v_fma_f32 v26, v26, v245, v244
    v_fma_f32 v27, v27, v245, v244
    v_mfma_f32_16x16x32_bf16 v[136:139], a[120:123], v[56:59], v[136:139]
    v_mul_f32 v24, v24, v72
    v_mul_f32 v25, v25, v73
    v_mfma_f32_16x16x32_bf16 v[140:143], a[124:127], v[56:59], v[140:143]
    buffer_load_dwordx4 a[116:119], v6, s[52:55], s9 offen offset:2048
    v_mul_f32 v26, v26, v74
    v_mfma_f32_16x16x32_bf16 v[144:147], a[128:131], v[56:59], v[144:147]
    v_mul_f32 v27, v27, v75
    v_exp_f32 v24, v24
    v_exp_f32 v25, v25
    v_mfma_f32_16x16x32_bf16 v[148:151], a[120:123], v[60:63], v[148:151]
    v_exp_f32 v26, v26
    s_add_u32 s9, s9, 3072
    v_mfma_f32_16x16x32_bf16 v[152:155], a[124:127], v[60:63], v[152:155]
    v_exp_f32 v27, v27
    v_add_f32 v24, 1.0, v24
    v_mfma_f32_16x16x32_bf16 v[156:159], a[128:131], v[60:63], v[156:159]
    v_add_f32 v25, 1.0, v25
    v_add_f32 v26, 1.0, v26
    v_add_f32 v27, 1.0, v27
    s_waitcnt vmcnt(27) lgkmcnt(0)
    v_mfma_f32_16x16x32_bf16 v[112:115], a[0:3], v[32:35], v[112:115]
    ds_read_b128 v[48:51], v7 offset:20480
    ds_read_b128 v[52:55], v7 offset:20736
    v_mfma_f32_16x16x32_bf16 v[116:119], a[4:7], v[32:35], v[116:119]
    ds_read_b128 v[56:59], v7 offset:20992
    ds_read_b128 v[60:63], v7 offset:21248
    v_mfma_f32_16x16x32_bf16 v[120:123], a[8:11], v[32:35], v[120:123]
    buffer_load_dwordx4 a[120:123], v6, s[52:55], s9 offen offset:0
    v_rcp_f32 v24, v24
    v_rcp_f32 v25, v25
    v_mfma_f32_16x16x32_bf16 v[124:127], a[0:3], v[36:39], v[124:127]
    v_rcp_f32 v26, v26
    v_rcp_f32 v27, v27
    v_mfma_f32_16x16x32_bf16 v[128:131], a[4:7], v[36:39], v[128:131]
    v_mul_f32 v72, v72, v24
    buffer_load_dwordx4 a[124:127], v6, s[52:55], s9 offen offset:1024
    v_mul_f32 v73, v73, v25
    v_mfma_f32_16x16x32_bf16 v[132:135], a[8:11], v[36:39], v[132:135]
    v_mul_f32 v74, v74, v26
    v_mul_f32 v75, v75, v27
    v_mfma_f32_16x16x32_bf16 v[136:139], a[0:3], v[40:43], v[136:139]
    v_cvt_pk_bf16_f32 v24, v72, v73
    v_cvt_pk_bf16_f32 v25, v74, v75
    v_mfma_f32_16x16x32_bf16 v[140:143], a[4:7], v[40:43], v[140:143]
    buffer_load_dwordx4 a[128:131], v6, s[52:55], s9 offen offset:2048
    ds_write_b64 v13, v[24:25] offset:0
    v_mul_f32 v28, v76, v76
    v_mfma_f32_16x16x32_bf16 v[144:147], a[8:11], v[40:43], v[144:147]
    v_mul_f32 v29, v77, v77
    v_mul_f32 v30, v78, v78
    v_mfma_f32_16x16x32_bf16 v[148:151], a[0:3], v[44:47], v[148:151]
    v_mul_f32 v31, v79, v79
    s_add_u32 s9, s9, 3072
    v_fma_f32 v28, v28, v247, v246
    v_mfma_f32_16x16x32_bf16 v[152:155], a[4:7], v[44:47], v[152:155]
    v_fma_f32 v29, v29, v247, v246
    v_fma_f32 v30, v30, v247, v246
    v_mfma_f32_16x16x32_bf16 v[156:159], a[8:11], v[44:47], v[156:159]
    v_fma_f32 v31, v31, v247, v246
    v_mul_f32 v28, v28, v76
    v_mul_f32 v29, v29, v77
    s_waitcnt vmcnt(27) lgkmcnt(1)
    v_mfma_f32_16x16x32_bf16 v[112:115], a[12:15], v[48:51], v[112:115]
    ds_read_b128 v[32:35], v7 offset:24576
    ds_read_b128 v[36:39], v7 offset:24832
    v_mfma_f32_16x16x32_bf16 v[116:119], a[16:19], v[48:51], v[116:119]
    ds_read_b128 v[40:43], v7 offset:25088
    ds_read_b128 v[44:47], v7 offset:25344
    v_mfma_f32_16x16x32_bf16 v[120:123], a[20:23], v[48:51], v[120:123]
    buffer_load_dwordx4 a[0:3], v6, s[52:55], s9 offen offset:0
    v_mul_f32 v30, v30, v78
    v_mul_f32 v31, v31, v79
    v_mfma_f32_16x16x32_bf16 v[124:127], a[12:15], v[52:55], v[124:127]
    v_exp_f32 v28, v28
    v_exp_f32 v29, v29
    v_mfma_f32_16x16x32_bf16 v[128:131], a[16:19], v[52:55], v[128:131]
    v_exp_f32 v30, v30
    buffer_load_dwordx4 a[4:7], v6, s[52:55], s9 offen offset:1024
    v_exp_f32 v31, v31
    v_mfma_f32_16x16x32_bf16 v[132:135], a[20:23], v[52:55], v[132:135]
    v_add_f32 v28, 1.0, v28
    v_add_f32 v29, 1.0, v29
    v_mfma_f32_16x16x32_bf16 v[136:139], a[12:15], v[56:59], v[136:139]
    v_add_f32 v30, 1.0, v30
    v_add_f32 v31, 1.0, v31
    v_mfma_f32_16x16x32_bf16 v[140:143], a[16:19], v[56:59], v[140:143]
    buffer_load_dwordx4 a[8:11], v6, s[52:55], s9 offen offset:2048
    v_rcp_f32 v28, v28
    v_rcp_f32 v29, v29
    v_mfma_f32_16x16x32_bf16 v[144:147], a[20:23], v[56:59], v[144:147]
    v_rcp_f32 v30, v30
    v_rcp_f32 v31, v31
    v_mfma_f32_16x16x32_bf16 v[148:151], a[12:15], v[60:63], v[148:151]
    v_mul_f32 v76, v76, v28
    s_add_u32 s9, s9, 3072
    v_mul_f32 v77, v77, v29
    v_mfma_f32_16x16x32_bf16 v[152:155], a[16:19], v[60:63], v[152:155]
    v_mul_f32 v78, v78, v30
    v_mul_f32 v79, v79, v31
    v_mfma_f32_16x16x32_bf16 v[156:159], a[20:23], v[60:63], v[156:159]
    v_cvt_pk_bf16_f32 v28, v76, v77
    v_cvt_pk_bf16_f32 v29, v78, v79
    ds_write_b64 v11, v[28:29] offset:256
    s_waitcnt vmcnt(27) lgkmcnt(1)
    v_mfma_f32_16x16x32_bf16 v[112:115], a[24:27], v[32:35], v[112:115]
    ds_read_b128 v[48:51], v7 offset:28672
    ds_read_b128 v[52:55], v7 offset:28928
    v_mfma_f32_16x16x32_bf16 v[116:119], a[28:31], v[32:35], v[116:119]
    ds_read_b128 v[56:59], v7 offset:29184
    ds_read_b128 v[60:63], v7 offset:29440
    v_mfma_f32_16x16x32_bf16 v[120:123], a[32:35], v[32:35], v[120:123]
    buffer_load_dwordx4 a[12:15], v6, s[52:55], s9 offen offset:0
    v_mul_f32 v16, v80, v80
    v_mul_f32 v17, v81, v81
    v_mfma_f32_16x16x32_bf16 v[124:127], a[24:27], v[36:39], v[124:127]
    v_mul_f32 v18, v82, v82
    v_mul_f32 v19, v83, v83
    v_mfma_f32_16x16x32_bf16 v[128:131], a[28:31], v[36:39], v[128:131]
    v_fma_f32 v16, v16, v247, v246
    buffer_load_dwordx4 a[16:19], v6, s[52:55], s9 offen offset:1024
    v_mfma_f32_16x16x32_bf16 v[132:135], a[32:35], v[36:39], v[132:135]
    v_fma_f32 v17, v17, v247, v246
    v_fma_f32 v18, v18, v247, v246
    v_fma_f32 v19, v19, v247, v246
    v_mfma_f32_16x16x32_bf16 v[136:139], a[24:27], v[40:43], v[136:139]
    v_mul_f32 v16, v16, v80
    v_mul_f32 v17, v17, v81
    v_mfma_f32_16x16x32_bf16 v[140:143], a[28:31], v[40:43], v[140:143]
    buffer_load_dwordx4 a[20:23], v6, s[52:55], s9 offen offset:2048
    v_mul_f32 v18, v18, v82
    v_mfma_f32_16x16x32_bf16 v[144:147], a[32:35], v[40:43], v[144:147]
    v_mul_f32 v19, v19, v83
    v_exp_f32 v16, v16
    v_exp_f32 v17, v17
    v_mfma_f32_16x16x32_bf16 v[148:151], a[24:27], v[44:47], v[148:151]
    v_exp_f32 v18, v18
    s_add_u32 s9, s9, 3072
    v_mfma_f32_16x16x32_bf16 v[152:155], a[28:31], v[44:47], v[152:155]
    v_exp_f32 v19, v19
    v_add_f32 v16, 1.0, v16
    v_mfma_f32_16x16x32_bf16 v[156:159], a[32:35], v[44:47], v[156:159]
    v_add_f32 v17, 1.0, v17
    v_add_f32 v18, 1.0, v18
    v_add_f32 v19, 1.0, v19
    s_waitcnt vmcnt(27) lgkmcnt(0)
    v_mfma_f32_16x16x32_bf16 v[112:115], a[36:39], v[48:51], v[112:115]
    ds_read_b128 v[32:35], v7 offset:32768
    ds_read_b128 v[36:39], v7 offset:33024
    v_mfma_f32_16x16x32_bf16 v[116:119], a[40:43], v[48:51], v[116:119]
    ds_read_b128 v[40:43], v7 offset:33280
    ds_read_b128 v[44:47], v7 offset:33536
    v_mfma_f32_16x16x32_bf16 v[120:123], a[44:47], v[48:51], v[120:123]
    buffer_load_dwordx4 a[24:27], v6, s[52:55], s9 offen offset:0
    v_rcp_f32 v16, v16
    v_rcp_f32 v17, v17
    v_mfma_f32_16x16x32_bf16 v[124:127], a[36:39], v[52:55], v[124:127]
    v_rcp_f32 v18, v18
    v_rcp_f32 v19, v19
    v_mfma_f32_16x16x32_bf16 v[128:131], a[40:43], v[52:55], v[128:131]
    v_mul_f32 v80, v80, v16
    buffer_load_dwordx4 a[28:31], v6, s[52:55], s9 offen offset:1024
    v_mul_f32 v81, v81, v17
    v_mfma_f32_16x16x32_bf16 v[132:135], a[44:47], v[52:55], v[132:135]
    v_mul_f32 v82, v82, v18
    v_mul_f32 v83, v83, v19
    v_mfma_f32_16x16x32_bf16 v[136:139], a[36:39], v[56:59], v[136:139]
    v_cvt_pk_bf16_f32 v16, v80, v81
    v_cvt_pk_bf16_f32 v17, v82, v83
    v_mfma_f32_16x16x32_bf16 v[140:143], a[40:43], v[56:59], v[140:143]
    buffer_load_dwordx4 a[32:35], v6, s[52:55], s9 offen offset:2048
    ds_write_b64 v12, v[16:17] offset:256
    v_mul_f32 v20, v84, v84
    v_mfma_f32_16x16x32_bf16 v[144:147], a[44:47], v[56:59], v[144:147]
    v_mul_f32 v21, v85, v85
    v_mul_f32 v22, v86, v86
    v_mfma_f32_16x16x32_bf16 v[148:151], a[36:39], v[60:63], v[148:151]
    v_mul_f32 v23, v87, v87
    s_add_u32 s9, s9, 3072
    v_fma_f32 v20, v20, v247, v246
    v_mfma_f32_16x16x32_bf16 v[152:155], a[40:43], v[60:63], v[152:155]
    v_fma_f32 v21, v21, v247, v246
    v_fma_f32 v22, v22, v247, v246
    v_mfma_f32_16x16x32_bf16 v[156:159], a[44:47], v[60:63], v[156:159]
    v_fma_f32 v23, v23, v247, v246
    v_mul_f32 v20, v20, v84
    v_mul_f32 v21, v21, v85
    s_waitcnt vmcnt(27) lgkmcnt(1)
    v_mfma_f32_16x16x32_bf16 v[112:115], a[48:51], v[32:35], v[112:115]
    ds_read_b128 v[48:51], v7 offset:36864
    ds_read_b128 v[52:55], v7 offset:37120
    v_mfma_f32_16x16x32_bf16 v[116:119], a[52:55], v[32:35], v[116:119]
    ds_read_b128 v[56:59], v7 offset:37376
    ds_read_b128 v[60:63], v7 offset:37632
    v_mfma_f32_16x16x32_bf16 v[120:123], a[56:59], v[32:35], v[120:123]
    buffer_load_dwordx4 a[36:39], v6, s[52:55], s9 offen offset:0
    v_mul_f32 v22, v22, v86
    v_mul_f32 v23, v23, v87
    v_mfma_f32_16x16x32_bf16 v[124:127], a[48:51], v[36:39], v[124:127]
    v_exp_f32 v20, v20
    v_exp_f32 v21, v21
    v_mfma_f32_16x16x32_bf16 v[128:131], a[52:55], v[36:39], v[128:131]
    v_exp_f32 v22, v22
    buffer_load_dwordx4 a[40:43], v6, s[52:55], s9 offen offset:1024
    v_exp_f32 v23, v23
    v_mfma_f32_16x16x32_bf16 v[132:135], a[56:59], v[36:39], v[132:135]
    v_add_f32 v20, 1.0, v20
    v_add_f32 v21, 1.0, v21
    v_mfma_f32_16x16x32_bf16 v[136:139], a[48:51], v[40:43], v[136:139]
    v_add_f32 v22, 1.0, v22
    v_add_f32 v23, 1.0, v23
    v_mfma_f32_16x16x32_bf16 v[140:143], a[52:55], v[40:43], v[140:143]
    buffer_load_dwordx4 a[44:47], v6, s[52:55], s9 offen offset:2048
    v_rcp_f32 v20, v20
    v_rcp_f32 v21, v21
    v_mfma_f32_16x16x32_bf16 v[144:147], a[56:59], v[40:43], v[144:147]
    v_rcp_f32 v22, v22
    v_rcp_f32 v23, v23
    v_mfma_f32_16x16x32_bf16 v[148:151], a[48:51], v[44:47], v[148:151]
    v_mul_f32 v84, v84, v20
    s_add_u32 s9, s9, 3072
    v_mul_f32 v85, v85, v21
    v_mfma_f32_16x16x32_bf16 v[152:155], a[52:55], v[44:47], v[152:155]
    v_mul_f32 v86, v86, v22
    v_mul_f32 v87, v87, v23
    v_mfma_f32_16x16x32_bf16 v[156:159], a[56:59], v[44:47], v[156:159]
    v_cvt_pk_bf16_f32 v20, v84, v85
    v_cvt_pk_bf16_f32 v21, v86, v87
    ds_write_b64 v13, v[20:21] offset:256
    s_waitcnt vmcnt(27) lgkmcnt(1)
    v_mfma_f32_16x16x32_bf16 v[112:115], a[60:63], v[48:51], v[112:115]
    ds_read_b128 v[32:35], v7 offset:40960
    ds_read_b128 v[36:39], v7 offset:41216
    v_mfma_f32_16x16x32_bf16 v[116:119], a[64:67], v[48:51], v[116:119]
    ds_read_b128 v[40:43], v7 offset:41472
    ds_read_b128 v[44:47], v7 offset:41728
    v_mfma_f32_16x16x32_bf16 v[120:123], a[68:71], v[48:51], v[120:123]
    buffer_load_dwordx4 a[48:51], v6, s[52:55], s9 offen offset:0
    v_mul_f32 v24, v88, v88
    v_mul_f32 v25, v89, v89
    v_mfma_f32_16x16x32_bf16 v[124:127], a[60:63], v[52:55], v[124:127]
    v_mul_f32 v26, v90, v90
    v_mul_f32 v27, v91, v91
    v_mfma_f32_16x16x32_bf16 v[128:131], a[64:67], v[52:55], v[128:131]
    v_fma_f32 v24, v24, v249, v248
    buffer_load_dwordx4 a[52:55], v6, s[52:55], s9 offen offset:1024
    v_mfma_f32_16x16x32_bf16 v[132:135], a[68:71], v[52:55], v[132:135]
    v_fma_f32 v25, v25, v249, v248
    v_fma_f32 v26, v26, v249, v248
    v_fma_f32 v27, v27, v249, v248
    v_mfma_f32_16x16x32_bf16 v[136:139], a[60:63], v[56:59], v[136:139]
    v_mul_f32 v24, v24, v88
    v_mul_f32 v25, v25, v89
    v_mfma_f32_16x16x32_bf16 v[140:143], a[64:67], v[56:59], v[140:143]
    buffer_load_dwordx4 a[56:59], v6, s[52:55], s9 offen offset:2048
    v_mul_f32 v26, v26, v90
    v_mfma_f32_16x16x32_bf16 v[144:147], a[68:71], v[56:59], v[144:147]
    v_mul_f32 v27, v27, v91
    v_exp_f32 v24, v24
    v_exp_f32 v25, v25
    v_mfma_f32_16x16x32_bf16 v[148:151], a[60:63], v[60:63], v[148:151]
    v_exp_f32 v26, v26
    s_add_u32 s9, s9, 3072
    v_mfma_f32_16x16x32_bf16 v[152:155], a[64:67], v[60:63], v[152:155]
    v_exp_f32 v27, v27
    v_add_f32 v24, 1.0, v24
    v_mfma_f32_16x16x32_bf16 v[156:159], a[68:71], v[60:63], v[156:159]
    v_add_f32 v25, 1.0, v25
    v_add_f32 v26, 1.0, v26
    v_add_f32 v27, 1.0, v27
    s_waitcnt vmcnt(27) lgkmcnt(0)
    v_mfma_f32_16x16x32_bf16 v[112:115], a[72:75], v[32:35], v[112:115]
    ds_read_b128 v[48:51], v7 offset:45056
    ds_read_b128 v[52:55], v7 offset:45312
    v_mfma_f32_16x16x32_bf16 v[116:119], a[76:79], v[32:35], v[116:119]
    ds_read_b128 v[56:59], v7 offset:45568
    ds_read_b128 v[60:63], v7 offset:45824
    v_mfma_f32_16x16x32_bf16 v[120:123], a[80:83], v[32:35], v[120:123]
    buffer_load_dwordx4 a[60:63], v6, s[52:55], s9 offen offset:0
    v_rcp_f32 v24, v24
    v_rcp_f32 v25, v25
    v_mfma_f32_16x16x32_bf16 v[124:127], a[72:75], v[36:39], v[124:127]
    v_rcp_f32 v26, v26
    v_rcp_f32 v27, v27
    v_mfma_f32_16x16x32_bf16 v[128:131], a[76:79], v[36:39], v[128:131]
    v_mul_f32 v88, v88, v24
    buffer_load_dwordx4 a[64:67], v6, s[52:55], s9 offen offset:1024
    v_mul_f32 v89, v89, v25
    v_mfma_f32_16x16x32_bf16 v[132:135], a[80:83], v[36:39], v[132:135]
    v_mul_f32 v90, v90, v26
    v_mul_f32 v91, v91, v27
    v_mfma_f32_16x16x32_bf16 v[136:139], a[72:75], v[40:43], v[136:139]
    v_cvt_pk_bf16_f32 v24, v88, v89
    v_cvt_pk_bf16_f32 v25, v90, v91
    v_mfma_f32_16x16x32_bf16 v[140:143], a[76:79], v[40:43], v[140:143]
    buffer_load_dwordx4 a[68:71], v6, s[52:55], s9 offen offset:2048
    ds_write_b64 v11, v[24:25] offset:512
    v_mul_f32 v28, v92, v92
    v_mfma_f32_16x16x32_bf16 v[144:147], a[80:83], v[40:43], v[144:147]
    v_mul_f32 v29, v93, v93
    v_mul_f32 v30, v94, v94
    v_mfma_f32_16x16x32_bf16 v[148:151], a[72:75], v[44:47], v[148:151]
    v_mul_f32 v31, v95, v95
    s_add_u32 s9, s9, 3072
    v_fma_f32 v28, v28, v249, v248
    v_mfma_f32_16x16x32_bf16 v[152:155], a[76:79], v[44:47], v[152:155]
    v_fma_f32 v29, v29, v249, v248
    v_fma_f32 v30, v30, v249, v248
    v_mfma_f32_16x16x32_bf16 v[156:159], a[80:83], v[44:47], v[156:159]
    v_fma_f32 v31, v31, v249, v248
    v_mul_f32 v28, v28, v92
    v_mul_f32 v29, v29, v93
    s_waitcnt vmcnt(27) lgkmcnt(1)
    v_mfma_f32_16x16x32_bf16 v[112:115], a[84:87], v[48:51], v[112:115]
    ds_read_b128 v[32:35], v7 offset:49152
    ds_read_b128 v[36:39], v7 offset:49408
    v_mfma_f32_16x16x32_bf16 v[116:119], a[88:91], v[48:51], v[116:119]
    ds_read_b128 v[40:43], v7 offset:49664
    ds_read_b128 v[44:47], v7 offset:49920
    v_mfma_f32_16x16x32_bf16 v[120:123], a[92:95], v[48:51], v[120:123]
    buffer_load_dwordx4 a[72:75], v6, s[52:55], s9 offen offset:0
    v_mul_f32 v30, v30, v94
    v_mul_f32 v31, v31, v95
    v_mfma_f32_16x16x32_bf16 v[124:127], a[84:87], v[52:55], v[124:127]
    v_exp_f32 v28, v28
    v_exp_f32 v29, v29
    v_mfma_f32_16x16x32_bf16 v[128:131], a[88:91], v[52:55], v[128:131]
    v_exp_f32 v30, v30
    buffer_load_dwordx4 a[76:79], v6, s[52:55], s9 offen offset:1024
    v_exp_f32 v31, v31
    v_mfma_f32_16x16x32_bf16 v[132:135], a[92:95], v[52:55], v[132:135]
    v_add_f32 v28, 1.0, v28
    v_add_f32 v29, 1.0, v29
    v_mfma_f32_16x16x32_bf16 v[136:139], a[84:87], v[56:59], v[136:139]
    v_add_f32 v30, 1.0, v30
    v_add_f32 v31, 1.0, v31
    v_mfma_f32_16x16x32_bf16 v[140:143], a[88:91], v[56:59], v[140:143]
    buffer_load_dwordx4 a[80:83], v6, s[52:55], s9 offen offset:2048
    v_rcp_f32 v28, v28
    v_rcp_f32 v29, v29
    v_mfma_f32_16x16x32_bf16 v[144:147], a[92:95], v[56:59], v[144:147]
    v_rcp_f32 v30, v30
    v_rcp_f32 v31, v31
    v_mfma_f32_16x16x32_bf16 v[148:151], a[84:87], v[60:63], v[148:151]
    v_mul_f32 v92, v92, v28
    s_add_u32 s9, s9, 3072
    v_mul_f32 v93, v93, v29
    v_mfma_f32_16x16x32_bf16 v[152:155], a[88:91], v[60:63], v[152:155]
    v_mul_f32 v94, v94, v30
    v_mul_f32 v95, v95, v31
    v_mfma_f32_16x16x32_bf16 v[156:159], a[92:95], v[60:63], v[156:159]
    v_cvt_pk_bf16_f32 v28, v92, v93
    v_cvt_pk_bf16_f32 v29, v94, v95
    ds_write_b64 v12, v[28:29] offset:512
    s_waitcnt vmcnt(27) lgkmcnt(1)
    v_mfma_f32_16x16x32_bf16 v[112:115], a[96:99], v[32:35], v[112:115]
    ds_read_b128 v[48:51], v7 offset:53248
    ds_read_b128 v[52:55], v7 offset:53504
    v_mfma_f32_16x16x32_bf16 v[116:119], a[100:103], v[32:35], v[116:119]
    ds_read_b128 v[56:59], v7 offset:53760
    ds_read_b128 v[60:63], v7 offset:54016
    v_mfma_f32_16x16x32_bf16 v[120:123], a[104:107], v[32:35], v[120:123]
    buffer_load_dwordx4 a[84:87], v6, s[52:55], s9 offen offset:0
    v_mul_f32 v16, v96, v96
    v_mul_f32 v17, v97, v97
    v_mfma_f32_16x16x32_bf16 v[124:127], a[96:99], v[36:39], v[124:127]
    v_mul_f32 v18, v98, v98
    v_mul_f32 v19, v99, v99
    v_mfma_f32_16x16x32_bf16 v[128:131], a[100:103], v[36:39], v[128:131]
    v_fma_f32 v16, v16, v249, v248
    buffer_load_dwordx4 a[88:91], v6, s[52:55], s9 offen offset:1024
    v_mfma_f32_16x16x32_bf16 v[132:135], a[104:107], v[36:39], v[132:135]
    v_fma_f32 v17, v17, v249, v248
    v_fma_f32 v18, v18, v249, v248
    v_fma_f32 v19, v19, v249, v248
    v_mfma_f32_16x16x32_bf16 v[136:139], a[96:99], v[40:43], v[136:139]
    v_mul_f32 v16, v16, v96
    v_mul_f32 v17, v17, v97
    v_mfma_f32_16x16x32_bf16 v[140:143], a[100:103], v[40:43], v[140:143]
    buffer_load_dwordx4 a[92:95], v6, s[52:55], s9 offen offset:2048
    v_mul_f32 v18, v18, v98
    v_mfma_f32_16x16x32_bf16 v[144:147], a[104:107], v[40:43], v[144:147]
    v_mul_f32 v19, v19, v99
    v_exp_f32 v16, v16
    v_exp_f32 v17, v17
    v_mfma_f32_16x16x32_bf16 v[148:151], a[96:99], v[44:47], v[148:151]
    v_exp_f32 v18, v18
    s_add_u32 s9, s9, 3072
    v_mfma_f32_16x16x32_bf16 v[152:155], a[100:103], v[44:47], v[152:155]
    v_exp_f32 v19, v19
    v_add_f32 v16, 1.0, v16
    v_mfma_f32_16x16x32_bf16 v[156:159], a[104:107], v[44:47], v[156:159]
    v_add_f32 v17, 1.0, v17
    v_add_f32 v18, 1.0, v18
    v_add_f32 v19, 1.0, v19
    s_waitcnt vmcnt(27) lgkmcnt(0)
    v_mfma_f32_16x16x32_bf16 v[112:115], a[108:111], v[48:51], v[112:115]
    ds_read_b128 v[32:35], v7 offset:57344
    ds_read_b128 v[36:39], v7 offset:57600
    v_mfma_f32_16x16x32_bf16 v[116:119], a[112:115], v[48:51], v[116:119]
    ds_read_b128 v[40:43], v7 offset:57856
    ds_read_b128 v[44:47], v7 offset:58112
    v_mfma_f32_16x16x32_bf16 v[120:123], a[116:119], v[48:51], v[120:123]
    buffer_load_dwordx4 a[96:99], v6, s[52:55], s9 offen offset:0
    v_rcp_f32 v16, v16
    v_rcp_f32 v17, v17
    v_mfma_f32_16x16x32_bf16 v[124:127], a[108:111], v[52:55], v[124:127]
    v_rcp_f32 v18, v18
    v_rcp_f32 v19, v19
    v_mfma_f32_16x16x32_bf16 v[128:131], a[112:115], v[52:55], v[128:131]
    v_mul_f32 v96, v96, v16
    buffer_load_dwordx4 a[100:103], v6, s[52:55], s9 offen offset:1024
    v_mul_f32 v97, v97, v17
    v_mfma_f32_16x16x32_bf16 v[132:135], a[116:119], v[52:55], v[132:135]
    v_mul_f32 v98, v98, v18
    v_mul_f32 v99, v99, v19
    v_mfma_f32_16x16x32_bf16 v[136:139], a[108:111], v[56:59], v[136:139]
    v_cvt_pk_bf16_f32 v16, v96, v97
    v_cvt_pk_bf16_f32 v17, v98, v99
    v_mfma_f32_16x16x32_bf16 v[140:143], a[112:115], v[56:59], v[140:143]
    buffer_load_dwordx4 a[104:107], v6, s[52:55], s9 offen offset:2048
    ds_write_b64 v13, v[16:17] offset:512
    v_mul_f32 v20, v100, v100
    v_mfma_f32_16x16x32_bf16 v[144:147], a[116:119], v[56:59], v[144:147]
    v_mul_f32 v21, v101, v101
    v_mul_f32 v22, v102, v102
    v_mfma_f32_16x16x32_bf16 v[148:151], a[108:111], v[60:63], v[148:151]
    v_mul_f32 v23, v103, v103
    s_add_u32 s9, s9, 3072
    v_fma_f32 v20, v20, v251, v250
    v_mfma_f32_16x16x32_bf16 v[152:155], a[112:115], v[60:63], v[152:155]
    v_fma_f32 v21, v21, v251, v250
    v_fma_f32 v22, v22, v251, v250
    v_mfma_f32_16x16x32_bf16 v[156:159], a[116:119], v[60:63], v[156:159]
    v_fma_f32 v23, v23, v251, v250
    v_mul_f32 v20, v20, v100
    v_mul_f32 v21, v21, v101
    s_waitcnt vmcnt(27) lgkmcnt(1)
    v_mfma_f32_16x16x32_bf16 v[112:115], a[120:123], v[32:35], v[112:115]
    ds_read_b128 v[48:51], v7 offset:61440
    ds_read_b128 v[52:55], v7 offset:61696
    v_mfma_f32_16x16x32_bf16 v[116:119], a[124:127], v[32:35], v[116:119]
    ds_read_b128 v[56:59], v7 offset:61952
    ds_read_b128 v[60:63], v7 offset:62208
    v_mfma_f32_16x16x32_bf16 v[120:123], a[128:131], v[32:35], v[120:123]
    buffer_load_dwordx4 a[108:111], v6, s[52:55], s9 offen offset:0
    v_mul_f32 v22, v22, v102
    v_mul_f32 v23, v23, v103
    v_mfma_f32_16x16x32_bf16 v[124:127], a[120:123], v[36:39], v[124:127]
    v_exp_f32 v20, v20
    v_exp_f32 v21, v21
    v_mfma_f32_16x16x32_bf16 v[128:131], a[124:127], v[36:39], v[128:131]
    v_exp_f32 v22, v22
    buffer_load_dwordx4 a[112:115], v6, s[52:55], s9 offen offset:1024
    v_exp_f32 v23, v23
    v_mfma_f32_16x16x32_bf16 v[132:135], a[128:131], v[36:39], v[132:135]
    v_add_f32 v20, 1.0, v20
    v_add_f32 v21, 1.0, v21
    v_mfma_f32_16x16x32_bf16 v[136:139], a[120:123], v[40:43], v[136:139]
    v_add_f32 v22, 1.0, v22
    v_add_f32 v23, 1.0, v23
    v_mfma_f32_16x16x32_bf16 v[140:143], a[124:127], v[40:43], v[140:143]
    buffer_load_dwordx4 a[116:119], v6, s[52:55], s9 offen offset:2048
    v_rcp_f32 v20, v20
    v_rcp_f32 v21, v21
    v_mfma_f32_16x16x32_bf16 v[144:147], a[128:131], v[40:43], v[144:147]
    v_rcp_f32 v22, v22
    v_rcp_f32 v23, v23
    v_mfma_f32_16x16x32_bf16 v[148:151], a[120:123], v[44:47], v[148:151]
    v_mul_f32 v100, v100, v20
    s_add_u32 s9, s9, 3072
    v_mul_f32 v101, v101, v21
    v_mfma_f32_16x16x32_bf16 v[152:155], a[124:127], v[44:47], v[152:155]
    v_mul_f32 v102, v102, v22
    v_mul_f32 v103, v103, v23
    v_mfma_f32_16x16x32_bf16 v[156:159], a[128:131], v[44:47], v[156:159]
    v_cvt_pk_bf16_f32 v20, v100, v101
    v_cvt_pk_bf16_f32 v21, v102, v103
    ds_write_b64 v11, v[20:21] offset:768
    s_waitcnt vmcnt(27) lgkmcnt(1)
    v_mfma_f32_16x16x32_bf16 v[112:115], a[0:3], v[48:51], v[112:115]
    ds_read_b128 v[32:35], v8 offset:0
    ds_read_b128 v[36:39], v8 offset:256
    v_mfma_f32_16x16x32_bf16 v[116:119], a[4:7], v[48:51], v[116:119]
    ds_read_b128 v[40:43], v8 offset:512
    ds_read_b128 v[44:47], v8 offset:768
    v_mfma_f32_16x16x32_bf16 v[120:123], a[8:11], v[48:51], v[120:123]
    buffer_load_dwordx4 a[120:123], v6, s[52:55], s9 offen offset:0
    v_mul_f32 v24, v104, v104
    v_mul_f32 v25, v105, v105
    v_mfma_f32_16x16x32_bf16 v[124:127], a[0:3], v[52:55], v[124:127]
    v_mul_f32 v26, v106, v106
    v_mul_f32 v27, v107, v107
    v_mfma_f32_16x16x32_bf16 v[128:131], a[4:7], v[52:55], v[128:131]
    v_fma_f32 v24, v24, v251, v250
    buffer_load_dwordx4 a[124:127], v6, s[52:55], s9 offen offset:1024
    v_mfma_f32_16x16x32_bf16 v[132:135], a[8:11], v[52:55], v[132:135]
    v_fma_f32 v25, v25, v251, v250
    v_fma_f32 v26, v26, v251, v250
    v_fma_f32 v27, v27, v251, v250
    v_mfma_f32_16x16x32_bf16 v[136:139], a[0:3], v[56:59], v[136:139]
    v_mul_f32 v24, v24, v104
    v_mul_f32 v25, v25, v105
    v_mfma_f32_16x16x32_bf16 v[140:143], a[4:7], v[56:59], v[140:143]
    buffer_load_dwordx4 a[128:131], v6, s[52:55], s9 offen offset:2048
    v_mul_f32 v26, v26, v106
    v_mfma_f32_16x16x32_bf16 v[144:147], a[8:11], v[56:59], v[144:147]
    v_mul_f32 v27, v27, v107
    v_exp_f32 v24, v24
    v_exp_f32 v25, v25
    v_mfma_f32_16x16x32_bf16 v[148:151], a[0:3], v[60:63], v[148:151]
    v_exp_f32 v26, v26
    s_add_u32 s9, s9, 3072
    v_mfma_f32_16x16x32_bf16 v[152:155], a[4:7], v[60:63], v[152:155]
    v_exp_f32 v27, v27
    v_add_f32 v24, 1.0, v24
    v_mfma_f32_16x16x32_bf16 v[156:159], a[8:11], v[60:63], v[156:159]
    v_add_f32 v25, 1.0, v25
    v_add_f32 v26, 1.0, v26
    v_add_f32 v27, 1.0, v27
    s_waitcnt vmcnt(27) lgkmcnt(0)
    v_mfma_f32_16x16x32_bf16 v[112:115], a[12:15], v[32:35], v[112:115]
    ds_read_b128 v[48:51], v8 offset:4096
    ds_read_b128 v[52:55], v8 offset:4352
    v_mfma_f32_16x16x32_bf16 v[116:119], a[16:19], v[32:35], v[116:119]
    ds_read_b128 v[56:59], v8 offset:4608
    ds_read_b128 v[60:63], v8 offset:4864
    v_mfma_f32_16x16x32_bf16 v[120:123], a[20:23], v[32:35], v[120:123]
    buffer_load_dwordx4 a[0:3], v6, s[52:55], s9 offen offset:0
    v_rcp_f32 v24, v24
    v_rcp_f32 v25, v25
    v_mfma_f32_16x16x32_bf16 v[124:127], a[12:15], v[36:39], v[124:127]
    v_rcp_f32 v26, v26
    v_rcp_f32 v27, v27
    v_mfma_f32_16x16x32_bf16 v[128:131], a[16:19], v[36:39], v[128:131]
    v_mul_f32 v104, v104, v24
    buffer_load_dwordx4 a[4:7], v6, s[52:55], s9 offen offset:1024
    v_mul_f32 v105, v105, v25
    v_mfma_f32_16x16x32_bf16 v[132:135], a[20:23], v[36:39], v[132:135]
    v_mul_f32 v106, v106, v26
    v_mul_f32 v107, v107, v27
    v_mfma_f32_16x16x32_bf16 v[136:139], a[12:15], v[40:43], v[136:139]
    v_cvt_pk_bf16_f32 v24, v104, v105
    v_cvt_pk_bf16_f32 v25, v106, v107
    v_mfma_f32_16x16x32_bf16 v[140:143], a[16:19], v[40:43], v[140:143]
    buffer_load_dwordx4 a[8:11], v6, s[52:55], s9 offen offset:2048
    ds_write_b64 v12, v[24:25] offset:768
    v_mul_f32 v28, v108, v108
    v_mfma_f32_16x16x32_bf16 v[144:147], a[20:23], v[40:43], v[144:147]
    v_mul_f32 v29, v109, v109
    v_mul_f32 v30, v110, v110
    v_mfma_f32_16x16x32_bf16 v[148:151], a[12:15], v[44:47], v[148:151]
    v_mul_f32 v31, v111, v111
    s_add_u32 s9, s9, 3072
    v_fma_f32 v28, v28, v251, v250
    v_mfma_f32_16x16x32_bf16 v[152:155], a[16:19], v[44:47], v[152:155]
    v_fma_f32 v29, v29, v251, v250
    v_fma_f32 v30, v30, v251, v250
    v_mfma_f32_16x16x32_bf16 v[156:159], a[20:23], v[44:47], v[156:159]
    v_fma_f32 v31, v31, v251, v250
    v_mul_f32 v28, v28, v108
    v_mul_f32 v29, v29, v109
    s_waitcnt vmcnt(27) lgkmcnt(1)
    v_mfma_f32_16x16x32_bf16 v[112:115], a[24:27], v[48:51], v[112:115]
    ds_read_b128 v[32:35], v7 offset:0
    ds_read_b128 v[36:39], v7 offset:256
    v_mfma_f32_16x16x32_bf16 v[116:119], a[28:31], v[48:51], v[116:119]
    ds_read_b128 v[40:43], v7 offset:512
    ds_read_b128 v[44:47], v7 offset:768
    v_mfma_f32_16x16x32_bf16 v[120:123], a[32:35], v[48:51], v[120:123]
    buffer_load_dwordx4 a[12:15], v6, s[52:55], s9 offen offset:0
    v_mul_f32 v30, v30, v110
    v_mul_f32 v31, v31, v111
    v_mfma_f32_16x16x32_bf16 v[124:127], a[24:27], v[52:55], v[124:127]
    v_exp_f32 v28, v28
    v_exp_f32 v29, v29
    v_mfma_f32_16x16x32_bf16 v[128:131], a[28:31], v[52:55], v[128:131]
    v_exp_f32 v30, v30
    buffer_load_dwordx4 a[16:19], v6, s[52:55], s9 offen offset:1024
    v_exp_f32 v31, v31
    v_mfma_f32_16x16x32_bf16 v[132:135], a[32:35], v[52:55], v[132:135]
    v_add_f32 v28, 1.0, v28
    v_add_f32 v29, 1.0, v29
    v_mfma_f32_16x16x32_bf16 v[136:139], a[24:27], v[56:59], v[136:139]
    v_add_f32 v30, 1.0, v30
    v_add_f32 v31, 1.0, v31
    v_mfma_f32_16x16x32_bf16 v[140:143], a[28:31], v[56:59], v[140:143]
    buffer_load_dwordx4 a[20:23], v6, s[52:55], s9 offen offset:2048
    v_rcp_f32 v28, v28
    v_rcp_f32 v29, v29
    v_mfma_f32_16x16x32_bf16 v[144:147], a[32:35], v[56:59], v[144:147]
    v_rcp_f32 v30, v30
    v_rcp_f32 v31, v31
    v_mfma_f32_16x16x32_bf16 v[148:151], a[24:27], v[60:63], v[148:151]
    v_mul_f32 v108, v108, v28
    s_add_u32 s9, s9, 3072
    v_mul_f32 v109, v109, v29
    v_mfma_f32_16x16x32_bf16 v[152:155], a[28:31], v[60:63], v[152:155]
    v_mul_f32 v110, v110, v30
    v_mul_f32 v111, v111, v31
    v_mfma_f32_16x16x32_bf16 v[156:159], a[32:35], v[60:63], v[156:159]
    v_cvt_pk_bf16_f32 v28, v108, v109
    v_cvt_pk_bf16_f32 v29, v110, v111
    ds_write_b64 v13, v[28:29] offset:768
    s_waitcnt vmcnt(27) lgkmcnt(1)
    v_mfma_f32_16x16x32_bf16 v[160:163], a[36:39], v[32:35], 0
    ds_read_b128 v[48:51], v7 offset:4096
    ds_read_b128 v[52:55], v7 offset:4352
    v_mfma_f32_16x16x32_bf16 v[164:167], a[40:43], v[32:35], 0
    ds_read_b128 v[56:59], v7 offset:4608
    ds_read_b128 v[60:63], v7 offset:4864
    buffer_load_dwordx4 a[24:27], v6, s[52:55], s9 offen offset:0
    v_mfma_f32_16x16x32_bf16 v[168:171], a[44:47], v[32:35], 0
    v_mul_f32 v16, v112, v112
    v_mul_f32 v17, v113, v113
    v_mfma_f32_16x16x32_bf16 v[172:175], a[36:39], v[36:39], 0
    v_mul_f32 v18, v114, v114
    v_mul_f32 v19, v115, v115
    v_fma_f32 v16, v16, v245, v244
    v_mfma_f32_16x16x32_bf16 v[176:179], a[40:43], v[36:39], 0
    buffer_load_dwordx4 a[28:31], v6, s[52:55], s9 offen offset:1024
    v_fma_f32 v17, v17, v245, v244
    v_mfma_f32_16x16x32_bf16 v[180:183], a[44:47], v[36:39], 0
    v_fma_f32 v18, v18, v245, v244
    v_fma_f32 v19, v19, v245, v244
    v_mul_f32 v16, v16, v112
    v_mfma_f32_16x16x32_bf16 v[184:187], a[36:39], v[40:43], 0
    v_mul_f32 v17, v17, v113
    buffer_load_dwordx4 a[32:35], v6, s[52:55], s9 offen offset:2048
    v_mul_f32 v18, v18, v114
    v_mfma_f32_16x16x32_bf16 v[188:191], a[40:43], v[40:43], 0
    v_mul_f32 v19, v19, v115
    v_exp_f32 v16, v16
    v_mfma_f32_16x16x32_bf16 v[192:195], a[44:47], v[40:43], 0
    v_exp_f32 v17, v17
    v_exp_f32 v18, v18
    s_add_u32 s9, s9, 3072
    v_mfma_f32_16x16x32_bf16 v[196:199], a[36:39], v[44:47], 0
    v_exp_f32 v19, v19
    v_add_f32 v16, 1.0, v16
    v_mfma_f32_16x16x32_bf16 v[200:203], a[40:43], v[44:47], 0
    v_add_f32 v17, 1.0, v17
    v_add_f32 v18, 1.0, v18
    v_add_f32 v19, 1.0, v19
    v_mfma_f32_16x16x32_bf16 v[204:207], a[44:47], v[44:47], 0
    v_rcp_f32 v16, v16
    v_rcp_f32 v17, v17
    v_rcp_f32 v18, v18
    s_waitcnt vmcnt(27) lgkmcnt(0)
    v_mfma_f32_16x16x32_bf16 v[160:163], a[48:51], v[48:51], v[160:163]
    ds_read_b128 v[32:35], v7 offset:8192
    ds_read_b128 v[36:39], v7 offset:8448
    v_mfma_f32_16x16x32_bf16 v[164:167], a[52:55], v[48:51], v[164:167]
    ds_read_b128 v[40:43], v7 offset:8704
    ds_read_b128 v[44:47], v7 offset:8960
    buffer_load_dwordx4 a[36:39], v6, s[52:55], s9 offen offset:0
    v_mfma_f32_16x16x32_bf16 v[168:171], a[56:59], v[48:51], v[168:171]
    v_rcp_f32 v19, v19
    v_mul_f32 v112, v112, v16
    v_mfma_f32_16x16x32_bf16 v[172:175], a[48:51], v[52:55], v[172:175]
    v_mul_f32 v113, v113, v17
    v_mul_f32 v114, v114, v18
    v_mul_f32 v115, v115, v19
    v_mfma_f32_16x16x32_bf16 v[176:179], a[52:55], v[52:55], v[176:179]
    buffer_load_dwordx4 a[40:43], v6, s[52:55], s9 offen offset:1024
    v_cvt_pk_bf16_f32 v16, v112, v113
    v_mfma_f32_16x16x32_bf16 v[180:183], a[56:59], v[52:55], v[180:183]
    v_cvt_pk_bf16_f32 v17, v114, v115
    ds_write_b64 v11, v[16:17] offset:24576
    v_mul_f32 v20, v116, v116
    v_mfma_f32_16x16x32_bf16 v[184:187], a[48:51], v[56:59], v[184:187]
    v_mul_f32 v21, v117, v117
    buffer_load_dwordx4 a[44:47], v6, s[52:55], s9 offen offset:2048
    v_mul_f32 v22, v118, v118
    v_mfma_f32_16x16x32_bf16 v[188:191], a[52:55], v[56:59], v[188:191]
    v_mul_f32 v23, v119, v119
    v_fma_f32 v20, v20, v245, v244
    v_mfma_f32_16x16x32_bf16 v[192:195], a[56:59], v[56:59], v[192:195]
    v_fma_f32 v21, v21, v245, v244
    v_fma_f32 v22, v22, v245, v244
    s_add_u32 s9, s9, 3072
    v_mfma_f32_16x16x32_bf16 v[196:199], a[48:51], v[60:63], v[196:199]
    v_fma_f32 v23, v23, v245, v244
    v_mul_f32 v20, v20, v116
    v_mfma_f32_16x16x32_bf16 v[200:203], a[52:55], v[60:63], v[200:203]
    v_mul_f32 v21, v21, v117
    v_mul_f32 v22, v22, v118
    v_mul_f32 v23, v23, v119
    v_mfma_f32_16x16x32_bf16 v[204:207], a[56:59], v[60:63], v[204:207]
    v_exp_f32 v20, v20
    v_exp_f32 v21, v21
    v_exp_f32 v22, v22
    s_waitcnt vmcnt(27) lgkmcnt(1)
    v_mfma_f32_16x16x32_bf16 v[160:163], a[60:63], v[32:35], v[160:163]
    ds_read_b128 v[48:51], v7 offset:12288
    ds_read_b128 v[52:55], v7 offset:12544
    v_mfma_f32_16x16x32_bf16 v[164:167], a[64:67], v[32:35], v[164:167]
    ds_read_b128 v[56:59], v7 offset:12800
    ds_read_b128 v[60:63], v7 offset:13056
    buffer_load_dwordx4 a[48:51], v6, s[52:55], s9 offen offset:0
    v_mfma_f32_16x16x32_bf16 v[168:171], a[68:71], v[32:35], v[168:171]
    v_exp_f32 v23, v23
    v_add_f32 v20, 1.0, v20
    v_mfma_f32_16x16x32_bf16 v[172:175], a[60:63], v[36:39], v[172:175]
    v_add_f32 v21, 1.0, v21
    v_add_f32 v22, 1.0, v22
    v_add_f32 v23, 1.0, v23
    v_mfma_f32_16x16x32_bf16 v[176:179], a[64:67], v[36:39], v[176:179]
    buffer_load_dwordx4 a[52:55], v6, s[52:55], s9 offen offset:1024
    v_rcp_f32 v20, v20
    v_mfma_f32_16x16x32_bf16 v[180:183], a[68:71], v[36:39], v[180:183]
    v_rcp_f32 v21, v21
    v_rcp_f32 v22, v22
    v_rcp_f32 v23, v23
    v_mfma_f32_16x16x32_bf16 v[184:187], a[60:63], v[40:43], v[184:187]
    v_mul_f32 v116, v116, v20
    buffer_load_dwordx4 a[56:59], v6, s[52:55], s9 offen offset:2048
    v_mul_f32 v117, v117, v21
    v_mfma_f32_16x16x32_bf16 v[188:191], a[64:67], v[40:43], v[188:191]
    v_mul_f32 v118, v118, v22
    v_mul_f32 v119, v119, v23
    v_mfma_f32_16x16x32_bf16 v[192:195], a[68:71], v[40:43], v[192:195]
    v_cvt_pk_bf16_f32 v20, v116, v117
    v_cvt_pk_bf16_f32 v21, v118, v119
    s_add_u32 s9, s9, 3072
    v_mfma_f32_16x16x32_bf16 v[196:199], a[60:63], v[44:47], v[196:199]
    ds_write_b64 v12, v[20:21] offset:24576
    v_mul_f32 v24, v120, v120
    v_mfma_f32_16x16x32_bf16 v[200:203], a[64:67], v[44:47], v[200:203]
    v_mul_f32 v25, v121, v121
    v_mul_f32 v26, v122, v122
    v_mul_f32 v27, v123, v123
    v_mfma_f32_16x16x32_bf16 v[204:207], a[68:71], v[44:47], v[204:207]
    v_fma_f32 v24, v24, v245, v244
    v_fma_f32 v25, v25, v245, v244
    v_fma_f32 v26, v26, v245, v244
    s_waitcnt vmcnt(27) lgkmcnt(1)
    v_mfma_f32_16x16x32_bf16 v[160:163], a[72:75], v[48:51], v[160:163]
    ds_read_b128 v[32:35], v7 offset:16384
    ds_read_b128 v[36:39], v7 offset:16640
    v_mfma_f32_16x16x32_bf16 v[164:167], a[76:79], v[48:51], v[164:167]
    ds_read_b128 v[40:43], v7 offset:16896
    ds_read_b128 v[44:47], v7 offset:17152
    buffer_load_dwordx4 a[60:63], v6, s[52:55], s9 offen offset:0
    v_mfma_f32_16x16x32_bf16 v[168:171], a[80:83], v[48:51], v[168:171]
    v_fma_f32 v27, v27, v245, v244
    v_mul_f32 v24, v24, v120
    v_mul_f32 v25, v25, v121
    v_mfma_f32_16x16x32_bf16 v[172:175], a[72:75], v[52:55], v[172:175]
    v_mul_f32 v26, v26, v122
    v_mul_f32 v27, v27, v123
    v_mfma_f32_16x16x32_bf16 v[176:179], a[76:79], v[52:55], v[176:179]
    v_exp_f32 v24, v24
    buffer_load_dwordx4 a[64:67], v6, s[52:55], s9 offen offset:1024
    v_exp_f32 v25, v25
    v_mfma_f32_16x16x32_bf16 v[180:183], a[80:83], v[52:55], v[180:183]
    v_exp_f32 v26, v26
    v_exp_f32 v27, v27
    v_add_f32 v24, 1.0, v24
    v_mfma_f32_16x16x32_bf16 v[184:187], a[72:75], v[56:59], v[184:187]
    v_add_f32 v25, 1.0, v25
    v_add_f32 v26, 1.0, v26
    v_mfma_f32_16x16x32_bf16 v[188:191], a[76:79], v[56:59], v[188:191]
    buffer_load_dwordx4 a[68:71], v6, s[52:55], s9 offen offset:2048
    v_add_f32 v27, 1.0, v27
    v_rcp_f32 v24, v24
    v_mfma_f32_16x16x32_bf16 v[192:195], a[80:83], v[56:59], v[192:195]
    v_rcp_f32 v25, v25
    v_rcp_f32 v26, v26
    v_rcp_f32 v27, v27
    v_mfma_f32_16x16x32_bf16 v[196:199], a[72:75], v[60:63], v[196:199]
    v_mul_f32 v120, v120, v24
    s_add_u32 s9, s9, 3072
    v_mfma_f32_16x16x32_bf16 v[200:203], a[76:79], v[60:63], v[200:203]
    v_mul_f32 v121, v121, v25
    v_mul_f32 v122, v122, v26
    v_mul_f32 v123, v123, v27
    v_mfma_f32_16x16x32_bf16 v[204:207], a[80:83], v[60:63], v[204:207]
    v_cvt_pk_bf16_f32 v24, v120, v121
    v_cvt_pk_bf16_f32 v25, v122, v123
    ds_write_b64 v13, v[24:25] offset:24576
    s_waitcnt vmcnt(27) lgkmcnt(1)
    v_mfma_f32_16x16x32_bf16 v[160:163], a[84:87], v[32:35], v[160:163]
    ds_read_b128 v[48:51], v7 offset:20480
    ds_read_b128 v[52:55], v7 offset:20736
    v_mfma_f32_16x16x32_bf16 v[164:167], a[88:91], v[32:35], v[164:167]
    ds_read_b128 v[56:59], v7 offset:20992
    ds_read_b128 v[60:63], v7 offset:21248
    buffer_load_dwordx4 a[72:75], v6, s[52:55], s9 offen offset:0
    v_mfma_f32_16x16x32_bf16 v[168:171], a[92:95], v[32:35], v[168:171]
    v_mul_f32 v28, v124, v124
    v_mul_f32 v29, v125, v125
    v_mfma_f32_16x16x32_bf16 v[172:175], a[84:87], v[36:39], v[172:175]
    v_mul_f32 v30, v126, v126
    v_mul_f32 v31, v127, v127
    v_fma_f32 v28, v28, v247, v246
    v_mfma_f32_16x16x32_bf16 v[176:179], a[88:91], v[36:39], v[176:179]
    buffer_load_dwordx4 a[76:79], v6, s[52:55], s9 offen offset:1024
    v_fma_f32 v29, v29, v247, v246
    v_mfma_f32_16x16x32_bf16 v[180:183], a[92:95], v[36:39], v[180:183]
    v_fma_f32 v30, v30, v247, v246
    v_fma_f32 v31, v31, v247, v246
    v_mul_f32 v28, v28, v124
    v_mfma_f32_16x16x32_bf16 v[184:187], a[84:87], v[40:43], v[184:187]
    v_mul_f32 v29, v29, v125
    buffer_load_dwordx4 a[80:83], v6, s[52:55], s9 offen offset:2048
    v_mul_f32 v30, v30, v126
    v_mfma_f32_16x16x32_bf16 v[188:191], a[88:91], v[40:43], v[188:191]
    v_mul_f32 v31, v31, v127
    v_exp_f32 v28, v28
    v_mfma_f32_16x16x32_bf16 v[192:195], a[92:95], v[40:43], v[192:195]
    v_exp_f32 v29, v29
    v_exp_f32 v30, v30
    s_add_u32 s9, s9, 3072
    v_mfma_f32_16x16x32_bf16 v[196:199], a[84:87], v[44:47], v[196:199]
    v_exp_f32 v31, v31
    v_add_f32 v28, 1.0, v28
    v_mfma_f32_16x16x32_bf16 v[200:203], a[88:91], v[44:47], v[200:203]
    v_add_f32 v29, 1.0, v29
    v_add_f32 v30, 1.0, v30
    v_add_f32 v31, 1.0, v31
    v_mfma_f32_16x16x32_bf16 v[204:207], a[92:95], v[44:47], v[204:207]
    v_rcp_f32 v28, v28
    v_rcp_f32 v29, v29
    v_rcp_f32 v30, v30
    s_waitcnt vmcnt(27) lgkmcnt(0)
    v_mfma_f32_16x16x32_bf16 v[160:163], a[96:99], v[48:51], v[160:163]
    ds_read_b128 v[32:35], v7 offset:24576
    ds_read_b128 v[36:39], v7 offset:24832
    v_mfma_f32_16x16x32_bf16 v[164:167], a[100:103], v[48:51], v[164:167]
    ds_read_b128 v[40:43], v7 offset:25088
    ds_read_b128 v[44:47], v7 offset:25344
    buffer_load_dwordx4 a[84:87], v6, s[52:55], s9 offen offset:0
    v_mfma_f32_16x16x32_bf16 v[168:171], a[104:107], v[48:51], v[168:171]
    v_rcp_f32 v31, v31
    v_mul_f32 v124, v124, v28
    v_mfma_f32_16x16x32_bf16 v[172:175], a[96:99], v[52:55], v[172:175]
    v_mul_f32 v125, v125, v29
    v_mul_f32 v126, v126, v30
    v_mul_f32 v127, v127, v31
    v_mfma_f32_16x16x32_bf16 v[176:179], a[100:103], v[52:55], v[176:179]
    buffer_load_dwordx4 a[88:91], v6, s[52:55], s9 offen offset:1024
    v_cvt_pk_bf16_f32 v28, v124, v125
    v_mfma_f32_16x16x32_bf16 v[180:183], a[104:107], v[52:55], v[180:183]
    v_cvt_pk_bf16_f32 v29, v126, v127
    ds_write_b64 v11, v[28:29] offset:24832
    v_mul_f32 v16, v128, v128
    v_mfma_f32_16x16x32_bf16 v[184:187], a[96:99], v[56:59], v[184:187]
    v_mul_f32 v17, v129, v129
    buffer_load_dwordx4 a[92:95], v6, s[52:55], s9 offen offset:2048
    v_mul_f32 v18, v130, v130
    v_mfma_f32_16x16x32_bf16 v[188:191], a[100:103], v[56:59], v[188:191]
    v_mul_f32 v19, v131, v131
    v_fma_f32 v16, v16, v247, v246
    v_mfma_f32_16x16x32_bf16 v[192:195], a[104:107], v[56:59], v[192:195]
    v_fma_f32 v17, v17, v247, v246
    v_fma_f32 v18, v18, v247, v246
    s_add_u32 s9, s9, 3072
    v_mfma_f32_16x16x32_bf16 v[196:199], a[96:99], v[60:63], v[196:199]
    v_fma_f32 v19, v19, v247, v246
    v_mul_f32 v16, v16, v128
    v_mfma_f32_16x16x32_bf16 v[200:203], a[100:103], v[60:63], v[200:203]
    v_mul_f32 v17, v17, v129
    v_mul_f32 v18, v18, v130
    v_mul_f32 v19, v19, v131
    v_mfma_f32_16x16x32_bf16 v[204:207], a[104:107], v[60:63], v[204:207]
    v_exp_f32 v16, v16
    v_exp_f32 v17, v17
    v_exp_f32 v18, v18
    s_waitcnt vmcnt(27) lgkmcnt(1)
    v_mfma_f32_16x16x32_bf16 v[160:163], a[108:111], v[32:35], v[160:163]
    ds_read_b128 v[48:51], v7 offset:28672
    ds_read_b128 v[52:55], v7 offset:28928
    v_mfma_f32_16x16x32_bf16 v[164:167], a[112:115], v[32:35], v[164:167]
    ds_read_b128 v[56:59], v7 offset:29184
    ds_read_b128 v[60:63], v7 offset:29440
    buffer_load_dwordx4 a[96:99], v6, s[52:55], s9 offen offset:0
    v_mfma_f32_16x16x32_bf16 v[168:171], a[116:119], v[32:35], v[168:171]
    v_exp_f32 v19, v19
    v_add_f32 v16, 1.0, v16
    v_mfma_f32_16x16x32_bf16 v[172:175], a[108:111], v[36:39], v[172:175]
    v_add_f32 v17, 1.0, v17
    v_add_f32 v18, 1.0, v18
    v_add_f32 v19, 1.0, v19
    v_mfma_f32_16x16x32_bf16 v[176:179], a[112:115], v[36:39], v[176:179]
    buffer_load_dwordx4 a[100:103], v6, s[52:55], s9 offen offset:1024
    v_rcp_f32 v16, v16
    v_mfma_f32_16x16x32_bf16 v[180:183], a[116:119], v[36:39], v[180:183]
    v_rcp_f32 v17, v17
    v_rcp_f32 v18, v18
    v_rcp_f32 v19, v19
    v_mfma_f32_16x16x32_bf16 v[184:187], a[108:111], v[40:43], v[184:187]
    v_mul_f32 v128, v128, v16
    buffer_load_dwordx4 a[104:107], v6, s[52:55], s9 offen offset:2048
    v_mul_f32 v129, v129, v17
    v_mfma_f32_16x16x32_bf16 v[188:191], a[112:115], v[40:43], v[188:191]
    v_mul_f32 v130, v130, v18
    v_mul_f32 v131, v131, v19
    v_mfma_f32_16x16x32_bf16 v[192:195], a[116:119], v[40:43], v[192:195]
    v_cvt_pk_bf16_f32 v16, v128, v129
    v_cvt_pk_bf16_f32 v17, v130, v131
    s_add_u32 s9, s9, 3072
    v_mfma_f32_16x16x32_bf16 v[196:199], a[108:111], v[44:47], v[196:199]
    ds_write_b64 v12, v[16:17] offset:24832
    v_mul_f32 v20, v132, v132
    v_mfma_f32_16x16x32_bf16 v[200:203], a[112:115], v[44:47], v[200:203]
    v_mul_f32 v21, v133, v133
    v_mul_f32 v22, v134, v134
    v_mul_f32 v23, v135, v135
    v_mfma_f32_16x16x32_bf16 v[204:207], a[116:119], v[44:47], v[204:207]
    v_fma_f32 v20, v20, v247, v246
    v_fma_f32 v21, v21, v247, v246
    v_fma_f32 v22, v22, v247, v246
    s_waitcnt vmcnt(27) lgkmcnt(1)
    v_mfma_f32_16x16x32_bf16 v[160:163], a[120:123], v[48:51], v[160:163]
    ds_read_b128 v[32:35], v7 offset:32768
    ds_read_b128 v[36:39], v7 offset:33024
    v_mfma_f32_16x16x32_bf16 v[164:167], a[124:127], v[48:51], v[164:167]
    ds_read_b128 v[40:43], v7 offset:33280
    ds_read_b128 v[44:47], v7 offset:33536
    buffer_load_dwordx4 a[108:111], v6, s[52:55], s9 offen offset:0
    v_mfma_f32_16x16x32_bf16 v[168:171], a[128:131], v[48:51], v[168:171]
    v_fma_f32 v23, v23, v247, v246
    v_mul_f32 v20, v20, v132
    v_mul_f32 v21, v21, v133
    v_mfma_f32_16x16x32_bf16 v[172:175], a[120:123], v[52:55], v[172:175]
    v_mul_f32 v22, v22, v134
    v_mul_f32 v23, v23, v135
    v_mfma_f32_16x16x32_bf16 v[176:179], a[124:127], v[52:55], v[176:179]
    v_exp_f32 v20, v20
    buffer_load_dwordx4 a[112:115], v6, s[52:55], s9 offen offset:1024
    v_exp_f32 v21, v21
    v_mfma_f32_16x16x32_bf16 v[180:183], a[128:131], v[52:55], v[180:183]
    v_exp_f32 v22, v22
    v_exp_f32 v23, v23
    v_add_f32 v20, 1.0, v20
    v_mfma_f32_16x16x32_bf16 v[184:187], a[120:123], v[56:59], v[184:187]
    v_add_f32 v21, 1.0, v21
    v_add_f32 v22, 1.0, v22
    v_mfma_f32_16x16x32_bf16 v[188:191], a[124:127], v[56:59], v[188:191]
    buffer_load_dwordx4 a[116:119], v6, s[52:55], s9 offen offset:2048
    v_add_f32 v23, 1.0, v23
    v_rcp_f32 v20, v20
    v_mfma_f32_16x16x32_bf16 v[192:195], a[128:131], v[56:59], v[192:195]
    v_rcp_f32 v21, v21
    v_rcp_f32 v22, v22
    v_rcp_f32 v23, v23
    v_mfma_f32_16x16x32_bf16 v[196:199], a[120:123], v[60:63], v[196:199]
    v_mul_f32 v132, v132, v20
    s_add_u32 s9, s9, 5145600
    v_mfma_f32_16x16x32_bf16 v[200:203], a[124:127], v[60:63], v[200:203]
    v_mul_f32 v133, v133, v21
    v_mul_f32 v134, v134, v22
    v_mul_f32 v135, v135, v23
    v_mfma_f32_16x16x32_bf16 v[204:207], a[128:131], v[60:63], v[204:207]
    v_cvt_pk_bf16_f32 v20, v132, v133
    v_cvt_pk_bf16_f32 v21, v134, v135
    ds_write_b64 v13, v[20:21] offset:24832
    s_waitcnt vmcnt(27) lgkmcnt(1)
    v_mfma_f32_16x16x32_bf16 v[160:163], a[0:3], v[32:35], v[160:163]
    ds_read_b128 v[48:51], v7 offset:36864
    ds_read_b128 v[52:55], v7 offset:37120
    v_mfma_f32_16x16x32_bf16 v[164:167], a[4:7], v[32:35], v[164:167]
    ds_read_b128 v[56:59], v7 offset:37376
    ds_read_b128 v[60:63], v7 offset:37632
    buffer_load_dwordx4 a[120:123], v6, s[52:55], s9 offen offset:0
    v_mfma_f32_16x16x32_bf16 v[168:171], a[8:11], v[32:35], v[168:171]
    v_mul_f32 v24, v136, v136
    v_mul_f32 v25, v137, v137
    v_mfma_f32_16x16x32_bf16 v[172:175], a[0:3], v[36:39], v[172:175]
    v_mul_f32 v26, v138, v138
    v_mul_f32 v27, v139, v139
    v_fma_f32 v24, v24, v249, v248
    v_mfma_f32_16x16x32_bf16 v[176:179], a[4:7], v[36:39], v[176:179]
    buffer_load_dwordx4 a[124:127], v6, s[52:55], s9 offen offset:1024
    v_fma_f32 v25, v25, v249, v248
    v_mfma_f32_16x16x32_bf16 v[180:183], a[8:11], v[36:39], v[180:183]
    v_fma_f32 v26, v26, v249, v248
    v_fma_f32 v27, v27, v249, v248
    v_mul_f32 v24, v24, v136
    v_mfma_f32_16x16x32_bf16 v[184:187], a[0:3], v[40:43], v[184:187]
    v_mul_f32 v25, v25, v137
    buffer_load_dwordx4 a[128:131], v6, s[52:55], s9 offen offset:2048
    v_mul_f32 v26, v26, v138
    v_mfma_f32_16x16x32_bf16 v[188:191], a[4:7], v[40:43], v[188:191]
    v_mul_f32 v27, v27, v139
    v_exp_f32 v24, v24
    v_mfma_f32_16x16x32_bf16 v[192:195], a[8:11], v[40:43], v[192:195]
    v_exp_f32 v25, v25
    v_exp_f32 v26, v26
    s_add_u32 s9, s9, 3072
    v_mfma_f32_16x16x32_bf16 v[196:199], a[0:3], v[44:47], v[196:199]
    v_exp_f32 v27, v27
    v_add_f32 v24, 1.0, v24
    v_mfma_f32_16x16x32_bf16 v[200:203], a[4:7], v[44:47], v[200:203]
    v_add_f32 v25, 1.0, v25
    v_add_f32 v26, 1.0, v26
    v_add_f32 v27, 1.0, v27
    v_mfma_f32_16x16x32_bf16 v[204:207], a[8:11], v[44:47], v[204:207]
    v_rcp_f32 v24, v24
    v_rcp_f32 v25, v25
    v_rcp_f32 v26, v26
    s_waitcnt vmcnt(27) lgkmcnt(0)
    v_mfma_f32_16x16x32_bf16 v[160:163], a[12:15], v[48:51], v[160:163]
    ds_read_b128 v[32:35], v7 offset:40960
    ds_read_b128 v[36:39], v7 offset:41216
    v_mfma_f32_16x16x32_bf16 v[164:167], a[16:19], v[48:51], v[164:167]
    ds_read_b128 v[40:43], v7 offset:41472
    ds_read_b128 v[44:47], v7 offset:41728
    buffer_load_dwordx4 a[0:3], v6, s[52:55], s9 offen offset:0
    v_mfma_f32_16x16x32_bf16 v[168:171], a[20:23], v[48:51], v[168:171]
    v_rcp_f32 v27, v27
    v_mul_f32 v136, v136, v24
    v_mfma_f32_16x16x32_bf16 v[172:175], a[12:15], v[52:55], v[172:175]
    v_mul_f32 v137, v137, v25
    v_mul_f32 v138, v138, v26
    v_mul_f32 v139, v139, v27
    v_mfma_f32_16x16x32_bf16 v[176:179], a[16:19], v[52:55], v[176:179]
    buffer_load_dwordx4 a[4:7], v6, s[52:55], s9 offen offset:1024
    v_cvt_pk_bf16_f32 v24, v136, v137
    v_mfma_f32_16x16x32_bf16 v[180:183], a[20:23], v[52:55], v[180:183]
    v_cvt_pk_bf16_f32 v25, v138, v139
    ds_write_b64 v11, v[24:25] offset:25088
    v_mul_f32 v28, v140, v140
    v_mfma_f32_16x16x32_bf16 v[184:187], a[12:15], v[56:59], v[184:187]
    v_mul_f32 v29, v141, v141
    buffer_load_dwordx4 a[8:11], v6, s[52:55], s9 offen offset:2048
    v_mul_f32 v30, v142, v142
    v_mfma_f32_16x16x32_bf16 v[188:191], a[16:19], v[56:59], v[188:191]
    v_mul_f32 v31, v143, v143
    v_fma_f32 v28, v28, v249, v248
    v_mfma_f32_16x16x32_bf16 v[192:195], a[20:23], v[56:59], v[192:195]
    v_fma_f32 v29, v29, v249, v248
    v_fma_f32 v30, v30, v249, v248
    s_add_u32 s9, s9, 3072
    v_mfma_f32_16x16x32_bf16 v[196:199], a[12:15], v[60:63], v[196:199]
    v_fma_f32 v31, v31, v249, v248
    v_mul_f32 v28, v28, v140
    v_mfma_f32_16x16x32_bf16 v[200:203], a[16:19], v[60:63], v[200:203]
    v_mul_f32 v29, v29, v141
    v_mul_f32 v30, v30, v142
    v_mul_f32 v31, v31, v143
    v_mfma_f32_16x16x32_bf16 v[204:207], a[20:23], v[60:63], v[204:207]
    v_exp_f32 v28, v28
    v_exp_f32 v29, v29
    v_exp_f32 v30, v30
    s_waitcnt vmcnt(27) lgkmcnt(1)
    v_mfma_f32_16x16x32_bf16 v[160:163], a[24:27], v[32:35], v[160:163]
    ds_read_b128 v[48:51], v7 offset:45056
    ds_read_b128 v[52:55], v7 offset:45312
    v_mfma_f32_16x16x32_bf16 v[164:167], a[28:31], v[32:35], v[164:167]
    ds_read_b128 v[56:59], v7 offset:45568
    ds_read_b128 v[60:63], v7 offset:45824
    buffer_load_dwordx4 a[12:15], v6, s[52:55], s9 offen offset:0
    v_mfma_f32_16x16x32_bf16 v[168:171], a[32:35], v[32:35], v[168:171]
    v_exp_f32 v31, v31
    v_add_f32 v28, 1.0, v28
    v_mfma_f32_16x16x32_bf16 v[172:175], a[24:27], v[36:39], v[172:175]
    v_add_f32 v29, 1.0, v29
    v_add_f32 v30, 1.0, v30
    v_add_f32 v31, 1.0, v31
    v_mfma_f32_16x16x32_bf16 v[176:179], a[28:31], v[36:39], v[176:179]
    buffer_load_dwordx4 a[16:19], v6, s[52:55], s9 offen offset:1024
    v_rcp_f32 v28, v28
    v_mfma_f32_16x16x32_bf16 v[180:183], a[32:35], v[36:39], v[180:183]
    v_rcp_f32 v29, v29
    v_rcp_f32 v30, v30
    v_rcp_f32 v31, v31
    v_mfma_f32_16x16x32_bf16 v[184:187], a[24:27], v[40:43], v[184:187]
    v_mul_f32 v140, v140, v28
    buffer_load_dwordx4 a[20:23], v6, s[52:55], s9 offen offset:2048
    v_mul_f32 v141, v141, v29
    v_mfma_f32_16x16x32_bf16 v[188:191], a[28:31], v[40:43], v[188:191]
    v_mul_f32 v142, v142, v30
    v_mul_f32 v143, v143, v31
    v_mfma_f32_16x16x32_bf16 v[192:195], a[32:35], v[40:43], v[192:195]
    v_cvt_pk_bf16_f32 v28, v140, v141
    v_cvt_pk_bf16_f32 v29, v142, v143
    s_add_u32 s9, s9, 3072
    v_mfma_f32_16x16x32_bf16 v[196:199], a[24:27], v[44:47], v[196:199]
    ds_write_b64 v12, v[28:29] offset:25088
    v_mul_f32 v16, v144, v144
    v_mfma_f32_16x16x32_bf16 v[200:203], a[28:31], v[44:47], v[200:203]
    v_mul_f32 v17, v145, v145
    v_mul_f32 v18, v146, v146
    v_mul_f32 v19, v147, v147
    v_mfma_f32_16x16x32_bf16 v[204:207], a[32:35], v[44:47], v[204:207]
    v_fma_f32 v16, v16, v249, v248
    v_fma_f32 v17, v17, v249, v248
    v_fma_f32 v18, v18, v249, v248
    s_waitcnt vmcnt(27) lgkmcnt(1)
    v_mfma_f32_16x16x32_bf16 v[160:163], a[36:39], v[48:51], v[160:163]
    ds_read_b128 v[32:35], v7 offset:49152
    ds_read_b128 v[36:39], v7 offset:49408
    v_mfma_f32_16x16x32_bf16 v[164:167], a[40:43], v[48:51], v[164:167]
    ds_read_b128 v[40:43], v7 offset:49664
    ds_read_b128 v[44:47], v7 offset:49920
    buffer_load_dwordx4 a[24:27], v6, s[52:55], s9 offen offset:0
    v_mfma_f32_16x16x32_bf16 v[168:171], a[44:47], v[48:51], v[168:171]
    v_fma_f32 v19, v19, v249, v248
    v_mul_f32 v16, v16, v144
    v_mul_f32 v17, v17, v145
    v_mfma_f32_16x16x32_bf16 v[172:175], a[36:39], v[52:55], v[172:175]
    v_mul_f32 v18, v18, v146
    v_mul_f32 v19, v19, v147
    v_mfma_f32_16x16x32_bf16 v[176:179], a[40:43], v[52:55], v[176:179]
    v_exp_f32 v16, v16
    buffer_load_dwordx4 a[28:31], v6, s[52:55], s9 offen offset:1024
    v_exp_f32 v17, v17
    v_mfma_f32_16x16x32_bf16 v[180:183], a[44:47], v[52:55], v[180:183]
    v_exp_f32 v18, v18
    v_exp_f32 v19, v19
    v_add_f32 v16, 1.0, v16
    v_mfma_f32_16x16x32_bf16 v[184:187], a[36:39], v[56:59], v[184:187]
    v_add_f32 v17, 1.0, v17
    v_add_f32 v18, 1.0, v18
    v_mfma_f32_16x16x32_bf16 v[188:191], a[40:43], v[56:59], v[188:191]
    buffer_load_dwordx4 a[32:35], v6, s[52:55], s9 offen offset:2048
    v_add_f32 v19, 1.0, v19
    v_rcp_f32 v16, v16
    v_mfma_f32_16x16x32_bf16 v[192:195], a[44:47], v[56:59], v[192:195]
    v_rcp_f32 v17, v17
    v_rcp_f32 v18, v18
    v_rcp_f32 v19, v19
    v_mfma_f32_16x16x32_bf16 v[196:199], a[36:39], v[60:63], v[196:199]
    v_mul_f32 v144, v144, v16
    s_add_u32 s9, s9, 3072
    v_mfma_f32_16x16x32_bf16 v[200:203], a[40:43], v[60:63], v[200:203]
    v_mul_f32 v145, v145, v17
    v_mul_f32 v146, v146, v18
    v_mul_f32 v147, v147, v19
    v_mfma_f32_16x16x32_bf16 v[204:207], a[44:47], v[60:63], v[204:207]
    v_cvt_pk_bf16_f32 v16, v144, v145
    v_cvt_pk_bf16_f32 v17, v146, v147
    ds_write_b64 v13, v[16:17] offset:25088
    s_waitcnt vmcnt(27) lgkmcnt(1)
    v_mfma_f32_16x16x32_bf16 v[160:163], a[48:51], v[32:35], v[160:163]
    ds_read_b128 v[48:51], v7 offset:53248
    ds_read_b128 v[52:55], v7 offset:53504
    v_mfma_f32_16x16x32_bf16 v[164:167], a[52:55], v[32:35], v[164:167]
    ds_read_b128 v[56:59], v7 offset:53760
    ds_read_b128 v[60:63], v7 offset:54016
    buffer_load_dwordx4 a[36:39], v6, s[52:55], s9 offen offset:0
    v_mfma_f32_16x16x32_bf16 v[168:171], a[56:59], v[32:35], v[168:171]
    v_mul_f32 v20, v148, v148
    v_mul_f32 v21, v149, v149
    v_mfma_f32_16x16x32_bf16 v[172:175], a[48:51], v[36:39], v[172:175]
    v_mul_f32 v22, v150, v150
    v_mul_f32 v23, v151, v151
    v_fma_f32 v20, v20, v251, v250
    v_mfma_f32_16x16x32_bf16 v[176:179], a[52:55], v[36:39], v[176:179]
    buffer_load_dwordx4 a[40:43], v6, s[52:55], s9 offen offset:1024
    v_fma_f32 v21, v21, v251, v250
    v_mfma_f32_16x16x32_bf16 v[180:183], a[56:59], v[36:39], v[180:183]
    v_fma_f32 v22, v22, v251, v250
    v_fma_f32 v23, v23, v251, v250
    v_mul_f32 v20, v20, v148
    v_mfma_f32_16x16x32_bf16 v[184:187], a[48:51], v[40:43], v[184:187]
    v_mul_f32 v21, v21, v149
    buffer_load_dwordx4 a[44:47], v6, s[52:55], s9 offen offset:2048
    v_mul_f32 v22, v22, v150
    v_mfma_f32_16x16x32_bf16 v[188:191], a[52:55], v[40:43], v[188:191]
    v_mul_f32 v23, v23, v151
    v_exp_f32 v20, v20
    v_mfma_f32_16x16x32_bf16 v[192:195], a[56:59], v[40:43], v[192:195]
    v_exp_f32 v21, v21
    v_exp_f32 v22, v22
    s_add_u32 s9, s9, 3072
    v_mfma_f32_16x16x32_bf16 v[196:199], a[48:51], v[44:47], v[196:199]
    v_exp_f32 v23, v23
    v_add_f32 v20, 1.0, v20
    v_mfma_f32_16x16x32_bf16 v[200:203], a[52:55], v[44:47], v[200:203]
    v_add_f32 v21, 1.0, v21
    v_add_f32 v22, 1.0, v22
    v_add_f32 v23, 1.0, v23
    v_mfma_f32_16x16x32_bf16 v[204:207], a[56:59], v[44:47], v[204:207]
    v_rcp_f32 v20, v20
    v_rcp_f32 v21, v21
    v_rcp_f32 v22, v22
    s_waitcnt vmcnt(27) lgkmcnt(0)
    v_mfma_f32_16x16x32_bf16 v[160:163], a[60:63], v[48:51], v[160:163]
    ds_read_b128 v[32:35], v7 offset:57344
    ds_read_b128 v[36:39], v7 offset:57600
    v_mfma_f32_16x16x32_bf16 v[164:167], a[64:67], v[48:51], v[164:167]
    ds_read_b128 v[40:43], v7 offset:57856
    ds_read_b128 v[44:47], v7 offset:58112
    buffer_load_dwordx4 a[48:51], v6, s[52:55], s9 offen offset:0
    v_mfma_f32_16x16x32_bf16 v[168:171], a[68:71], v[48:51], v[168:171]
    v_rcp_f32 v23, v23
    v_mul_f32 v148, v148, v20
    v_mfma_f32_16x16x32_bf16 v[172:175], a[60:63], v[52:55], v[172:175]
    v_mul_f32 v149, v149, v21
    v_mul_f32 v150, v150, v22
    v_mul_f32 v151, v151, v23
    v_mfma_f32_16x16x32_bf16 v[176:179], a[64:67], v[52:55], v[176:179]
    buffer_load_dwordx4 a[52:55], v6, s[52:55], s9 offen offset:1024
    v_cvt_pk_bf16_f32 v20, v148, v149
    v_mfma_f32_16x16x32_bf16 v[180:183], a[68:71], v[52:55], v[180:183]
    v_cvt_pk_bf16_f32 v21, v150, v151
    ds_write_b64 v11, v[20:21] offset:25344
    v_mul_f32 v24, v152, v152
    v_mfma_f32_16x16x32_bf16 v[184:187], a[60:63], v[56:59], v[184:187]
    v_mul_f32 v25, v153, v153
    buffer_load_dwordx4 a[56:59], v6, s[52:55], s9 offen offset:2048
    v_mul_f32 v26, v154, v154
    v_mfma_f32_16x16x32_bf16 v[188:191], a[64:67], v[56:59], v[188:191]
    v_mul_f32 v27, v155, v155
    v_fma_f32 v24, v24, v251, v250
    v_mfma_f32_16x16x32_bf16 v[192:195], a[68:71], v[56:59], v[192:195]
    v_fma_f32 v25, v25, v251, v250
    v_fma_f32 v26, v26, v251, v250
    s_add_u32 s9, s9, 3072
    v_mfma_f32_16x16x32_bf16 v[196:199], a[60:63], v[60:63], v[196:199]
    v_fma_f32 v27, v27, v251, v250
    v_mul_f32 v24, v24, v152
    v_mfma_f32_16x16x32_bf16 v[200:203], a[64:67], v[60:63], v[200:203]
    v_mul_f32 v25, v25, v153
    v_mul_f32 v26, v26, v154
    v_mul_f32 v27, v27, v155
    v_mfma_f32_16x16x32_bf16 v[204:207], a[68:71], v[60:63], v[204:207]
    v_exp_f32 v24, v24
    v_exp_f32 v25, v25
    v_exp_f32 v26, v26
    s_waitcnt vmcnt(27) lgkmcnt(1)
    v_mfma_f32_16x16x32_bf16 v[160:163], a[72:75], v[32:35], v[160:163]
    ds_read_b128 v[48:51], v7 offset:61440
    ds_read_b128 v[52:55], v7 offset:61696
    v_mfma_f32_16x16x32_bf16 v[164:167], a[76:79], v[32:35], v[164:167]
    ds_read_b128 v[56:59], v7 offset:61952
    ds_read_b128 v[60:63], v7 offset:62208
    buffer_load_dwordx4 a[60:63], v6, s[52:55], s9 offen offset:0
    v_mfma_f32_16x16x32_bf16 v[168:171], a[80:83], v[32:35], v[168:171]
    v_exp_f32 v27, v27
    v_add_f32 v24, 1.0, v24
    v_mfma_f32_16x16x32_bf16 v[172:175], a[72:75], v[36:39], v[172:175]
    v_add_f32 v25, 1.0, v25
    v_add_f32 v26, 1.0, v26
    v_add_f32 v27, 1.0, v27
    v_mfma_f32_16x16x32_bf16 v[176:179], a[76:79], v[36:39], v[176:179]
    buffer_load_dwordx4 a[64:67], v6, s[52:55], s9 offen offset:1024
    v_rcp_f32 v24, v24
    v_mfma_f32_16x16x32_bf16 v[180:183], a[80:83], v[36:39], v[180:183]
    v_rcp_f32 v25, v25
    v_rcp_f32 v26, v26
    v_rcp_f32 v27, v27
    v_mfma_f32_16x16x32_bf16 v[184:187], a[72:75], v[40:43], v[184:187]
    v_mul_f32 v152, v152, v24
    buffer_load_dwordx4 a[68:71], v6, s[52:55], s9 offen offset:2048
    v_mul_f32 v153, v153, v25
    v_mfma_f32_16x16x32_bf16 v[188:191], a[76:79], v[40:43], v[188:191]
    v_mul_f32 v154, v154, v26
    v_mul_f32 v155, v155, v27
    v_mfma_f32_16x16x32_bf16 v[192:195], a[80:83], v[40:43], v[192:195]
    v_cvt_pk_bf16_f32 v24, v152, v153
    v_cvt_pk_bf16_f32 v25, v154, v155
    s_add_u32 s9, s9, 3072
    v_mfma_f32_16x16x32_bf16 v[196:199], a[72:75], v[44:47], v[196:199]
    ds_write_b64 v12, v[24:25] offset:25344
    v_mul_f32 v28, v156, v156
    v_mfma_f32_16x16x32_bf16 v[200:203], a[76:79], v[44:47], v[200:203]
    v_mul_f32 v29, v157, v157
    v_mul_f32 v30, v158, v158
    v_mul_f32 v31, v159, v159
    v_mfma_f32_16x16x32_bf16 v[204:207], a[80:83], v[44:47], v[204:207]
    v_fma_f32 v28, v28, v251, v250
    v_fma_f32 v29, v29, v251, v250
    v_fma_f32 v30, v30, v251, v250
    s_waitcnt vmcnt(27) lgkmcnt(1)
    v_mfma_f32_16x16x32_bf16 v[160:163], a[84:87], v[48:51], v[160:163]
    ds_read_b128 v[32:35], v8 offset:0
    ds_read_b128 v[36:39], v8 offset:256
    v_mfma_f32_16x16x32_bf16 v[164:167], a[88:91], v[48:51], v[164:167]
    ds_read_b128 v[40:43], v8 offset:512
    ds_read_b128 v[44:47], v8 offset:768
    buffer_load_dwordx4 a[72:75], v6, s[52:55], s9 offen offset:0
    v_mfma_f32_16x16x32_bf16 v[168:171], a[92:95], v[48:51], v[168:171]
    v_fma_f32 v31, v31, v251, v250
    v_mul_f32 v28, v28, v156
    v_mul_f32 v29, v29, v157
    v_mfma_f32_16x16x32_bf16 v[172:175], a[84:87], v[52:55], v[172:175]
    v_mul_f32 v30, v30, v158
    v_mul_f32 v31, v31, v159
    v_mfma_f32_16x16x32_bf16 v[176:179], a[88:91], v[52:55], v[176:179]
    v_exp_f32 v28, v28
    buffer_load_dwordx4 a[76:79], v6, s[52:55], s9 offen offset:1024
    v_exp_f32 v29, v29
    v_mfma_f32_16x16x32_bf16 v[180:183], a[92:95], v[52:55], v[180:183]
    v_exp_f32 v30, v30
    v_exp_f32 v31, v31
    v_add_f32 v28, 1.0, v28
    v_mfma_f32_16x16x32_bf16 v[184:187], a[84:87], v[56:59], v[184:187]
    v_add_f32 v29, 1.0, v29
    v_add_f32 v30, 1.0, v30
    v_mfma_f32_16x16x32_bf16 v[188:191], a[88:91], v[56:59], v[188:191]
    buffer_load_dwordx4 a[80:83], v6, s[52:55], s9 offen offset:2048
    v_add_f32 v31, 1.0, v31
    v_rcp_f32 v28, v28
    v_mfma_f32_16x16x32_bf16 v[192:195], a[92:95], v[56:59], v[192:195]
    v_rcp_f32 v29, v29
    v_rcp_f32 v30, v30
    v_rcp_f32 v31, v31
    v_mfma_f32_16x16x32_bf16 v[196:199], a[84:87], v[60:63], v[196:199]
    v_mul_f32 v156, v156, v28
    s_add_u32 s9, s9, 3072
    v_mfma_f32_16x16x32_bf16 v[200:203], a[88:91], v[60:63], v[200:203]
    v_mul_f32 v157, v157, v29
    v_mul_f32 v158, v158, v30
    v_mul_f32 v159, v159, v31
    v_mfma_f32_16x16x32_bf16 v[204:207], a[92:95], v[60:63], v[204:207]
    v_cvt_pk_bf16_f32 v28, v156, v157
    v_cvt_pk_bf16_f32 v29, v158, v159
    ds_write_b64 v13, v[28:29] offset:25344
    s_waitcnt vmcnt(27) lgkmcnt(1)
    v_mfma_f32_16x16x32_bf16 v[160:163], a[96:99], v[32:35], v[160:163]
    v_mfma_f32_16x16x32_bf16 v[164:167], a[100:103], v[32:35], v[164:167]
    ds_read_b128 v[48:51], v8 offset:4096
    v_mfma_f32_16x16x32_bf16 v[168:171], a[104:107], v[32:35], v[168:171]
    ds_read_b128 v[52:55], v8 offset:4352
    v_mfma_f32_16x16x32_bf16 v[172:175], a[96:99], v[36:39], v[172:175]
    v_mfma_f32_16x16x32_bf16 v[176:179], a[100:103], v[36:39], v[176:179]
    ds_read_b128 v[56:59], v8 offset:4608
    v_mfma_f32_16x16x32_bf16 v[180:183], a[104:107], v[36:39], v[180:183]
    ds_read_b128 v[60:63], v8 offset:4864
    v_mfma_f32_16x16x32_bf16 v[184:187], a[96:99], v[40:43], v[184:187]
    v_mfma_f32_16x16x32_bf16 v[188:191], a[100:103], v[40:43], v[188:191]
    buffer_load_dwordx4 a[84:87], v6, s[52:55], s9 offen offset:0
    v_mfma_f32_16x16x32_bf16 v[192:195], a[104:107], v[40:43], v[192:195]
    buffer_load_dwordx4 a[88:91], v6, s[52:55], s9 offen offset:1024
    v_mfma_f32_16x16x32_bf16 v[196:199], a[96:99], v[44:47], v[196:199]
    v_mfma_f32_16x16x32_bf16 v[200:203], a[100:103], v[44:47], v[200:203]
    buffer_load_dwordx4 a[92:95], v6, s[52:55], s9 offen offset:2048
    v_mfma_f32_16x16x32_bf16 v[204:207], a[104:107], v[44:47], v[204:207]
    s_add_u32 s9, s9, 3072
    s_waitcnt lgkmcnt(4)
    s_barrier
    s_waitcnt vmcnt(27) lgkmcnt(0)
    v_mfma_f32_16x16x32_bf16 v[160:163], a[108:111], v[48:51], v[160:163]
    v_mfma_f32_16x16x32_bf16 v[164:167], a[112:115], v[48:51], v[164:167]
    ds_read_b128 v[32:35], v9 offset:0
    v_mfma_f32_16x16x32_bf16 v[168:171], a[116:119], v[48:51], v[168:171]
    ds_read_b128 v[36:39], v9 offset:256
    v_mfma_f32_16x16x32_bf16 v[172:175], a[108:111], v[52:55], v[172:175]
    v_mfma_f32_16x16x32_bf16 v[176:179], a[112:115], v[52:55], v[176:179]
    ds_read_b128 v[40:43], v9 offset:512
    v_mfma_f32_16x16x32_bf16 v[180:183], a[116:119], v[52:55], v[180:183]
    ds_read_b128 v[44:47], v9 offset:768
    v_mfma_f32_16x16x32_bf16 v[184:187], a[108:111], v[56:59], v[184:187]
    v_mfma_f32_16x16x32_bf16 v[188:191], a[112:115], v[56:59], v[188:191]
    buffer_load_dwordx4 a[96:99], v6, s[52:55], s9 offen offset:0
    v_mfma_f32_16x16x32_bf16 v[192:195], a[116:119], v[56:59], v[192:195]
    buffer_load_dwordx4 a[100:103], v6, s[52:55], s9 offen offset:1024
    v_mfma_f32_16x16x32_bf16 v[196:199], a[108:111], v[60:63], v[196:199]
    v_mfma_f32_16x16x32_bf16 v[200:203], a[112:115], v[60:63], v[200:203]
    buffer_load_dwordx4 a[104:107], v6, s[52:55], s9 offen offset:2048
    v_mfma_f32_16x16x32_bf16 v[204:207], a[116:119], v[60:63], v[204:207]
    s_add_u32 s9, s9, 3072
    s_waitcnt vmcnt(27) lgkmcnt(0)
    v_mfma_f32_16x16x32_bf16 v[64:67], a[120:123], v[32:35], 0
    ds_read_b128 v[48:51], v9 offset:4096
    ds_read_b128 v[52:55], v9 offset:4352
    ds_read_b128 v[56:59], v9 offset:4608
    v_mfma_f32_16x16x32_bf16 v[68:71], a[124:127], v[32:35], 0
    ds_read_b128 v[60:63], v9 offset:4864
    buffer_load_dwordx4 a[108:111], v6, s[52:55], s9 offen offset:0
    v_mul_f32 v16, v160, v160
    v_mul_f32 v17, v161, v161
    v_mfma_f32_16x16x32_bf16 v[72:75], a[128:131], v[32:35], 0
    v_mul_f32 v18, v162, v162
    v_mul_f32 v19, v163, v163
    v_fma_f32 v16, v16, v245, v244
    v_fma_f32 v17, v17, v245, v244
    v_mfma_f32_16x16x32_bf16 v[76:79], a[120:123], v[36:39], 0
    v_fma_f32 v18, v18, v245, v244
    v_fma_f32 v19, v19, v245, v244
    v_mul_f32 v16, v16, v160
    buffer_load_dwordx4 a[112:115], v6, s[52:55], s9 offen offset:1024
    v_mfma_f32_16x16x32_bf16 v[80:83], a[124:127], v[36:39], 0
    v_mul_f32 v17, v17, v161
    v_mul_f32 v18, v18, v162
    v_mul_f32 v19, v19, v163
    v_mfma_f32_16x16x32_bf16 v[84:87], a[128:131], v[36:39], 0
    v_exp_f32 v16, v16
    v_exp_f32 v17, v17
    v_exp_f32 v18, v18
    v_exp_f32 v19, v19
    v_mfma_f32_16x16x32_bf16 v[88:91], a[120:123], v[40:43], 0
    v_add_f32 v16, 1.0, v16
    v_add_f32 v17, 1.0, v17
    buffer_load_dwordx4 a[116:119], v6, s[52:55], s9 offen offset:2048
    v_add_f32 v18, 1.0, v18
    v_mfma_f32_16x16x32_bf16 v[92:95], a[124:127], v[40:43], 0
    v_add_f32 v19, 1.0, v19
    v_rcp_f32 v16, v16
    v_rcp_f32 v17, v17
    v_rcp_f32 v18, v18
    v_mfma_f32_16x16x32_bf16 v[96:99], a[128:131], v[40:43], 0
    v_rcp_f32 v19, v19
    v_mul_f32 v160, v160, v16
    v_mul_f32 v161, v161, v17
    v_mfma_f32_16x16x32_bf16 v[100:103], a[120:123], v[44:47], 0
    v_mul_f32 v162, v162, v18
    s_add_u32 s9, s9, 3072
    v_mul_f32 v163, v163, v19
    v_cvt_pk_bf16_f32 v16, v160, v161
    v_mfma_f32_16x16x32_bf16 v[104:107], a[124:127], v[44:47], 0
    v_cvt_pk_bf16_f32 v17, v162, v163
    ds_write_b64 v11, v[16:17] offset:49152
    v_mul_f32 v20, v164, v164
    v_mul_f32 v21, v165, v165
    v_mfma_f32_16x16x32_bf16 v[108:111], a[128:131], v[44:47], 0
    v_mul_f32 v22, v166, v166
    v_mul_f32 v23, v167, v167
    v_fma_f32 v20, v20, v245, v244
    v_fma_f32 v21, v21, v245, v244
    s_waitcnt vmcnt(27) lgkmcnt(1)
    v_mfma_f32_16x16x32_bf16 v[64:67], a[0:3], v[48:51], v[64:67]
    ds_read_b128 v[32:35], v9 offset:8192
    ds_read_b128 v[36:39], v9 offset:8448
    ds_read_b128 v[40:43], v9 offset:8704
    v_mfma_f32_16x16x32_bf16 v[68:71], a[4:7], v[48:51], v[68:71]
    ds_read_b128 v[44:47], v9 offset:8960
    buffer_load_dwordx4 a[120:123], v6, s[52:55], s9 offen offset:0
    v_fma_f32 v22, v22, v245, v244
    v_fma_f32 v23, v23, v245, v244
    v_mfma_f32_16x16x32_bf16 v[72:75], a[8:11], v[48:51], v[72:75]
    v_mul_f32 v20, v20, v164
    v_mul_f32 v21, v21, v165
    v_mul_f32 v22, v22, v166
    v_mul_f32 v23, v23, v167
    v_mfma_f32_16x16x32_bf16 v[76:79], a[0:3], v[52:55], v[76:79]
    v_exp_f32 v20, v20
    v_exp_f32 v21, v21
    v_exp_f32 v22, v22
    buffer_load_dwordx4 a[124:127], v6, s[52:55], s9 offen offset:1024
    v_mfma_f32_16x16x32_bf16 v[80:83], a[4:7], v[52:55], v[80:83]
    v_exp_f32 v23, v23
    v_add_f32 v20, 1.0, v20
    v_add_f32 v21, 1.0, v21
    v_mfma_f32_16x16x32_bf16 v[84:87], a[8:11], v[52:55], v[84:87]
    v_add_f32 v22, 1.0, v22
    v_add_f32 v23, 1.0, v23
    v_rcp_f32 v20, v20
    v_rcp_f32 v21, v21
    v_mfma_f32_16x16x32_bf16 v[88:91], a[0:3], v[56:59], v[88:91]
    v_rcp_f32 v22, v22
    v_rcp_f32 v23, v23
    buffer_load_dwordx4 a[128:131], v6, s[52:55], s9 offen offset:2048
    v_mul_f32 v164, v164, v20
    v_mfma_f32_16x16x32_bf16 v[92:95], a[4:7], v[56:59], v[92:95]
    v_mul_f32 v165, v165, v21
    v_mul_f32 v166, v166, v22
    v_mul_f32 v167, v167, v23
    v_cvt_pk_bf16_f32 v20, v164, v165
    v_mfma_f32_16x16x32_bf16 v[96:99], a[8:11], v[56:59], v[96:99]
    v_cvt_pk_bf16_f32 v21, v166, v167
    ds_write_b64 v12, v[20:21] offset:49152
    v_mul_f32 v24, v168, v168
    v_mfma_f32_16x16x32_bf16 v[100:103], a[0:3], v[60:63], v[100:103]
    v_mul_f32 v25, v169, v169
    s_add_u32 s9, s9, 3072
    v_mul_f32 v26, v170, v170
    v_mul_f32 v27, v171, v171
    v_mfma_f32_16x16x32_bf16 v[104:107], a[4:7], v[60:63], v[104:107]
    v_fma_f32 v24, v24, v245, v244
    v_fma_f32 v25, v25, v245, v244
    v_fma_f32 v26, v26, v245, v244
    v_fma_f32 v27, v27, v245, v244
    v_mfma_f32_16x16x32_bf16 v[108:111], a[8:11], v[60:63], v[108:111]
    v_mul_f32 v24, v24, v168
    v_mul_f32 v25, v25, v169
    v_mul_f32 v26, v26, v170
    v_mul_f32 v27, v27, v171
    s_waitcnt vmcnt(27) lgkmcnt(1)
    v_mfma_f32_16x16x32_bf16 v[64:67], a[12:15], v[32:35], v[64:67]
    ds_read_b128 v[48:51], v9 offset:12288
    ds_read_b128 v[52:55], v9 offset:12544
    ds_read_b128 v[56:59], v9 offset:12800
    v_mfma_f32_16x16x32_bf16 v[68:71], a[16:19], v[32:35], v[68:71]
    ds_read_b128 v[60:63], v9 offset:13056
    buffer_load_dwordx4 a[0:3], v6, s[52:55], s9 offen offset:0
    v_exp_f32 v24, v24
    v_exp_f32 v25, v25
    v_mfma_f32_16x16x32_bf16 v[72:75], a[20:23], v[32:35], v[72:75]
    v_exp_f32 v26, v26
    v_exp_f32 v27, v27
    v_add_f32 v24, 1.0, v24
    v_add_f32 v25, 1.0, v25
    v_mfma_f32_16x16x32_bf16 v[76:79], a[12:15], v[36:39], v[76:79]
    v_add_f32 v26, 1.0, v26
    v_add_f32 v27, 1.0, v27
    v_rcp_f32 v24, v24
    buffer_load_dwordx4 a[4:7], v6, s[52:55], s9 offen offset:1024
    v_mfma_f32_16x16x32_bf16 v[80:83], a[16:19], v[36:39], v[80:83]
    v_rcp_f32 v25, v25
    v_rcp_f32 v26, v26
    v_rcp_f32 v27, v27
    v_mfma_f32_16x16x32_bf16 v[84:87], a[20:23], v[36:39], v[84:87]
    v_mul_f32 v168, v168, v24
    v_mul_f32 v169, v169, v25
    v_mul_f32 v170, v170, v26
    v_mul_f32 v171, v171, v27
    v_mfma_f32_16x16x32_bf16 v[88:91], a[12:15], v[40:43], v[88:91]
    v_cvt_pk_bf16_f32 v24, v168, v169
    v_cvt_pk_bf16_f32 v25, v170, v171
    buffer_load_dwordx4 a[8:11], v6, s[52:55], s9 offen offset:2048
    ds_write_b64 v13, v[24:25] offset:49152
    v_mfma_f32_16x16x32_bf16 v[92:95], a[16:19], v[40:43], v[92:95]
    v_mul_f32 v28, v172, v172
    v_mul_f32 v29, v173, v173
    v_mul_f32 v30, v174, v174
    v_mul_f32 v31, v175, v175
    v_mfma_f32_16x16x32_bf16 v[96:99], a[20:23], v[40:43], v[96:99]
    v_fma_f32 v28, v28, v247, v246
    v_fma_f32 v29, v29, v247, v246
    v_fma_f32 v30, v30, v247, v246
    v_mfma_f32_16x16x32_bf16 v[100:103], a[12:15], v[44:47], v[100:103]
    v_fma_f32 v31, v31, v247, v246
    s_add_u32 s9, s9, 3072
    v_mul_f32 v28, v28, v172
    v_mul_f32 v29, v29, v173
    v_mfma_f32_16x16x32_bf16 v[104:107], a[16:19], v[44:47], v[104:107]
    v_mul_f32 v30, v30, v174
    v_mul_f32 v31, v31, v175
    v_exp_f32 v28, v28
    v_exp_f32 v29, v29
    v_mfma_f32_16x16x32_bf16 v[108:111], a[20:23], v[44:47], v[108:111]
    v_exp_f32 v30, v30
    v_exp_f32 v31, v31
    v_add_f32 v28, 1.0, v28
    v_add_f32 v29, 1.0, v29
    s_waitcnt vmcnt(27) lgkmcnt(1)
    v_mfma_f32_16x16x32_bf16 v[64:67], a[24:27], v[48:51], v[64:67]
    ds_read_b128 v[32:35], v9 offset:16384
    ds_read_b128 v[36:39], v9 offset:16640
    ds_read_b128 v[40:43], v9 offset:16896
    v_mfma_f32_16x16x32_bf16 v[68:71], a[28:31], v[48:51], v[68:71]
    ds_read_b128 v[44:47], v9 offset:17152
    buffer_load_dwordx4 a[12:15], v6, s[52:55], s9 offen offset:0
    v_add_f32 v30, 1.0, v30
    v_add_f32 v31, 1.0, v31
    v_mfma_f32_16x16x32_bf16 v[72:75], a[32:35], v[48:51], v[72:75]
    v_rcp_f32 v28, v28
    v_rcp_f32 v29, v29
    v_rcp_f32 v30, v30
    v_rcp_f32 v31, v31
    v_mfma_f32_16x16x32_bf16 v[76:79], a[24:27], v[52:55], v[76:79]
    v_mul_f32 v172, v172, v28
    v_mul_f32 v173, v173, v29
    v_mul_f32 v174, v174, v30
    buffer_load_dwordx4 a[16:19], v6, s[52:55], s9 offen offset:1024
    v_mfma_f32_16x16x32_bf16 v[80:83], a[28:31], v[52:55], v[80:83]
    v_mul_f32 v175, v175, v31
    v_cvt_pk_bf16_f32 v28, v172, v173
    v_cvt_pk_bf16_f32 v29, v174, v175
    v_mfma_f32_16x16x32_bf16 v[84:87], a[32:35], v[52:55], v[84:87]
    ds_write_b64 v11, v[28:29] offset:49408
    v_mul_f32 v16, v176, v176
    v_mul_f32 v17, v177, v177
    v_mul_f32 v18, v178, v178
    v_mfma_f32_16x16x32_bf16 v[88:91], a[24:27], v[56:59], v[88:91]
    v_mul_f32 v19, v179, v179
    v_fma_f32 v16, v16, v247, v246
    buffer_load_dwordx4 a[20:23], v6, s[52:55], s9 offen offset:2048
    v_fma_f32 v17, v17, v247, v246
    v_mfma_f32_16x16x32_bf16 v[92:95], a[28:31], v[56:59], v[92:95]
    v_fma_f32 v18, v18, v247, v246
    v_fma_f32 v19, v19, v247, v246
    v_mul_f32 v16, v16, v176
    v_mul_f32 v17, v17, v177
    v_mfma_f32_16x16x32_bf16 v[96:99], a[32:35], v[56:59], v[96:99]
    v_mul_f32 v18, v18, v178
    v_mul_f32 v19, v19, v179
    v_exp_f32 v16, v16
    v_mfma_f32_16x16x32_bf16 v[100:103], a[24:27], v[60:63], v[100:103]
    v_exp_f32 v17, v17
    s_add_u32 s9, s9, 3072
    v_exp_f32 v18, v18
    v_exp_f32 v19, v19
    v_mfma_f32_16x16x32_bf16 v[104:107], a[28:31], v[60:63], v[104:107]
    v_add_f32 v16, 1.0, v16
    v_add_f32 v17, 1.0, v17
    v_add_f32 v18, 1.0, v18
    v_add_f32 v19, 1.0, v19
    v_mfma_f32_16x16x32_bf16 v[108:111], a[32:35], v[60:63], v[108:111]
    v_rcp_f32 v16, v16
    v_rcp_f32 v17, v17
    v_rcp_f32 v18, v18
    v_rcp_f32 v19, v19
    s_waitcnt vmcnt(27) lgkmcnt(1)
    v_mfma_f32_16x16x32_bf16 v[64:67], a[36:39], v[32:35], v[64:67]
    ds_read_b128 v[48:51], v9 offset:20480
    ds_read_b128 v[52:55], v9 offset:20736
    ds_read_b128 v[56:59], v9 offset:20992
    v_mfma_f32_16x16x32_bf16 v[68:71], a[40:43], v[32:35], v[68:71]
    ds_read_b128 v[60:63], v9 offset:21248
    buffer_load_dwordx4 a[24:27], v6, s[52:55], s9 offen offset:0
    v_mul_f32 v176, v176, v16
    v_mul_f32 v177, v177, v17
    v_mfma_f32_16x16x32_bf16 v[72:75], a[44:47], v[32:35], v[72:75]
    v_mul_f32 v178, v178, v18
    v_mul_f32 v179, v179, v19
    v_cvt_pk_bf16_f32 v16, v176, v177
    v_cvt_pk_bf16_f32 v17, v178, v179
    v_mfma_f32_16x16x32_bf16 v[76:79], a[36:39], v[36:39], v[76:79]
    ds_write_b64 v12, v[16:17] offset:49408
    v_mul_f32 v20, v180, v180
    v_mul_f32 v21, v181, v181
    buffer_load_dwordx4 a[28:31], v6, s[52:55], s9 offen offset:1024
    v_mfma_f32_16x16x32_bf16 v[80:83], a[40:43], v[36:39], v[80:83]
    v_mul_f32 v22, v182, v182
    v_mul_f32 v23, v183, v183
    v_fma_f32 v20, v20, v247, v246
    v_fma_f32 v21, v21, v247, v246
    v_mfma_f32_16x16x32_bf16 v[84:87], a[44:47], v[36:39], v[84:87]
    v_fma_f32 v22, v22, v247, v246
    v_fma_f32 v23, v23, v247, v246
    v_mul_f32 v20, v20, v180
    v_mul_f32 v21, v21, v181
    v_mfma_f32_16x16x32_bf16 v[88:91], a[36:39], v[40:43], v[88:91]
    v_mul_f32 v22, v22, v182
    buffer_load_dwordx4 a[32:35], v6, s[52:55], s9 offen offset:2048
    v_mul_f32 v23, v23, v183
    v_mfma_f32_16x16x32_bf16 v[92:95], a[40:43], v[40:43], v[92:95]
    v_exp_f32 v20, v20
    v_exp_f32 v21, v21
    v_exp_f32 v22, v22
    v_exp_f32 v23, v23
    v_mfma_f32_16x16x32_bf16 v[96:99], a[44:47], v[40:43], v[96:99]
    v_add_f32 v20, 1.0, v20
    v_add_f32 v21, 1.0, v21
    v_add_f32 v22, 1.0, v22
    v_add_f32 v23, 1.0, v23
    v_mfma_f32_16x16x32_bf16 v[100:103], a[36:39], v[44:47], v[100:103]
    s_add_u32 s9, s9, 3072
    v_rcp_f32 v20, v20
    v_rcp_f32 v21, v21
    v_rcp_f32 v22, v22
    v_mfma_f32_16x16x32_bf16 v[104:107], a[40:43], v[44:47], v[104:107]
    v_rcp_f32 v23, v23
    v_mul_f32 v180, v180, v20
    v_mul_f32 v181, v181, v21
    v_mul_f32 v182, v182, v22
    v_mfma_f32_16x16x32_bf16 v[108:111], a[44:47], v[44:47], v[108:111]
    v_mul_f32 v183, v183, v23
    v_cvt_pk_bf16_f32 v20, v180, v181
    v_cvt_pk_bf16_f32 v21, v182, v183
    ds_write_b64 v13, v[20:21] offset:49408
    s_waitcnt vmcnt(27) lgkmcnt(2)
    v_mfma_f32_16x16x32_bf16 v[64:67], a[48:51], v[48:51], v[64:67]
    ds_read_b128 v[32:35], v9 offset:24576
    ds_read_b128 v[36:39], v9 offset:24832
    ds_read_b128 v[40:43], v9 offset:25088
    v_mfma_f32_16x16x32_bf16 v[68:71], a[52:55], v[48:51], v[68:71]
    ds_read_b128 v[44:47], v9 offset:25344
    buffer_load_dwordx4 a[36:39], v6, s[52:55], s9 offen offset:0
    v_mul_f32 v24, v184, v184
    v_mul_f32 v25, v185, v185
    v_mfma_f32_16x16x32_bf16 v[72:75], a[56:59], v[48:51], v[72:75]
    v_mul_f32 v26, v186, v186
    v_mul_f32 v27, v187, v187
    v_fma_f32 v24, v24, v249, v248
    v_fma_f32 v25, v25, v249, v248
    v_mfma_f32_16x16x32_bf16 v[76:79], a[48:51], v[52:55], v[76:79]
    v_fma_f32 v26, v26, v249, v248
    v_fma_f32 v27, v27, v249, v248
    v_mul_f32 v24, v24, v184
    buffer_load_dwordx4 a[40:43], v6, s[52:55], s9 offen offset:1024
    v_mfma_f32_16x16x32_bf16 v[80:83], a[52:55], v[52:55], v[80:83]
    v_mul_f32 v25, v25, v185
    v_mul_f32 v26, v26, v186
    v_mul_f32 v27, v27, v187
    v_mfma_f32_16x16x32_bf16 v[84:87], a[56:59], v[52:55], v[84:87]
    v_exp_f32 v24, v24
    v_exp_f32 v25, v25
    v_exp_f32 v26, v26
    v_exp_f32 v27, v27
    v_mfma_f32_16x16x32_bf16 v[88:91], a[48:51], v[56:59], v[88:91]
    v_add_f32 v24, 1.0, v24
    v_add_f32 v25, 1.0, v25
    buffer_load_dwordx4 a[44:47], v6, s[52:55], s9 offen offset:2048
    v_add_f32 v26, 1.0, v26
    v_mfma_f32_16x16x32_bf16 v[92:95], a[52:55], v[56:59], v[92:95]
    v_add_f32 v27, 1.0, v27
    v_rcp_f32 v24, v24
    v_rcp_f32 v25, v25
    v_rcp_f32 v26, v26
    v_mfma_f32_16x16x32_bf16 v[96:99], a[56:59], v[56:59], v[96:99]
    v_rcp_f32 v27, v27
    v_mul_f32 v184, v184, v24
    v_mul_f32 v185, v185, v25
    v_mfma_f32_16x16x32_bf16 v[100:103], a[48:51], v[60:63], v[100:103]
    v_mul_f32 v186, v186, v26
    s_add_u32 s9, s9, 3072
    v_mul_f32 v187, v187, v27
    v_cvt_pk_bf16_f32 v24, v184, v185
    v_mfma_f32_16x16x32_bf16 v[104:107], a[52:55], v[60:63], v[104:107]
    v_cvt_pk_bf16_f32 v25, v186, v187
    ds_write_b64 v11, v[24:25] offset:49664
    v_mul_f32 v28, v188, v188
    v_mul_f32 v29, v189, v189
    v_mfma_f32_16x16x32_bf16 v[108:111], a[56:59], v[60:63], v[108:111]
    v_mul_f32 v30, v190, v190
    v_mul_f32 v31, v191, v191
    v_fma_f32 v28, v28, v249, v248
    v_fma_f32 v29, v29, v249, v248
    s_waitcnt vmcnt(27) lgkmcnt(1)
    v_mfma_f32_16x16x32_bf16 v[64:67], a[60:63], v[32:35], v[64:67]
    ds_read_b128 v[48:51], v9 offset:28672
    ds_read_b128 v[52:55], v9 offset:28928
    ds_read_b128 v[56:59], v9 offset:29184
    v_mfma_f32_16x16x32_bf16 v[68:71], a[64:67], v[32:35], v[68:71]
    ds_read_b128 v[60:63], v9 offset:29440
    buffer_load_dwordx4 a[48:51], v6, s[52:55], s9 offen offset:0
    v_fma_f32 v30, v30, v249, v248
    v_fma_f32 v31, v31, v249, v248
    v_mfma_f32_16x16x32_bf16 v[72:75], a[68:71], v[32:35], v[72:75]
    v_mul_f32 v28, v28, v188
    v_mul_f32 v29, v29, v189
    v_mul_f32 v30, v30, v190
    v_mul_f32 v31, v31, v191
    v_mfma_f32_16x16x32_bf16 v[76:79], a[60:63], v[36:39], v[76:79]
    v_exp_f32 v28, v28
    v_exp_f32 v29, v29
    v_exp_f32 v30, v30
    buffer_load_dwordx4 a[52:55], v6, s[52:55], s9 offen offset:1024
    v_mfma_f32_16x16x32_bf16 v[80:83], a[64:67], v[36:39], v[80:83]
    v_exp_f32 v31, v31
    v_add_f32 v28, 1.0, v28
    v_add_f32 v29, 1.0, v29
    v_mfma_f32_16x16x32_bf16 v[84:87], a[68:71], v[36:39], v[84:87]
    v_add_f32 v30, 1.0, v30
    v_add_f32 v31, 1.0, v31
    v_rcp_f32 v28, v28
    v_rcp_f32 v29, v29
    v_mfma_f32_16x16x32_bf16 v[88:91], a[60:63], v[40:43], v[88:91]
    v_rcp_f32 v30, v30
    v_rcp_f32 v31, v31
    buffer_load_dwordx4 a[56:59], v6, s[52:55], s9 offen offset:2048
    v_mul_f32 v188, v188, v28
    v_mfma_f32_16x16x32_bf16 v[92:95], a[64:67], v[40:43], v[92:95]
    v_mul_f32 v189, v189, v29
    v_mul_f32 v190, v190, v30
    v_mul_f32 v191, v191, v31
    v_cvt_pk_bf16_f32 v28, v188, v189
    v_mfma_f32_16x16x32_bf16 v[96:99], a[68:71], v[40:43], v[96:99]
    v_cvt_pk_bf16_f32 v29, v190, v191
    ds_write_b64 v12, v[28:29] offset:49664
    v_mul_f32 v16, v192, v192
    v_mfma_f32_16x16x32_bf16 v[100:103], a[60:63], v[44:47], v[100:103]
    v_mul_f32 v17, v193, v193
    s_add_u32 s9, s9, 3072
    v_mul_f32 v18, v194, v194
    v_mul_f32 v19, v195, v195
    v_mfma_f32_16x16x32_bf16 v[104:107], a[64:67], v[44:47], v[104:107]
    v_fma_f32 v16, v16, v249, v248
    v_fma_f32 v17, v17, v249, v248
    v_fma_f32 v18, v18, v249, v248
    v_fma_f32 v19, v19, v249, v248
    v_mfma_f32_16x16x32_bf16 v[108:111], a[68:71], v[44:47], v[108:111]
    v_mul_f32 v16, v16, v192
    v_mul_f32 v17, v17, v193
    v_mul_f32 v18, v18, v194
    v_mul_f32 v19, v19, v195
    s_waitcnt vmcnt(27) lgkmcnt(1)
    v_mfma_f32_16x16x32_bf16 v[64:67], a[72:75], v[48:51], v[64:67]
    ds_read_b128 v[32:35], v9 offset:32768
    ds_read_b128 v[36:39], v9 offset:33024
    ds_read_b128 v[40:43], v9 offset:33280
    v_mfma_f32_16x16x32_bf16 v[68:71], a[76:79], v[48:51], v[68:71]
    ds_read_b128 v[44:47], v9 offset:33536
    buffer_load_dwordx4 a[60:63], v6, s[52:55], s9 offen offset:0
    v_exp_f32 v16, v16
    v_exp_f32 v17, v17
    v_mfma_f32_16x16x32_bf16 v[72:75], a[80:83], v[48:51], v[72:75]
    v_exp_f32 v18, v18
    v_exp_f32 v19, v19
    v_add_f32 v16, 1.0, v16
    v_add_f32 v17, 1.0, v17
    v_mfma_f32_16x16x32_bf16 v[76:79], a[72:75], v[52:55], v[76:79]
    v_add_f32 v18, 1.0, v18
    v_add_f32 v19, 1.0, v19
    v_rcp_f32 v16, v16
    buffer_load_dwordx4 a[64:67], v6, s[52:55], s9 offen offset:1024
    v_mfma_f32_16x16x32_bf16 v[80:83], a[76:79], v[52:55], v[80:83]
    v_rcp_f32 v17, v17
    v_rcp_f32 v18, v18
    v_rcp_f32 v19, v19
    v_mfma_f32_16x16x32_bf16 v[84:87], a[80:83], v[52:55], v[84:87]
    v_mul_f32 v192, v192, v16
    v_mul_f32 v193, v193, v17
    v_mul_f32 v194, v194, v18
    v_mul_f32 v195, v195, v19
    v_mfma_f32_16x16x32_bf16 v[88:91], a[72:75], v[56:59], v[88:91]
    v_cvt_pk_bf16_f32 v16, v192, v193
    v_cvt_pk_bf16_f32 v17, v194, v195
    buffer_load_dwordx4 a[68:71], v6, s[52:55], s9 offen offset:2048
    ds_write_b64 v13, v[16:17] offset:49664
    v_mfma_f32_16x16x32_bf16 v[92:95], a[76:79], v[56:59], v[92:95]
    v_mul_f32 v20, v196, v196
    v_mul_f32 v21, v197, v197
    v_mul_f32 v22, v198, v198
    v_mul_f32 v23, v199, v199
    v_mfma_f32_16x16x32_bf16 v[96:99], a[80:83], v[56:59], v[96:99]
    v_fma_f32 v20, v20, v251, v250
    v_fma_f32 v21, v21, v251, v250
    v_fma_f32 v22, v22, v251, v250
    v_mfma_f32_16x16x32_bf16 v[100:103], a[72:75], v[60:63], v[100:103]
    v_fma_f32 v23, v23, v251, v250
    s_add_u32 s9, s9, 3072
    v_mul_f32 v20, v20, v196
    v_mul_f32 v21, v21, v197
    v_mfma_f32_16x16x32_bf16 v[104:107], a[76:79], v[60:63], v[104:107]
    v_mul_f32 v22, v22, v198
    v_mul_f32 v23, v23, v199
    v_exp_f32 v20, v20
    v_exp_f32 v21, v21
    v_mfma_f32_16x16x32_bf16 v[108:111], a[80:83], v[60:63], v[108:111]
    v_exp_f32 v22, v22
    v_exp_f32 v23, v23
    v_add_f32 v20, 1.0, v20
    v_add_f32 v21, 1.0, v21
    s_waitcnt vmcnt(27) lgkmcnt(1)
    v_mfma_f32_16x16x32_bf16 v[64:67], a[84:87], v[32:35], v[64:67]
    ds_read_b128 v[48:51], v9 offset:36864
    ds_read_b128 v[52:55], v9 offset:37120
    ds_read_b128 v[56:59], v9 offset:37376
    v_mfma_f32_16x16x32_bf16 v[68:71], a[88:91], v[32:35], v[68:71]
    ds_read_b128 v[60:63], v9 offset:37632
    buffer_load_dwordx4 a[72:75], v6, s[52:55], s9 offen offset:0
    v_add_f32 v22, 1.0, v22
    v_add_f32 v23, 1.0, v23
    v_mfma_f32_16x16x32_bf16 v[72:75], a[92:95], v[32:35], v[72:75]
    v_rcp_f32 v20, v20
    v_rcp_f32 v21, v21
    v_rcp_f32 v22, v22
    v_rcp_f32 v23, v23
    v_mfma_f32_16x16x32_bf16 v[76:79], a[84:87], v[36:39], v[76:79]
    v_mul_f32 v196, v196, v20
    v_mul_f32 v197, v197, v21
    v_mul_f32 v198, v198, v22
    buffer_load_dwordx4 a[76:79], v6, s[52:55], s9 offen offset:1024
    v_mfma_f32_16x16x32_bf16 v[80:83], a[88:91], v[36:39], v[80:83]
    v_mul_f32 v199, v199, v23
    v_cvt_pk_bf16_f32 v20, v196, v197
    v_cvt_pk_bf16_f32 v21, v198, v199
    v_mfma_f32_16x16x32_bf16 v[84:87], a[92:95], v[36:39], v[84:87]
    ds_write_b64 v11, v[20:21] offset:49920
    v_mul_f32 v24, v200, v200
    v_mul_f32 v25, v201, v201
    v_mul_f32 v26, v202, v202
    v_mfma_f32_16x16x32_bf16 v[88:91], a[84:87], v[40:43], v[88:91]
    v_mul_f32 v27, v203, v203
    v_fma_f32 v24, v24, v251, v250
    buffer_load_dwordx4 a[80:83], v6, s[52:55], s9 offen offset:2048
    v_fma_f32 v25, v25, v251, v250
    v_mfma_f32_16x16x32_bf16 v[92:95], a[88:91], v[40:43], v[92:95]
    v_fma_f32 v26, v26, v251, v250
    v_fma_f32 v27, v27, v251, v250
    v_mul_f32 v24, v24, v200
    v_mul_f32 v25, v25, v201
    v_mfma_f32_16x16x32_bf16 v[96:99], a[92:95], v[40:43], v[96:99]
    v_mul_f32 v26, v26, v202
    v_mul_f32 v27, v27, v203
    v_exp_f32 v24, v24
    v_mfma_f32_16x16x32_bf16 v[100:103], a[84:87], v[44:47], v[100:103]
    v_exp_f32 v25, v25
    s_add_u32 s9, s9, 3072
    v_exp_f32 v26, v26
    v_exp_f32 v27, v27
    v_mfma_f32_16x16x32_bf16 v[104:107], a[88:91], v[44:47], v[104:107]
    v_add_f32 v24, 1.0, v24
    v_add_f32 v25, 1.0, v25
    v_add_f32 v26, 1.0, v26
    v_add_f32 v27, 1.0, v27
    v_mfma_f32_16x16x32_bf16 v[108:111], a[92:95], v[44:47], v[108:111]
    v_rcp_f32 v24, v24
    v_rcp_f32 v25, v25
    v_rcp_f32 v26, v26
    v_rcp_f32 v27, v27
    s_waitcnt vmcnt(27) lgkmcnt(1)
    v_mfma_f32_16x16x32_bf16 v[64:67], a[96:99], v[48:51], v[64:67]
    ds_read_b128 v[32:35], v9 offset:40960
    ds_read_b128 v[36:39], v9 offset:41216
    ds_read_b128 v[40:43], v9 offset:41472
    v_mfma_f32_16x16x32_bf16 v[68:71], a[100:103], v[48:51], v[68:71]
    ds_read_b128 v[44:47], v9 offset:41728
    buffer_load_dwordx4 a[84:87], v6, s[52:55], s9 offen offset:0
    v_mul_f32 v200, v200, v24
    v_mul_f32 v201, v201, v25
    v_mfma_f32_16x16x32_bf16 v[72:75], a[104:107], v[48:51], v[72:75]
    v_mul_f32 v202, v202, v26
    v_mul_f32 v203, v203, v27
    v_cvt_pk_bf16_f32 v24, v200, v201
    v_cvt_pk_bf16_f32 v25, v202, v203
    v_mfma_f32_16x16x32_bf16 v[76:79], a[96:99], v[52:55], v[76:79]
    ds_write_b64 v12, v[24:25] offset:49920
    v_mul_f32 v28, v204, v204
    v_mul_f32 v29, v205, v205
    buffer_load_dwordx4 a[88:91], v6, s[52:55], s9 offen offset:1024
    v_mfma_f32_16x16x32_bf16 v[80:83], a[100:103], v[52:55], v[80:83]
    v_mul_f32 v30, v206, v206
    v_mul_f32 v31, v207, v207
    v_fma_f32 v28, v28, v251, v250
    v_fma_f32 v29, v29, v251, v250
    v_mfma_f32_16x16x32_bf16 v[84:87], a[104:107], v[52:55], v[84:87]
    v_fma_f32 v30, v30, v251, v250
    v_fma_f32 v31, v31, v251, v250
    v_mul_f32 v28, v28, v204
    v_mul_f32 v29, v29, v205
    v_mfma_f32_16x16x32_bf16 v[88:91], a[96:99], v[56:59], v[88:91]
    v_mul_f32 v30, v30, v206
    buffer_load_dwordx4 a[92:95], v6, s[52:55], s9 offen offset:2048
    v_mul_f32 v31, v31, v207
    v_mfma_f32_16x16x32_bf16 v[92:95], a[100:103], v[56:59], v[92:95]
    v_exp_f32 v28, v28
    v_exp_f32 v29, v29
    v_exp_f32 v30, v30
    v_exp_f32 v31, v31
    v_mfma_f32_16x16x32_bf16 v[96:99], a[104:107], v[56:59], v[96:99]
    v_add_f32 v28, 1.0, v28
    v_add_f32 v29, 1.0, v29
    v_add_f32 v30, 1.0, v30
    v_add_f32 v31, 1.0, v31
    v_mfma_f32_16x16x32_bf16 v[100:103], a[96:99], v[60:63], v[100:103]
    s_add_u32 s9, s9, 3072
    v_rcp_f32 v28, v28
    v_rcp_f32 v29, v29
    v_rcp_f32 v30, v30
    v_mfma_f32_16x16x32_bf16 v[104:107], a[100:103], v[60:63], v[104:107]
    v_rcp_f32 v31, v31
    v_mul_f32 v204, v204, v28
    v_mul_f32 v205, v205, v29
    v_mul_f32 v206, v206, v30
    v_mfma_f32_16x16x32_bf16 v[108:111], a[104:107], v[60:63], v[108:111]
    v_mul_f32 v207, v207, v31
    v_cvt_pk_bf16_f32 v28, v204, v205
    v_cvt_pk_bf16_f32 v29, v206, v207
    ds_write_b64 v13, v[28:29] offset:49920
    s_waitcnt vmcnt(27) lgkmcnt(2)
    v_mfma_f32_16x16x32_bf16 v[64:67], a[108:111], v[32:35], v[64:67]
    v_mfma_f32_16x16x32_bf16 v[68:71], a[112:115], v[32:35], v[68:71]
    ds_read_b128 v[48:51], v9 offset:45056
    v_mfma_f32_16x16x32_bf16 v[72:75], a[116:119], v[32:35], v[72:75]
    ds_read_b128 v[52:55], v9 offset:45312
    v_mfma_f32_16x16x32_bf16 v[76:79], a[108:111], v[36:39], v[76:79]
    v_mfma_f32_16x16x32_bf16 v[80:83], a[112:115], v[36:39], v[80:83]
    ds_read_b128 v[56:59], v9 offset:45568
    v_mfma_f32_16x16x32_bf16 v[84:87], a[116:119], v[36:39], v[84:87]
    ds_read_b128 v[60:63], v9 offset:45824
    v_mfma_f32_16x16x32_bf16 v[88:91], a[108:111], v[40:43], v[88:91]
    v_mfma_f32_16x16x32_bf16 v[92:95], a[112:115], v[40:43], v[92:95]
    buffer_load_dwordx4 a[96:99], v6, s[52:55], s9 offen offset:0
    v_mfma_f32_16x16x32_bf16 v[96:99], a[116:119], v[40:43], v[96:99]
    buffer_load_dwordx4 a[100:103], v6, s[52:55], s9 offen offset:1024
    v_mfma_f32_16x16x32_bf16 v[100:103], a[108:111], v[44:47], v[100:103]
    v_mfma_f32_16x16x32_bf16 v[104:107], a[112:115], v[44:47], v[104:107]
    buffer_load_dwordx4 a[104:107], v6, s[52:55], s9 offen offset:2048
    v_mfma_f32_16x16x32_bf16 v[108:111], a[116:119], v[44:47], v[108:111]
    s_add_u32 s9, s9, 3072
    s_waitcnt lgkmcnt(4)
    s_barrier
    s_waitcnt vmcnt(27) lgkmcnt(0)
    v_mfma_f32_16x16x32_bf16 v[64:67], a[120:123], v[48:51], v[64:67]
    v_mfma_f32_16x16x32_bf16 v[68:71], a[124:127], v[48:51], v[68:71]
    ds_read_b128 v[32:35], v9 offset:49152
    v_mfma_f32_16x16x32_bf16 v[72:75], a[128:131], v[48:51], v[72:75]
    ds_read_b128 v[36:39], v9 offset:49408
    v_mfma_f32_16x16x32_bf16 v[76:79], a[120:123], v[52:55], v[76:79]
    v_mfma_f32_16x16x32_bf16 v[80:83], a[124:127], v[52:55], v[80:83]
    ds_read_b128 v[40:43], v9 offset:49664
    v_mfma_f32_16x16x32_bf16 v[84:87], a[128:131], v[52:55], v[84:87]
    ds_read_b128 v[44:47], v9 offset:49920
    v_mfma_f32_16x16x32_bf16 v[88:91], a[120:123], v[56:59], v[88:91]
    v_mfma_f32_16x16x32_bf16 v[92:95], a[124:127], v[56:59], v[92:95]
    buffer_load_dwordx4 a[108:111], v6, s[52:55], s9 offen offset:0
    v_mfma_f32_16x16x32_bf16 v[96:99], a[128:131], v[56:59], v[96:99]
    buffer_load_dwordx4 a[112:115], v6, s[52:55], s9 offen offset:1024
    v_mfma_f32_16x16x32_bf16 v[100:103], a[120:123], v[60:63], v[100:103]
    v_mfma_f32_16x16x32_bf16 v[104:107], a[124:127], v[60:63], v[104:107]
    buffer_load_dwordx4 a[116:119], v6, s[52:55], s9 offen offset:2048
    v_mfma_f32_16x16x32_bf16 v[108:111], a[128:131], v[60:63], v[108:111]
    s_add_u32 s9, s9, 3072
    s_waitcnt vmcnt(27) lgkmcnt(0)
    v_mfma_f32_16x16x32_bf16 v[64:67], a[0:3], v[32:35], v[64:67]
    v_mfma_f32_16x16x32_bf16 v[68:71], a[4:7], v[32:35], v[68:71]
    ds_read_b128 v[48:51], v9 offset:53248
    v_mfma_f32_16x16x32_bf16 v[72:75], a[8:11], v[32:35], v[72:75]
    ds_read_b128 v[52:55], v9 offset:53504
    v_mfma_f32_16x16x32_bf16 v[76:79], a[0:3], v[36:39], v[76:79]
    v_mfma_f32_16x16x32_bf16 v[80:83], a[4:7], v[36:39], v[80:83]
    ds_read_b128 v[56:59], v9 offset:53760
    v_mfma_f32_16x16x32_bf16 v[84:87], a[8:11], v[36:39], v[84:87]
    ds_read_b128 v[60:63], v9 offset:54016
    v_mfma_f32_16x16x32_bf16 v[88:91], a[0:3], v[40:43], v[88:91]
    v_mfma_f32_16x16x32_bf16 v[92:95], a[4:7], v[40:43], v[92:95]
    buffer_load_dwordx4 a[120:123], v6, s[52:55], s9 offen offset:0
    v_mfma_f32_16x16x32_bf16 v[96:99], a[8:11], v[40:43], v[96:99]
    buffer_load_dwordx4 a[124:127], v6, s[52:55], s9 offen offset:1024
    v_mfma_f32_16x16x32_bf16 v[100:103], a[0:3], v[44:47], v[100:103]
    v_mfma_f32_16x16x32_bf16 v[104:107], a[4:7], v[44:47], v[104:107]
    buffer_load_dwordx4 a[128:131], v6, s[52:55], s9 offen offset:2048
    v_mfma_f32_16x16x32_bf16 v[108:111], a[8:11], v[44:47], v[108:111]
    s_add_u32 s9, s9, 3072
    s_waitcnt vmcnt(27) lgkmcnt(0)
    v_mfma_f32_16x16x32_bf16 v[64:67], a[12:15], v[48:51], v[64:67]
    v_mfma_f32_16x16x32_bf16 v[68:71], a[16:19], v[48:51], v[68:71]
    ds_read_b128 v[32:35], v9 offset:57344
    v_mfma_f32_16x16x32_bf16 v[72:75], a[20:23], v[48:51], v[72:75]
    ds_read_b128 v[36:39], v9 offset:57600
    v_mfma_f32_16x16x32_bf16 v[76:79], a[12:15], v[52:55], v[76:79]
    v_mfma_f32_16x16x32_bf16 v[80:83], a[16:19], v[52:55], v[80:83]
    ds_read_b128 v[40:43], v9 offset:57856
    v_mfma_f32_16x16x32_bf16 v[84:87], a[20:23], v[52:55], v[84:87]
    ds_read_b128 v[44:47], v9 offset:58112
    v_mfma_f32_16x16x32_bf16 v[88:91], a[12:15], v[56:59], v[88:91]
    v_mfma_f32_16x16x32_bf16 v[92:95], a[16:19], v[56:59], v[92:95]
    buffer_load_dwordx4 a[0:3], v6, s[52:55], s9 offen offset:0
    v_mfma_f32_16x16x32_bf16 v[96:99], a[20:23], v[56:59], v[96:99]
    buffer_load_dwordx4 a[4:7], v6, s[52:55], s9 offen offset:1024
    v_mfma_f32_16x16x32_bf16 v[100:103], a[12:15], v[60:63], v[100:103]
    v_mfma_f32_16x16x32_bf16 v[104:107], a[16:19], v[60:63], v[104:107]
    buffer_load_dwordx4 a[8:11], v6, s[52:55], s9 offen offset:2048
    v_mfma_f32_16x16x32_bf16 v[108:111], a[20:23], v[60:63], v[108:111]
    s_add_u32 s9, s9, 3072
    s_waitcnt vmcnt(27) lgkmcnt(0)
    v_mfma_f32_16x16x32_bf16 v[64:67], a[24:27], v[32:35], v[64:67]
    v_mfma_f32_16x16x32_bf16 v[68:71], a[28:31], v[32:35], v[68:71]
    ds_read_b128 v[48:51], v9 offset:61440
    v_mfma_f32_16x16x32_bf16 v[72:75], a[32:35], v[32:35], v[72:75]
    ds_read_b128 v[52:55], v9 offset:61696
    v_mfma_f32_16x16x32_bf16 v[76:79], a[24:27], v[36:39], v[76:79]
    v_mfma_f32_16x16x32_bf16 v[80:83], a[28:31], v[36:39], v[80:83]
    ds_read_b128 v[56:59], v9 offset:61952
    v_mfma_f32_16x16x32_bf16 v[84:87], a[32:35], v[36:39], v[84:87]
    ds_read_b128 v[60:63], v9 offset:62208
    v_mfma_f32_16x16x32_bf16 v[88:91], a[24:27], v[40:43], v[88:91]
    v_mfma_f32_16x16x32_bf16 v[92:95], a[28:31], v[40:43], v[92:95]
    buffer_load_dwordx4 a[12:15], v6, s[52:55], s9 offen offset:0
    v_mfma_f32_16x16x32_bf16 v[96:99], a[32:35], v[40:43], v[96:99]
    buffer_load_dwordx4 a[16:19], v6, s[52:55], s9 offen offset:1024
    v_mfma_f32_16x16x32_bf16 v[100:103], a[24:27], v[44:47], v[100:103]
    v_mfma_f32_16x16x32_bf16 v[104:107], a[28:31], v[44:47], v[104:107]
    buffer_load_dwordx4 a[20:23], v6, s[52:55], s9 offen offset:2048
    v_mfma_f32_16x16x32_bf16 v[108:111], a[32:35], v[44:47], v[108:111]
    s_add_u32 s9, s9, 3072
    s_waitcnt vmcnt(27) lgkmcnt(0)
    v_mfma_f32_16x16x32_bf16 v[64:67], a[36:39], v[48:51], v[64:67]
    v_mfma_f32_16x16x32_bf16 v[68:71], a[40:43], v[48:51], v[68:71]
    ds_read_b128 v[32:35], v10 offset:0
    v_mfma_f32_16x16x32_bf16 v[72:75], a[44:47], v[48:51], v[72:75]
    ds_read_b128 v[36:39], v10 offset:256
    v_mfma_f32_16x16x32_bf16 v[76:79], a[36:39], v[52:55], v[76:79]
    v_mfma_f32_16x16x32_bf16 v[80:83], a[40:43], v[52:55], v[80:83]
    ds_read_b128 v[40:43], v10 offset:512
    v_mfma_f32_16x16x32_bf16 v[84:87], a[44:47], v[52:55], v[84:87]
    ds_read_b128 v[44:47], v10 offset:768
    v_mfma_f32_16x16x32_bf16 v[88:91], a[36:39], v[56:59], v[88:91]
    v_mfma_f32_16x16x32_bf16 v[92:95], a[40:43], v[56:59], v[92:95]
    buffer_load_dwordx4 a[24:27], v6, s[52:55], s9 offen offset:0
    v_mfma_f32_16x16x32_bf16 v[96:99], a[44:47], v[56:59], v[96:99]
    buffer_load_dwordx4 a[28:31], v6, s[52:55], s9 offen offset:1024
    v_mfma_f32_16x16x32_bf16 v[100:103], a[36:39], v[60:63], v[100:103]
    v_mfma_f32_16x16x32_bf16 v[104:107], a[40:43], v[60:63], v[104:107]
    buffer_load_dwordx4 a[32:35], v6, s[52:55], s9 offen offset:2048
    v_mfma_f32_16x16x32_bf16 v[108:111], a[44:47], v[60:63], v[108:111]
    s_add_u32 s9, s9, 3072
    s_waitcnt vmcnt(27) lgkmcnt(0)
    v_mfma_f32_16x16x32_bf16 v[64:67], a[48:51], v[32:35], v[64:67]
    v_mfma_f32_16x16x32_bf16 v[68:71], a[52:55], v[32:35], v[68:71]
    ds_read_b128 v[48:51], v10 offset:4096
    v_mfma_f32_16x16x32_bf16 v[72:75], a[56:59], v[32:35], v[72:75]
    ds_read_b128 v[52:55], v10 offset:4352
    v_mfma_f32_16x16x32_bf16 v[76:79], a[48:51], v[36:39], v[76:79]
    v_mfma_f32_16x16x32_bf16 v[80:83], a[52:55], v[36:39], v[80:83]
    ds_read_b128 v[56:59], v10 offset:4608
    v_mfma_f32_16x16x32_bf16 v[84:87], a[56:59], v[36:39], v[84:87]
    ds_read_b128 v[60:63], v10 offset:4864
    v_mfma_f32_16x16x32_bf16 v[88:91], a[48:51], v[40:43], v[88:91]
    v_mfma_f32_16x16x32_bf16 v[92:95], a[52:55], v[40:43], v[92:95]
    buffer_load_dwordx4 a[36:39], v6, s[52:55], s9 offen offset:0
    v_mfma_f32_16x16x32_bf16 v[96:99], a[56:59], v[40:43], v[96:99]
    buffer_load_dwordx4 a[40:43], v6, s[52:55], s9 offen offset:1024
    v_mfma_f32_16x16x32_bf16 v[100:103], a[48:51], v[44:47], v[100:103]
    v_mfma_f32_16x16x32_bf16 v[104:107], a[52:55], v[44:47], v[104:107]
    buffer_load_dwordx4 a[44:47], v6, s[52:55], s9 offen offset:2048
    v_mfma_f32_16x16x32_bf16 v[108:111], a[56:59], v[44:47], v[108:111]
    s_add_u32 s9, s9, 3072
    s_waitcnt vmcnt(27) lgkmcnt(0)
    v_mfma_f32_16x16x32_bf16 v[64:67], a[60:63], v[48:51], v[64:67]
    v_mfma_f32_16x16x32_bf16 v[68:71], a[64:67], v[48:51], v[68:71]
    ds_read_b128 v[32:35], v9 offset:0
    v_mfma_f32_16x16x32_bf16 v[72:75], a[68:71], v[48:51], v[72:75]
    ds_read_b128 v[36:39], v9 offset:256
    v_mfma_f32_16x16x32_bf16 v[76:79], a[60:63], v[52:55], v[76:79]
    v_mfma_f32_16x16x32_bf16 v[80:83], a[64:67], v[52:55], v[80:83]
    ds_read_b128 v[40:43], v9 offset:512
    v_mfma_f32_16x16x32_bf16 v[84:87], a[68:71], v[52:55], v[84:87]
    ds_read_b128 v[44:47], v9 offset:768
    v_mfma_f32_16x16x32_bf16 v[88:91], a[60:63], v[56:59], v[88:91]
    v_mfma_f32_16x16x32_bf16 v[92:95], a[64:67], v[56:59], v[92:95]
    buffer_load_dwordx4 a[48:51], v6, s[52:55], s9 offen offset:0
    v_mfma_f32_16x16x32_bf16 v[96:99], a[68:71], v[56:59], v[96:99]
    buffer_load_dwordx4 a[52:55], v6, s[52:55], s9 offen offset:1024
    v_mfma_f32_16x16x32_bf16 v[100:103], a[60:63], v[60:63], v[100:103]
    v_mfma_f32_16x16x32_bf16 v[104:107], a[64:67], v[60:63], v[104:107]
    buffer_load_dwordx4 a[56:59], v6, s[52:55], s9 offen offset:2048
    v_mfma_f32_16x16x32_bf16 v[108:111], a[68:71], v[60:63], v[108:111]
    s_add_u32 s9, s9, 3072
    s_waitcnt vmcnt(27) lgkmcnt(0)
    v_mfma_f32_16x16x32_bf16 v[112:115], a[72:75], v[32:35], 0
    v_mfma_f32_16x16x32_bf16 v[116:119], a[76:79], v[32:35], 0
    ds_read_b128 v[48:51], v9 offset:4096
    v_mfma_f32_16x16x32_bf16 v[120:123], a[80:83], v[32:35], 0
    ds_read_b128 v[52:55], v9 offset:4352
    v_mfma_f32_16x16x32_bf16 v[124:127], a[72:75], v[36:39], 0
    v_mfma_f32_16x16x32_bf16 v[128:131], a[76:79], v[36:39], 0
    ds_read_b128 v[56:59], v9 offset:4608
    v_mfma_f32_16x16x32_bf16 v[132:135], a[80:83], v[36:39], 0
    ds_read_b128 v[60:63], v9 offset:4864
    v_mfma_f32_16x16x32_bf16 v[136:139], a[72:75], v[40:43], 0
    v_mfma_f32_16x16x32_bf16 v[140:143], a[76:79], v[40:43], 0
    buffer_load_dwordx4 a[60:63], v6, s[52:55], s9 offen offset:0
    v_mfma_f32_16x16x32_bf16 v[144:147], a[80:83], v[40:43], 0
    buffer_load_dwordx4 a[64:67], v6, s[52:55], s9 offen offset:1024
    v_mfma_f32_16x16x32_bf16 v[148:151], a[72:75], v[44:47], 0
    v_mfma_f32_16x16x32_bf16 v[152:155], a[76:79], v[44:47], 0
    buffer_load_dwordx4 a[68:71], v6, s[52:55], s9 offen offset:2048
    v_mfma_f32_16x16x32_bf16 v[156:159], a[80:83], v[44:47], 0
    s_add_u32 s9, s9, 3072
    s_waitcnt vmcnt(27) lgkmcnt(0)
    v_mfma_f32_16x16x32_bf16 v[112:115], a[84:87], v[48:51], v[112:115]
    v_mfma_f32_16x16x32_bf16 v[116:119], a[88:91], v[48:51], v[116:119]
    ds_read_b128 v[32:35], v9 offset:8192
    v_mfma_f32_16x16x32_bf16 v[120:123], a[92:95], v[48:51], v[120:123]
    ds_read_b128 v[36:39], v9 offset:8448
    v_mfma_f32_16x16x32_bf16 v[124:127], a[84:87], v[52:55], v[124:127]
    ds_read_b128 v[40:43], v9 offset:8704
    v_mfma_f32_16x16x32_bf16 v[128:131], a[88:91], v[52:55], v[128:131]
    v_mfma_f32_16x16x32_bf16 v[132:135], a[92:95], v[52:55], v[132:135]
    ds_read_b128 v[44:47], v9 offset:8960
    v_mfma_f32_16x16x32_bf16 v[136:139], a[84:87], v[56:59], v[136:139]
    buffer_load_dwordx4 a[72:75], v6, s[52:55], s9 offen offset:0
    v_mfma_f32_16x16x32_bf16 v[140:143], a[88:91], v[56:59], v[140:143]
    v_cvt_pk_bf16_f32 v16, v64, v65
    v_mfma_f32_16x16x32_bf16 v[144:147], a[92:95], v[56:59], v[144:147]
    v_mfma_f32_16x16x32_bf16 v[148:151], a[84:87], v[60:63], v[148:151]
    buffer_load_dwordx4 a[76:79], v6, s[52:55], s9 offen offset:1024
    v_mfma_f32_16x16x32_bf16 v[152:155], a[88:91], v[60:63], v[152:155]
    buffer_load_dwordx4 a[80:83], v6, s[52:55], s9 offen offset:2048
    v_mfma_f32_16x16x32_bf16 v[156:159], a[92:95], v[60:63], v[156:159]
    s_add_u32 s9, s9, 3072
    s_waitcnt vmcnt(27) lgkmcnt(0)
    v_mfma_f32_16x16x32_bf16 v[112:115], a[96:99], v[32:35], v[112:115]
    v_mfma_f32_16x16x32_bf16 v[116:119], a[100:103], v[32:35], v[116:119]
    ds_read_b128 v[48:51], v9 offset:12288
    v_mfma_f32_16x16x32_bf16 v[120:123], a[104:107], v[32:35], v[120:123]
    ds_read_b128 v[52:55], v9 offset:12544
    v_mfma_f32_16x16x32_bf16 v[124:127], a[96:99], v[36:39], v[124:127]
    ds_read_b128 v[56:59], v9 offset:12800
    v_mfma_f32_16x16x32_bf16 v[128:131], a[100:103], v[36:39], v[128:131]
    ds_read_b128 v[60:63], v9 offset:13056
    v_mfma_f32_16x16x32_bf16 v[132:135], a[104:107], v[36:39], v[132:135]
    buffer_load_dwordx4 a[84:87], v6, s[52:55], s9 offen offset:0
    v_mfma_f32_16x16x32_bf16 v[136:139], a[96:99], v[40:43], v[136:139]
    v_mfma_f32_16x16x32_bf16 v[140:143], a[100:103], v[40:43], v[140:143]
    v_cvt_pk_bf16_f32 v17, v66, v67
    v_mfma_f32_16x16x32_bf16 v[144:147], a[104:107], v[40:43], v[144:147]
    buffer_load_dwordx4 a[88:91], v6, s[52:55], s9 offen offset:1024
    v_mfma_f32_16x16x32_bf16 v[148:151], a[96:99], v[44:47], v[148:151]
    v_cvt_pk_bf16_f32 v18, v76, v77
    v_mfma_f32_16x16x32_bf16 v[152:155], a[100:103], v[44:47], v[152:155]
    buffer_load_dwordx4 a[92:95], v6, s[52:55], s9 offen offset:2048
    v_mfma_f32_16x16x32_bf16 v[156:159], a[104:107], v[44:47], v[156:159]
    s_add_u32 s9, s9, 3072
    s_waitcnt vmcnt(27) lgkmcnt(0)
    v_mfma_f32_16x16x32_bf16 v[112:115], a[108:111], v[48:51], v[112:115]
    v_mfma_f32_16x16x32_bf16 v[116:119], a[112:115], v[48:51], v[116:119]
    ds_read_b128 v[32:35], v9 offset:16384
    v_mfma_f32_16x16x32_bf16 v[120:123], a[116:119], v[48:51], v[120:123]
    ds_read_b128 v[36:39], v9 offset:16640
    v_mfma_f32_16x16x32_bf16 v[124:127], a[108:111], v[52:55], v[124:127]
    ds_read_b128 v[40:43], v9 offset:16896
    v_mfma_f32_16x16x32_bf16 v[128:131], a[112:115], v[52:55], v[128:131]
    ds_read_b128 v[44:47], v9 offset:17152
    v_mfma_f32_16x16x32_bf16 v[132:135], a[116:119], v[52:55], v[132:135]
    buffer_load_dwordx4 a[96:99], v6, s[52:55], s9 offen offset:0
    v_mfma_f32_16x16x32_bf16 v[136:139], a[108:111], v[56:59], v[136:139]
    v_mfma_f32_16x16x32_bf16 v[140:143], a[112:115], v[56:59], v[140:143]
    v_cvt_pk_bf16_f32 v19, v78, v79
    v_mfma_f32_16x16x32_bf16 v[144:147], a[116:119], v[56:59], v[144:147]
    buffer_load_dwordx4 a[100:103], v6, s[52:55], s9 offen offset:1024
    v_mfma_f32_16x16x32_bf16 v[148:151], a[108:111], v[60:63], v[148:151]
    s_add_u32 s14, s12, 0
    buffer_store_dwordx4 v[16:19], v6, s[56:59], s14 offen sc1
    v_mfma_f32_16x16x32_bf16 v[152:155], a[112:115], v[60:63], v[152:155]
    buffer_load_dwordx4 a[104:107], v6, s[52:55], s9 offen offset:2048
    v_mfma_f32_16x16x32_bf16 v[156:159], a[116:119], v[60:63], v[156:159]
    s_add_u32 s9, s9, 3072
    s_waitcnt vmcnt(28) lgkmcnt(0)
    v_mfma_f32_16x16x32_bf16 v[112:115], a[120:123], v[32:35], v[112:115]
    v_mfma_f32_16x16x32_bf16 v[116:119], a[124:127], v[32:35], v[116:119]
    ds_read_b128 v[48:51], v9 offset:20480
    v_mfma_f32_16x16x32_bf16 v[120:123], a[128:131], v[32:35], v[120:123]
    ds_read_b128 v[52:55], v9 offset:20736
    v_mfma_f32_16x16x32_bf16 v[124:127], a[120:123], v[36:39], v[124:127]
    ds_read_b128 v[56:59], v9 offset:20992
    v_mfma_f32_16x16x32_bf16 v[128:131], a[124:127], v[36:39], v[128:131]
    ds_read_b128 v[60:63], v9 offset:21248
    v_mfma_f32_16x16x32_bf16 v[132:135], a[128:131], v[36:39], v[132:135]
    buffer_load_dwordx4 a[108:111], v6, s[52:55], s9 offen offset:0
    v_mfma_f32_16x16x32_bf16 v[136:139], a[120:123], v[40:43], v[136:139]
    v_mfma_f32_16x16x32_bf16 v[140:143], a[124:127], v[40:43], v[140:143]
    v_cvt_pk_bf16_f32 v20, v88, v89
    v_mfma_f32_16x16x32_bf16 v[144:147], a[128:131], v[40:43], v[144:147]
    buffer_load_dwordx4 a[112:115], v6, s[52:55], s9 offen offset:1024
    v_mfma_f32_16x16x32_bf16 v[148:151], a[120:123], v[44:47], v[148:151]
    v_cvt_pk_bf16_f32 v21, v90, v91
    v_mfma_f32_16x16x32_bf16 v[152:155], a[124:127], v[44:47], v[152:155]
    buffer_load_dwordx4 a[116:119], v6, s[52:55], s9 offen offset:2048
    v_mfma_f32_16x16x32_bf16 v[156:159], a[128:131], v[44:47], v[156:159]
    s_add_u32 s9, s9, 3072
    s_waitcnt vmcnt(28) lgkmcnt(0)
    v_mfma_f32_16x16x32_bf16 v[112:115], a[0:3], v[48:51], v[112:115]
    v_mfma_f32_16x16x32_bf16 v[116:119], a[4:7], v[48:51], v[116:119]
    ds_read_b128 v[32:35], v9 offset:24576
    v_mfma_f32_16x16x32_bf16 v[120:123], a[8:11], v[48:51], v[120:123]
    ds_read_b128 v[36:39], v9 offset:24832
    v_mfma_f32_16x16x32_bf16 v[124:127], a[0:3], v[52:55], v[124:127]
    ds_read_b128 v[40:43], v9 offset:25088
    v_mfma_f32_16x16x32_bf16 v[128:131], a[4:7], v[52:55], v[128:131]
    v_mfma_f32_16x16x32_bf16 v[132:135], a[8:11], v[52:55], v[132:135]
    ds_read_b128 v[44:47], v9 offset:25344
    v_mfma_f32_16x16x32_bf16 v[136:139], a[0:3], v[56:59], v[136:139]
    buffer_load_dwordx4 a[120:123], v6, s[52:55], s9 offen offset:0
    v_mfma_f32_16x16x32_bf16 v[140:143], a[4:7], v[56:59], v[140:143]
    v_cvt_pk_bf16_f32 v22, v100, v101
    v_mfma_f32_16x16x32_bf16 v[144:147], a[8:11], v[56:59], v[144:147]
    v_mfma_f32_16x16x32_bf16 v[148:151], a[0:3], v[60:63], v[148:151]
    buffer_load_dwordx4 a[124:127], v6, s[52:55], s9 offen offset:1024
    v_mfma_f32_16x16x32_bf16 v[152:155], a[4:7], v[60:63], v[152:155]
    buffer_load_dwordx4 a[128:131], v6, s[52:55], s9 offen offset:2048
    v_mfma_f32_16x16x32_bf16 v[156:159], a[8:11], v[60:63], v[156:159]
    s_add_u32 s9, s9, 3072
    s_waitcnt vmcnt(28) lgkmcnt(0)
    v_mfma_f32_16x16x32_bf16 v[112:115], a[12:15], v[32:35], v[112:115]
    v_mfma_f32_16x16x32_bf16 v[116:119], a[16:19], v[32:35], v[116:119]
    ds_read_b128 v[48:51], v9 offset:28672
    v_mfma_f32_16x16x32_bf16 v[120:123], a[20:23], v[32:35], v[120:123]
    ds_read_b128 v[52:55], v9 offset:28928
    v_mfma_f32_16x16x32_bf16 v[124:127], a[12:15], v[36:39], v[124:127]
    ds_read_b128 v[56:59], v9 offset:29184
    v_mfma_f32_16x16x32_bf16 v[128:131], a[16:19], v[36:39], v[128:131]
    ds_read_b128 v[60:63], v9 offset:29440
    v_mfma_f32_16x16x32_bf16 v[132:135], a[20:23], v[36:39], v[132:135]
    buffer_load_dwordx4 a[0:3], v6, s[52:55], s9 offen offset:0
    v_mfma_f32_16x16x32_bf16 v[136:139], a[12:15], v[40:43], v[136:139]
    v_mfma_f32_16x16x32_bf16 v[140:143], a[16:19], v[40:43], v[140:143]
    v_cvt_pk_bf16_f32 v23, v102, v103
    v_mfma_f32_16x16x32_bf16 v[144:147], a[20:23], v[40:43], v[144:147]
    buffer_load_dwordx4 a[4:7], v6, s[52:55], s9 offen offset:1024
    v_mfma_f32_16x16x32_bf16 v[148:151], a[12:15], v[44:47], v[148:151]
    s_add_u32 s14, s12, 1024
    buffer_store_dwordx4 v[20:23], v6, s[56:59], s14 offen sc1
    v_mfma_f32_16x16x32_bf16 v[152:155], a[16:19], v[44:47], v[152:155]
    buffer_load_dwordx4 a[8:11], v6, s[52:55], s9 offen offset:2048
    v_mfma_f32_16x16x32_bf16 v[156:159], a[20:23], v[44:47], v[156:159]
    s_add_u32 s9, s9, 3072
    s_waitcnt vmcnt(29) lgkmcnt(0)
    v_mfma_f32_16x16x32_bf16 v[112:115], a[24:27], v[48:51], v[112:115]
    v_mfma_f32_16x16x32_bf16 v[116:119], a[28:31], v[48:51], v[116:119]
    ds_read_b128 v[32:35], v9 offset:32768
    v_mfma_f32_16x16x32_bf16 v[120:123], a[32:35], v[48:51], v[120:123]
    ds_read_b128 v[36:39], v9 offset:33024
    v_mfma_f32_16x16x32_bf16 v[124:127], a[24:27], v[52:55], v[124:127]
    ds_read_b128 v[40:43], v9 offset:33280
    v_mfma_f32_16x16x32_bf16 v[128:131], a[28:31], v[52:55], v[128:131]
    ds_read_b128 v[44:47], v9 offset:33536
    v_mfma_f32_16x16x32_bf16 v[132:135], a[32:35], v[52:55], v[132:135]
    buffer_load_dwordx4 a[12:15], v6, s[52:55], s9 offen offset:0
    v_mfma_f32_16x16x32_bf16 v[136:139], a[24:27], v[56:59], v[136:139]
    v_mfma_f32_16x16x32_bf16 v[140:143], a[28:31], v[56:59], v[140:143]
    v_cvt_pk_bf16_f32 v24, v68, v69
    v_mfma_f32_16x16x32_bf16 v[144:147], a[32:35], v[56:59], v[144:147]
    buffer_load_dwordx4 a[16:19], v6, s[52:55], s9 offen offset:1024
    v_mfma_f32_16x16x32_bf16 v[148:151], a[24:27], v[60:63], v[148:151]
    v_cvt_pk_bf16_f32 v25, v70, v71
    v_mfma_f32_16x16x32_bf16 v[152:155], a[28:31], v[60:63], v[152:155]
    buffer_load_dwordx4 a[20:23], v6, s[52:55], s9 offen offset:2048
    v_mfma_f32_16x16x32_bf16 v[156:159], a[32:35], v[60:63], v[156:159]
    s_add_u32 s9, s9, 3072
    s_waitcnt vmcnt(29) lgkmcnt(0)
    v_mfma_f32_16x16x32_bf16 v[112:115], a[36:39], v[32:35], v[112:115]
    v_mfma_f32_16x16x32_bf16 v[116:119], a[40:43], v[32:35], v[116:119]
    ds_read_b128 v[48:51], v9 offset:36864
    v_mfma_f32_16x16x32_bf16 v[120:123], a[44:47], v[32:35], v[120:123]
    ds_read_b128 v[52:55], v9 offset:37120
    v_mfma_f32_16x16x32_bf16 v[124:127], a[36:39], v[36:39], v[124:127]
    ds_read_b128 v[56:59], v9 offset:37376
    v_mfma_f32_16x16x32_bf16 v[128:131], a[40:43], v[36:39], v[128:131]
    ds_read_b128 v[60:63], v9 offset:37632
    v_mfma_f32_16x16x32_bf16 v[132:135], a[44:47], v[36:39], v[132:135]
    buffer_load_dwordx4 a[24:27], v6, s[52:55], s9 offen offset:0
    v_mfma_f32_16x16x32_bf16 v[136:139], a[36:39], v[40:43], v[136:139]
    v_mfma_f32_16x16x32_bf16 v[140:143], a[40:43], v[40:43], v[140:143]
    v_cvt_pk_bf16_f32 v26, v80, v81
    v_mfma_f32_16x16x32_bf16 v[144:147], a[44:47], v[40:43], v[144:147]
    buffer_load_dwordx4 a[28:31], v6, s[52:55], s9 offen offset:1024
    v_mfma_f32_16x16x32_bf16 v[148:151], a[36:39], v[44:47], v[148:151]
    v_cvt_pk_bf16_f32 v27, v82, v83
    v_mfma_f32_16x16x32_bf16 v[152:155], a[40:43], v[44:47], v[152:155]
    buffer_load_dwordx4 a[32:35], v6, s[52:55], s9 offen offset:2048
    v_mfma_f32_16x16x32_bf16 v[156:159], a[44:47], v[44:47], v[156:159]
    s_add_u32 s9, s9, 3072
    s_waitcnt vmcnt(29) lgkmcnt(0)
    v_mfma_f32_16x16x32_bf16 v[112:115], a[48:51], v[48:51], v[112:115]
    v_mfma_f32_16x16x32_bf16 v[116:119], a[52:55], v[48:51], v[116:119]
    ds_read_b128 v[32:35], v9 offset:40960
    v_mfma_f32_16x16x32_bf16 v[120:123], a[56:59], v[48:51], v[120:123]
    ds_read_b128 v[36:39], v9 offset:41216
    v_mfma_f32_16x16x32_bf16 v[124:127], a[48:51], v[52:55], v[124:127]
    ds_read_b128 v[40:43], v9 offset:41472
    v_mfma_f32_16x16x32_bf16 v[128:131], a[52:55], v[52:55], v[128:131]
    v_mfma_f32_16x16x32_bf16 v[132:135], a[56:59], v[52:55], v[132:135]
    ds_read_b128 v[44:47], v9 offset:41728
    v_mfma_f32_16x16x32_bf16 v[136:139], a[48:51], v[56:59], v[136:139]
    buffer_load_dwordx4 a[36:39], v6, s[52:55], s9 offen offset:0
    v_mfma_f32_16x16x32_bf16 v[140:143], a[52:55], v[56:59], v[140:143]
    s_add_u32 s14, s12, 2048
    buffer_store_dwordx4 v[24:27], v6, s[56:59], s14 offen sc1
    v_mfma_f32_16x16x32_bf16 v[144:147], a[56:59], v[56:59], v[144:147]
    v_mfma_f32_16x16x32_bf16 v[148:151], a[48:51], v[60:63], v[148:151]
    buffer_load_dwordx4 a[40:43], v6, s[52:55], s9 offen offset:1024
    v_mfma_f32_16x16x32_bf16 v[152:155], a[52:55], v[60:63], v[152:155]
    buffer_load_dwordx4 a[44:47], v6, s[52:55], s9 offen offset:2048
    v_mfma_f32_16x16x32_bf16 v[156:159], a[56:59], v[60:63], v[156:159]
    s_add_u32 s9, s9, 3072
    s_waitcnt vmcnt(30) lgkmcnt(0)
    v_mfma_f32_16x16x32_bf16 v[112:115], a[60:63], v[32:35], v[112:115]
    v_mfma_f32_16x16x32_bf16 v[116:119], a[64:67], v[32:35], v[116:119]
    ds_read_b128 v[48:51], v9 offset:45056
    v_mfma_f32_16x16x32_bf16 v[120:123], a[68:71], v[32:35], v[120:123]
    ds_read_b128 v[52:55], v9 offset:45312
    v_mfma_f32_16x16x32_bf16 v[124:127], a[60:63], v[36:39], v[124:127]
    ds_read_b128 v[56:59], v9 offset:45568
    v_mfma_f32_16x16x32_bf16 v[128:131], a[64:67], v[36:39], v[128:131]
    ds_read_b128 v[60:63], v9 offset:45824
    v_mfma_f32_16x16x32_bf16 v[132:135], a[68:71], v[36:39], v[132:135]
    buffer_load_dwordx4 a[48:51], v6, s[52:55], s9 offen offset:0
    v_mfma_f32_16x16x32_bf16 v[136:139], a[60:63], v[40:43], v[136:139]
    v_mfma_f32_16x16x32_bf16 v[140:143], a[64:67], v[40:43], v[140:143]
    v_cvt_pk_bf16_f32 v28, v92, v93
    v_mfma_f32_16x16x32_bf16 v[144:147], a[68:71], v[40:43], v[144:147]
    buffer_load_dwordx4 a[52:55], v6, s[52:55], s9 offen offset:1024
    v_mfma_f32_16x16x32_bf16 v[148:151], a[60:63], v[44:47], v[148:151]
    v_cvt_pk_bf16_f32 v29, v94, v95
    v_mfma_f32_16x16x32_bf16 v[152:155], a[64:67], v[44:47], v[152:155]
    buffer_load_dwordx4 a[56:59], v6, s[52:55], s9 offen offset:2048
    v_mfma_f32_16x16x32_bf16 v[156:159], a[68:71], v[44:47], v[156:159]
    s_add_u32 s9, s9, 3072
    s_waitcnt vmcnt(30) lgkmcnt(0)
    v_mfma_f32_16x16x32_bf16 v[112:115], a[72:75], v[48:51], v[112:115]
    v_mfma_f32_16x16x32_bf16 v[116:119], a[76:79], v[48:51], v[116:119]
    ds_read_b128 v[32:35], v9 offset:49152
    v_mfma_f32_16x16x32_bf16 v[120:123], a[80:83], v[48:51], v[120:123]
    ds_read_b128 v[36:39], v9 offset:49408
    v_mfma_f32_16x16x32_bf16 v[124:127], a[72:75], v[52:55], v[124:127]
    ds_read_b128 v[40:43], v9 offset:49664
    v_mfma_f32_16x16x32_bf16 v[128:131], a[76:79], v[52:55], v[128:131]
    ds_read_b128 v[44:47], v9 offset:49920
    v_mfma_f32_16x16x32_bf16 v[132:135], a[80:83], v[52:55], v[132:135]
    buffer_load_dwordx4 a[60:63], v6, s[52:55], s9 offen offset:0
    v_mfma_f32_16x16x32_bf16 v[136:139], a[72:75], v[56:59], v[136:139]
    v_mfma_f32_16x16x32_bf16 v[140:143], a[76:79], v[56:59], v[140:143]
    v_cvt_pk_bf16_f32 v30, v104, v105
    v_mfma_f32_16x16x32_bf16 v[144:147], a[80:83], v[56:59], v[144:147]
    buffer_load_dwordx4 a[64:67], v6, s[52:55], s9 offen offset:1024
    v_mfma_f32_16x16x32_bf16 v[148:151], a[72:75], v[60:63], v[148:151]
    v_cvt_pk_bf16_f32 v31, v106, v107
    v_mfma_f32_16x16x32_bf16 v[152:155], a[76:79], v[60:63], v[152:155]
    buffer_load_dwordx4 a[68:71], v6, s[52:55], s9 offen offset:2048
    v_mfma_f32_16x16x32_bf16 v[156:159], a[80:83], v[60:63], v[156:159]
    s_add_u32 s9, s9, 3072
    s_waitcnt vmcnt(30) lgkmcnt(0)
    v_mfma_f32_16x16x32_bf16 v[112:115], a[84:87], v[32:35], v[112:115]
    v_mfma_f32_16x16x32_bf16 v[116:119], a[88:91], v[32:35], v[116:119]
    ds_read_b128 v[48:51], v9 offset:53248
    v_mfma_f32_16x16x32_bf16 v[120:123], a[92:95], v[32:35], v[120:123]
    ds_read_b128 v[52:55], v9 offset:53504
    v_mfma_f32_16x16x32_bf16 v[124:127], a[84:87], v[36:39], v[124:127]
    ds_read_b128 v[56:59], v9 offset:53760
    v_mfma_f32_16x16x32_bf16 v[128:131], a[88:91], v[36:39], v[128:131]
    ds_read_b128 v[60:63], v9 offset:54016
    v_mfma_f32_16x16x32_bf16 v[132:135], a[92:95], v[36:39], v[132:135]
    buffer_load_dwordx4 a[72:75], v6, s[52:55], s9 offen offset:0
    v_mfma_f32_16x16x32_bf16 v[136:139], a[84:87], v[40:43], v[136:139]
    v_mfma_f32_16x16x32_bf16 v[140:143], a[88:91], v[40:43], v[140:143]
    s_add_u32 s14, s12, 3072
    buffer_store_dwordx4 v[28:31], v6, s[56:59], s14 offen sc1
    v_mfma_f32_16x16x32_bf16 v[144:147], a[92:95], v[40:43], v[144:147]
    buffer_load_dwordx4 a[76:79], v6, s[52:55], s9 offen offset:1024
    v_mfma_f32_16x16x32_bf16 v[148:151], a[84:87], v[44:47], v[148:151]
    v_cvt_pk_bf16_f32 v16, v72, v73
    v_mfma_f32_16x16x32_bf16 v[152:155], a[88:91], v[44:47], v[152:155]
    buffer_load_dwordx4 a[80:83], v6, s[52:55], s9 offen offset:2048
    v_mfma_f32_16x16x32_bf16 v[156:159], a[92:95], v[44:47], v[156:159]
    s_add_u32 s9, s9, 3072
    s_waitcnt vmcnt(30) lgkmcnt(0)
    v_mfma_f32_16x16x32_bf16 v[112:115], a[96:99], v[48:51], v[112:115]
    v_mfma_f32_16x16x32_bf16 v[116:119], a[100:103], v[48:51], v[116:119]
    ds_read_b128 v[32:35], v9 offset:57344
    v_mfma_f32_16x16x32_bf16 v[120:123], a[104:107], v[48:51], v[120:123]
    ds_read_b128 v[36:39], v9 offset:57600
    v_mfma_f32_16x16x32_bf16 v[124:127], a[96:99], v[52:55], v[124:127]
    ds_read_b128 v[40:43], v9 offset:57856
    v_mfma_f32_16x16x32_bf16 v[128:131], a[100:103], v[52:55], v[128:131]
    v_mfma_f32_16x16x32_bf16 v[132:135], a[104:107], v[52:55], v[132:135]
    ds_read_b128 v[44:47], v9 offset:58112
    v_mfma_f32_16x16x32_bf16 v[136:139], a[96:99], v[56:59], v[136:139]
    buffer_load_dwordx4 a[84:87], v6, s[52:55], s9 offen offset:0
    v_mfma_f32_16x16x32_bf16 v[140:143], a[100:103], v[56:59], v[140:143]
    v_cvt_pk_bf16_f32 v17, v74, v75
    v_mfma_f32_16x16x32_bf16 v[144:147], a[104:107], v[56:59], v[144:147]
    v_mfma_f32_16x16x32_bf16 v[148:151], a[96:99], v[60:63], v[148:151]
    buffer_load_dwordx4 a[88:91], v6, s[52:55], s9 offen offset:1024
    v_mfma_f32_16x16x32_bf16 v[152:155], a[100:103], v[60:63], v[152:155]
    buffer_load_dwordx4 a[92:95], v6, s[52:55], s9 offen offset:2048
    v_mfma_f32_16x16x32_bf16 v[156:159], a[104:107], v[60:63], v[156:159]
    s_add_u32 s9, s9, 3072
    s_waitcnt vmcnt(30) lgkmcnt(0)
    v_mfma_f32_16x16x32_bf16 v[112:115], a[108:111], v[32:35], v[112:115]
    v_mfma_f32_16x16x32_bf16 v[116:119], a[112:115], v[32:35], v[116:119]
    ds_read_b128 v[48:51], v9 offset:61440
    v_mfma_f32_16x16x32_bf16 v[120:123], a[116:119], v[32:35], v[120:123]
    ds_read_b128 v[52:55], v9 offset:61696
    v_mfma_f32_16x16x32_bf16 v[124:127], a[108:111], v[36:39], v[124:127]
    ds_read_b128 v[56:59], v9 offset:61952
    v_mfma_f32_16x16x32_bf16 v[128:131], a[112:115], v[36:39], v[128:131]
    ds_read_b128 v[60:63], v9 offset:62208
    v_mfma_f32_16x16x32_bf16 v[132:135], a[116:119], v[36:39], v[132:135]
    buffer_load_dwordx4 a[96:99], v6, s[52:55], s9 offen offset:0
    v_mfma_f32_16x16x32_bf16 v[136:139], a[108:111], v[40:43], v[136:139]
    v_mfma_f32_16x16x32_bf16 v[140:143], a[112:115], v[40:43], v[140:143]
    v_cvt_pk_bf16_f32 v18, v84, v85
    v_mfma_f32_16x16x32_bf16 v[144:147], a[116:119], v[40:43], v[144:147]
    buffer_load_dwordx4 a[100:103], v6, s[52:55], s9 offen offset:1024
    v_mfma_f32_16x16x32_bf16 v[148:151], a[108:111], v[44:47], v[148:151]
    v_cvt_pk_bf16_f32 v19, v86, v87
    v_mfma_f32_16x16x32_bf16 v[152:155], a[112:115], v[44:47], v[152:155]
    buffer_load_dwordx4 a[104:107], v6, s[52:55], s9 offen offset:2048
    v_mfma_f32_16x16x32_bf16 v[156:159], a[116:119], v[44:47], v[156:159]
    s_add_u32 s9, s9, 3072
    s_waitcnt vmcnt(30) lgkmcnt(0)
    v_mfma_f32_16x16x32_bf16 v[112:115], a[120:123], v[48:51], v[112:115]
    v_mfma_f32_16x16x32_bf16 v[116:119], a[124:127], v[48:51], v[116:119]
    ds_read_b128 v[32:35], v10 offset:0
    v_mfma_f32_16x16x32_bf16 v[120:123], a[128:131], v[48:51], v[120:123]
    ds_read_b128 v[36:39], v10 offset:256
    v_mfma_f32_16x16x32_bf16 v[124:127], a[120:123], v[52:55], v[124:127]
    ds_read_b128 v[40:43], v10 offset:512
    v_mfma_f32_16x16x32_bf16 v[128:131], a[124:127], v[52:55], v[128:131]
    ds_read_b128 v[44:47], v10 offset:768
    v_mfma_f32_16x16x32_bf16 v[132:135], a[128:131], v[52:55], v[132:135]
    buffer_load_dwordx4 a[108:111], v6, s[52:55], s9 offen offset:0
    v_mfma_f32_16x16x32_bf16 v[136:139], a[120:123], v[56:59], v[136:139]
    v_mfma_f32_16x16x32_bf16 v[140:143], a[124:127], v[56:59], v[140:143]
    s_add_u32 s14, s12, 4096
    buffer_store_dwordx4 v[16:19], v6, s[56:59], s14 offen sc1
    v_mfma_f32_16x16x32_bf16 v[144:147], a[128:131], v[56:59], v[144:147]
    buffer_load_dwordx4 a[112:115], v6, s[52:55], s9 offen offset:1024
    v_mfma_f32_16x16x32_bf16 v[148:151], a[120:123], v[60:63], v[148:151]
    v_cvt_pk_bf16_f32 v20, v96, v97
    v_mfma_f32_16x16x32_bf16 v[152:155], a[124:127], v[60:63], v[152:155]
    buffer_load_dwordx4 a[116:119], v6, s[52:55], s9 offen offset:2048
    v_mfma_f32_16x16x32_bf16 v[156:159], a[128:131], v[60:63], v[156:159]
    s_add_u32 s9, s9, 3072
    s_waitcnt vmcnt(30) lgkmcnt(0)
    v_mfma_f32_16x16x32_bf16 v[112:115], a[0:3], v[32:35], v[112:115]
    v_mfma_f32_16x16x32_bf16 v[116:119], a[4:7], v[32:35], v[116:119]
    ds_read_b128 v[48:51], v10 offset:4096
    v_mfma_f32_16x16x32_bf16 v[120:123], a[8:11], v[32:35], v[120:123]
    ds_read_b128 v[52:55], v10 offset:4352
    v_mfma_f32_16x16x32_bf16 v[124:127], a[0:3], v[36:39], v[124:127]
    ds_read_b128 v[56:59], v10 offset:4608
    v_mfma_f32_16x16x32_bf16 v[128:131], a[4:7], v[36:39], v[128:131]
    ds_read_b128 v[60:63], v10 offset:4864
    v_mfma_f32_16x16x32_bf16 v[132:135], a[8:11], v[36:39], v[132:135]
    buffer_load_dwordx4 a[120:123], v6, s[52:55], s9 offen offset:0
    v_mfma_f32_16x16x32_bf16 v[136:139], a[0:3], v[40:43], v[136:139]
    v_mfma_f32_16x16x32_bf16 v[140:143], a[4:7], v[40:43], v[140:143]
    v_cvt_pk_bf16_f32 v21, v98, v99
    v_mfma_f32_16x16x32_bf16 v[144:147], a[8:11], v[40:43], v[144:147]
    buffer_load_dwordx4 a[124:127], v6, s[52:55], s9 offen offset:1024
    v_mfma_f32_16x16x32_bf16 v[148:151], a[0:3], v[44:47], v[148:151]
    v_cvt_pk_bf16_f32 v22, v108, v109
    v_mfma_f32_16x16x32_bf16 v[152:155], a[4:7], v[44:47], v[152:155]
    buffer_load_dwordx4 a[128:131], v6, s[52:55], s9 offen offset:2048
    v_mfma_f32_16x16x32_bf16 v[156:159], a[8:11], v[44:47], v[156:159]
    s_add_u32 s9, s9, 3072
    s_waitcnt vmcnt(30) lgkmcnt(0)
    v_mfma_f32_16x16x32_bf16 v[112:115], a[12:15], v[48:51], v[112:115]
    v_mfma_f32_16x16x32_bf16 v[116:119], a[16:19], v[48:51], v[116:119]
    ds_read_b128 v[32:35], v9 offset:0
    v_mfma_f32_16x16x32_bf16 v[120:123], a[20:23], v[48:51], v[120:123]
    ds_read_b128 v[36:39], v9 offset:256
    v_mfma_f32_16x16x32_bf16 v[124:127], a[12:15], v[52:55], v[124:127]
    ds_read_b128 v[40:43], v9 offset:512
    v_mfma_f32_16x16x32_bf16 v[128:131], a[16:19], v[52:55], v[128:131]
    ds_read_b128 v[44:47], v9 offset:768
    v_mfma_f32_16x16x32_bf16 v[132:135], a[20:23], v[52:55], v[132:135]
    buffer_load_dwordx4 a[0:3], v6, s[52:55], s9 offen offset:0
    v_mfma_f32_16x16x32_bf16 v[136:139], a[12:15], v[56:59], v[136:139]
    v_mfma_f32_16x16x32_bf16 v[140:143], a[16:19], v[56:59], v[140:143]
    v_cvt_pk_bf16_f32 v23, v110, v111
    v_mfma_f32_16x16x32_bf16 v[144:147], a[20:23], v[56:59], v[144:147]
    buffer_load_dwordx4 a[4:7], v6, s[52:55], s9 offen offset:1024
    v_mfma_f32_16x16x32_bf16 v[148:151], a[12:15], v[60:63], v[148:151]
    s_add_u32 s14, s12, 5120
    buffer_store_dwordx4 v[20:23], v6, s[56:59], s14 offen sc1
    v_mfma_f32_16x16x32_bf16 v[152:155], a[16:19], v[60:63], v[152:155]
    buffer_load_dwordx4 a[8:11], v6, s[52:55], s9 offen offset:2048
    v_mfma_f32_16x16x32_bf16 v[156:159], a[20:23], v[60:63], v[156:159]
    s_add_u32 s9, s9, 3072
    s_waitcnt vmcnt(31) lgkmcnt(0)
    v_mfma_f32_16x16x32_bf16 v[160:163], a[24:27], v[32:35], 0
    v_mfma_f32_16x16x32_bf16 v[164:167], a[28:31], v[32:35], 0
    ds_read_b128 v[48:51], v9 offset:4096
    v_mfma_f32_16x16x32_bf16 v[168:171], a[32:35], v[32:35], 0
    ds_read_b128 v[52:55], v9 offset:4352
    v_mfma_f32_16x16x32_bf16 v[172:175], a[24:27], v[36:39], 0
    v_mfma_f32_16x16x32_bf16 v[176:179], a[28:31], v[36:39], 0
    ds_read_b128 v[56:59], v9 offset:4608
    v_mfma_f32_16x16x32_bf16 v[180:183], a[32:35], v[36:39], 0
    ds_read_b128 v[60:63], v9 offset:4864
    v_mfma_f32_16x16x32_bf16 v[184:187], a[24:27], v[40:43], 0
    v_mfma_f32_16x16x32_bf16 v[188:191], a[28:31], v[40:43], 0
    buffer_load_dwordx4 a[12:15], v6, s[52:55], s9 offen offset:0
    v_mfma_f32_16x16x32_bf16 v[192:195], a[32:35], v[40:43], 0
    buffer_load_dwordx4 a[16:19], v6, s[52:55], s9 offen offset:1024
    v_mfma_f32_16x16x32_bf16 v[196:199], a[24:27], v[44:47], 0
    v_mfma_f32_16x16x32_bf16 v[200:203], a[28:31], v[44:47], 0
    buffer_load_dwordx4 a[20:23], v6, s[52:55], s9 offen offset:2048
    v_mfma_f32_16x16x32_bf16 v[204:207], a[32:35], v[44:47], 0
    s_add_u32 s9, s9, 3072
    s_waitcnt vmcnt(30) lgkmcnt(0)
    v_mfma_f32_16x16x32_bf16 v[160:163], a[36:39], v[48:51], v[160:163]
    v_mfma_f32_16x16x32_bf16 v[164:167], a[40:43], v[48:51], v[164:167]
    ds_read_b128 v[32:35], v9 offset:8192
    v_mfma_f32_16x16x32_bf16 v[168:171], a[44:47], v[48:51], v[168:171]
    ds_read_b128 v[36:39], v9 offset:8448
    v_mfma_f32_16x16x32_bf16 v[172:175], a[36:39], v[52:55], v[172:175]
    ds_read_b128 v[40:43], v9 offset:8704
    v_mfma_f32_16x16x32_bf16 v[176:179], a[40:43], v[52:55], v[176:179]
    v_mfma_f32_16x16x32_bf16 v[180:183], a[44:47], v[52:55], v[180:183]
    ds_read_b128 v[44:47], v9 offset:8960
    v_mfma_f32_16x16x32_bf16 v[184:187], a[36:39], v[56:59], v[184:187]
    buffer_load_dwordx4 a[24:27], v6, s[52:55], s9 offen offset:0
    v_mfma_f32_16x16x32_bf16 v[188:191], a[40:43], v[56:59], v[188:191]
    v_cvt_pk_bf16_f32 v16, v112, v113
    v_mfma_f32_16x16x32_bf16 v[192:195], a[44:47], v[56:59], v[192:195]
    v_mfma_f32_16x16x32_bf16 v[196:199], a[36:39], v[60:63], v[196:199]
    buffer_load_dwordx4 a[28:31], v6, s[52:55], s9 offen offset:1024
    v_mfma_f32_16x16x32_bf16 v[200:203], a[40:43], v[60:63], v[200:203]
    buffer_load_dwordx4 a[32:35], v6, s[52:55], s9 offen offset:2048
    v_mfma_f32_16x16x32_bf16 v[204:207], a[44:47], v[60:63], v[204:207]
    s_add_u32 s9, s9, 3072
    s_waitcnt vmcnt(30) lgkmcnt(0)
    v_mfma_f32_16x16x32_bf16 v[160:163], a[48:51], v[32:35], v[160:163]
    v_mfma_f32_16x16x32_bf16 v[164:167], a[52:55], v[32:35], v[164:167]
    ds_read_b128 v[48:51], v9 offset:12288
    v_mfma_f32_16x16x32_bf16 v[168:171], a[56:59], v[32:35], v[168:171]
    ds_read_b128 v[52:55], v9 offset:12544
    v_mfma_f32_16x16x32_bf16 v[172:175], a[48:51], v[36:39], v[172:175]
    ds_read_b128 v[56:59], v9 offset:12800
    v_mfma_f32_16x16x32_bf16 v[176:179], a[52:55], v[36:39], v[176:179]
    ds_read_b128 v[60:63], v9 offset:13056
    v_mfma_f32_16x16x32_bf16 v[180:183], a[56:59], v[36:39], v[180:183]
    buffer_load_dwordx4 a[36:39], v6, s[52:55], s9 offen offset:0
    v_mfma_f32_16x16x32_bf16 v[184:187], a[48:51], v[40:43], v[184:187]
    v_mfma_f32_16x16x32_bf16 v[188:191], a[52:55], v[40:43], v[188:191]
    v_cvt_pk_bf16_f32 v17, v114, v115
    v_mfma_f32_16x16x32_bf16 v[192:195], a[56:59], v[40:43], v[192:195]
    buffer_load_dwordx4 a[40:43], v6, s[52:55], s9 offen offset:1024
    v_mfma_f32_16x16x32_bf16 v[196:199], a[48:51], v[44:47], v[196:199]
    v_cvt_pk_bf16_f32 v18, v124, v125
    v_mfma_f32_16x16x32_bf16 v[200:203], a[52:55], v[44:47], v[200:203]
    buffer_load_dwordx4 a[44:47], v6, s[52:55], s9 offen offset:2048
    v_mfma_f32_16x16x32_bf16 v[204:207], a[56:59], v[44:47], v[204:207]
    s_add_u32 s9, s9, 3072
    s_waitcnt vmcnt(30) lgkmcnt(0)
    v_mfma_f32_16x16x32_bf16 v[160:163], a[60:63], v[48:51], v[160:163]
    v_mfma_f32_16x16x32_bf16 v[164:167], a[64:67], v[48:51], v[164:167]
    ds_read_b128 v[32:35], v9 offset:16384
    v_mfma_f32_16x16x32_bf16 v[168:171], a[68:71], v[48:51], v[168:171]
    ds_read_b128 v[36:39], v9 offset:16640
    v_mfma_f32_16x16x32_bf16 v[172:175], a[60:63], v[52:55], v[172:175]
    ds_read_b128 v[40:43], v9 offset:16896
    v_mfma_f32_16x16x32_bf16 v[176:179], a[64:67], v[52:55], v[176:179]
    ds_read_b128 v[44:47], v9 offset:17152
    v_mfma_f32_16x16x32_bf16 v[180:183], a[68:71], v[52:55], v[180:183]
    buffer_load_dwordx4 a[48:51], v6, s[52:55], s9 offen offset:0
    v_mfma_f32_16x16x32_bf16 v[184:187], a[60:63], v[56:59], v[184:187]
    v_mfma_f32_16x16x32_bf16 v[188:191], a[64:67], v[56:59], v[188:191]
    v_cvt_pk_bf16_f32 v19, v126, v127
    v_mfma_f32_16x16x32_bf16 v[192:195], a[68:71], v[56:59], v[192:195]
    buffer_load_dwordx4 a[52:55], v6, s[52:55], s9 offen offset:1024
    v_mfma_f32_16x16x32_bf16 v[196:199], a[60:63], v[60:63], v[196:199]
    s_add_u32 s14, s12, 6144
    buffer_store_dwordx4 v[16:19], v6, s[56:59], s14 offen sc1
    v_mfma_f32_16x16x32_bf16 v[200:203], a[64:67], v[60:63], v[200:203]
    buffer_load_dwordx4 a[56:59], v6, s[52:55], s9 offen offset:2048
    v_mfma_f32_16x16x32_bf16 v[204:207], a[68:71], v[60:63], v[204:207]
    s_add_u32 s9, s9, 3072
    s_waitcnt vmcnt(30) lgkmcnt(0)
    v_mfma_f32_16x16x32_bf16 v[160:163], a[72:75], v[32:35], v[160:163]
    v_mfma_f32_16x16x32_bf16 v[164:167], a[76:79], v[32:35], v[164:167]
    ds_read_b128 v[48:51], v9 offset:20480
    v_mfma_f32_16x16x32_bf16 v[168:171], a[80:83], v[32:35], v[168:171]
    ds_read_b128 v[52:55], v9 offset:20736
    v_mfma_f32_16x16x32_bf16 v[172:175], a[72:75], v[36:39], v[172:175]
    ds_read_b128 v[56:59], v9 offset:20992
    v_mfma_f32_16x16x32_bf16 v[176:179], a[76:79], v[36:39], v[176:179]
    ds_read_b128 v[60:63], v9 offset:21248
    v_mfma_f32_16x16x32_bf16 v[180:183], a[80:83], v[36:39], v[180:183]
    buffer_load_dwordx4 a[60:63], v6, s[52:55], s9 offen offset:0
    v_mfma_f32_16x16x32_bf16 v[184:187], a[72:75], v[40:43], v[184:187]
    v_mfma_f32_16x16x32_bf16 v[188:191], a[76:79], v[40:43], v[188:191]
    v_cvt_pk_bf16_f32 v20, v136, v137
    v_mfma_f32_16x16x32_bf16 v[192:195], a[80:83], v[40:43], v[192:195]
    buffer_load_dwordx4 a[64:67], v6, s[52:55], s9 offen offset:1024
    v_mfma_f32_16x16x32_bf16 v[196:199], a[72:75], v[44:47], v[196:199]
    v_cvt_pk_bf16_f32 v21, v138, v139
    v_mfma_f32_16x16x32_bf16 v[200:203], a[76:79], v[44:47], v[200:203]
    buffer_load_dwordx4 a[68:71], v6, s[52:55], s9 offen offset:2048
    v_mfma_f32_16x16x32_bf16 v[204:207], a[80:83], v[44:47], v[204:207]
    s_add_u32 s9, s9, 3072
    s_waitcnt vmcnt(30) lgkmcnt(0)
    v_mfma_f32_16x16x32_bf16 v[160:163], a[84:87], v[48:51], v[160:163]
    v_mfma_f32_16x16x32_bf16 v[164:167], a[88:91], v[48:51], v[164:167]
    ds_read_b128 v[32:35], v9 offset:24576
    v_mfma_f32_16x16x32_bf16 v[168:171], a[92:95], v[48:51], v[168:171]
    ds_read_b128 v[36:39], v9 offset:24832
    v_mfma_f32_16x16x32_bf16 v[172:175], a[84:87], v[52:55], v[172:175]
    ds_read_b128 v[40:43], v9 offset:25088
    v_mfma_f32_16x16x32_bf16 v[176:179], a[88:91], v[52:55], v[176:179]
    v_mfma_f32_16x16x32_bf16 v[180:183], a[92:95], v[52:55], v[180:183]
    ds_read_b128 v[44:47], v9 offset:25344
    v_mfma_f32_16x16x32_bf16 v[184:187], a[84:87], v[56:59], v[184:187]
    buffer_load_dwordx4 a[72:75], v6, s[52:55], s9 offen offset:0
    v_mfma_f32_16x16x32_bf16 v[188:191], a[88:91], v[56:59], v[188:191]
    v_cvt_pk_bf16_f32 v22, v148, v149
    v_mfma_f32_16x16x32_bf16 v[192:195], a[92:95], v[56:59], v[192:195]
    v_mfma_f32_16x16x32_bf16 v[196:199], a[84:87], v[60:63], v[196:199]
    buffer_load_dwordx4 a[76:79], v6, s[52:55], s9 offen offset:1024
    v_mfma_f32_16x16x32_bf16 v[200:203], a[88:91], v[60:63], v[200:203]
    buffer_load_dwordx4 a[80:83], v6, s[52:55], s9 offen offset:2048
    v_mfma_f32_16x16x32_bf16 v[204:207], a[92:95], v[60:63], v[204:207]
    s_add_u32 s9, s9, 3072
    s_waitcnt vmcnt(30) lgkmcnt(0)
    v_mfma_f32_16x16x32_bf16 v[160:163], a[96:99], v[32:35], v[160:163]
    v_mfma_f32_16x16x32_bf16 v[164:167], a[100:103], v[32:35], v[164:167]
    ds_read_b128 v[48:51], v9 offset:28672
    v_mfma_f32_16x16x32_bf16 v[168:171], a[104:107], v[32:35], v[168:171]
    ds_read_b128 v[52:55], v9 offset:28928
    v_mfma_f32_16x16x32_bf16 v[172:175], a[96:99], v[36:39], v[172:175]
    ds_read_b128 v[56:59], v9 offset:29184
    v_mfma_f32_16x16x32_bf16 v[176:179], a[100:103], v[36:39], v[176:179]
    ds_read_b128 v[60:63], v9 offset:29440
    v_mfma_f32_16x16x32_bf16 v[180:183], a[104:107], v[36:39], v[180:183]
    buffer_load_dwordx4 a[84:87], v6, s[52:55], s9 offen offset:0
    v_mfma_f32_16x16x32_bf16 v[184:187], a[96:99], v[40:43], v[184:187]
    v_mfma_f32_16x16x32_bf16 v[188:191], a[100:103], v[40:43], v[188:191]
    v_cvt_pk_bf16_f32 v23, v150, v151
    v_mfma_f32_16x16x32_bf16 v[192:195], a[104:107], v[40:43], v[192:195]
    buffer_load_dwordx4 a[88:91], v6, s[52:55], s9 offen offset:1024
    v_mfma_f32_16x16x32_bf16 v[196:199], a[96:99], v[44:47], v[196:199]
    s_add_u32 s14, s12, 7168
    buffer_store_dwordx4 v[20:23], v6, s[56:59], s14 offen sc1
    v_mfma_f32_16x16x32_bf16 v[200:203], a[100:103], v[44:47], v[200:203]
    buffer_load_dwordx4 a[92:95], v6, s[52:55], s9 offen offset:2048
    v_mfma_f32_16x16x32_bf16 v[204:207], a[104:107], v[44:47], v[204:207]
    s_add_u32 s9, s9, 3072
    s_waitcnt vmcnt(30) lgkmcnt(0)
    v_mfma_f32_16x16x32_bf16 v[160:163], a[108:111], v[48:51], v[160:163]
    v_mfma_f32_16x16x32_bf16 v[164:167], a[112:115], v[48:51], v[164:167]
    ds_read_b128 v[32:35], v9 offset:32768
    v_mfma_f32_16x16x32_bf16 v[168:171], a[116:119], v[48:51], v[168:171]
    ds_read_b128 v[36:39], v9 offset:33024
    v_mfma_f32_16x16x32_bf16 v[172:175], a[108:111], v[52:55], v[172:175]
    ds_read_b128 v[40:43], v9 offset:33280
    v_mfma_f32_16x16x32_bf16 v[176:179], a[112:115], v[52:55], v[176:179]
    ds_read_b128 v[44:47], v9 offset:33536
    v_mfma_f32_16x16x32_bf16 v[180:183], a[116:119], v[52:55], v[180:183]
    buffer_load_dwordx4 a[96:99], v6, s[52:55], s9 offen offset:0
    v_mfma_f32_16x16x32_bf16 v[184:187], a[108:111], v[56:59], v[184:187]
    v_mfma_f32_16x16x32_bf16 v[188:191], a[112:115], v[56:59], v[188:191]
    v_cvt_pk_bf16_f32 v24, v116, v117
    v_mfma_f32_16x16x32_bf16 v[192:195], a[116:119], v[56:59], v[192:195]
    buffer_load_dwordx4 a[100:103], v6, s[52:55], s9 offen offset:1024
    v_mfma_f32_16x16x32_bf16 v[196:199], a[108:111], v[60:63], v[196:199]
    v_cvt_pk_bf16_f32 v25, v118, v119
    v_mfma_f32_16x16x32_bf16 v[200:203], a[112:115], v[60:63], v[200:203]
    buffer_load_dwordx4 a[104:107], v6, s[52:55], s9 offen offset:2048
    v_mfma_f32_16x16x32_bf16 v[204:207], a[116:119], v[60:63], v[204:207]
    s_add_u32 s9, s9, 3072
    s_waitcnt vmcnt(30) lgkmcnt(0)
    v_mfma_f32_16x16x32_bf16 v[160:163], a[120:123], v[32:35], v[160:163]
    v_mfma_f32_16x16x32_bf16 v[164:167], a[124:127], v[32:35], v[164:167]
    ds_read_b128 v[48:51], v9 offset:36864
    v_mfma_f32_16x16x32_bf16 v[168:171], a[128:131], v[32:35], v[168:171]
    v_mfma_f32_16x16x32_bf16 v[172:175], a[120:123], v[36:39], v[172:175]
    ds_read_b128 v[52:55], v9 offset:37120
    v_mfma_f32_16x16x32_bf16 v[176:179], a[124:127], v[36:39], v[176:179]
    v_mfma_f32_16x16x32_bf16 v[180:183], a[128:131], v[36:39], v[180:183]
    ds_read_b128 v[56:59], v9 offset:37376
    v_mfma_f32_16x16x32_bf16 v[184:187], a[120:123], v[40:43], v[184:187]
    v_mfma_f32_16x16x32_bf16 v[188:191], a[124:127], v[40:43], v[188:191]
    ds_read_b128 v[60:63], v9 offset:37632
    v_mfma_f32_16x16x32_bf16 v[192:195], a[128:131], v[40:43], v[192:195]
    v_mfma_f32_16x16x32_bf16 v[196:199], a[120:123], v[44:47], v[196:199]
    v_cvt_pk_bf16_f32 v26, v128, v129
    v_mfma_f32_16x16x32_bf16 v[200:203], a[124:127], v[44:47], v[200:203]
    v_mfma_f32_16x16x32_bf16 v[204:207], a[128:131], v[44:47], v[204:207]
    v_cvt_pk_bf16_f32 v27, v130, v131
    s_waitcnt vmcnt(26) lgkmcnt(0)
    v_mfma_f32_16x16x32_bf16 v[160:163], a[0:3], v[48:51], v[160:163]
    v_mfma_f32_16x16x32_bf16 v[164:167], a[4:7], v[48:51], v[164:167]
    v_mfma_f32_16x16x32_bf16 v[168:171], a[8:11], v[48:51], v[168:171]
    ds_read_b128 v[32:35], v9 offset:40960
    v_mfma_f32_16x16x32_bf16 v[172:175], a[0:3], v[52:55], v[172:175]
    v_mfma_f32_16x16x32_bf16 v[176:179], a[4:7], v[52:55], v[176:179]
    ds_read_b128 v[36:39], v9 offset:41216
    v_mfma_f32_16x16x32_bf16 v[180:183], a[8:11], v[52:55], v[180:183]
    v_mfma_f32_16x16x32_bf16 v[184:187], a[0:3], v[56:59], v[184:187]
    v_mfma_f32_16x16x32_bf16 v[188:191], a[4:7], v[56:59], v[188:191]
    ds_read_b128 v[40:43], v9 offset:41472
    v_mfma_f32_16x16x32_bf16 v[192:195], a[8:11], v[56:59], v[192:195]
    v_mfma_f32_16x16x32_bf16 v[196:199], a[0:3], v[60:63], v[196:199]
    ds_read_b128 v[44:47], v9 offset:41728
    v_mfma_f32_16x16x32_bf16 v[200:203], a[4:7], v[60:63], v[200:203]
    v_mfma_f32_16x16x32_bf16 v[204:207], a[8:11], v[60:63], v[204:207]
    s_add_u32 s14, s12, 8192
    buffer_store_dwordx4 v[24:27], v6, s[56:59], s14 offen sc1
    s_waitcnt vmcnt(24) lgkmcnt(0)
    v_mfma_f32_16x16x32_bf16 v[160:163], a[12:15], v[32:35], v[160:163]
    v_mfma_f32_16x16x32_bf16 v[164:167], a[16:19], v[32:35], v[164:167]
    ds_read_b128 v[48:51], v9 offset:45056
    v_mfma_f32_16x16x32_bf16 v[168:171], a[20:23], v[32:35], v[168:171]
    v_mfma_f32_16x16x32_bf16 v[172:175], a[12:15], v[36:39], v[172:175]
    ds_read_b128 v[52:55], v9 offset:45312
    v_mfma_f32_16x16x32_bf16 v[176:179], a[16:19], v[36:39], v[176:179]
    v_mfma_f32_16x16x32_bf16 v[180:183], a[20:23], v[36:39], v[180:183]
    ds_read_b128 v[56:59], v9 offset:45568
    v_mfma_f32_16x16x32_bf16 v[184:187], a[12:15], v[40:43], v[184:187]
    v_mfma_f32_16x16x32_bf16 v[188:191], a[16:19], v[40:43], v[188:191]
    ds_read_b128 v[60:63], v9 offset:45824
    v_mfma_f32_16x16x32_bf16 v[192:195], a[20:23], v[40:43], v[192:195]
    v_mfma_f32_16x16x32_bf16 v[196:199], a[12:15], v[44:47], v[196:199]
    v_cvt_pk_bf16_f32 v28, v140, v141
    v_mfma_f32_16x16x32_bf16 v[200:203], a[16:19], v[44:47], v[200:203]
    v_mfma_f32_16x16x32_bf16 v[204:207], a[20:23], v[44:47], v[204:207]
    v_cvt_pk_bf16_f32 v29, v142, v143
    s_waitcnt vmcnt(21) lgkmcnt(0)
    v_mfma_f32_16x16x32_bf16 v[160:163], a[24:27], v[48:51], v[160:163]
    v_mfma_f32_16x16x32_bf16 v[164:167], a[28:31], v[48:51], v[164:167]
    ds_read_b128 v[32:35], v9 offset:49152
    v_mfma_f32_16x16x32_bf16 v[168:171], a[32:35], v[48:51], v[168:171]
    v_mfma_f32_16x16x32_bf16 v[172:175], a[24:27], v[52:55], v[172:175]
    ds_read_b128 v[36:39], v9 offset:49408
    v_mfma_f32_16x16x32_bf16 v[176:179], a[28:31], v[52:55], v[176:179]
    v_mfma_f32_16x16x32_bf16 v[180:183], a[32:35], v[52:55], v[180:183]
    ds_read_b128 v[40:43], v9 offset:49664
    v_mfma_f32_16x16x32_bf16 v[184:187], a[24:27], v[56:59], v[184:187]
    v_mfma_f32_16x16x32_bf16 v[188:191], a[28:31], v[56:59], v[188:191]
    ds_read_b128 v[44:47], v9 offset:49920
    v_mfma_f32_16x16x32_bf16 v[192:195], a[32:35], v[56:59], v[192:195]
    v_mfma_f32_16x16x32_bf16 v[196:199], a[24:27], v[60:63], v[196:199]
    v_cvt_pk_bf16_f32 v30, v152, v153
    v_mfma_f32_16x16x32_bf16 v[200:203], a[28:31], v[60:63], v[200:203]
    v_mfma_f32_16x16x32_bf16 v[204:207], a[32:35], v[60:63], v[204:207]
    v_cvt_pk_bf16_f32 v31, v154, v155
    s_waitcnt vmcnt(18) lgkmcnt(0)
    v_mfma_f32_16x16x32_bf16 v[160:163], a[36:39], v[32:35], v[160:163]
    v_mfma_f32_16x16x32_bf16 v[164:167], a[40:43], v[32:35], v[164:167]
    ds_read_b128 v[48:51], v9 offset:53248
    v_mfma_f32_16x16x32_bf16 v[168:171], a[44:47], v[32:35], v[168:171]
    v_mfma_f32_16x16x32_bf16 v[172:175], a[36:39], v[36:39], v[172:175]
    ds_read_b128 v[52:55], v9 offset:53504
    v_mfma_f32_16x16x32_bf16 v[176:179], a[40:43], v[36:39], v[176:179]
    v_mfma_f32_16x16x32_bf16 v[180:183], a[44:47], v[36:39], v[180:183]
    ds_read_b128 v[56:59], v9 offset:53760
    v_mfma_f32_16x16x32_bf16 v[184:187], a[36:39], v[40:43], v[184:187]
    v_mfma_f32_16x16x32_bf16 v[188:191], a[40:43], v[40:43], v[188:191]
    ds_read_b128 v[60:63], v9 offset:54016
    v_mfma_f32_16x16x32_bf16 v[192:195], a[44:47], v[40:43], v[192:195]
    v_mfma_f32_16x16x32_bf16 v[196:199], a[36:39], v[44:47], v[196:199]
    s_add_u32 s14, s12, 9216
    buffer_store_dwordx4 v[28:31], v6, s[56:59], s14 offen sc1
    v_mfma_f32_16x16x32_bf16 v[200:203], a[40:43], v[44:47], v[200:203]
    v_mfma_f32_16x16x32_bf16 v[204:207], a[44:47], v[44:47], v[204:207]
    v_cvt_pk_bf16_f32 v16, v120, v121
    s_waitcnt vmcnt(15) lgkmcnt(0)
    v_mfma_f32_16x16x32_bf16 v[160:163], a[48:51], v[48:51], v[160:163]
    v_mfma_f32_16x16x32_bf16 v[164:167], a[52:55], v[48:51], v[164:167]
    v_mfma_f32_16x16x32_bf16 v[168:171], a[56:59], v[48:51], v[168:171]
    ds_read_b128 v[32:35], v9 offset:57344
    v_mfma_f32_16x16x32_bf16 v[172:175], a[48:51], v[52:55], v[172:175]
    v_mfma_f32_16x16x32_bf16 v[176:179], a[52:55], v[52:55], v[176:179]
    ds_read_b128 v[36:39], v9 offset:57600
    v_mfma_f32_16x16x32_bf16 v[180:183], a[56:59], v[52:55], v[180:183]
    v_mfma_f32_16x16x32_bf16 v[184:187], a[48:51], v[56:59], v[184:187]
    v_mfma_f32_16x16x32_bf16 v[188:191], a[52:55], v[56:59], v[188:191]
    ds_read_b128 v[40:43], v9 offset:57856
    v_mfma_f32_16x16x32_bf16 v[192:195], a[56:59], v[56:59], v[192:195]
    v_mfma_f32_16x16x32_bf16 v[196:199], a[48:51], v[60:63], v[196:199]
    ds_read_b128 v[44:47], v9 offset:58112
    v_mfma_f32_16x16x32_bf16 v[200:203], a[52:55], v[60:63], v[200:203]
    v_mfma_f32_16x16x32_bf16 v[204:207], a[56:59], v[60:63], v[204:207]
    v_cvt_pk_bf16_f32 v17, v122, v123
    s_waitcnt vmcnt(12) lgkmcnt(0)
    v_mfma_f32_16x16x32_bf16 v[160:163], a[60:63], v[32:35], v[160:163]
    v_mfma_f32_16x16x32_bf16 v[164:167], a[64:67], v[32:35], v[164:167]
    ds_read_b128 v[48:51], v9 offset:61440
    v_mfma_f32_16x16x32_bf16 v[168:171], a[68:71], v[32:35], v[168:171]
    v_mfma_f32_16x16x32_bf16 v[172:175], a[60:63], v[36:39], v[172:175]
    ds_read_b128 v[52:55], v9 offset:61696
    v_mfma_f32_16x16x32_bf16 v[176:179], a[64:67], v[36:39], v[176:179]
    v_mfma_f32_16x16x32_bf16 v[180:183], a[68:71], v[36:39], v[180:183]
    ds_read_b128 v[56:59], v9 offset:61952
    v_mfma_f32_16x16x32_bf16 v[184:187], a[60:63], v[40:43], v[184:187]
    v_mfma_f32_16x16x32_bf16 v[188:191], a[64:67], v[40:43], v[188:191]
    ds_read_b128 v[60:63], v9 offset:62208
    v_mfma_f32_16x16x32_bf16 v[192:195], a[68:71], v[40:43], v[192:195]
    v_mfma_f32_16x16x32_bf16 v[196:199], a[60:63], v[44:47], v[196:199]
    v_cvt_pk_bf16_f32 v18, v132, v133
    v_mfma_f32_16x16x32_bf16 v[200:203], a[64:67], v[44:47], v[200:203]
    v_mfma_f32_16x16x32_bf16 v[204:207], a[68:71], v[44:47], v[204:207]
    v_cvt_pk_bf16_f32 v19, v134, v135
    s_waitcnt vmcnt(9) lgkmcnt(0)
    v_mfma_f32_16x16x32_bf16 v[160:163], a[72:75], v[48:51], v[160:163]
    v_mfma_f32_16x16x32_bf16 v[164:167], a[76:79], v[48:51], v[164:167]
    ds_read_b128 v[32:35], v10 offset:0
    v_mfma_f32_16x16x32_bf16 v[168:171], a[80:83], v[48:51], v[168:171]
    v_mfma_f32_16x16x32_bf16 v[172:175], a[72:75], v[52:55], v[172:175]
    ds_read_b128 v[36:39], v10 offset:256
    v_mfma_f32_16x16x32_bf16 v[176:179], a[76:79], v[52:55], v[176:179]
    v_mfma_f32_16x16x32_bf16 v[180:183], a[80:83], v[52:55], v[180:183]
    ds_read_b128 v[40:43], v10 offset:512
    v_mfma_f32_16x16x32_bf16 v[184:187], a[72:75], v[56:59], v[184:187]
    v_mfma_f32_16x16x32_bf16 v[188:191], a[76:79], v[56:59], v[188:191]
    ds_read_b128 v[44:47], v10 offset:768
    v_mfma_f32_16x16x32_bf16 v[192:195], a[80:83], v[56:59], v[192:195]
    v_mfma_f32_16x16x32_bf16 v[196:199], a[72:75], v[60:63], v[196:199]
    s_add_u32 s14, s12, 10240
    buffer_store_dwordx4 v[16:19], v6, s[56:59], s14 offen sc1
    v_mfma_f32_16x16x32_bf16 v[200:203], a[76:79], v[60:63], v[200:203]
    v_mfma_f32_16x16x32_bf16 v[204:207], a[80:83], v[60:63], v[204:207]
    v_cvt_pk_bf16_f32 v20, v144, v145
    s_waitcnt vmcnt(6) lgkmcnt(0)
    v_mfma_f32_16x16x32_bf16 v[160:163], a[84:87], v[32:35], v[160:163]
    v_mfma_f32_16x16x32_bf16 v[164:167], a[88:91], v[32:35], v[164:167]
    ds_read_b128 v[48:51], v10 offset:4096
    v_mfma_f32_16x16x32_bf16 v[168:171], a[92:95], v[32:35], v[168:171]
    v_mfma_f32_16x16x32_bf16 v[172:175], a[84:87], v[36:39], v[172:175]
    ds_read_b128 v[52:55], v10 offset:4352
    v_mfma_f32_16x16x32_bf16 v[176:179], a[88:91], v[36:39], v[176:179]
    v_mfma_f32_16x16x32_bf16 v[180:183], a[92:95], v[36:39], v[180:183]
    ds_read_b128 v[56:59], v10 offset:4608
    v_mfma_f32_16x16x32_bf16 v[184:187], a[84:87], v[40:43], v[184:187]
    v_mfma_f32_16x16x32_bf16 v[188:191], a[88:91], v[40:43], v[188:191]
    ds_read_b128 v[60:63], v10 offset:4864
    v_mfma_f32_16x16x32_bf16 v[192:195], a[92:95], v[40:43], v[192:195]
    v_mfma_f32_16x16x32_bf16 v[196:199], a[84:87], v[44:47], v[196:199]
    v_cvt_pk_bf16_f32 v21, v146, v147
    v_mfma_f32_16x16x32_bf16 v[200:203], a[88:91], v[44:47], v[200:203]
    v_mfma_f32_16x16x32_bf16 v[204:207], a[92:95], v[44:47], v[204:207]
    v_cvt_pk_bf16_f32 v22, v156, v157
    s_waitcnt vmcnt(3) lgkmcnt(0)
    v_mfma_f32_16x16x32_bf16 v[160:163], a[96:99], v[48:51], v[160:163]
    v_mfma_f32_16x16x32_bf16 v[164:167], a[100:103], v[48:51], v[164:167]
    v_mfma_f32_16x16x32_bf16 v[168:171], a[104:107], v[48:51], v[168:171]
    v_mfma_f32_16x16x32_bf16 v[172:175], a[96:99], v[52:55], v[172:175]
    v_mfma_f32_16x16x32_bf16 v[176:179], a[100:103], v[52:55], v[176:179]
    v_mfma_f32_16x16x32_bf16 v[180:183], a[104:107], v[52:55], v[180:183]
    v_cvt_pk_bf16_f32 v23, v158, v159
    v_mfma_f32_16x16x32_bf16 v[184:187], a[96:99], v[56:59], v[184:187]
    v_mfma_f32_16x16x32_bf16 v[188:191], a[100:103], v[56:59], v[188:191]
    v_mfma_f32_16x16x32_bf16 v[192:195], a[104:107], v[56:59], v[192:195]
    v_mfma_f32_16x16x32_bf16 v[196:199], a[96:99], v[60:63], v[196:199]
    v_mfma_f32_16x16x32_bf16 v[200:203], a[100:103], v[60:63], v[200:203]
    v_mfma_f32_16x16x32_bf16 v[204:207], a[104:107], v[60:63], v[204:207]
    s_add_u32 s14, s12, 11264
    buffer_store_dwordx4 v[20:23], v6, s[56:59], s14 offen sc1
    s_nop 7
    v_cvt_pk_bf16_f32 v16, v160, v161
    v_cvt_pk_bf16_f32 v17, v162, v163
    v_cvt_pk_bf16_f32 v18, v172, v173
    v_cvt_pk_bf16_f32 v19, v174, v175
    s_add_u32 s14, s12, 12288
    buffer_store_dwordx4 v[16:19], v6, s[56:59], s14 offen sc1
    v_cvt_pk_bf16_f32 v20, v184, v185
    v_cvt_pk_bf16_f32 v21, v186, v187
    v_cvt_pk_bf16_f32 v22, v196, v197
    v_cvt_pk_bf16_f32 v23, v198, v199
    s_add_u32 s14, s12, 13312
    buffer_store_dwordx4 v[20:23], v6, s[56:59], s14 offen sc1
    v_cvt_pk_bf16_f32 v24, v164, v165
    v_cvt_pk_bf16_f32 v25, v166, v167
    v_cvt_pk_bf16_f32 v26, v176, v177
    v_cvt_pk_bf16_f32 v27, v178, v179
    s_add_u32 s14, s12, 14336
    buffer_store_dwordx4 v[24:27], v6, s[56:59], s14 offen sc1
    v_cvt_pk_bf16_f32 v28, v188, v189
    v_cvt_pk_bf16_f32 v29, v190, v191
    v_cvt_pk_bf16_f32 v30, v200, v201
    v_cvt_pk_bf16_f32 v31, v202, v203
    s_add_u32 s14, s12, 15360
    buffer_store_dwordx4 v[28:31], v6, s[56:59], s14 offen sc1
    v_cvt_pk_bf16_f32 v16, v168, v169
    v_cvt_pk_bf16_f32 v17, v170, v171
    v_cvt_pk_bf16_f32 v18, v180, v181
    v_cvt_pk_bf16_f32 v19, v182, v183
    s_add_u32 s14, s12, 16384
    buffer_store_dwordx4 v[16:19], v6, s[56:59], s14 offen sc1
    v_cvt_pk_bf16_f32 v20, v192, v193
    v_cvt_pk_bf16_f32 v21, v194, v195
    v_cvt_pk_bf16_f32 v22, v204, v205
    v_cvt_pk_bf16_f32 v23, v206, v207
    s_add_u32 s14, s12, 17408
    buffer_store_dwordx4 v[20:23], v6, s[56:59], s14 offen sc1
    s_add_u32 s48, s46, 45420544
    s_addc_u32 s49, s47, 0
    s_mov_b32 s50, 32768
    s_mov_b32 s51, 0x20000
    s_add_u32 s60, s46, 16678912
    s_addc_u32 s61, s47, 0
    s_mov_b32 s62, 2359296
    s_mov_b32 s63, 0x20000
    s_add_u32 s64, s46, 21397504
    s_addc_u32 s65, s47, 0
    s_mov_b32 s66, 2359296
    s_mov_b32 s67, 0x20000
    s_mov_b32 s68, s46
    s_mov_b32 s69, s47
    s_mov_b32 s70, 13824
    s_mov_b32 s71, 0x20000
    s_mov_b32 s72, s42
    s_mov_b32 s73, s43
    s_mov_b32 s74, 2359296
    s_mov_b32 s75, 0x20000
    s_waitcnt vmcnt(0)
    s_barrier
    s_cmp_lg_u32 s3, 0
    s_cbranch_scc1 K5_NOFLAG
    s_lshl_b32 s9, s5, 3
    s_add_u32 s9, s9, s4
    s_lshl_b32 s9, s9, 7
    v_mov_b32 v16, s9
    v_mov_b32 v17, 1
    s_mov_b64 exec, 1
    buffer_store_dword v17, v16, s[48:51], 0 offen sc1
    s_mov_b64 exec, -1
K5_NOFLAG:
    s_mul_i32 s16, s4, 9
    s_add_u32 s16, s16, 0
    s_add_u32 s16, s16, s3
    s_and_b32 s17, s16, 1
    s_lshr_b32 s16, s16, 1
    s_mul_i32 s18, s5, 36
    s_add_u32 s18, s18, s16
    s_lshl_b32 s18, s18, 11
    s_lshl_b32 s19, s17, 10
    s_add_u32 s18, s18, s19
    v_add_u32 v108, s18, v6
    s_lshl_b32 s18, s16, 1
    v_lshrrev_b32 v109, 1, v3
    v_add_u32 v109, s18, v109
    v_lshlrev_b32 v109, 15, v109
    s_lshl_b32 s19, s5, 6
    s_lshl_b32 s20, s17, 5
    s_add_u32 s19, s19, s20
    v_add_u32 v110, s19, v2
    v_lshlrev_b32 v111, 4, v110
    v_add_u32 v109, v109, v111
    v_and_b32 v111, 1, v3
    v_lshlrev_b32 v111, 3, v111
    v_add_u32 v109, v109, v111
    s_lshl_b32 s18, s16, 6
    v_lshlrev_b32 v111, 4, v3
    v_add_u32 v111, s18, v111
    v_mul_u32_u24 v110, 1152, v110
    v_lshrrev_b32 v16, 1, v111
    v_add_u32 v110, v110, v16
    v_add_u32 v111, 11520, v111
    buffer_load_dwordx2 v[96:97], v109, s[60:63], 0 offen offset:0
    buffer_load_dwordx2 v[98:99], v109, s[60:63], 0 offen offset:256
    buffer_load_dwordx2 v[100:101], v109, s[64:67], 0 offen offset:0
    buffer_load_dwordx2 v[102:103], v109, s[64:67], 0 offen offset:256
    buffer_load_dwordx4 v[104:107], v111, s[68:71], 0 offen
    s_lshl_b32 s19, s17, 9
    v_lshlrev_b32 v16, 4, v2
    v_add_u32 v16, s19, v16
    v_add_u32 v16, 147468, v16
    ds_read_b32 v208, v16 offset:0
    ds_read_b32 v210, v16 offset:256
    s_mul_i32 s16, s4, 9
    s_add_u32 s16, s16, 4
    s_add_u32 s16, s16, s3
    s_and_b32 s17, s16, 1
    s_lshr_b32 s16, s16, 1
    s_mul_i32 s18, s5, 36
    s_add_u32 s18, s18, s16
    s_lshl_b32 s18, s18, 11
    s_lshl_b32 s19, s17, 10
    s_add_u32 s18, s18, s19
    v_add_u32 v156, s18, v6
    s_lshl_b32 s18, s16, 1
    v_lshrrev_b32 v157, 1, v3
    v_add_u32 v157, s18, v157
    v_lshlrev_b32 v157, 15, v157
    s_lshl_b32 s19, s5, 6
    s_lshl_b32 s20, s17, 5
    s_add_u32 s19, s19, s20
    v_add_u32 v158, s19, v2
    v_lshlrev_b32 v159, 4, v158
    v_add_u32 v157, v157, v159
    v_and_b32 v159, 1, v3
    v_lshlrev_b32 v159, 3, v159
    v_add_u32 v157, v157, v159
    s_lshl_b32 s18, s16, 6
    v_lshlrev_b32 v159, 4, v3
    v_add_u32 v159, s18, v159
    v_mul_u32_u24 v158, 1152, v158
    v_lshrrev_b32 v16, 1, v159
    v_add_u32 v158, v158, v16
    v_add_u32 v159, 11520, v159
    buffer_load_dwordx2 v[144:145], v157, s[60:63], 0 offen offset:0
    buffer_load_dwordx2 v[146:147], v157, s[60:63], 0 offen offset:256
    buffer_load_dwordx2 v[148:149], v157, s[64:67], 0 offen offset:0
    buffer_load_dwordx2 v[150:151], v157, s[64:67], 0 offen offset:256
    buffer_load_dwordx4 v[152:155], v159, s[68:71], 0 offen
    s_lshl_b32 s19, s17, 9
    v_lshlrev_b32 v16, 4, v2
    v_add_u32 v16, s19, v16
    v_add_u32 v16, 147468, v16
    ds_read_b32 v212, v16 offset:0
    ds_read_b32 v214, v16 offset:256
    s_cmp_lg_u32 s3, 0
    s_cbranch_scc1 K5_NS2
    s_mul_i32 s16, s4, 9
    s_add_u32 s16, s16, 8
    s_add_u32 s16, s16, s3
    s_and_b32 s17, s16, 1
    s_lshr_b32 s16, s16, 1
    s_mul_i32 s18, s5, 36
    s_add_u32 s18, s18, s16
    s_lshl_b32 s18, s18, 11
    s_lshl_b32 s19, s17, 10
    s_add_u32 s18, s18, s19
    v_add_u32 v204, s18, v6
    s_lshl_b32 s18, s16, 1
    v_lshrrev_b32 v205, 1, v3
    v_add_u32 v205, s18, v205
    v_lshlrev_b32 v205, 15, v205
    s_lshl_b32 s19, s5, 6
    s_lshl_b32 s20, s17, 5
    s_add_u32 s19, s19, s20
    v_add_u32 v206, s19, v2
    v_lshlrev_b32 v207, 4, v206
    v_add_u32 v205, v205, v207
    v_and_b32 v207, 1, v3
    v_lshlrev_b32 v207, 3, v207
    v_add_u32 v205, v205, v207
    s_lshl_b32 s18, s16, 6
    v_lshlrev_b32 v207, 4, v3
    v_add_u32 v207, s18, v207
    v_mul_u32_u24 v206, 1152, v206
    v_lshrrev_b32 v16, 1, v207
    v_add_u32 v206, v206, v16
    v_add_u32 v207, 11520, v207
    buffer_load_dwordx2 v[192:193], v205, s[60:63], 0 offen offset:0
    buffer_load_dwordx2 v[194:195], v205, s[60:63], 0 offen offset:256
    buffer_load_dwordx2 v[196:197], v205, s[64:67], 0 offen offset:0
    buffer_load_dwordx2 v[198:199], v205, s[64:67], 0 offen offset:256
    buffer_load_dwordx4 v[200:203], v207, s[68:71], 0 offen
    s_lshl_b32 s19, s17, 9
    v_lshlrev_b32 v16, 4, v2
    v_add_u32 v16, s19, v16
    v_add_u32 v16, 147468, v16
    ds_read_b32 v216, v16 offset:0
    ds_read_b32 v218, v16 offset:256
K5_NS2:
    s_cmp_lg_u32 s3, 1
    s_cbranch_scc1 K5_NOPOLL
    s_lshl_b32 s9, s5, 3
    v_add_u32 v16, s9, v1
    v_lshlrev_b32 v16, 7, v16
    s_mov_b64 exec, 0xff
    s_mov_b32 s12, 400000
K5_POLL:
    buffer_load_dword v17, v16, s[48:51], 0 offen sc1
    s_waitcnt vmcnt(0)
    v_cmp_ne_u32 vcc, 1, v17
    s_cbranch_vccz K5_POLLOK
    s_sleep 1
    s_sub_u32 s12, s12, 1
    s_cmp_lg_u32 s12, 0
    s_cbranch_scc1 K5_POLL
K5_POLLOK:
    s_mov_b64 exec, -1
K5_NOPOLL:
    s_barrier
    s_waitcnt lgkmcnt(0)
    s_mov_b32 s16, 0
    buffer_load_dwordx4 v[64:67], v108, s[56:59], s16 offen sc1
    s_mov_b32 s16, 2359296
    buffer_load_dwordx4 v[68:71], v108, s[56:59], s16 offen sc1
    s_mov_b32 s16, 4718592
    buffer_load_dwordx4 v[72:75], v108, s[56:59], s16 offen sc1
    s_mov_b32 s16, 7077888
    buffer_load_dwordx4 v[76:79], v108, s[56:59], s16 offen sc1
    s_mov_b32 s16, 9437184
    buffer_load_dwordx4 v[80:83], v108, s[56:59], s16 offen sc1
    s_mov_b32 s16, 11796480
    buffer_load_dwordx4 v[84:87], v108, s[56:59], s16 offen sc1
    s_mov_b32 s16, 14155776
    buffer_load_dwordx4 v[88:91], v108, s[56:59], s16 offen sc1
    s_mov_b32 s16, 16515072
    buffer_load_dwordx4 v[92:95], v108, s[56:59], s16 offen sc1
    s_mov_b32 s16, 0
    buffer_load_dwordx4 v[112:115], v156, s[56:59], s16 offen sc1
    s_mov_b32 s16, 2359296
    buffer_load_dwordx4 v[116:119], v156, s[56:59], s16 offen sc1
    s_mov_b32 s16, 4718592
    buffer_load_dwordx4 v[120:123], v156, s[56:59], s16 offen sc1
    s_mov_b32 s16, 7077888
    buffer_load_dwordx4 v[124:127], v156, s[56:59], s16 offen sc1
    s_mov_b32 s16, 9437184
    buffer_load_dwordx4 v[128:131], v156, s[56:59], s16 offen sc1
    s_mov_b32 s16, 11796480
    buffer_load_dwordx4 v[132:135], v156, s[56:59], s16 offen sc1
    s_mov_b32 s16, 14155776
    buffer_load_dwordx4 v[136:139], v156, s[56:59], s16 offen sc1
    s_mov_b32 s16, 16515072
    buffer_load_dwordx4 v[140:143], v156, s[56:59], s16 offen sc1
    s_cmp_lg_u32 s3, 0
    s_cbranch_scc1 K5_NP2
    s_mov_b32 s16, 0
    buffer_load_dwordx4 v[160:163], v204, s[56:59], s16 offen sc1
    s_mov_b32 s16, 2359296
    buffer_load_dwordx4 v[164:167], v204, s[56:59], s16 offen sc1
    s_mov_b32 s16, 4718592
    buffer_load_dwordx4 v[168:171], v204, s[56:59], s16 offen sc1
    s_mov_b32 s16, 7077888
    buffer_load_dwordx4 v[172:175], v204, s[56:59], s16 offen sc1
    s_mov_b32 s16, 9437184
    buffer_load_dwordx4 v[176:179], v204, s[56:59], s16 offen sc1
    s_mov_b32 s16, 11796480
    buffer_load_dwordx4 v[180:183], v204, s[56:59], s16 offen sc1
    s_mov_b32 s16, 14155776
    buffer_load_dwordx4 v[184:187], v204, s[56:59], s16 offen sc1
    s_mov_b32 s16, 16515072
    buffer_load_dwordx4 v[188:191], v204, s[56:59], s16 offen sc1
    s_waitcnt vmcnt(16)
    v_lshlrev_b32 v16, 16, v64
    v_and_b32 v17, 0xffff0000, v64
    v_lshlrev_b32 v18, 16, v65
    v_and_b32 v19, 0xffff0000, v65
    v_lshlrev_b32 v20, 16, v66
    v_and_b32 v21, 0xffff0000, v66
    v_lshlrev_b32 v22, 16, v67
    v_and_b32 v23, 0xffff0000, v67
    v_lshlrev_b32 v24, 16, v68
    v_and_b32 v25, 0xffff0000, v68
    v_pk_add_f32 v[16:17], v[16:17], v[24:25]
    v_lshlrev_b32 v26, 16, v69
    v_and_b32 v27, 0xffff0000, v69
    v_pk_add_f32 v[18:19], v[18:19], v[26:27]
    v_lshlrev_b32 v24, 16, v70
    v_and_b32 v25, 0xffff0000, v70
    v_pk_add_f32 v[20:21], v[20:21], v[24:25]
    v_lshlrev_b32 v26, 16, v71
    v_and_b32 v27, 0xffff0000, v71
    v_pk_add_f32 v[22:23], v[22:23], v[26:27]
    v_lshlrev_b32 v24, 16, v72
    v_and_b32 v25, 0xffff0000, v72
    v_pk_add_f32 v[16:17], v[16:17], v[24:25]
    v_lshlrev_b32 v26, 16, v73
    v_and_b32 v27, 0xffff0000, v73
    v_pk_add_f32 v[18:19], v[18:19], v[26:27]
    v_lshlrev_b32 v24, 16, v74
    v_and_b32 v25, 0xffff0000, v74
    v_pk_add_f32 v[20:21], v[20:21], v[24:25]
    v_lshlrev_b32 v26, 16, v75
    v_and_b32 v27, 0xffff0000, v75
    v_pk_add_f32 v[22:23], v[22:23], v[26:27]
    v_lshlrev_b32 v24, 16, v76
    v_and_b32 v25, 0xffff0000, v76
    v_pk_add_f32 v[16:17], v[16:17], v[24:25]
    v_lshlrev_b32 v26, 16, v77
    v_and_b32 v27, 0xffff0000, v77
    v_pk_add_f32 v[18:19], v[18:19], v[26:27]
    v_lshlrev_b32 v24, 16, v78
    v_and_b32 v25, 0xffff0000, v78
    v_pk_add_f32 v[20:21], v[20:21], v[24:25]
    v_lshlrev_b32 v26, 16, v79
    v_and_b32 v27, 0xffff0000, v79
    v_pk_add_f32 v[22:23], v[22:23], v[26:27]
    v_lshlrev_b32 v24, 16, v80
    v_and_b32 v25, 0xffff0000, v80
    v_pk_add_f32 v[16:17], v[16:17], v[24:25]
    v_lshlrev_b32 v26, 16, v81
    v_and_b32 v27, 0xffff0000, v81
    v_pk_add_f32 v[18:19], v[18:19], v[26:27]
    v_lshlrev_b32 v24, 16, v82
    v_and_b32 v25, 0xffff0000, v82
    v_pk_add_f32 v[20:21], v[20:21], v[24:25]
    v_lshlrev_b32 v26, 16, v83
    v_and_b32 v27, 0xffff0000, v83
    v_pk_add_f32 v[22:23], v[22:23], v[26:27]
    v_lshlrev_b32 v24, 16, v84
    v_and_b32 v25, 0xffff0000, v84
    v_pk_add_f32 v[16:17], v[16:17], v[24:25]
    v_lshlrev_b32 v26, 16, v85
    v_and_b32 v27, 0xffff0000, v85
    v_pk_add_f32 v[18:19], v[18:19], v[26:27]
    v_lshlrev_b32 v24, 16, v86
    v_and_b32 v25, 0xffff0000, v86
    v_pk_add_f32 v[20:21], v[20:21], v[24:25]
    v_lshlrev_b32 v26, 16, v87
    v_and_b32 v27, 0xffff0000, v87
    v_pk_add_f32 v[22:23], v[22:23], v[26:27]
    v_lshlrev_b32 v24, 16, v88
    v_and_b32 v25, 0xffff0000, v88
    v_pk_add_f32 v[16:17], v[16:17], v[24:25]
    v_lshlrev_b32 v26, 16, v89
    v_and_b32 v27, 0xffff0000, v89
    v_pk_add_f32 v[18:19], v[18:19], v[26:27]
    v_lshlrev_b32 v24, 16, v90
    v_and_b32 v25, 0xffff0000, v90
    v_pk_add_f32 v[20:21], v[20:21], v[24:25]
    v_lshlrev_b32 v26, 16, v91
    v_and_b32 v27, 0xffff0000, v91
    v_pk_add_f32 v[22:23], v[22:23], v[26:27]
    v_lshlrev_b32 v24, 16, v92
    v_and_b32 v25, 0xffff0000, v92
    v_pk_add_f32 v[16:17], v[16:17], v[24:25]
    v_lshlrev_b32 v26, 16, v93
    v_and_b32 v27, 0xffff0000, v93
    v_pk_add_f32 v[18:19], v[18:19], v[26:27]
    v_lshlrev_b32 v24, 16, v94
    v_and_b32 v25, 0xffff0000, v94
    v_pk_add_f32 v[20:21], v[20:21], v[24:25]
    v_lshlrev_b32 v26, 16, v95
    v_and_b32 v27, 0xffff0000, v95
    v_pk_add_f32 v[22:23], v[22:23], v[26:27]
    v_lshlrev_b32 v24, 16, v100
    v_and_b32 v25, 0xffff0000, v100
    v_pk_fma_f32 v[16:17], v[16:17], v[208:209], v[24:25] op_sel_hi:[1,0,1]
    v_lshlrev_b32 v26, 16, v96
    v_and_b32 v27, 0xffff0000, v96
    v_pk_fma_f32 v[16:17], v[16:17], v[104:105], v[26:27]
    v_lshlrev_b32 v24, 16, v101
    v_and_b32 v25, 0xffff0000, v101
    v_pk_fma_f32 v[18:19], v[18:19], v[208:209], v[24:25] op_sel_hi:[1,0,1]
    v_lshlrev_b32 v26, 16, v97
    v_and_b32 v27, 0xffff0000, v97
    v_pk_fma_f32 v[18:19], v[18:19], v[106:107], v[26:27]
    v_cvt_pk_bf16_f32 v28, v16, v17
    v_cvt_pk_bf16_f32 v29, v18, v19
    buffer_store_dwordx2 v[28:29], v110, s[72:75], 0 offen
    v_add_u32 v110, 18432, v110
    v_lshlrev_b32 v24, 16, v102
    v_and_b32 v25, 0xffff0000, v102
    v_pk_fma_f32 v[20:21], v[20:21], v[210:211], v[24:25] op_sel_hi:[1,0,1]
    v_lshlrev_b32 v26, 16, v98
    v_and_b32 v27, 0xffff0000, v98
    v_pk_fma_f32 v[20:21], v[20:21], v[104:105], v[26:27]
    v_lshlrev_b32 v24, 16, v103
    v_and_b32 v25, 0xffff0000, v103
    v_pk_fma_f32 v[22:23], v[22:23], v[210:211], v[24:25] op_sel_hi:[1,0,1]
    v_lshlrev_b32 v26, 16, v99
    v_and_b32 v27, 0xffff0000, v99
    v_pk_fma_f32 v[22:23], v[22:23], v[106:107], v[26:27]
    v_cvt_pk_bf16_f32 v30, v20, v21
    v_cvt_pk_bf16_f32 v31, v22, v23
    buffer_store_dwordx2 v[30:31], v110, s[72:75], 0 offen
    s_waitcnt vmcnt(10)
    v_lshlrev_b32 v16, 16, v112
    v_and_b32 v17, 0xffff0000, v112
    v_lshlrev_b32 v18, 16, v113
    v_and_b32 v19, 0xffff0000, v113
    v_lshlrev_b32 v20, 16, v114
    v_and_b32 v21, 0xffff0000, v114
    v_lshlrev_b32 v22, 16, v115
    v_and_b32 v23, 0xffff0000, v115
    v_lshlrev_b32 v24, 16, v116
    v_and_b32 v25, 0xffff0000, v116
    v_pk_add_f32 v[16:17], v[16:17], v[24:25]
    v_lshlrev_b32 v26, 16, v117
    v_and_b32 v27, 0xffff0000, v117
    v_pk_add_f32 v[18:19], v[18:19], v[26:27]
    v_lshlrev_b32 v24, 16, v118
    v_and_b32 v25, 0xffff0000, v118
    v_pk_add_f32 v[20:21], v[20:21], v[24:25]
    v_lshlrev_b32 v26, 16, v119
    v_and_b32 v27, 0xffff0000, v119
    v_pk_add_f32 v[22:23], v[22:23], v[26:27]
    v_lshlrev_b32 v24, 16, v120
    v_and_b32 v25, 0xffff0000, v120
    v_pk_add_f32 v[16:17], v[16:17], v[24:25]
    v_lshlrev_b32 v26, 16, v121
    v_and_b32 v27, 0xffff0000, v121
    v_pk_add_f32 v[18:19], v[18:19], v[26:27]
    v_lshlrev_b32 v24, 16, v122
    v_and_b32 v25, 0xffff0000, v122
    v_pk_add_f32 v[20:21], v[20:21], v[24:25]
    v_lshlrev_b32 v26, 16, v123
    v_and_b32 v27, 0xffff0000, v123
    v_pk_add_f32 v[22:23], v[22:23], v[26:27]
    v_lshlrev_b32 v24, 16, v124
    v_and_b32 v25, 0xffff0000, v124
    v_pk_add_f32 v[16:17], v[16:17], v[24:25]
    v_lshlrev_b32 v26, 16, v125
    v_and_b32 v27, 0xffff0000, v125
    v_pk_add_f32 v[18:19], v[18:19], v[26:27]
    v_lshlrev_b32 v24, 16, v126
    v_and_b32 v25, 0xffff0000, v126
    v_pk_add_f32 v[20:21], v[20:21], v[24:25]
    v_lshlrev_b32 v26, 16, v127
    v_and_b32 v27, 0xffff0000, v127
    v_pk_add_f32 v[22:23], v[22:23], v[26:27]
    v_lshlrev_b32 v24, 16, v128
    v_and_b32 v25, 0xffff0000, v128
    v_pk_add_f32 v[16:17], v[16:17], v[24:25]
    v_lshlrev_b32 v26, 16, v129
    v_and_b32 v27, 0xffff0000, v129
    v_pk_add_f32 v[18:19], v[18:19], v[26:27]
    v_lshlrev_b32 v24, 16, v130
    v_and_b32 v25, 0xffff0000, v130
    v_pk_add_f32 v[20:21], v[20:21], v[24:25]
    v_lshlrev_b32 v26, 16, v131
    v_and_b32 v27, 0xffff0000, v131
    v_pk_add_f32 v[22:23], v[22:23], v[26:27]
    v_lshlrev_b32 v24, 16, v132
    v_and_b32 v25, 0xffff0000, v132
    v_pk_add_f32 v[16:17], v[16:17], v[24:25]
    v_lshlrev_b32 v26, 16, v133
    v_and_b32 v27, 0xffff0000, v133
    v_pk_add_f32 v[18:19], v[18:19], v[26:27]
    v_lshlrev_b32 v24, 16, v134
    v_and_b32 v25, 0xffff0000, v134
    v_pk_add_f32 v[20:21], v[20:21], v[24:25]
    v_lshlrev_b32 v26, 16, v135
    v_and_b32 v27, 0xffff0000, v135
    v_pk_add_f32 v[22:23], v[22:23], v[26:27]
    v_lshlrev_b32 v24, 16, v136
    v_and_b32 v25, 0xffff0000, v136
    v_pk_add_f32 v[16:17], v[16:17], v[24:25]
    v_lshlrev_b32 v26, 16, v137
    v_and_b32 v27, 0xffff0000, v137
    v_pk_add_f32 v[18:19], v[18:19], v[26:27]
    v_lshlrev_b32 v24, 16, v138
    v_and_b32 v25, 0xffff0000, v138
    v_pk_add_f32 v[20:21], v[20:21], v[24:25]
    v_lshlrev_b32 v26, 16, v139
    v_and_b32 v27, 0xffff0000, v139
    v_pk_add_f32 v[22:23], v[22:23], v[26:27]
    v_lshlrev_b32 v24, 16, v140
    v_and_b32 v25, 0xffff0000, v140
    v_pk_add_f32 v[16:17], v[16:17], v[24:25]
    v_lshlrev_b32 v26, 16, v141
    v_and_b32 v27, 0xffff0000, v141
    v_pk_add_f32 v[18:19], v[18:19], v[26:27]
    v_lshlrev_b32 v24, 16, v142
    v_and_b32 v25, 0xffff0000, v142
    v_pk_add_f32 v[20:21], v[20:21], v[24:25]
    v_lshlrev_b32 v26, 16, v143
    v_and_b32 v27, 0xffff0000, v143
    v_pk_add_f32 v[22:23], v[22:23], v[26:27]
    v_lshlrev_b32 v24, 16, v148
    v_and_b32 v25, 0xffff0000, v148
    v_pk_fma_f32 v[16:17], v[16:17], v[212:213], v[24:25] op_sel_hi:[1,0,1]
    v_lshlrev_b32 v26, 16, v144
    v_and_b32 v27, 0xffff0000, v144
    v_pk_fma_f32 v[16:17], v[16:17], v[152:153], v[26:27]
    v_lshlrev_b32 v24, 16, v149
    v_and_b32 v25, 0xffff0000, v149
    v_pk_fma_f32 v[18:19], v[18:19], v[212:213], v[24:25] op_sel_hi:[1,0,1]
    v_lshlrev_b32 v26, 16, v145
    v_and_b32 v27, 0xffff0000, v145
    v_pk_fma_f32 v[18:19], v[18:19], v[154:155], v[26:27]
    v_cvt_pk_bf16_f32 v28, v16, v17
    v_cvt_pk_bf16_f32 v29, v18, v19
    buffer_store_dwordx2 v[28:29], v158, s[72:75], 0 offen
    v_add_u32 v158, 18432, v158
    v_lshlrev_b32 v24, 16, v150
    v_and_b32 v25, 0xffff0000, v150
    v_pk_fma_f32 v[20:21], v[20:21], v[214:215], v[24:25] op_sel_hi:[1,0,1]
    v_lshlrev_b32 v26, 16, v146
    v_and_b32 v27, 0xffff0000, v146
    v_pk_fma_f32 v[20:21], v[20:21], v[152:153], v[26:27]
    v_lshlrev_b32 v24, 16, v151
    v_and_b32 v25, 0xffff0000, v151
    v_pk_fma_f32 v[22:23], v[22:23], v[214:215], v[24:25] op_sel_hi:[1,0,1]
    v_lshlrev_b32 v26, 16, v147
    v_and_b32 v27, 0xffff0000, v147
    v_pk_fma_f32 v[22:23], v[22:23], v[154:155], v[26:27]
    v_cvt_pk_bf16_f32 v30, v20, v21
    v_cvt_pk_bf16_f32 v31, v22, v23
    buffer_store_dwordx2 v[30:31], v158, s[72:75], 0 offen
    s_waitcnt vmcnt(4)
    v_lshlrev_b32 v16, 16, v160
    v_and_b32 v17, 0xffff0000, v160
    v_lshlrev_b32 v18, 16, v161
    v_and_b32 v19, 0xffff0000, v161
    v_lshlrev_b32 v20, 16, v162
    v_and_b32 v21, 0xffff0000, v162
    v_lshlrev_b32 v22, 16, v163
    v_and_b32 v23, 0xffff0000, v163
    v_lshlrev_b32 v24, 16, v164
    v_and_b32 v25, 0xffff0000, v164
    v_pk_add_f32 v[16:17], v[16:17], v[24:25]
    v_lshlrev_b32 v26, 16, v165
    v_and_b32 v27, 0xffff0000, v165
    v_pk_add_f32 v[18:19], v[18:19], v[26:27]
    v_lshlrev_b32 v24, 16, v166
    v_and_b32 v25, 0xffff0000, v166
    v_pk_add_f32 v[20:21], v[20:21], v[24:25]
    v_lshlrev_b32 v26, 16, v167
    v_and_b32 v27, 0xffff0000, v167
    v_pk_add_f32 v[22:23], v[22:23], v[26:27]
    v_lshlrev_b32 v24, 16, v168
    v_and_b32 v25, 0xffff0000, v168
    v_pk_add_f32 v[16:17], v[16:17], v[24:25]
    v_lshlrev_b32 v26, 16, v169
    v_and_b32 v27, 0xffff0000, v169
    v_pk_add_f32 v[18:19], v[18:19], v[26:27]
    v_lshlrev_b32 v24, 16, v170
    v_and_b32 v25, 0xffff0000, v170
    v_pk_add_f32 v[20:21], v[20:21], v[24:25]
    v_lshlrev_b32 v26, 16, v171
    v_and_b32 v27, 0xffff0000, v171
    v_pk_add_f32 v[22:23], v[22:23], v[26:27]
    v_lshlrev_b32 v24, 16, v172
    v_and_b32 v25, 0xffff0000, v172
    v_pk_add_f32 v[16:17], v[16:17], v[24:25]
    v_lshlrev_b32 v26, 16, v173
    v_and_b32 v27, 0xffff0000, v173
    v_pk_add_f32 v[18:19], v[18:19], v[26:27]
    v_lshlrev_b32 v24, 16, v174
    v_and_b32 v25, 0xffff0000, v174
    v_pk_add_f32 v[20:21], v[20:21], v[24:25]
    v_lshlrev_b32 v26, 16, v175
    v_and_b32 v27, 0xffff0000, v175
    v_pk_add_f32 v[22:23], v[22:23], v[26:27]
    v_lshlrev_b32 v24, 16, v176
    v_and_b32 v25, 0xffff0000, v176
    v_pk_add_f32 v[16:17], v[16:17], v[24:25]
    v_lshlrev_b32 v26, 16, v177
    v_and_b32 v27, 0xffff0000, v177
    v_pk_add_f32 v[18:19], v[18:19], v[26:27]
    v_lshlrev_b32 v24, 16, v178
    v_and_b32 v25, 0xffff0000, v178
    v_pk_add_f32 v[20:21], v[20:21], v[24:25]
    v_lshlrev_b32 v26, 16, v179
    v_and_b32 v27, 0xffff0000, v179
    v_pk_add_f32 v[22:23], v[22:23], v[26:27]
    v_lshlrev_b32 v24, 16, v180
    v_and_b32 v25, 0xffff0000, v180
    v_pk_add_f32 v[16:17], v[16:17], v[24:25]
    v_lshlrev_b32 v26, 16, v181
    v_and_b32 v27, 0xffff0000, v181
    v_pk_add_f32 v[18:19], v[18:19], v[26:27]
    v_lshlrev_b32 v24, 16, v182
    v_and_b32 v25, 0xffff0000, v182
    v_pk_add_f32 v[20:21], v[20:21], v[24:25]
    v_lshlrev_b32 v26, 16, v183
    v_and_b32 v27, 0xffff0000, v183
    v_pk_add_f32 v[22:23], v[22:23], v[26:27]
    v_lshlrev_b32 v24, 16, v184
    v_and_b32 v25, 0xffff0000, v184
    v_pk_add_f32 v[16:17], v[16:17], v[24:25]
    v_lshlrev_b32 v26, 16, v185
    v_and_b32 v27, 0xffff0000, v185
    v_pk_add_f32 v[18:19], v[18:19], v[26:27]
    v_lshlrev_b32 v24, 16, v186
    v_and_b32 v25, 0xffff0000, v186
    v_pk_add_f32 v[20:21], v[20:21], v[24:25]
    v_lshlrev_b32 v26, 16, v187
    v_and_b32 v27, 0xffff0000, v187
    v_pk_add_f32 v[22:23], v[22:23], v[26:27]
    v_lshlrev_b32 v24, 16, v188
    v_and_b32 v25, 0xffff0000, v188
    v_pk_add_f32 v[16:17], v[16:17], v[24:25]
    v_lshlrev_b32 v26, 16, v189
    v_and_b32 v27, 0xffff0000, v189
    v_pk_add_f32 v[18:19], v[18:19], v[26:27]
    v_lshlrev_b32 v24, 16, v190
    v_and_b32 v25, 0xffff0000, v190
    v_pk_add_f32 v[20:21], v[20:21], v[24:25]
    v_lshlrev_b32 v26, 16, v191
    v_and_b32 v27, 0xffff0000, v191
    v_pk_add_f32 v[22:23], v[22:23], v[26:27]
    v_lshlrev_b32 v24, 16, v196
    v_and_b32 v25, 0xffff0000, v196
    v_pk_fma_f32 v[16:17], v[16:17], v[216:217], v[24:25] op_sel_hi:[1,0,1]
    v_lshlrev_b32 v26, 16, v192
    v_and_b32 v27, 0xffff0000, v192
    v_pk_fma_f32 v[16:17], v[16:17], v[200:201], v[26:27]
    v_lshlrev_b32 v24, 16, v197
    v_and_b32 v25, 0xffff0000, v197
    v_pk_fma_f32 v[18:19], v[18:19], v[216:217], v[24:25] op_sel_hi:[1,0,1]
    v_lshlrev_b32 v26, 16, v193
    v_and_b32 v27, 0xffff0000, v193
    v_pk_fma_f32 v[18:19], v[18:19], v[202:203], v[26:27]
    v_cvt_pk_bf16_f32 v28, v16, v17
    v_cvt_pk_bf16_f32 v29, v18, v19
    buffer_store_dwordx2 v[28:29], v206, s[72:75], 0 offen
    v_add_u32 v206, 18432, v206
    v_lshlrev_b32 v24, 16, v198
    v_and_b32 v25, 0xffff0000, v198
    v_pk_fma_f32 v[20:21], v[20:21], v[218:219], v[24:25] op_sel_hi:[1,0,1]
    v_lshlrev_b32 v26, 16, v194
    v_and_b32 v27, 0xffff0000, v194
    v_pk_fma_f32 v[20:21], v[20:21], v[200:201], v[26:27]
    v_lshlrev_b32 v24, 16, v199
    v_and_b32 v25, 0xffff0000, v199
    v_pk_fma_f32 v[22:23], v[22:23], v[218:219], v[24:25] op_sel_hi:[1,0,1]
    v_lshlrev_b32 v26, 16, v195
    v_and_b32 v27, 0xffff0000, v195
    v_pk_fma_f32 v[22:23], v[22:23], v[202:203], v[26:27]
    v_cvt_pk_bf16_f32 v30, v20, v21
    v_cvt_pk_bf16_f32 v31, v22, v23
    buffer_store_dwordx2 v[30:31], v206, s[72:75], 0 offen
    s_branch K5_FIN
K5_NP2:
    s_waitcnt vmcnt(8)
    v_lshlrev_b32 v16, 16, v64
    v_and_b32 v17, 0xffff0000, v64
    v_lshlrev_b32 v18, 16, v65
    v_and_b32 v19, 0xffff0000, v65
    v_lshlrev_b32 v20, 16, v66
    v_and_b32 v21, 0xffff0000, v66
    v_lshlrev_b32 v22, 16, v67
    v_and_b32 v23, 0xffff0000, v67
    v_lshlrev_b32 v24, 16, v68
    v_and_b32 v25, 0xffff0000, v68
    v_pk_add_f32 v[16:17], v[16:17], v[24:25]
    v_lshlrev_b32 v26, 16, v69
    v_and_b32 v27, 0xffff0000, v69
    v_pk_add_f32 v[18:19], v[18:19], v[26:27]
    v_lshlrev_b32 v24, 16, v70
    v_and_b32 v25, 0xffff0000, v70
    v_pk_add_f32 v[20:21], v[20:21], v[24:25]
    v_lshlrev_b32 v26, 16, v71
    v_and_b32 v27, 0xffff0000, v71
    v_pk_add_f32 v[22:23], v[22:23], v[26:27]
    v_lshlrev_b32 v24, 16, v72
    v_and_b32 v25, 0xffff0000, v72
    v_pk_add_f32 v[16:17], v[16:17], v[24:25]
    v_lshlrev_b32 v26, 16, v73
    v_and_b32 v27, 0xffff0000, v73
    v_pk_add_f32 v[18:19], v[18:19], v[26:27]
    v_lshlrev_b32 v24, 16, v74
    v_and_b32 v25, 0xffff0000, v74
    v_pk_add_f32 v[20:21], v[20:21], v[24:25]
    v_lshlrev_b32 v26, 16, v75
    v_and_b32 v27, 0xffff0000, v75
    v_pk_add_f32 v[22:23], v[22:23], v[26:27]
    v_lshlrev_b32 v24, 16, v76
    v_and_b32 v25, 0xffff0000, v76
    v_pk_add_f32 v[16:17], v[16:17], v[24:25]
    v_lshlrev_b32 v26, 16, v77
    v_and_b32 v27, 0xffff0000, v77
    v_pk_add_f32 v[18:19], v[18:19], v[26:27]
    v_lshlrev_b32 v24, 16, v78
    v_and_b32 v25, 0xffff0000, v78
    v_pk_add_f32 v[20:21], v[20:21], v[24:25]
    v_lshlrev_b32 v26, 16, v79
    v_and_b32 v27, 0xffff0000, v79
    v_pk_add_f32 v[22:23], v[22:23], v[26:27]
    v_lshlrev_b32 v24, 16, v80
    v_and_b32 v25, 0xffff0000, v80
    v_pk_add_f32 v[16:17], v[16:17], v[24:25]
    v_lshlrev_b32 v26, 16, v81
    v_and_b32 v27, 0xffff0000, v81
    v_pk_add_f32 v[18:19], v[18:19], v[26:27]
    v_lshlrev_b32 v24, 16, v82
    v_and_b32 v25, 0xffff0000, v82
    v_pk_add_f32 v[20:21], v[20:21], v[24:25]
    v_lshlrev_b32 v26, 16, v83
    v_and_b32 v27, 0xffff0000, v83
    v_pk_add_f32 v[22:23], v[22:23], v[26:27]
    v_lshlrev_b32 v24, 16, v84
    v_and_b32 v25, 0xffff0000, v84
    v_pk_add_f32 v[16:17], v[16:17], v[24:25]
    v_lshlrev_b32 v26, 16, v85
    v_and_b32 v27, 0xffff0000, v85
    v_pk_add_f32 v[18:19], v[18:19], v[26:27]
    v_lshlrev_b32 v24, 16, v86
    v_and_b32 v25, 0xffff0000, v86
    v_pk_add_f32 v[20:21], v[20:21], v[24:25]
    v_lshlrev_b32 v26, 16, v87
    v_and_b32 v27, 0xffff0000, v87
    v_pk_add_f32 v[22:23], v[22:23], v[26:27]
    v_lshlrev_b32 v24, 16, v88
    v_and_b32 v25, 0xffff0000, v88
    v_pk_add_f32 v[16:17], v[16:17], v[24:25]
    v_lshlrev_b32 v26, 16, v89
    v_and_b32 v27, 0xffff0000, v89
    v_pk_add_f32 v[18:19], v[18:19], v[26:27]
    v_lshlrev_b32 v24, 16, v90
    v_and_b32 v25, 0xffff0000, v90
    v_pk_add_f32 v[20:21], v[20:21], v[24:25]
    v_lshlrev_b32 v26, 16, v91
    v_and_b32 v27, 0xffff0000, v91
    v_pk_add_f32 v[22:23], v[22:23], v[26:27]
    v_lshlrev_b32 v24, 16, v92
    v_and_b32 v25, 0xffff0000, v92
    v_pk_add_f32 v[16:17], v[16:17], v[24:25]
    v_lshlrev_b32 v26, 16, v93
    v_and_b32 v27, 0xffff0000, v93
    v_pk_add_f32 v[18:19], v[18:19], v[26:27]
    v_lshlrev_b32 v24, 16, v94
    v_and_b32 v25, 0xffff0000, v94
    v_pk_add_f32 v[20:21], v[20:21], v[24:25]
    v_lshlrev_b32 v26, 16, v95
    v_and_b32 v27, 0xffff0000, v95
    v_pk_add_f32 v[22:23], v[22:23], v[26:27]
    v_lshlrev_b32 v24, 16, v100
    v_and_b32 v25, 0xffff0000, v100
    v_pk_fma_f32 v[16:17], v[16:17], v[208:209], v[24:25] op_sel_hi:[1,0,1]
    v_lshlrev_b32 v26, 16, v96
    v_and_b32 v27, 0xffff0000, v96
    v_pk_fma_f32 v[16:17], v[16:17], v[104:105], v[26:27]
    v_lshlrev_b32 v24, 16, v101
    v_and_b32 v25, 0xffff0000, v101
    v_pk_fma_f32 v[18:19], v[18:19], v[208:209], v[24:25] op_sel_hi:[1,0,1]
    v_lshlrev_b32 v26, 16, v97
    v_and_b32 v27, 0xffff0000, v97
    v_pk_fma_f32 v[18:19], v[18:19], v[106:107], v[26:27]
    v_cvt_pk_bf16_f32 v28, v16, v17
    v_cvt_pk_bf16_f32 v29, v18, v19
    buffer_store_dwordx2 v[28:29], v110, s[72:75], 0 offen
    v_add_u32 v110, 18432, v110
    v_lshlrev_b32 v24, 16, v102
    v_and_b32 v25, 0xffff0000, v102
    v_pk_fma_f32 v[20:21], v[20:21], v[210:211], v[24:25] op_sel_hi:[1,0,1]
    v_lshlrev_b32 v26, 16, v98
    v_and_b32 v27, 0xffff0000, v98
    v_pk_fma_f32 v[20:21], v[20:21], v[104:105], v[26:27]
    v_lshlrev_b32 v24, 16, v103
    v_and_b32 v25, 0xffff0000, v103
    v_pk_fma_f32 v[22:23], v[22:23], v[210:211], v[24:25] op_sel_hi:[1,0,1]
    v_lshlrev_b32 v26, 16, v99
    v_and_b32 v27, 0xffff0000, v99
    v_pk_fma_f32 v[22:23], v[22:23], v[106:107], v[26:27]
    v_cvt_pk_bf16_f32 v30, v20, v21
    v_cvt_pk_bf16_f32 v31, v22, v23
    buffer_store_dwordx2 v[30:31], v110, s[72:75], 0 offen
    s_waitcnt vmcnt(2)
    v_lshlrev_b32 v16, 16, v112
    v_and_b32 v17, 0xffff0000, v112
    v_lshlrev_b32 v18, 16, v113
    v_and_b32 v19, 0xffff0000, v113
    v_lshlrev_b32 v20, 16, v114
    v_and_b32 v21, 0xffff0000, v114
    v_lshlrev_b32 v22, 16, v115
    v_and_b32 v23, 0xffff0000, v115
    v_lshlrev_b32 v24, 16, v116
    v_and_b32 v25, 0xffff0000, v116
    v_pk_add_f32 v[16:17], v[16:17], v[24:25]
    v_lshlrev_b32 v26, 16, v117
    v_and_b32 v27, 0xffff0000, v117
    v_pk_add_f32 v[18:19], v[18:19], v[26:27]
    v_lshlrev_b32 v24, 16, v118
    v_and_b32 v25, 0xffff0000, v118
    v_pk_add_f32 v[20:21], v[20:21], v[24:25]
    v_lshlrev_b32 v26, 16, v119
    v_and_b32 v27, 0xffff0000, v119
    v_pk_add_f32 v[22:23], v[22:23], v[26:27]
    v_lshlrev_b32 v24, 16, v120
    v_and_b32 v25, 0xffff0000, v120
    v_pk_add_f32 v[16:17], v[16:17], v[24:25]
    v_lshlrev_b32 v26, 16, v121
    v_and_b32 v27, 0xffff0000, v121
    v_pk_add_f32 v[18:19], v[18:19], v[26:27]
    v_lshlrev_b32 v24, 16, v122
    v_and_b32 v25, 0xffff0000, v122
    v_pk_add_f32 v[20:21], v[20:21], v[24:25]
    v_lshlrev_b32 v26, 16, v123
    v_and_b32 v27, 0xffff0000, v123
    v_pk_add_f32 v[22:23], v[22:23], v[26:27]
    v_lshlrev_b32 v24, 16, v124
    v_and_b32 v25, 0xffff0000, v124
    v_pk_add_f32 v[16:17], v[16:17], v[24:25]
    v_lshlrev_b32 v26, 16, v125
    v_and_b32 v27, 0xffff0000, v125
    v_pk_add_f32 v[18:19], v[18:19], v[26:27]
    v_lshlrev_b32 v24, 16, v126
    v_and_b32 v25, 0xffff0000, v126
    v_pk_add_f32 v[20:21], v[20:21], v[24:25]
    v_lshlrev_b32 v26, 16, v127
    v_and_b32 v27, 0xffff0000, v127
    v_pk_add_f32 v[22:23], v[22:23], v[26:27]
    v_lshlrev_b32 v24, 16, v128
    v_and_b32 v25, 0xffff0000, v128
    v_pk_add_f32 v[16:17], v[16:17], v[24:25]
    v_lshlrev_b32 v26, 16, v129
    v_and_b32 v27, 0xffff0000, v129
    v_pk_add_f32 v[18:19], v[18:19], v[26:27]
    v_lshlrev_b32 v24, 16, v130
    v_and_b32 v25, 0xffff0000, v130
    v_pk_add_f32 v[20:21], v[20:21], v[24:25]
    v_lshlrev_b32 v26, 16, v131
    v_and_b32 v27, 0xffff0000, v131
    v_pk_add_f32 v[22:23], v[22:23], v[26:27]
    v_lshlrev_b32 v24, 16, v132
    v_and_b32 v25, 0xffff0000, v132
    v_pk_add_f32 v[16:17], v[16:17], v[24:25]
    v_lshlrev_b32 v26, 16, v133
    v_and_b32 v27, 0xffff0000, v133
    v_pk_add_f32 v[18:19], v[18:19], v[26:27]
    v_lshlrev_b32 v24, 16, v134
    v_and_b32 v25, 0xffff0000, v134
    v_pk_add_f32 v[20:21], v[20:21], v[24:25]
    v_lshlrev_b32 v26, 16, v135
    v_and_b32 v27, 0xffff0000, v135
    v_pk_add_f32 v[22:23], v[22:23], v[26:27]
    v_lshlrev_b32 v24, 16, v136
    v_and_b32 v25, 0xffff0000, v136
    v_pk_add_f32 v[16:17], v[16:17], v[24:25]
    v_lshlrev_b32 v26, 16, v137
    v_and_b32 v27, 0xffff0000, v137
    v_pk_add_f32 v[18:19], v[18:19], v[26:27]
    v_lshlrev_b32 v24, 16, v138
    v_and_b32 v25, 0xffff0000, v138
    v_pk_add_f32 v[20:21], v[20:21], v[24:25]
    v_lshlrev_b32 v26, 16, v139
    v_and_b32 v27, 0xffff0000, v139
    v_pk_add_f32 v[22:23], v[22:23], v[26:27]
    v_lshlrev_b32 v24, 16, v140
    v_and_b32 v25, 0xffff0000, v140
    v_pk_add_f32 v[16:17], v[16:17], v[24:25]
    v_lshlrev_b32 v26, 16, v141
    v_and_b32 v27, 0xffff0000, v141
    v_pk_add_f32 v[18:19], v[18:19], v[26:27]
    v_lshlrev_b32 v24, 16, v142
    v_and_b32 v25, 0xffff0000, v142
    v_pk_add_f32 v[20:21], v[20:21], v[24:25]
    v_lshlrev_b32 v26, 16, v143
    v_and_b32 v27, 0xffff0000, v143
    v_pk_add_f32 v[22:23], v[22:23], v[26:27]
    v_lshlrev_b32 v24, 16, v148
    v_and_b32 v25, 0xffff0000, v148
    v_pk_fma_f32 v[16:17], v[16:17], v[212:213], v[24:25] op_sel_hi:[1,0,1]
    v_lshlrev_b32 v26, 16, v144
    v_and_b32 v27, 0xffff0000, v144
    v_pk_fma_f32 v[16:17], v[16:17], v[152:153], v[26:27]
    v_lshlrev_b32 v24, 16, v149
    v_and_b32 v25, 0xffff0000, v149
    v_pk_fma_f32 v[18:19], v[18:19], v[212:213], v[24:25] op_sel_hi:[1,0,1]
    v_lshlrev_b32 v26, 16, v145
    v_and_b32 v27, 0xffff0000, v145
    v_pk_fma_f32 v[18:19], v[18:19], v[154:155], v[26:27]
    v_cvt_pk_bf16_f32 v28, v16, v17
    v_cvt_pk_bf16_f32 v29, v18, v19
    buffer_store_dwordx2 v[28:29], v158, s[72:75], 0 offen
    v_add_u32 v158, 18432, v158
    v_lshlrev_b32 v24, 16, v150
    v_and_b32 v25, 0xffff0000, v150
    v_pk_fma_f32 v[20:21], v[20:21], v[214:215], v[24:25] op_sel_hi:[1,0,1]
    v_lshlrev_b32 v26, 16, v146
    v_and_b32 v27, 0xffff0000, v146
    v_pk_fma_f32 v[20:21], v[20:21], v[152:153], v[26:27]
    v_lshlrev_b32 v24, 16, v151
    v_and_b32 v25, 0xffff0000, v151
    v_pk_fma_f32 v[22:23], v[22:23], v[214:215], v[24:25] op_sel_hi:[1,0,1]
    v_lshlrev_b32 v26, 16, v147
    v_and_b32 v27, 0xffff0000, v147
    v_pk_fma_f32 v[22:23], v[22:23], v[154:155], v[26:27]
    v_cvt_pk_bf16_f32 v30, v20, v21
    v_cvt_pk_bf16_f32 v31, v22, v23
    buffer_store_dwordx2 v[30:31], v158, s[72:75], 0 offen
K5_FIN:
K5_END:
    s_endpgm
CODE_END:
    s_endpgm
.section .rodata,"a"
.p2align 6
KD_START:
.amdhsa_kernel k2_kernel
  .amdhsa_next_free_vgpr 512
  .amdhsa_next_free_sgpr 102
  .amdhsa_accum_offset 256
  .amdhsa_group_segment_fixed_size 0
  .amdhsa_kernarg_size 128
  .amdhsa_user_sgpr_count 2
  .amdhsa_user_sgpr_kernarg_segment_ptr 1
  .amdhsa_system_sgpr_workgroup_id_x 1
  .amdhsa_float_denorm_mode_32 3
  .amdhsa_float_denorm_mode_16_64 3
.end_amdhsa_kernel
.section .rodata,"a"
.p2align 6
.amdhsa_kernel k3_kernel
  .amdhsa_next_free_vgpr 168
  .amdhsa_next_free_sgpr 102
  .amdhsa_accum_offset 168
  .amdhsa_group_segment_fixed_size 0
  .amdhsa_kernarg_size 128
  .amdhsa_user_sgpr_count 2
  .amdhsa_user_sgpr_kernarg_segment_ptr 1
  .amdhsa_system_sgpr_workgroup_id_x 1
  .amdhsa_float_denorm_mode_32 3
  .amdhsa_float_denorm_mode_16_64 3
.end_amdhsa_kernel
.section .rodata,"a"
.p2align 6
.amdhsa_kernel k5_kernel
  .amdhsa_next_free_vgpr 388
  .amdhsa_next_free_sgpr 102
  .amdhsa_accum_offset 256
  .amdhsa_group_segment_fixed_size 0
  .amdhsa_kernarg_size 128
  .amdhsa_user_sgpr_count 2
  .amdhsa_user_sgpr_kernarg_segment_ptr 1
  .amdhsa_system_sgpr_workgroup_id_x 1
  .amdhsa_float_denorm_mode_32 3
  .amdhsa_float_denorm_mode_16_64 3
.end_amdhsa_kernel
```
